```python
import torch

def _softmax(x, axis=-1):
    return torch.softmax(x, dim=axis)

def _gelu(x):
    return torch.nn.functional.gelu(x, approximate='tanh')

def _silu(x):
    return torch.nn.functional.silu(x)

def _sigmoid(x):
    return torch.sigmoid(x)

def _layernorm(x, axis=-1, eps=1e-05):
    m = x.mean(dim=axis, keepdim=True)
    v = x.var(dim=axis, keepdim=True, unbiased=False)
    return (x - m) / torch.sqrt(v + eps)

def _scatter_add(tgt, idx, src, axis=0):
    return tgt.clone().index_add_(axis, idx, src)

def _segment_sum(src, seg, n):
    out = torch.zeros((n,) + src.shape[1:], dtype=src.dtype)
    return out.index_add_(0, seg, src)

def _pad(x, pw):
    flat = tuple((v for pair in reversed(pw) for v in pair))
    return torch.nn.functional.pad(x, flat)
kernel_name = 'interleave_layers__spectral_fnet__mixer_gmlp__prompt'

def setup_inputs():

    _w = lambda a: (lambda t: t.to(torch.bfloat16) if t.is_floating_point() else t)(torch.as_tensor(a))

    def _A_setup():
        B, S, D = (1, 2048, 448)
        ns = torch.arange(S)[:, None] * torch.arange(S)[None, :]
        nd = torch.arange(D)[:, None] * torch.arange(D)[None, :]
        Ws_re = torch.cos(-2.0 * torch.pi * ns / S).to(float)
        Ws_im = torch.sin(-2.0 * torch.pi * ns / S).to(float)
        Wd_re = torch.cos(-2.0 * torch.pi * nd / D).to(float)
        Wd_im = torch.sin(-2.0 * torch.pi * nd / D).to(float)
        return {'x': _w((lambda *s: torch.randn(*s, dtype=torch.bfloat16) * 0.05)(B, S, D)), 'dft_seq_re': _w(Ws_re), 'dft_seq_im': _w(Ws_im), 'dft_hid_re': _w(Wd_re), 'dft_hid_im': _w(Wd_im)}
    _A_in = _A_setup()

    def _B_setup():
        B, S, D, F = (1, 2048, 448, 1792)
        Fh = F // 2
        return {'x': _w((lambda *s: torch.randn(*s, dtype=torch.bfloat16) * 0.05)(B, S, D)), 'w_in': _w((lambda *s: torch.randn(*s, dtype=torch.bfloat16) * 1.6)(D, 2 * Fh)), 'w_sp': _w(0.01 * (lambda *s: torch.randn(*s, dtype=torch.bfloat16) * 1.6)(S, S)), 'b_sp': _w(1.0 + 0.01 * (lambda *s: torch.randn(*s, dtype=torch.bfloat16) * 1.6)(S)), 'w_out': _w((lambda *s: torch.randn(*s, dtype=torch.bfloat16) * 1.6)(Fh, D))}
    _B_in = _B_setup()
    return {'A_x': _A_in['x'], 'A_dft_seq_re': _A_in['dft_seq_re'], 'A_dft_seq_im': _A_in['dft_seq_im'], 'A_dft_hid_re': _A_in['dft_hid_re'], 'A_dft_hid_im': _A_in['dft_hid_im'], 'B_x': _B_in['x'], 'B_w_in': _B_in['w_in'], 'B_w_sp': _B_in['w_sp'], 'B_b_sp': _B_in['b_sp'], 'B_w_out': _B_in['w_out']}

def reference(A_x, A_dft_seq_re, A_dft_seq_im, A_dft_hid_re, A_dft_hid_im, B_x, B_w_in, B_w_sp, B_b_sp, B_w_out):

    def _A_ref(x, dft_seq_re, dft_seq_im, dft_hid_re, dft_hid_im):
        a = torch.einsum('bsd,ed->bse', x, dft_hid_re)
        b = torch.einsum('bsd,ed->bse', x, dft_hid_im)
        y = torch.einsum('ts,bse->bte', dft_seq_re, a) - torch.einsum('ts,bse->bte', dft_seq_im, b)
        return y

    def _B_ref(x, w_in, w_sp, b_sp, w_out):
        B, S, D = x.shape
        F = w_in.shape[-1]
        Fh = F // 2
        z = _gelu(torch.einsum('bsd,df->bsf', x, w_in))
        z1 = z[..., :Fh].clone()
        z2 = _layernorm(z[..., Fh:], axis=-1)
        g = torch.einsum('ts,bsf->btf', w_sp, z2) + b_sp[None, :, None]
        return torch.einsum('bsf,fd->bsd', z1 * g, w_out)
    x = A_x
    x = x + _A_ref(_layernorm(x, axis=-1), A_dft_seq_re, A_dft_seq_im, A_dft_hid_re, A_dft_hid_im)
    x = x + _B_ref(_layernorm(x, axis=-1), B_w_in, B_w_sp, B_b_sp, B_w_out)
    x = x + _A_ref(_layernorm(x, axis=-1), A_dft_seq_re, A_dft_seq_im, A_dft_hid_re, A_dft_hid_im)
    x = x + _B_ref(_layernorm(x, axis=-1), B_w_in, B_w_sp, B_b_sp, B_w_out)
    return x
```

```asm
; @launch grid=(256,1,1) block=(256,1,1) lds=163840
.amdgcn_target "amdgcn-amd-amdhsa--gfx950"
.text
.globl interleave_layers__spectral_fnet__mixer_gmlp__prompt_kernel
.p2align 12
.p2align 8
.type interleave_layers__spectral_fnet__mixer_gmlp__prompt_kernel,@function
interleave_layers__spectral_fnet__mixer_gmlp__prompt_kernel:
    s_cmp_ge_u32 s2, 256
    s_cbranch_scc1 L_end
    s_load_dwordx2 s[4:5], s[0:1], 0
    s_load_dwordx2 s[36:37], s[0:1], 96
    s_load_dwordx2 s[20:21], s[0:1], 56
    s_load_dwordx2 s[16:17], s[0:1], 48
    s_load_dwordx2 s[24:25], s[0:1], 64
    s_load_dwordx2 s[28:29], s[0:1], 72
    s_load_dwordx2 s[32:33], s[0:1], 80
    s_getpc_b64 s[96:97]
L_pc:
    s_lshr_b32 s72, s2, 3
    s_lshl_b32 s72, s72, 9
    v_lshrrev_b32 v2, 6, v0
    v_and_b32 v3, 63, v0
    v_lshl_add_u32 v2, v2, 7, s72
    v_lshl_add_u32 v2, v3, 14, v2
    v_min_u32 v2, L_end-L_pc, v2
    v_add_co_u32 v2, vcc, s96, v2
    v_mov_b32 v3, s97
    s_mov_b64 exec, 31
    v_addc_co_u32 v3, vcc, 0, v3, vcc
    global_load_dword v3, v[2:3], off
    s_mov_b64 exec, -1
    v_lshrrev_b32 v5, 6, v0
    v_and_b32 v1, 63, v0
    v_readfirstlane_b32 s42, v5
    v_and_b32 v4, 15, v0
    v_lshrrev_b32 v5, 4, v1
    v_lshlrev_b32_e64 v7, 4, v1
    s_bfe_u32 s41, s2, 196611
    s_min_u32 s89, s41, 6
    s_bfe_u32 s73, s2, 196608
    s_lshl_b32 s73, s73, 1
    s_lshr_b32 s74, s2, 7
    s_add_u32 s73, s73, s74
    s_sub_u32 s74, 32, s73
    s_cmp_eq_u32 s73, 0
    s_cselect_b32 s74, 16, s74
    s_bitcmp1_b32 s2, 6
    s_cselect_b32 s40, s74, s73
    s_and_b32 s50, s42, 1
    s_lshr_b32 s51, s42, 1
    s_nop 0
    s_mov_b32 s6, 1835008
    s_mov_b32 s7, 0x20000
    s_mov_b32 s38, 39845888
    s_mov_b32 s39, 0x20000
    s_mov_b32 s22, 8388608
    s_mov_b32 s23, 0x20000
    s_mov_b32 s18, 1605632
    s_mov_b32 s19, 0x20000
    s_mov_b32 s26, 4096
    s_mov_b32 s27, 0x20000
    s_mov_b32 s30, 802816
    s_mov_b32 s31, 0x20000
    s_mov_b32 s34, 1835008
    s_mov_b32 s35, 0x20000
    s_mov_b32 s48, s40
    s_sub_u32 s49, 64, s40
    s_cmp_eq_u32 s40, 0
    s_cselect_b32 s49, 32, s49
    s_waitcnt lgkmcnt(0)
    s_cmp_eq_u32 s51, 0
    s_cselect_b32 s43, s48, s49
    s_cmp_eq_u32 s41, 7
    s_cbranch_scc0 L_hskip
L_helper:
    s_lshl_b32 s79, s42, 5
    s_add_u32 s79, s79, s40
    s_add_u32 s70, s79, 0
    s_mul_i32 s71, s70, 147
    s_lshr_b32 s71, s71, 11
    s_mul_i32 s72, s71, 14
    s_sub_u32 s72, s70, s72
    s_add_u32 s74, s72, 42
    s_cmp_lt_u32 s72, 7
    s_cselect_b32 s73, 7, -7
    s_cselect_b32 s74, s72, s74
    v_mul_i32_i24 v65, s73, v5
    v_add_u32_e64 v65, s74, v65
    v_mul_u32_u24 v65, 28672, v65
    v_lshl_add_u32 v65, v4, 4, v65
    s_lshl_b32 s75, s71, 8
    s_nop 0
    buffer_load_dwordx4 v[224:227], v65, s[16:19], s75 offen
    s_add_u32 s75, s75, 3584
    buffer_load_dwordx4 v[228:231], v65, s[16:19], s75 offen
    s_add_u32 s75, s75, 3584
    buffer_load_dwordx4 v[232:235], v65, s[16:19], s75 offen
    s_add_u32 s75, s75, 3584
    buffer_load_dwordx4 v[236:239], v65, s[16:19], s75 offen
    s_add_u32 s75, s75, 3584
    buffer_load_dwordx4 v[240:243], v65, s[16:19], s75 offen
    s_add_u32 s75, s75, 3584
    buffer_load_dwordx4 v[244:247], v65, s[16:19], s75 offen
    s_add_u32 s75, s75, 3584
    buffer_load_dwordx4 v[248:251], v65, s[16:19], s75 offen
    s_add_u32 s75, s75, 3584
    buffer_load_dwordx4 v[252:255], v65, s[16:19], s75 offen
    s_add_u32 s75, s75, 3584
    s_mul_i32 s76, s71, 114688
    s_lshl_b32 s72, s72, 10
    s_add_u32 s76, s76, s72
    s_add_u32 s76, s76, 2097152
    s_cmp_ge_u32 s79, 68
    s_cbranch_scc1 h2_192
    s_add_u32 s70, s79, 128
    s_mul_i32 s71, s70, 147
    s_lshr_b32 s71, s71, 11
    s_mul_i32 s72, s71, 14
    s_sub_u32 s72, s70, s72
    s_add_u32 s74, s72, 42
    s_cmp_lt_u32 s72, 7
    s_cselect_b32 s73, 7, -7
    s_cselect_b32 s74, s72, s74
    v_mul_i32_i24 v65, s73, v5
    v_add_u32 v65, s74, v65
    v_mul_u32_u24 v65, 28672, v65
    v_lshl_add_u32 v65, v4, 4, v65
    s_lshl_b32 s75, s71, 8
    s_nop 0
    buffer_load_dwordx4 v[192:195], v65, s[16:19], s75 offen
    s_add_u32 s75, s75, 3584
    buffer_load_dwordx4 v[196:199], v65, s[16:19], s75 offen
    s_add_u32 s75, s75, 3584
    buffer_load_dwordx4 v[200:203], v65, s[16:19], s75 offen
    s_add_u32 s75, s75, 3584
    buffer_load_dwordx4 v[204:207], v65, s[16:19], s75 offen
    s_add_u32 s75, s75, 3584
    buffer_load_dwordx4 v[208:211], v65, s[16:19], s75 offen
    s_add_u32 s75, s75, 3584
    buffer_load_dwordx4 v[212:215], v65, s[16:19], s75 offen
    s_add_u32 s75, s75, 3584
    buffer_load_dwordx4 v[216:219], v65, s[16:19], s75 offen
    s_add_u32 s75, s75, 3584
    buffer_load_dwordx4 v[220:223], v65, s[16:19], s75 offen
    s_add_u32 s75, s75, 3584
    s_mul_i32 s77, s71, 114688
    s_lshl_b32 s72, s72, 10
    s_add_u32 s77, s77, s72
    s_add_u32 s77, s77, 2097152
h2_192:
    buffer_load_dword v10, off, s[36:39], 0 offset:0 sc1
    s_lshl_b32 s70, s50, 10
    s_add_u32 s70, s70, s43
    s_lshl_b32 s70, s70, 1
    v_lshlrev_b32 v66, 7, v4
    buffer_load_ushort v11, v66, s[24:27], s70 offen
    s_branch L_hrest
L_hskip:
    s_lshl_b32 s72, s50, 10
    s_lshl_b32 s80, s51, 5
    s_add_u32 s72, s72, s80
    s_add_u32 s72, s72, s40
    s_mul_i32 s73, s42, 14848
    s_mul_i32 s72, s72, 896
    s_lshl_b32 s79, s41, 1
    s_mul_i32 s80, s79, 928
    s_add_u32 m0, s80, s73
    s_mul_i32 s80, s79, 57344
    s_add_u32 s80, s80, s72
    s_bfm_b64 exec, 56, 0
    buffer_load_dwordx4 v7, s[4:7], s80 offen lds
    s_add_u32 m0, m0, 928
    s_add_u32 s80, s80, 57344
    buffer_load_dwordx4 v7, s[4:7], s80 offen lds
    s_mov_b64 exec, -1
    s_add_u32 s79, s79, 2
    s_and_b32 s79, s79, 15
    s_mul_i32 s80, s79, 928
    s_add_u32 m0, s80, s73
    s_mul_i32 s80, s79, 57344
    s_add_u32 s80, s80, s72
    s_bfm_b64 exec, 56, 0
    buffer_load_dwordx4 v7, s[4:7], s80 offen lds
    s_add_u32 m0, m0, 928
    s_add_u32 s80, s80, 57344
    buffer_load_dwordx4 v7, s[4:7], s80 offen lds
    s_mov_b64 exec, -1
    s_add_u32 s79, s79, 2
    s_and_b32 s79, s79, 15
    s_mul_i32 s80, s79, 928
    s_add_u32 m0, s80, s73
    s_mul_i32 s80, s79, 57344
    s_add_u32 s80, s80, s72
    s_bfm_b64 exec, 56, 0
    buffer_load_dwordx4 v7, s[4:7], s80 offen lds
    s_add_u32 m0, m0, 928
    s_add_u32 s80, s80, 57344
    buffer_load_dwordx4 v7, s[4:7], s80 offen lds
    s_mov_b64 exec, -1
    s_add_u32 s79, s79, 2
    s_and_b32 s79, s79, 15
    s_mul_i32 s80, s79, 928
    s_add_u32 m0, s80, s73
    s_mul_i32 s80, s79, 57344
    s_add_u32 s80, s80, s72
    s_bfm_b64 exec, 56, 0
    buffer_load_dwordx4 v7, s[4:7], s80 offen lds
    s_add_u32 m0, m0, 928
    s_add_u32 s80, s80, 57344
    buffer_load_dwordx4 v7, s[4:7], s80 offen lds
    s_mov_b64 exec, -1
    s_add_u32 s79, s79, 2
    s_and_b32 s79, s79, 15
    s_mul_i32 s80, s79, 928
    s_add_u32 m0, s80, s73
    s_mul_i32 s80, s79, 57344
    s_add_u32 s80, s80, s72
    s_bfm_b64 exec, 56, 0
    buffer_load_dwordx4 v7, s[4:7], s80 offen lds
    s_add_u32 m0, m0, 928
    s_add_u32 s80, s80, 57344
    buffer_load_dwordx4 v7, s[4:7], s80 offen lds
    s_mov_b64 exec, -1
    buffer_load_dword v10, off, s[36:39], 0 offset:0 sc1
    s_lshl_b32 s70, s50, 10
    s_add_u32 s70, s70, s43
    s_lshl_b32 s70, s70, 1
    v_lshlrev_b32 v65, 7, v4
    buffer_load_ushort v11, v65, s[24:27], s70 offen
    v_mov_b32 v16, -1
    v_mov_b32 v17, -1
    v_mov_b32 v18, -1
    v_mov_b32 v19, -1
    v_lshrrev_b32 v14, 3, v1
    v_and_b32 v20, 7, v1
    v_xor_b32 v6, v20, v5
    v_xor_b32 v20, v20, v14
    v_mul_u32_u24 v14, 28672, v14
    v_lshl_add_u32 v14, v20, 4, v14
    s_mul_i32 s82, s42, 458752
    s_lshl_b32 s71, s89, 12
    s_add_u32 s82, s82, s71
    s_lshl_b32 s71, s40, 7
    s_add_u32 s82, s82, s71
    v_add_u32 v8, 0x10000, v7
    v_add_u32 v9, 0x20000, v7
    v_lshlrev_b32_e64 v21, 2, v1
    s_mov_b32 s53, 0x3727c5ac
    s_mov_b32 s54, 0x3f803f80
    s_mov_b32 s55, 0x05040100
    s_mov_b32 s56, 0x07060302
    s_mov_b32 s47, 200000
    s_lshl2_add_u32 s52, s40, s42
    s_add_u32 s78, s82, 14680064
    buffer_store_dwordx4 v[16:19], v14, s[36:39], s78 offen sc1
    s_add_u32 s78, s82, 14909440
    buffer_store_dwordx4 v[16:19], v14, s[36:39], s78 offen sc1
    s_mov_b64 exec, 0
    s_cmp_eq_u32 s42, 0
    s_cbranch_scc1 L_pad_541
    s_cmp_eq_u32 s42, 1
    s_cbranch_scc1 L_pad_1218
    s_cmp_eq_u32 s42, 2
    s_cbranch_scc1 L_pad_1787
    s_branch L_pad_2344
L_ret_0:
    s_mov_b64 exec, -1
    s_mul_i32 s71, s42, 14848
    v_mul_u32_u24 v64, 928, v4
    v_mul_u32_u24 v20, 112, v5
    v_add_u32 v64, s71, v64
    v_add_u32 v23, v64, v20
    v_sub_u32_e64 v64, v64, v20
    v_add_u32 v64, 784, v64
    s_lshr_b32 s70, s40, 1
    s_xor_b32 s70, s70, s42
    s_and_b32 s70, s70, 1
    s_lshl1_add_u32 s70, s89, s70
    s_lshl_b32 s70, s70, 2
    v_lshrrev_b32 v67, 2, v4
    v_and_b32_e64 v76, 3, v4
    v_mad_u32_u24 v67, v67, 56, v76
    v_add_u32 v67, s70, v67
    v_cmp_eq_u32 vcc, 0, v67
    v_mov_b32 v77, 224
    s_and_b32 s70, s42, 2
    v_cndmask_b32 v67, v67, v77, vcc
    v_mad_u32_u24 v76, v67, v5, s70
    v_and_b32 v76, 7, v76
    v_cvt_f32_u32 v76, v76
    v_cvt_f32_u32_e64 v67, v67
    v_mul_f32 v76, 0x3e000000, v76
    v_mul_f32 v78, 0x3c924925, v67
    v_mul_f32 v67, 0x3b124925, v67
    v_cos_f32_e64 v78, v78
    s_mul_i32 s70, s42, 14336
    s_add_u32 s70, s70, 100352
    v_add_u32 v77, s70, v7
    v_add_f32 v78, v78, v78
    v_cos_f32 v80, v76
    v_add_f32 v76, v76, v67
    v_cos_f32 v81, v76
    v_add_f32 v76, v76, v67
    v_cos_f32 v82, v76
    v_add_f32 v76, v76, v67
    v_cos_f32 v83, v76
    v_add_f32 v76, v76, v67
    s_add_u32 s79, s79, 2
    s_and_b32 s79, s79, 15
    s_mul_i32 s80, s79, 928
    s_add_u32 m0, s80, s73
    s_mul_i32 s80, s79, 57344
    s_add_u32 s80, s80, s72
    s_bfm_b64 exec, 56, 0
    buffer_load_dwordx4 v7, s[4:7], s80 offen lds
    s_add_u32 m0, m0, 928
    s_add_u32 s80, s80, 57344
    buffer_load_dwordx4 v7, s[4:7], s80 offen lds
    s_mov_b64 exec, -1
    v_cos_f32 v84, v76
    v_add_f32 v76, v76, v67
    v_cos_f32 v85, v76
    v_add_f32 v76, v76, v67
    v_cos_f32 v86, v76
    v_add_f32 v76, v76, v67
    v_cos_f32 v87, v76
    v_add_f32 v76, v76, v67
    v_cvt_pk_bf16_f32 v104, v80, v81
    v_cvt_pk_bf16_f32 v105, v82, v83
    v_cvt_pk_bf16_f32 v106, v84, v85
    v_cvt_pk_bf16_f32 v107, v86, v87
    ds_write_b128 v77, v[104:107] offset:0
    v_cos_f32 v88, v76
    v_add_f32 v76, v76, v67
    v_cos_f32_e64 v89, v76
    s_add_u32 s79, s79, 2
    s_and_b32 s79, s79, 15
    s_mul_i32 s80, s79, 928
    s_add_u32 m0, s80, s73
    s_mul_i32 s80, s79, 57344
    s_add_u32 s80, s80, s72
    s_bfm_b64 exec, 56, 0
    buffer_load_dwordx4 v7, s[4:7], s80 offen lds
    s_add_u32 m0, m0, 928
    s_add_u32 s80, s80, 57344
    buffer_load_dwordx4 v7, s[4:7], s80 offen lds
    s_mov_b64 exec, -1
    v_add_f32 v76, v76, v67
    v_cos_f32 v90, v76
    v_add_f32 v76, v76, v67
    v_cos_f32 v91, v76
    v_add_f32 v76, v76, v67
    v_cos_f32 v92, v76
    v_add_f32 v76, v76, v67
    v_cos_f32 v93, v76
    v_add_f32 v76, v76, v67
    v_cos_f32 v94, v76
    v_add_f32 v76, v76, v67
    v_cos_f32 v95, v76
    v_add_f32_e64 v76, v76, v67
    v_cvt_pk_bf16_f32 v108, v88, v87
    v_cvt_pk_bf16_f32 v109, v86, v85
    s_add_u32 s79, s79, 2
    s_and_b32 s79, s79, 15
    s_mul_i32 s80, s79, 928
    s_add_u32 m0, s80, s73
    s_mul_i32 s80, s79, 57344
    s_add_u32 s80, s80, s72
    s_bfm_b64 exec, 56, 0
    buffer_load_dwordx4 v7, s[4:7], s80 offen lds
    s_add_u32 m0, m0, 928
    s_add_u32 s80, s80, 57344
    buffer_load_dwordx4 v7, s[4:7], s80 offen lds
    s_mov_b64 exec, -1
    v_cvt_pk_bf16_f32 v110, v84, v83
    v_cvt_pk_bf16_f32 v111, v82, v81
    ds_write_b128 v77, v[108:111] offset:13312
    v_cvt_pk_bf16_f32 v104, v88, v89
    v_cvt_pk_bf16_f32 v105, v90, v91
    v_cvt_pk_bf16_f32 v106, v92, v93
    v_cvt_pk_bf16_f32 v107, v94, v95
    ds_write_b128 v77, v[104:107] offset:1024
    v_pk_fma_f32 v[96:97], v[88:89], v[78:79], v[80:81] op_sel_hi:[1,0,1] neg_lo:[0,0,1] neg_hi:[0,0,1]
    v_pk_fma_f32 v[98:99], v[90:91], v[78:79], v[82:83] op_sel_hi:[1,0,1] neg_lo:[0,0,1] neg_hi:[0,0,1]
    v_pk_fma_f32 v[100:101], v[92:93], v[78:79], v[84:85] op_sel_hi:[1,0,1] neg_lo:[0,0,1] neg_hi:[0,0,1]
    v_pk_fma_f32 v[102:103], v[94:95], v[78:79], v[86:87] op_sel_hi:[1,0,1] neg_lo:[0,0,1] neg_hi:[0,0,1]
    v_cvt_pk_bf16_f32 v108, v96, v95
    v_cvt_pk_bf16_f32 v109, v94, v93
    v_cvt_pk_bf16_f32 v110, v92, v91
    s_and_b32 s8, s40, 7
    s_mul_i32 s9, s8, 7
    s_add_u32 s8, s9, 1
    s_lshr_b32 s8, s8, 1
    s_cmp_lt_u32 s40, 24
    s_cselect_b32 s8, s8, s9
    s_lshr_b32 s9, s40, 3
    s_add_u32 s9, s8, s9
    s_lshr_b32 s8, s9, 2
    s_lshl_b32 s8, s8, 6
    s_and_b32 s9, s9, 3
    s_add_u32 s8, s8, s9
    s_mul_i32 s8, s8, 1792
    s_lshl1_add_u32 s9, s41, s51
    s_lshl3_add_u32 s9, s9, s50
    s_lshl3_add_u32 s8, s9, s8
    v_mul_u32_u24 v65, 28672, v5
    v_lshrrev_b32 v68, 2, v4
    v_lshl_add_u32 v65, v68, 4, v65
    v_and_b32_e64 v68, 3, v4
    v_lshl_add_u32 v65, v68, 1, v65
    s_add_u32 s9, s8, 0
    s_nop 0
    buffer_load_ushort v68, v65, s[28:31], s9 offen
    v_cvt_pk_bf16_f32 v111, v90, v89
    ds_write_b128 v77, v[108:111] offset:12288
    v_cvt_pk_bf16_f32 v104, v96, v97
    v_cvt_pk_bf16_f32 v105, v98, v99
    v_cvt_pk_bf16_f32 v106, v100, v101
    v_cvt_pk_bf16_f32 v107, v102, v103
    ds_write_b128 v77, v[104:107] offset:2048
    v_pk_fma_f32 v[80:81], v[96:97], v[78:79], v[88:89] op_sel_hi:[1,0,1] neg_lo:[0,0,1] neg_hi:[0,0,1]
    v_pk_fma_f32 v[82:83], v[98:99], v[78:79], v[90:91] op_sel_hi:[1,0,1] neg_lo:[0,0,1] neg_hi:[0,0,1]
    v_pk_fma_f32 v[84:85], v[100:101], v[78:79], v[92:93] op_sel_hi:[1,0,1] neg_lo:[0,0,1] neg_hi:[0,0,1]
    v_pk_fma_f32 v[86:87], v[102:103], v[78:79], v[94:95] op_sel_hi:[1,0,1] neg_lo:[0,0,1] neg_hi:[0,0,1]
    v_cvt_pk_bf16_f32 v108, v80, v103
    v_cvt_pk_bf16_f32 v109, v102, v101
    v_cvt_pk_bf16_f32 v110, v100, v99
    v_cvt_pk_bf16_f32 v111, v98, v97
    s_add_u32 s9, s8, 7168
    buffer_load_ushort v69, v65, s[28:31], s9 offen
    ds_write_b128 v77, v[108:111] offset:11264
    v_cvt_pk_bf16_f32 v104, v80, v81
    v_cvt_pk_bf16_f32 v105, v82, v83
    v_cvt_pk_bf16_f32 v106, v84, v85
    v_cvt_pk_bf16_f32 v107, v86, v87
    ds_write_b128 v77, v[104:107] offset:3072
    v_pk_fma_f32 v[88:89], v[80:81], v[78:79], v[96:97] op_sel_hi:[1,0,1] neg_lo:[0,0,1] neg_hi:[0,0,1]
    v_pk_fma_f32 v[90:91], v[82:83], v[78:79], v[98:99] op_sel_hi:[1,0,1] neg_lo:[0,0,1] neg_hi:[0,0,1]
    v_pk_fma_f32 v[92:93], v[84:85], v[78:79], v[100:101] op_sel_hi:[1,0,1] neg_lo:[0,0,1] neg_hi:[0,0,1]
    v_pk_fma_f32 v[94:95], v[86:87], v[78:79], v[102:103] op_sel_hi:[1,0,1] neg_lo:[0,0,1] neg_hi:[0,0,1]
    v_cvt_pk_bf16_f32 v108, v88, v87
    v_cvt_pk_bf16_f32 v109, v86, v85
    v_cvt_pk_bf16_f32 v110, v84, v83
    v_cvt_pk_bf16_f32 v111, v82, v81
    ds_write_b128 v77, v[108:111] offset:10240
    s_add_u32 s9, s8, 14336
    buffer_load_ushort v70, v65, s[28:31], s9 offen
    v_cvt_pk_bf16_f32 v104, v88, v89
    v_cvt_pk_bf16_f32 v105, v90, v91
    v_cvt_pk_bf16_f32 v106, v92, v93
    v_cvt_pk_bf16_f32 v107, v94, v95
    ds_write_b128 v77, v[104:107] offset:4096
    v_pk_fma_f32 v[96:97], v[88:89], v[78:79], v[80:81] op_sel_hi:[1,0,1] neg_lo:[0,0,1] neg_hi:[0,0,1]
    v_pk_fma_f32 v[98:99], v[90:91], v[78:79], v[82:83] op_sel_hi:[1,0,1] neg_lo:[0,0,1] neg_hi:[0,0,1]
    v_pk_fma_f32 v[100:101], v[92:93], v[78:79], v[84:85] op_sel_hi:[1,0,1] neg_lo:[0,0,1] neg_hi:[0,0,1]
    v_pk_fma_f32 v[102:103], v[94:95], v[78:79], v[86:87] op_sel_hi:[1,0,1] neg_lo:[0,0,1] neg_hi:[0,0,1]
    v_cvt_pk_bf16_f32 v108, v96, v95
    v_cvt_pk_bf16_f32 v109, v94, v93
    v_cvt_pk_bf16_f32 v110, v92, v91
    v_cvt_pk_bf16_f32 v111, v90, v89
    ds_write_b128 v77, v[108:111] offset:9216
    v_cvt_pk_bf16_f32 v104, v96, v97
    s_add_u32 s9, s8, 21504
    buffer_load_ushort v71, v65, s[28:31], s9 offen
    v_cvt_pk_bf16_f32 v105, v98, v99
    v_cvt_pk_bf16_f32 v106, v100, v101
    v_cvt_pk_bf16_f32 v107, v102, v103
    ds_write_b128 v77, v[104:107] offset:5120
    v_pk_fma_f32 v[80:81], v[96:97], v[78:79], v[88:89] op_sel_hi:[1,0,1] neg_lo:[0,0,1] neg_hi:[0,0,1]
    v_pk_fma_f32 v[82:83], v[98:99], v[78:79], v[90:91] op_sel_hi:[1,0,1] neg_lo:[0,0,1] neg_hi:[0,0,1]
    v_pk_fma_f32 v[84:85], v[100:101], v[78:79], v[92:93] op_sel_hi:[1,0,1] neg_lo:[0,0,1] neg_hi:[0,0,1]
    v_pk_fma_f32 v[86:87], v[102:103], v[78:79], v[94:95] op_sel_hi:[1,0,1] neg_lo:[0,0,1] neg_hi:[0,0,1]
    v_cvt_pk_bf16_f32 v108, v80, v103
    v_cvt_pk_bf16_f32 v109, v102, v101
    v_cvt_pk_bf16_f32 v110, v100, v99
    v_cvt_pk_bf16_f32 v111, v98, v97
    ds_write_b128 v77, v[108:111] offset:8192
    v_cvt_pk_bf16_f32 v104, v80, v81
    v_cvt_pk_bf16_f32 v105, v82, v83
    v_cvt_pk_bf16_f32 v106, v84, v85
    s_add_u32 s9, s8, 896
    buffer_load_ushort v72, v65, s[28:31], s9 offen
    v_cvt_pk_bf16_f32 v107, v86, v87
    ds_write_b128 v77, v[104:107] offset:6144
    v_pk_fma_f32 v[88:89], v[80:81], v[78:79], v[96:97] op_sel_hi:[1,0,1] neg_lo:[0,0,1] neg_hi:[0,0,1]
    v_cvt_pk_bf16_f32 v108, v88, v87
    v_cvt_pk_bf16_f32 v109, v86, v85
    v_cvt_pk_bf16_f32 v110, v84, v83
    v_cvt_pk_bf16_f32 v111, v82, v81
    ds_write_b128 v77, v[108:111] offset:7168
    s_lshl_b32 s70, s50, 4
    v_add_u32 v24, s70, v4
    v_lshrrev_b32 v25, 1, v5
    v_lshlrev_b32 v25, 2, v25
    v_and_or_b32 v25, v5, 1, v25
    v_cvt_f32_u32_e64 v25, v25
    s_cmp_eq_u32 s43, 0
    s_cselect_b32 s70, 32, 31
    s_add_u32 s9, s8, 8064
    buffer_load_ushort v73, v65, s[28:31], s9 offen
    v_add_f32 v25, v25, v25
    v_cvt_f32_u32 v27, v24
    v_and_b32_e64 v28, 1, v24
    v_mul_f32 v27, 0x3d000000, v27
    v_lshl_or_b32 v28, v28, 16, v28
    v_mul_f32 v32, v25, v27
    v_lshlrev_b32 v28, 15, v28
    v_add_f32_e64 v33, v32, v27
    v_fma_f32 v34, 4.0, v27, v32
    v_add_f32 v35, v34, v27
    v_cos_f32 v36, v32
    v_cos_f32 v37, v33
    v_cos_f32 v38, v34
    v_cos_f32_e64 v39, v35
    s_add_u32 s9, s8, 15232
    buffer_load_ushort v74, v65, s[28:31], s9 offen
    v_sin_f32 v32, v32
    v_sin_f32 v33, v33
    v_sin_f32 v34, v34
    v_sin_f32 v35, v35
    v_cvt_pk_bf16_f32 v48, v36, v32
    v_cvt_pk_bf16_f32 v49, v37, v33
    v_cvt_pk_bf16_f32 v50, v38, v34
    v_cvt_pk_bf16_f32 v51, v39, v35
    v_xor_b32 v52, v28, v48
    v_xor_b32 v53, v28, v49
    v_xor_b32 v54, v28, v50
    v_xor_b32 v55, v28, v51
    v_sub_u32 v24, s70, v24
    v_cvt_f32_u32 v27, v24
    v_and_b32_e64 v28, 1, v24
    s_add_u32 s9, s8, 22400
    buffer_load_ushort v75, v65, s[28:31], s9 offen
    v_mul_f32 v27, 0x3d000000, v27
    v_lshl_or_b32 v28, v28, 16, v28
    v_mul_f32 v32, v25, v27
    v_lshlrev_b32 v28, 15, v28
    v_add_f32_e64 v33, v32, v27
    v_fma_f32 v34, 4.0, v27, v32
    v_add_f32 v35, v34, v27
    v_cos_f32 v36, v32
    v_cos_f32 v37, v33
    v_cos_f32 v38, v34
    v_cos_f32 v39, v35
    v_sin_f32 v32, v32
    v_sin_f32 v33, v33
    v_sin_f32 v34, v34
    v_sin_f32 v35, v35
    s_bitcmp1_b32 s41, 1
    s_cselect_b32 s74, s49, s48
    s_and_b32 s75, s41, 1
    s_lshl1_add_u32 s75, s75, s51
    s_lshl_b32 s75, s75, 9
    s_add_u32 s74, s74, s75
    s_lshr_b32 s75, s41, 2
L_pad_541:
    s_cbranch_execz L_ret_0
    s_lshl1_add_u32 s75, s75, s50
    s_lshl2_add_u32 s74, s74, s75
    s_lshl_b32 s74, s74, 10
    s_lshl_b32 s75, s42, 13
    s_add_u32 m0, s75, 67584
    v_xor_b32 v66, 0, v7
    buffer_load_dwordx4 v66, s[20:23], s74 offen  lds
    v_cvt_pk_bf16_f32 v56, v36, v32
    v_cvt_pk_bf16_f32 v57, v37, v33
    v_cvt_pk_bf16_f32 v58, v38, v34
    v_cvt_pk_bf16_f32 v59, v39, v35
    v_xor_b32 v60, v28, v56
    v_xor_b32 v61, v28, v57
    v_xor_b32 v62, v28, v58
    v_xor_b32 v63, v28, v59
    v_mov_b32 v12, 0xc0135761
    v_mov_b32 v13, 0xc0135761
    s_mov_b32 s60, 0xbdd2d3e8
    s_mov_b32 s61, 0xbdd2d3e8
    s_mov_b32 s62, 0xaaaaaaaa
    s_mov_b32 s63, 0xaaaaaaaa
    s_mov_b32 s64, 0xcccccccc
    s_add_u32 m0, s75, 68608
    s_add_u32 s74, s74, 0x40000
    v_xor_b32_e64 v66, 16, v7
    buffer_load_dwordx4 v66, s[20:23], s74 offen  lds
    s_mov_b32 s65, 0xcccccccc
    s_mov_b64 s[66:67], 0xffff
    s_mul_i32 s46, s41, 7
    s_and_b32 s70, s41, 1
    s_add_u32 s45, s46, s70
    s_cmp_eq_u32 s70, 0
    s_cselect_b32 s70, 6, 0
    s_add_u32 s46, s46, s70
    v_lshrrev_b32 v15, 1, v5
    v_lshlrev_b32 v15, 8, v15
    v_lshl_add_u32 v15, v4, 4, v15
    v_and_b32_e64 v24, 1, v5
    v_lshl_add_u32 v15, v24, 16, v15
    s_lshl_b32 s70, s52, 9
    s_mul_i32 s71, s52, 28672
    s_lshl_b32 s83, s45, 16
    s_add_u32 m0, s75, 69632
    s_add_u32 s74, s74, 0x40000
    v_xor_b32_e64 v66, 32, v7
    buffer_load_dwordx4 v66, s[20:23], s74 offen  lds
    s_add_u32 s83, s83, s70
    s_lshl_b32 s84, s46, 16
    s_add_u32 s84, s84, s70
    s_lshl_b32 s70, s41, 9
    s_add_u32 s86, s71, s70
    s_add_u32 s85, s86, s70
    s_add_u32 s86, s86, 24576
    v_lshlrev_b32_e64 v22, 3, v1
    s_mul_i32 s87, s52, 14336
    s_lshl_b32 s70, s89, 11
    s_add_u32 s87, s87, s70
    s_cmp_eq_u32 s41, 7
    s_cselect_b32 s92, 14680064, 0
    s_add_u32 s82, s82, s92
    s_add_u32 s92, s92, s87
    s_add_u32 m0, s75, 70656
    s_add_u32 s74, s74, 0x40000
    v_xor_b32 v66, 48, v7
    buffer_load_dwordx4 v66, s[20:23], s74 offen  lds
    s_lshl_b32 s70, s42, 4
    v_add_u32 v112, s70, v4
    v_lshl_add_u32 v113, v5, 8, s40
    v_mul_u32_u24_e64 v113, v112, v113
    v_and_b32 v113, 0x7ff, v113
    v_cvt_f32_u32 v113, v113
    v_cvt_f32_u32 v114, v112
    v_mul_f32 v113, 0x3a000000, v113
    v_mul_f32 v114, 0x3c800000, v114
    v_and_b32_e64 v115, 1, v112
    v_lshl_or_b32 v115, v115, 16, v115
    v_lshlrev_b32 v115, 15, v115
    v_cos_f32 v116, v113
    v_sin_f32 v120, v113
    v_add_f32 v113, v113, v114
    s_add_u32 m0, s75, 71680
    s_add_u32 s74, s74, 0x40000
    v_xor_b32_e64 v66, 64, v7
    buffer_load_dwordx4 v66, s[20:23], s74 offen  lds
    v_cos_f32 v117, v113
    v_sin_f32 v121, v113
    v_add_f32 v113, v113, v114
    v_cos_f32 v118, v113
    v_sin_f32 v122, v113
    v_add_f32 v113, v113, v114
    v_cos_f32 v119, v113
    v_sin_f32 v123, v113
    v_add_f32_e64 v113, v113, v114
    v_cvt_pk_bf16_f32 v24, v116, v118
    v_cvt_pk_bf16_f32 v32, v120, v122
    v_cvt_pk_bf16_f32 v40, -v120, -v122
    v_xor_b32 v26, v115, v24
    v_xor_b32 v34, v115, v32
    v_xor_b32_e64 v42, v115, v40
    s_add_u32 m0, s75, 72704
    s_add_u32 s74, s74, 0x40000
    v_xor_b32 v66, 80, v7
    buffer_load_dwordx4 v66, s[20:23], s74 offen  lds
    v_cvt_pk_bf16_f32 v28, v117, v119
    v_cvt_pk_bf16_f32 v36, v121, v123
    v_cvt_pk_bf16_f32 v44, -v121, -v123
    v_xor_b32 v30, v115, v28
    v_xor_b32 v38, v115, v36
    v_xor_b32 v46, v115, v44
    v_cos_f32 v116, v113
    v_sin_f32 v120, v113
    v_add_f32 v113, v113, v114
    v_cos_f32 v117, v113
    v_sin_f32 v121, v113
    v_add_f32 v113, v113, v114
    v_cos_f32 v118, v113
    v_sin_f32 v122, v113
    v_add_f32 v113, v113, v114
    s_add_u32 m0, s75, 73728
    s_add_u32 s74, s74, 0x40000
    v_xor_b32 v66, 96, v7
    buffer_load_dwordx4 v66, s[20:23], s74 offen  lds
    v_cos_f32 v119, v113
    v_sin_f32 v123, v113
    v_add_f32_e64 v113, v113, v114
    v_cvt_pk_bf16_f32 v25, v116, v118
    v_cvt_pk_bf16_f32 v33, v120, v122
    v_cvt_pk_bf16_f32 v41, -v120, -v122
    v_xor_b32 v27, v115, v25
    v_xor_b32 v35, v115, v33
    v_xor_b32_e64 v43, v115, v41
    v_cvt_pk_bf16_f32 v29, v117, v119
    v_cvt_pk_bf16_f32 v37, v121, v123
    v_cvt_pk_bf16_f32 v45, -v121, -v123
    v_xor_b32 v31, v115, v29
    v_xor_b32 v39, v115, v37
    v_xor_b32 v47, v115, v45
    s_waitcnt vmcnt(15)
    ds_read_b128 v[200:203], v23 offset:0
    ds_read_b128 v[204:207], v23 offset:16
    ds_read_b128 v[208:211], v23 offset:32
    ds_read_b128 v[212:215], v23 offset:48
    ds_read_b128 v[216:219], v23 offset:64
    ds_read_b128 v[220:223], v23 offset:80
    ds_read_b128 v[224:227], v23 offset:96
    ds_read_b128 v[228:231], v64 offset:0
    ds_read_b128 v[232:235], v64 offset:16
    ds_read_b128 v[236:239], v64 offset:32
    ds_read_b128 v[240:243], v64 offset:48
    ds_read_b128 v[244:247], v64 offset:64
    ds_read_b128 v[248:251], v64 offset:80
    ds_read_b128 v[252:255], v64 offset:96
    s_lshl_b32 s70, s51, 10
    s_lshl3_add_u32 s70, s50, s70
    s_add_u32 s70, s70, 59392
    s_lshl_b32 s71, s42, 11
    s_add_u32 s71, s71, 100352
    v_add_u32 v65, s70, v7
    v_add_u32_e64 v105, s71, v7
    v_lshl_add_u32 v67, v4, 7, s71
    v_lshl_add_u32 v67, v6, 4, v67
    v_xor_b32 v104, 64, v67
    v_lshlrev_b32 v84, 4, v5
    v_mov_b32 v80, 0
    v_mov_b32 v81, 0
    v_mov_b32 v82, 0
    v_mov_b32 v83, 0
    s_waitcnt lgkmcnt(13)
    v_dot2c_f32_bf16 v80, s54, v200
    v_dot2c_f32_bf16 v82, v200, v200
    v_dot2c_f32_bf16 v81, s54, v201
    v_dot2c_f32_bf16 v83, v201, v201
    v_dot2c_f32_bf16 v80, s54, v202
    v_dot2c_f32_bf16 v82, v202, v202
    v_dot2c_f32_bf16 v81, s54, v203
    v_dot2c_f32_bf16 v83, v203, v203
    s_waitcnt lgkmcnt(12)
    v_dot2c_f32_bf16 v80, s54, v204
    v_dot2c_f32_bf16 v82, v204, v204
    v_dot2c_f32_bf16 v81, s54, v205
    v_dot2c_f32_bf16 v83, v205, v205
    v_dot2c_f32_bf16 v80, s54, v206
    v_dot2c_f32_bf16 v82, v206, v206
    v_dot2c_f32_bf16 v81, s54, v207
    v_dot2c_f32_bf16 v83, v207, v207
    s_waitcnt lgkmcnt(11)
    v_dot2c_f32_bf16 v80, s54, v208
    v_dot2c_f32_bf16 v82, v208, v208
    v_dot2c_f32_bf16 v81, s54, v209
    v_dot2c_f32_bf16 v83, v209, v209
    v_dot2c_f32_bf16 v80, s54, v210
    v_dot2c_f32_bf16 v82, v210, v210
    v_dot2c_f32_bf16 v81, s54, v211
    v_dot2c_f32_bf16 v83, v211, v211
    s_waitcnt lgkmcnt(10)
    v_dot2c_f32_bf16 v80, s54, v212
    v_dot2c_f32_bf16 v82, v212, v212
    v_dot2c_f32_bf16 v81, s54, v213
    v_dot2c_f32_bf16 v83, v213, v213
    v_dot2c_f32_bf16 v80, s54, v214
    v_dot2c_f32_bf16 v82, v214, v214
    v_dot2c_f32_bf16 v81, s54, v215
    v_dot2c_f32_bf16 v83, v215, v215
    s_waitcnt lgkmcnt(9)
    v_dot2c_f32_bf16 v80, s54, v216
    v_dot2c_f32_bf16 v82, v216, v216
    v_dot2c_f32_bf16 v81, s54, v217
    v_dot2c_f32_bf16 v83, v217, v217
    v_dot2c_f32_bf16 v80, s54, v218
    v_dot2c_f32_bf16 v82, v218, v218
    v_dot2c_f32_bf16 v81, s54, v219
    v_dot2c_f32_bf16 v83, v219, v219
    s_waitcnt lgkmcnt(8)
    v_dot2c_f32_bf16 v80, s54, v220
    v_dot2c_f32_bf16 v82, v220, v220
    v_dot2c_f32_bf16 v81, s54, v221
    v_dot2c_f32_bf16 v83, v221, v221
    v_dot2c_f32_bf16 v80, s54, v222
    v_dot2c_f32_bf16 v82, v222, v222
    v_dot2c_f32_bf16 v81, s54, v223
    v_dot2c_f32_bf16 v83, v223, v223
    s_waitcnt lgkmcnt(7)
    v_dot2c_f32_bf16 v80, s54, v224
    v_dot2c_f32_bf16 v82, v224, v224
    v_dot2c_f32_bf16 v81, s54, v225
    v_dot2c_f32_bf16 v83, v225, v225
    v_dot2c_f32_bf16 v80, s54, v226
    v_dot2c_f32_bf16 v82, v226, v226
    v_dot2c_f32_bf16 v81, s54, v227
    v_dot2c_f32_bf16 v83, v227, v227
    s_waitcnt lgkmcnt(6)
    v_dot2c_f32_bf16 v80, s54, v228
    v_dot2c_f32_bf16 v82, v228, v228
    v_dot2c_f32_bf16 v81, s54, v229
    v_dot2c_f32_bf16 v83, v229, v229
    v_dot2c_f32_bf16 v80, s54, v230
    v_dot2c_f32_bf16 v82, v230, v230
    v_dot2c_f32_bf16 v81, s54, v231
    v_dot2c_f32_bf16 v83, v231, v231
    s_waitcnt lgkmcnt(5)
    v_dot2c_f32_bf16 v80, s54, v232
    v_dot2c_f32_bf16 v82, v232, v232
    v_dot2c_f32_bf16 v81, s54, v233
    v_dot2c_f32_bf16 v83, v233, v233
    v_dot2c_f32_bf16 v80, s54, v234
    v_dot2c_f32_bf16 v82, v234, v234
    v_dot2c_f32_bf16 v81, s54, v235
    v_dot2c_f32_bf16 v83, v235, v235
    s_waitcnt lgkmcnt(4)
    v_dot2c_f32_bf16 v80, s54, v236
    v_dot2c_f32_bf16 v82, v236, v236
    v_dot2c_f32_bf16 v81, s54, v237
    v_dot2c_f32_bf16 v83, v237, v237
    v_dot2c_f32_bf16 v80, s54, v238
    v_dot2c_f32_bf16 v82, v238, v238
    v_dot2c_f32_bf16 v81, s54, v239
    v_dot2c_f32_bf16 v83, v239, v239
    s_waitcnt lgkmcnt(3)
    v_dot2c_f32_bf16 v80, s54, v240
    v_dot2c_f32_bf16 v82, v240, v240
    v_dot2c_f32_bf16 v81, s54, v241
    v_dot2c_f32_bf16 v83, v241, v241
    v_dot2c_f32_bf16 v80, s54, v242
    v_dot2c_f32_bf16 v82, v242, v242
    v_dot2c_f32_bf16 v81, s54, v243
    v_dot2c_f32_bf16 v83, v243, v243
    s_waitcnt lgkmcnt(2)
    v_dot2c_f32_bf16 v80, s54, v244
    v_dot2c_f32_bf16 v82, v244, v244
    v_dot2c_f32_bf16 v81, s54, v245
    v_dot2c_f32_bf16 v83, v245, v245
    v_dot2c_f32_bf16 v80, s54, v246
    v_dot2c_f32_bf16 v82, v246, v246
    v_dot2c_f32_bf16 v81, s54, v247
    v_dot2c_f32_bf16 v83, v247, v247
    s_waitcnt lgkmcnt(1)
    v_dot2c_f32_bf16 v80, s54, v248
    v_dot2c_f32_bf16 v82, v248, v248
    v_dot2c_f32_bf16 v81, s54, v249
    v_dot2c_f32_bf16 v83, v249, v249
    v_dot2c_f32_bf16 v80, s54, v250
    v_dot2c_f32_bf16 v82, v250, v250
    v_dot2c_f32_bf16 v81, s54, v251
    v_dot2c_f32_bf16 v83, v251, v251
    s_waitcnt lgkmcnt(0)
    v_dot2c_f32_bf16 v80, s54, v252
    v_dot2c_f32_bf16 v82, v252, v252
    v_dot2c_f32_bf16 v81, s54, v253
    v_dot2c_f32_bf16 v83, v253, v253
    v_dot2c_f32_bf16 v80, s54, v254
    v_dot2c_f32_bf16 v82, v254, v254
    v_dot2c_f32_bf16 v81, s54, v255
    v_dot2c_f32_bf16 v83, v255, v255
    v_readfirstlane_b32 s44, v10
    v_lshlrev_b32 v11, 16, v11
    s_mul_i32 s44, s44, 1664525
    s_add_u32 s44, s44, 1013904223
    v_mov_b32 v10, s44
    v_add_f32 v80, v80, v81
    v_add_f32 v82, v82, v83
    v_mov_b32 v106, v80
    v_mov_b32 v107, v82
    s_nop 0
    v_permlane32_swap_b32 v80, v106
    v_permlane32_swap_b32 v82, v107
    v_add_f32 v80, v80, v106
    v_add_f32 v82, v82, v107
    v_mov_b32 v106, v80
    v_mov_b32 v107, v82
    s_nop 0
    v_permlane16_swap_b32 v80, v106
    v_permlane16_swap_b32 v82, v107
    v_add_f32 v80, v80, v106
    v_add_f32_e64 v82, v82, v107
    v_mul_f32 v80, 0x3b124925, v80
    v_mul_f32 v82, 0x3b124925, v82
    v_fma_f32 v82, -v80, v80, v82
    v_max_f32 v82, 0, v82
    v_add_f32 v82, s53, v82
    v_rsq_f32 v81, v82
    s_nop 0
    ds_bpermute_b32 v76, v84, v81 offset:0
    ds_bpermute_b32 v77, v84, v81 offset:4
    ds_bpermute_b32 v78, v84, v81 offset:8
    ds_bpermute_b32 v79, v84, v81 offset:12
    s_barrier
    s_mul_i32 s70, s40, 7
    s_add_u32 s70, s70, s41
    s_lshl_b32 s70, s70, 7
    s_add_u32 s70, s70, 65536
    s_cmp_lg_u32 s42, 0
    s_cbranch_scc1 nf_1
    s_bfm_b64 exec, 32, 0
    buffer_store_dword v10, v21, s[36:39], s70 offen sc1
    s_mov_b64 exec, -1
nf_1:
    ds_read_b128 v[108:111], v8 offset:34816
    ds_read_b128 v[112:115], v8 offset:35840
    ds_read_b128 v[116:119], v8 offset:50176
    ds_read_b128 v[120:123], v8 offset:49152
    ds_read_b128 v[124:127], v8 offset:63488
    ds_read_b128 v[128:131], v8 offset:64512
    ds_read_b128 v[132:135], v9 offset:13312
    ds_read_b128 v[136:139], v9 offset:12288
    s_add_u32 m0, s75, 74752
    s_add_u32 s74, s74, 0x40000
    v_xor_b32 v66, 112, v7
    buffer_load_dwordx4 v66, s[20:23], s74 offen  lds
    s_waitcnt lgkmcnt(7)
    v_mfma_f32_16x16x32_bf16 v[80:83], v[200:203], v[108:111], 0
    ds_read_b128 v[108:111], v9 offset:14336
    s_waitcnt lgkmcnt(7)
    v_mfma_f32_16x16x32_bf16 v[80:83], v[204:207], v[112:115], v[80:83]
    ds_read_b128 v[112:115], v9 offset:15360
    s_waitcnt lgkmcnt(6)
    v_mfma_f32_16x16x32_bf16 v[84:87], v[204:207], v[116:119], 0
    ds_read_b128 v[116:119], v9 offset:1024
    v_mfma_f32_16x16x32_bf16 v[84:87], v[200:203], v[120:123], v[84:87]
    ds_read_b128 v[120:123], v9 offset:0
    s_waitcnt lgkmcnt(6)
    v_mfma_f32_16x16x32_bf16 v[88:91], v[200:203], v[124:127], 0
    ds_read_b128 v[124:127], v8 offset:51200
    v_mfma_f32_16x16x32_bf16 v[88:91], v[204:207], v[128:131], v[88:91]
    ds_read_b128 v[128:131], v8 offset:52224
    s_waitcnt lgkmcnt(6)
    v_mfma_f32_16x16x32_bf16 v[92:95], v[204:207], v[132:135], 0
    ds_read_b128 v[132:135], v8 offset:37888
    v_mfma_f32_16x16x32_bf16 v[92:95], v[200:203], v[136:139], v[92:95]
    ds_read_b128 v[136:139], v8 offset:36864
    s_waitcnt lgkmcnt(6)
    v_mfma_f32_16x16x32_bf16 v[92:95], v[208:211], v[108:111], v[92:95]
    ds_read_b128 v[108:111], v8 offset:38912
    v_mfma_f32_16x16x32_bf16 v[92:95], v[212:215], v[112:115], v[92:95]
    ds_read_b128 v[112:115], v8 offset:39936
    s_waitcnt lgkmcnt(6)
    v_mfma_f32_16x16x32_bf16 v[88:91], v[212:215], v[116:119], v[88:91]
    ds_read_b128 v[116:119], v8 offset:54272
    v_mfma_f32_16x16x32_bf16 v[88:91], v[208:211], v[120:123], v[88:91]
    ds_read_b128 v[120:123], v8 offset:53248
    s_waitcnt lgkmcnt(6)
    v_mfma_f32_16x16x32_bf16 v[84:87], v[208:211], v[124:127], v[84:87]
    ds_read_b128 v[124:127], v9 offset:2048
    v_mfma_f32_16x16x32_bf16 v[84:87], v[212:215], v[128:131], v[84:87]
    ds_read_b128 v[128:131], v9 offset:3072
    s_waitcnt lgkmcnt(6)
    v_mfma_f32_16x16x32_bf16 v[80:83], v[212:215], v[132:135], v[80:83]
    ds_read_b128 v[132:135], v9 offset:17408
    v_mfma_f32_16x16x32_bf16 v[80:83], v[208:211], v[136:139], v[80:83]
    ds_read_b128 v[136:139], v9 offset:16384
    s_waitcnt lgkmcnt(6)
    v_mfma_f32_16x16x32_bf16 v[80:83], v[216:219], v[108:111], v[80:83]
    ds_read_b128 v[108:111], v9 offset:18432
    v_mfma_f32_16x16x32_bf16 v[80:83], v[220:223], v[112:115], v[80:83]
    ds_read_b128 v[112:115], v9 offset:19456
    s_lshl_b32 s72, s42, 9
    s_add_u32 s72, s72, s49
    s_mul_i32 s73, s42, 7424
    s_mul_i32 s72, s72, 896
    s_add_u32 m0, s73, 29696
    s_add_u32 s81, s72, 0
    s_bfm_b64 exec, 56, 0
    buffer_load_dwordx4 v7, s[4:7], s81 offen lds
    s_add_u32 m0, m0, 928
    s_add_u32 s81, s81, 57344
    buffer_load_dwordx4 v7, s[4:7], s81 offen lds
    s_mov_b64 exec, -1
    s_waitcnt lgkmcnt(6)
    v_mfma_f32_16x16x32_bf16 v[84:87], v[220:223], v[116:119], v[84:87]
    ds_read_b128 v[116:119], v9 offset:5120
    v_mfma_f32_16x16x32_bf16 v[84:87], v[216:219], v[120:123], v[84:87]
    ds_read_b128 v[120:123], v9 offset:4096
    s_waitcnt lgkmcnt(6)
    v_mfma_f32_16x16x32_bf16 v[88:91], v[216:219], v[124:127], v[88:91]
    ds_read_b128 v[124:127], v8 offset:55296
    v_mfma_f32_16x16x32_bf16 v[88:91], v[220:223], v[128:131], v[88:91]
    ds_read_b128 v[128:131], v8 offset:56320
    s_waitcnt lgkmcnt(6)
    v_mfma_f32_16x16x32_bf16 v[92:95], v[220:223], v[132:135], v[92:95]
    ds_read_b128 v[132:135], v8 offset:41984
    v_mfma_f32_16x16x32_bf16 v[92:95], v[216:219], v[136:139], v[92:95]
    ds_read_b128 v[136:139], v8 offset:40960
    s_waitcnt lgkmcnt(6)
    v_mfma_f32_16x16x32_bf16 v[92:95], v[224:227], v[108:111], v[92:95]
    ds_read_b128 v[108:111], v8 offset:43008
    v_mfma_f32_16x16x32_bf16 v[100:103], v[228:231], v[112:115], 0
    ds_read_b128 v[112:115], v8 offset:44032
    s_waitcnt lgkmcnt(6)
    v_mfma_f32_16x16x32_bf16 v[96:99], v[228:231], v[116:119], 0
    ds_read_b128 v[116:119], v8 offset:58368
    v_mfma_f32_16x16x32_bf16 v[88:91], v[224:227], v[120:123], v[88:91]
    ds_read_b128 v[120:123], v8 offset:57344
    s_waitcnt lgkmcnt(6)
    v_mfma_f32_16x16x32_bf16 v[84:87], v[224:227], v[124:127], v[84:87]
    ds_read_b128 v[124:127], v9 offset:6144
    v_mfma_f32_16x16x32_bf16 v[84:87], v[228:231], v[128:131], v[84:87]
    ds_read_b128 v[128:131], v9 offset:7168
    s_waitcnt lgkmcnt(6)
    v_mfma_f32_16x16x32_bf16 v[80:83], v[228:231], v[132:135], v[80:83]
    ds_read_b128 v[132:135], v9 offset:21504
    v_mfma_f32_16x16x32_bf16 v[80:83], v[224:227], v[136:139], v[80:83]
    ds_read_b128 v[136:139], v9 offset:20480
    s_waitcnt lgkmcnt(6)
    v_mfma_f32_16x16x32_bf16 v[80:83], v[232:235], v[108:111], v[80:83]
    ds_read_b128 v[108:111], v9 offset:22528
    v_mfma_f32_16x16x32_bf16 v[80:83], v[236:239], v[112:115], v[80:83]
    ds_read_b128 v[112:115], v9 offset:23552
    s_waitcnt lgkmcnt(6)
    v_mfma_f32_16x16x32_bf16 v[84:87], v[236:239], v[116:119], v[84:87]
    ds_read_b128 v[116:119], v9 offset:9216
    v_mfma_f32_16x16x32_bf16 v[84:87], v[232:235], v[120:123], v[84:87]
    s_add_u32 m0, s73, 31552
    s_add_u32 s81, s72, 114688
    s_bfm_b64 exec, 56, 0
    buffer_load_dwordx4 v7, s[4:7], s81 offen lds
    s_add_u32 m0, m0, 928
    s_add_u32 s81, s81, 57344
    buffer_load_dwordx4 v7, s[4:7], s81 offen lds
    s_mov_b64 exec, -1
    ds_read_b128 v[120:123], v9 offset:8192
    s_waitcnt lgkmcnt(6)
    v_mfma_f32_16x16x32_bf16 v[96:99], v[232:235], v[124:127], v[96:99]
    ds_read_b128 v[124:127], v8 offset:59392
    v_mfma_f32_16x16x32_bf16 v[96:99], v[236:239], v[128:131], v[96:99]
    ds_read_b128 v[128:131], v8 offset:60416
    s_waitcnt lgkmcnt(6)
    v_mfma_f32_16x16x32_bf16 v[100:103], v[236:239], v[132:135], v[100:103]
    ds_read_b128 v[132:135], v8 offset:46080
    v_mfma_f32_16x16x32_bf16 v[100:103], v[232:235], v[136:139], v[100:103]
    ds_read_b128 v[136:139], v8 offset:45056
    s_waitcnt lgkmcnt(6)
    v_mfma_f32_16x16x32_bf16 v[100:103], v[240:243], v[108:111], v[100:103]
    ds_read_b128 v[108:111], v8 offset:47104
    v_mfma_f32_16x16x32_bf16 v[100:103], v[244:247], v[112:115], v[100:103]
    ds_read_b128 v[112:115], v8 offset:48128
    s_waitcnt lgkmcnt(6)
    v_mfma_f32_16x16x32_bf16 v[96:99], v[244:247], v[116:119], v[96:99]
    ds_read_b128 v[116:119], v8 offset:62464
    v_mfma_f32_16x16x32_bf16 v[96:99], v[240:243], v[120:123], v[96:99]
    ds_read_b128 v[120:123], v8 offset:61440
    s_waitcnt lgkmcnt(6)
    v_mfma_f32_16x16x32_bf16 v[84:87], v[240:243], v[124:127], v[84:87]
    ds_read_b128 v[124:127], v9 offset:10240
    v_mfma_f32_16x16x32_bf16 v[84:87], v[244:247], v[128:131], v[84:87]
    ds_read_b128 v[128:131], v9 offset:11264
    s_waitcnt lgkmcnt(6)
    v_mfma_f32_16x16x32_bf16 v[80:83], v[244:247], v[132:135], v[80:83]
    ds_read_b128 v[132:135], v9 offset:25600
    v_mfma_f32_16x16x32_bf16 v[80:83], v[240:243], v[136:139], v[80:83]
    ds_read_b128 v[136:139], v9 offset:24576
    s_waitcnt lgkmcnt(6)
    v_mfma_f32_16x16x32_bf16 v[80:83], v[248:251], v[108:111], v[80:83]
    v_mfma_f32_16x16x32_bf16 v[80:83], v[252:255], v[112:115], v[80:83]
    s_waitcnt lgkmcnt(4)
    v_mfma_f32_16x16x32_bf16 v[84:87], v[252:255], v[116:119], v[84:87]
    v_mfma_f32_16x16x32_bf16 v[84:87], v[248:251], v[120:123], v[84:87]
    s_waitcnt lgkmcnt(2)
    v_mfma_f32_16x16x32_bf16 v[96:99], v[248:251], v[124:127], v[96:99]
    v_mfma_f32_16x16x32_bf16 v[96:99], v[252:255], v[128:131], v[96:99]
    s_waitcnt lgkmcnt(0)
    v_mfma_f32_16x16x32_bf16 v[100:103], v[252:255], v[132:135], v[100:103]
    v_mfma_f32_16x16x32_bf16 v[100:103], v[248:251], v[136:139], v[100:103]
    v_pk_mul_f32 v[80:81], v[80:81], v[76:77]
    v_pk_mul_f32 v[82:83], v[82:83], v[78:79]
    v_cvt_pk_bf16_f32 v80, v80, v81
    v_cvt_pk_bf16_f32 v81, v82, v83
    ds_write_b64 v65, v[80:81] offset:0
    v_pk_mul_f32 v[84:85], v[84:85], v[76:77]
    v_pk_mul_f32 v[86:87], v[86:87], v[78:79]
    v_cvt_pk_bf16_f32 v84, v84, v85
    v_cvt_pk_bf16_f32 v85, v86, v87
    ds_write_b64 v65, v[84:85] offset:2048
    v_pk_add_f32 v[88:89], v[88:89], v[96:97] neg_lo:[0,1] neg_hi:[0,1]
    v_pk_add_f32 v[90:91], v[90:91], v[98:99] neg_lo:[0,1] neg_hi:[0,1]
    v_pk_mul_f32 v[88:89], v[88:89], v[76:77]
    v_pk_mul_f32 v[90:91], v[90:91], v[78:79]
    v_cvt_pk_bf16_f32 v88, v88, v89
    v_cvt_pk_bf16_f32 v89, v90, v91
    ds_write_b64 v65, v[88:89] offset:4096
    v_pk_add_f32 v[92:93], v[92:93], v[100:101] neg_lo:[0,1] neg_hi:[0,1]
    v_pk_add_f32 v[94:95], v[94:95], v[102:103] neg_lo:[0,1] neg_hi:[0,1]
    v_pk_mul_f32 v[92:93], v[92:93], v[76:77]
    v_pk_mul_f32 v[94:95], v[94:95], v[78:79]
    v_cvt_pk_bf16_f32 v92, v92, v93
    v_cvt_pk_bf16_f32 v93, v94, v95
    ds_write_b64 v65, v[92:93] offset:6144
    s_waitcnt lgkmcnt(0)
    s_barrier
    ds_read_b128 v[168:171], v7 offset:59392
    ds_read_b128 v[172:175], v7 offset:61440
    ds_read_b128 v[176:179], v7 offset:63488
    ds_read_b128 v[180:183], v8 offset:0
    ds_read_b128 v[184:187], v7 offset:60416
    ds_read_b128 v[188:191], v7 offset:62464
    ds_read_b128 v[192:195], v7 offset:64512
    ds_read_b128 v[196:199], v8 offset:1024
    s_waitcnt lgkmcnt(7)
    v_mfma_f32_16x16x32_bf16 v[80:83], v[168:171], v[24:27], 0
    s_waitcnt lgkmcnt(6)
    v_mfma_f32_16x16x32_bf16 v[84:87], v[172:175], v[24:27], 0
    v_mfma_f32_16x16x32_bf16 v[88:91], v[168:171], v[40:43], 0
    v_mfma_f32_16x16x32_bf16 v[92:95], v[172:175], v[40:43], 0
    s_waitcnt lgkmcnt(5)
    v_mfma_f32_16x16x32_bf16 v[80:83], v[176:179], v[32:35], v[80:83]
    s_waitcnt lgkmcnt(4)
    v_mfma_f32_16x16x32_bf16 v[84:87], v[180:183], v[32:35], v[84:87]
    v_mfma_f32_16x16x32_bf16 v[88:91], v[176:179], v[24:27], v[88:91]
    v_mfma_f32_16x16x32_bf16 v[92:95], v[180:183], v[24:27], v[92:95]
    s_waitcnt lgkmcnt(3)
    v_mfma_f32_16x16x32_bf16 v[80:83], v[184:187], v[28:31], v[80:83]
    s_waitcnt lgkmcnt(2)
    v_mfma_f32_16x16x32_bf16 v[84:87], v[188:191], v[28:31], v[84:87]
    v_mfma_f32_16x16x32_bf16 v[88:91], v[184:187], v[44:47], v[88:91]
    v_mfma_f32_16x16x32_bf16 v[92:95], v[188:191], v[44:47], v[92:95]
    s_waitcnt lgkmcnt(1)
    v_mfma_f32_16x16x32_bf16 v[80:83], v[192:195], v[36:39], v[80:83]
    s_waitcnt lgkmcnt(0)
    v_mfma_f32_16x16x32_bf16 v[84:87], v[196:199], v[36:39], v[84:87]
    v_mfma_f32_16x16x32_bf16 v[88:91], v[192:195], v[28:31], v[88:91]
    v_mfma_f32_16x16x32_bf16 v[92:95], v[196:199], v[28:31], v[92:95]
    s_nop 3
    v_cvt_pk_bf16_f32 v168, v80, v81
    v_cvt_pk_bf16_f32 v169, v82, v83
    v_cvt_pk_bf16_f32 v170, v84, v85
    v_cvt_pk_bf16_f32 v171, v86, v87
    v_and_b32 v168, -2, v168
    ds_write_b128 v67, v[168:171]
    v_cvt_pk_bf16_f32 v172, v88, v89
    v_cvt_pk_bf16_f32 v173, v90, v91
    v_cvt_pk_bf16_f32 v174, v92, v93
    v_cvt_pk_bf16_f32 v175, v94, v95
    v_and_b32_e64 v172, -2, v172
    ds_write_b128 v104, v[172:175]
    ds_read_b128 v[176:179], v105 offset:0
    ds_read_b128 v[180:183], v105 offset:1024
    s_add_u32 s78, s82, 14680064
    s_waitcnt lgkmcnt(1)
    buffer_store_dwordx4 v[176:179], v14, s[36:39], s78 offen sc1
    s_add_u32 s78, s82, 14909440
    s_waitcnt lgkmcnt(0)
    buffer_store_dwordx4 v[180:183], v14, s[36:39], s78 offen sc1
    s_add_u32 m0, s73, 33408
    s_add_u32 s81, s72, 229376
    s_bfm_b64 exec, 56, 0
    buffer_load_dwordx4 v7, s[4:7], s81 offen lds
    s_add_u32 m0, m0, 928
    s_add_u32 s81, s81, 57344
    buffer_load_dwordx4 v7, s[4:7], s81 offen lds
    s_mov_b64 exec, -1
    s_add_u32 m0, s73, 35264
    s_add_u32 s81, s72, 344064
    s_bfm_b64 exec, 56, 0
    buffer_load_dwordx4 v7, s[4:7], s81 offen lds
    s_add_u32 m0, m0, 928
    s_add_u32 s81, s81, 57344
    buffer_load_dwordx4 v7, s[4:7], s81 offen lds
    s_mov_b64 exec, -1
    s_waitcnt vmcnt(24)
    v_lshl_or_b32 v68, v69, 16, v68
    s_waitcnt vmcnt(22)
    v_lshl_or_b32 v69, v71, 16, v70
    s_waitcnt vmcnt(20)
    v_lshl_or_b32 v70, v73, 16, v72
    s_waitcnt vmcnt(18)
    v_lshl_or_b32 v71, v75, 16, v74
    s_mul_i32 s70, s41, 112
    s_cmp_lt_u32 s40, 28
    s_cselect_b32 s70, s70, 1024
    s_add_u32 s70, s70, s52
    s_lshl_b32 s70, s70, 10
    s_add_u32 s70, s70, 4194304
    buffer_store_dwordx4 v[68:71], v7, s[36:39], s70 offen sc1
L_join0:
    s_mul_i32 s88, s42, 7168
    s_add_u32 s88, s88, 65536
    v_lshlrev_b32 v20, 7, v1
    v_mov_b32 v65, s44
    s_bfm_b64 exec, 56, 0
    buffer_load_dword v65, v20, s[36:39], s88 offen sc1
    s_mov_b64 exec, -1
    s_lshl_b32 s72, s42, 10
    s_mul_i32 s73, s48, 28672
    s_add_u32 s73, s73, s72
    s_mul_i32 s74, s49, 28672
    s_add_u32 s74, s74, s72
    s_add_u32 s72, s72, 100352
    v_add_u32_e64 v66, s72, v7
    s_waitcnt vmcnt(12)
    s_lshl_b32 s71, s42, 13
    s_add_u32 s71, s71, 67584
    v_and_b32 v68, 7, v1
    v_lshrrev_b32 v67, 3, v1
    v_xor_b32_e64 v70, v67, v68
    v_lshl_add_u32 v69, v68, 10, s71
    v_lshl_add_u32 v69, v70, 4, v69
    ds_read_b128 v[112:115], v69 offset:0
    ds_read_b128 v[116:119], v69 offset:128
    ds_read_b128 v[120:123], v69 offset:256
    ds_read_b128 v[124:127], v69 offset:384
    ds_read_b128 v[128:131], v69 offset:512
    ds_read_b128 v[132:135], v69 offset:640
    ds_read_b128 v[136:139], v69 offset:768
    ds_read_b128 v[140:143], v69 offset:896
    s_lshr_b32 s71, s41, 2
    s_lshl1_add_u32 s71, s71, s50
    s_lshl1_add_u32 s71, s71, s51
    s_and_b32 s76, s41, 3
    s_lshl_b32 s76, s76, 6
    v_add_u32_e64 v68, s76, v68
    s_lshl_b32 s71, s71, 7
    s_lshl_b32 s76, s40, 18
    s_add_u32 s76, s76, s71
    s_add_u32 s76, s76, 6291456
    v_lshrrev_b32 v70, 5, v1
    v_lshlrev_b32 v68, 4, v68
    v_lshl_add_u32 v68, v70, 12, v68
    v_mad_i32_i24 v70, v70, -2, 1
    v_lshlrev_b32 v67, 3, v67
    v_mul_i32_i24_e64 v67, v70, v67
    s_waitcnt vmcnt(2)
    s_barrier
    s_waitcnt lgkmcnt(6)
    v_perm_b32 v104, v116, v112, s55
    s_waitcnt lgkmcnt(4)
    v_perm_b32 v105, v124, v120, s55
    s_waitcnt lgkmcnt(2)
    v_perm_b32 v106, v132, v128, s55
    s_waitcnt lgkmcnt(0)
    s_nop 0
    v_perm_b32 v107, v140, v136, s55
    v_accvgpr_write_b32 a0, v104
    v_accvgpr_write_b32 a1, v105
    v_accvgpr_write_b32 a2, v106
    v_accvgpr_write_b32 a3, v107
    v_perm_b32 v108, v116, v112, s56
    v_perm_b32 v109, v124, v120, s56
    v_perm_b32 v110, v132, v128, s56
L_pad_1218:
    s_cbranch_execz L_ret_0
    s_nop 0
    v_perm_b32 v111, v140, v136, s56
    v_accvgpr_write_b32 a4, v108
    v_accvgpr_write_b32 a5, v109
    v_accvgpr_write_b32 a6, v110
    v_accvgpr_write_b32 a7, v111
    v_perm_b32 v104, v117, v113, s55
    v_perm_b32 v105, v125, v121, s55
    v_perm_b32 v106, v133, v129, s55
    v_perm_b32 v107, v141, v137, s55
    v_accvgpr_write_b32 a8, v104
    v_accvgpr_write_b32 a9, v105
    v_accvgpr_write_b32 a10, v106
    v_accvgpr_write_b32 a11, v107
    v_perm_b32 v108, v117, v113, s56
    v_perm_b32 v109, v125, v121, s56
    v_perm_b32 v110, v133, v129, s56
    v_perm_b32 v111, v141, v137, s56
    v_accvgpr_write_b32 a12, v108
    v_accvgpr_write_b32 a13, v109
    v_accvgpr_write_b32 a14, v110
    v_accvgpr_write_b32 a15, v111
    v_perm_b32 v104, v118, v114, s55
    v_perm_b32 v105, v126, v122, s55
    v_perm_b32 v106, v134, v130, s55
    v_perm_b32 v107, v142, v138, s55
    v_accvgpr_write_b32 a16, v104
    v_accvgpr_write_b32 a17, v105
    v_accvgpr_write_b32 a18, v106
    v_accvgpr_write_b32 a19, v107
    v_perm_b32 v108, v118, v114, s56
    v_perm_b32 v109, v126, v122, s56
    v_perm_b32 v110, v134, v130, s56
    v_perm_b32 v111, v142, v138, s56
    v_accvgpr_write_b32 a20, v108
    v_accvgpr_write_b32 a21, v109
    v_accvgpr_write_b32 a22, v110
    v_accvgpr_write_b32 a23, v111
    v_perm_b32 v104, v119, v115, s55
    v_perm_b32 v105, v127, v123, s55
    v_perm_b32 v106, v135, v131, s55
    v_perm_b32 v107, v143, v139, s55
    v_accvgpr_write_b32 a24, v104
    v_accvgpr_write_b32 a25, v105
    v_accvgpr_write_b32 a26, v106
    v_accvgpr_write_b32 a27, v107
    v_perm_b32 v108, v119, v115, s56
    v_perm_b32 v109, v127, v123, s56
    v_perm_b32 v110, v135, v131, s56
    v_perm_b32 v111, v143, v139, s56
    v_accvgpr_write_b32 a28, v108
    v_accvgpr_write_b32 a29, v109
    v_accvgpr_write_b32 a30, v110
    v_accvgpr_write_b32 a31, v111
    ds_read_b128 v[88:91], v23 offset:0
    ds_read_b128 v[92:95], v23 offset:16
    ds_read_b128 v[96:99], v23 offset:32
    ds_read_b128 v[100:103], v23 offset:48
    s_waitcnt lgkmcnt(3)
    v_lshlrev_b32 v200, 16, v88
    v_and_b32 v201, 0xffff0000, v88
    v_lshlrev_b32_e64 v202, 16, v89
    v_and_b32 v203, 0xffff0000, v89
    v_lshlrev_b32_e64 v204, 16, v90
    v_and_b32 v205, 0xffff0000, v90
    v_lshlrev_b32_e64 v206, 16, v91
    v_and_b32 v207, 0xffff0000, v91
    ds_read_b128 v[88:91], v23 offset:64
    s_waitcnt lgkmcnt(3)
    v_lshlrev_b32 v208, 16, v92
    v_and_b32 v209, 0xffff0000, v92
    v_lshlrev_b32_e64 v210, 16, v93
    v_and_b32 v211, 0xffff0000, v93
    v_lshlrev_b32_e64 v212, 16, v94
    v_and_b32 v213, 0xffff0000, v94
    v_lshlrev_b32_e64 v214, 16, v95
    v_and_b32 v215, 0xffff0000, v95
    ds_read_b128 v[92:95], v23 offset:80
    s_waitcnt vmcnt(0)
    v_cmp_ne_u32 vcc, s44, v65
    s_cbranch_vccnz ps_2
pb_3:
    s_lshl_b32 s88, s42, 10
    s_add_u32 s88, s88, 655360
    v_lshlrev_b32 v20, 7, v1
    v_mov_b32_e64 v65, s44
    s_bfm_b64 exec, 8, 0
    buffer_load_dword v65, v20, s[36:39], s88 offen sc1
    s_mov_b64 exec, -1
    s_add_u32 m0, s72, 0
    s_add_u32 s88, s73, 14680064
    buffer_load_dwordx4 v7, s[36:39], s88 offen sc1 lds
    s_waitcnt lgkmcnt(3)
    v_lshlrev_b32 v216, 16, v96
    v_and_b32 v217, 0xffff0000, v96
    v_lshlrev_b32_e64 v218, 16, v97
    v_and_b32 v219, 0xffff0000, v97
    v_lshlrev_b32_e64 v220, 16, v98
    v_and_b32 v221, 0xffff0000, v98
    s_add_u32 m0, s72, 28672
    s_add_u32 s88, s74, 14680064
    buffer_load_dwordx4 v7, s[36:39], s88 offen sc1 lds
    v_lshlrev_b32_e64 v222, 16, v99
    v_and_b32 v223, 0xffff0000, v99
    ds_read_b128 v[96:99], v23 offset:96
    s_waitcnt lgkmcnt(3)
    v_lshlrev_b32 v224, 16, v100
    v_and_b32 v225, 0xffff0000, v100
    v_lshlrev_b32_e64 v226, 16, v101
    s_add_u32 m0, s72, 4096
    s_add_u32 s88, s73, 14684160
    buffer_load_dwordx4 v7, s[36:39], s88 offen sc1 lds
    v_and_b32 v227, 0xffff0000, v101
    v_lshlrev_b32_e64 v228, 16, v102
    v_and_b32 v229, 0xffff0000, v102
    v_lshlrev_b32_e64 v230, 16, v103
    v_and_b32 v231, 0xffff0000, v103
    ds_read_b128 v[100:103], v64 offset:0
    s_add_u32 m0, s72, 32768
    s_add_u32 s88, s74, 14684160
    buffer_load_dwordx4 v7, s[36:39], s88 offen sc1 lds
    s_waitcnt lgkmcnt(3)
    v_lshlrev_b32 v232, 16, v88
    v_and_b32 v233, 0xffff0000, v88
    v_lshlrev_b32_e64 v234, 16, v89
    v_and_b32 v235, 0xffff0000, v89
    v_lshlrev_b32_e64 v236, 16, v90
    v_and_b32 v237, 0xffff0000, v90
    s_add_u32 m0, s72, 8192
    s_add_u32 s88, s73, 14688256
    buffer_load_dwordx4 v7, s[36:39], s88 offen sc1 lds
    v_lshlrev_b32_e64 v238, 16, v91
    v_and_b32 v239, 0xffff0000, v91
    ds_read_b128 v[88:91], v64 offset:16
    s_waitcnt lgkmcnt(3)
    v_lshlrev_b32 v240, 16, v92
    v_and_b32 v241, 0xffff0000, v92
    v_lshlrev_b32_e64 v242, 16, v93
    s_add_u32 m0, s72, 36864
    s_add_u32 s88, s74, 14688256
    buffer_load_dwordx4 v7, s[36:39], s88 offen sc1 lds
    v_and_b32 v243, 0xffff0000, v93
    v_lshlrev_b32_e64 v244, 16, v94
    v_and_b32 v245, 0xffff0000, v94
    v_lshlrev_b32_e64 v246, 16, v95
    v_and_b32 v247, 0xffff0000, v95
    ds_read_b128 v[92:95], v64 offset:32
    s_add_u32 m0, s72, 12288
    s_add_u32 s88, s73, 14692352
    buffer_load_dwordx4 v7, s[36:39], s88 offen sc1 lds
    s_waitcnt lgkmcnt(3)
    v_lshlrev_b32 v248, 16, v96
    v_and_b32 v249, 0xffff0000, v96
    v_lshlrev_b32_e64 v250, 16, v97
    v_and_b32 v251, 0xffff0000, v97
    v_lshlrev_b32_e64 v252, 16, v98
    v_and_b32 v253, 0xffff0000, v98
    s_add_u32 m0, s72, 40960
    s_add_u32 s88, s74, 14692352
    buffer_load_dwordx4 v7, s[36:39], s88 offen sc1 lds
    v_lshlrev_b32_e64 v254, 16, v99
    v_and_b32 v255, 0xffff0000, v99
    ds_read_b128 v[96:99], v64 offset:48
    s_waitcnt lgkmcnt(3)
    v_lshlrev_b32 v3, 16, v100
    v_and_b32 v199, 0xffff0000, v100
    v_lshlrev_b32_e64 v198, 16, v101
    s_add_u32 m0, s72, 16384
    s_add_u32 s88, s73, 14696448
    buffer_load_dwordx4 v7, s[36:39], s88 offen sc1 lds
    v_and_b32 v197, 0xffff0000, v101
    v_lshlrev_b32_e64 v196, 16, v102
    v_and_b32 v195, 0xffff0000, v102
    v_lshlrev_b32_e64 v194, 16, v103
    v_and_b32 v193, 0xffff0000, v103
    ds_read_b128 v[100:103], v64 offset:64
    s_add_u32 m0, s72, 45056
    s_add_u32 s88, s74, 14696448
    buffer_load_dwordx4 v7, s[36:39], s88 offen sc1 lds
    s_waitcnt lgkmcnt(3)
    v_lshlrev_b32 v192, 16, v88
    v_and_b32 v191, 0xffff0000, v88
    v_lshlrev_b32_e64 v190, 16, v89
    v_and_b32 v189, 0xffff0000, v89
    v_lshlrev_b32_e64 v188, 16, v90
    v_and_b32 v187, 0xffff0000, v90
    s_add_u32 m0, s72, 20480
    s_add_u32 s88, s73, 14700544
    buffer_load_dwordx4 v7, s[36:39], s88 offen sc1 lds
    v_lshlrev_b32_e64 v186, 16, v91
    v_and_b32 v185, 0xffff0000, v91
    ds_read_b128 v[88:91], v64 offset:80
    s_waitcnt lgkmcnt(3)
    v_lshlrev_b32 v184, 16, v92
    v_and_b32 v183, 0xffff0000, v92
    v_lshlrev_b32_e64 v182, 16, v93
    s_add_u32 m0, s72, 49152
    s_add_u32 s88, s74, 14700544
    buffer_load_dwordx4 v7, s[36:39], s88 offen sc1 lds
    v_and_b32 v181, 0xffff0000, v93
    v_lshlrev_b32_e64 v180, 16, v94
    v_and_b32 v179, 0xffff0000, v94
    v_lshlrev_b32_e64 v178, 16, v95
    v_and_b32 v177, 0xffff0000, v95
    ds_read_b128 v[92:95], v64 offset:96
    s_add_u32 m0, s72, 24576
    s_add_u32 s88, s73, 14704640
    buffer_load_dwordx4 v7, s[36:39], s88 offen sc1 lds
    s_waitcnt lgkmcnt(3)
    v_lshlrev_b32 v176, 16, v96
    v_and_b32 v175, 0xffff0000, v96
    v_lshlrev_b32_e64 v174, 16, v97
    v_and_b32 v173, 0xffff0000, v97
    v_lshlrev_b32_e64 v172, 16, v98
    v_and_b32 v171, 0xffff0000, v98
    s_add_u32 m0, s72, 53248
    s_add_u32 s88, s74, 14704640
    buffer_load_dwordx4 v7, s[36:39], s88 offen sc1 lds
    v_lshlrev_b32_e64 v170, 16, v99
    v_and_b32 v169, 0xffff0000, v99
    s_waitcnt lgkmcnt(2)
    v_lshlrev_b32 v168, 16, v100
    v_and_b32 v167, 0xffff0000, v100
    v_lshlrev_b32_e64 v166, 16, v101
    v_and_b32 v165, 0xffff0000, v101
    v_lshlrev_b32_e64 v164, 16, v102
    v_and_b32 v163, 0xffff0000, v102
    v_lshlrev_b32_e64 v162, 16, v103
    v_and_b32 v161, 0xffff0000, v103
    s_waitcnt lgkmcnt(1)
    v_lshlrev_b32 v160, 16, v88
    v_and_b32 v159, 0xffff0000, v88
    v_lshlrev_b32_e64 v158, 16, v89
    v_and_b32 v157, 0xffff0000, v89
    v_lshlrev_b32_e64 v156, 16, v90
    v_and_b32 v155, 0xffff0000, v90
    v_lshlrev_b32_e64 v154, 16, v91
    v_and_b32 v153, 0xffff0000, v91
    s_waitcnt lgkmcnt(0)
    v_lshlrev_b32 v152, 16, v92
    v_and_b32 v151, 0xffff0000, v92
    v_lshlrev_b32_e64 v150, 16, v93
    v_and_b32 v149, 0xffff0000, v93
    v_lshlrev_b32_e64 v148, 16, v94
    v_and_b32 v147, 0xffff0000, v94
    v_lshlrev_b32_e64 v146, 16, v95
    v_and_b32 v145, 0xffff0000, v95
    v_mov_b32 v144, 0
    v_mov_b32 v2, v200
    s_mov_b64 exec, 0
    s_cmp_eq_u32 s42, 0
    s_cbranch_scc1 L_pad_9006
    s_cmp_eq_u32 s42, 1
    s_cbranch_scc1 L_pad_2931
    s_cmp_eq_u32 s42, 2
    s_cbranch_scc1 L_pad_3542
    s_branch L_pad_4147
L_ret_1:
    s_mov_b64 exec, -1
    v_lshrrev_b32 v73, 5, v1
    v_lshlrev_b32 v73, 10, v73
    v_and_b32 v74, 31, v1
    v_lshl_add_u32 v73, v74, 4, v73
    v_and_b32_e64 v74, 1, v5
    v_lshl_add_u32 v73, v74, 3, v73
    s_mul_i32 s70, s51, 28672
    s_sub_u32 s71, 28672, s70
    s_cmp_eq_u32 s40, 0
    s_cselect_b32 s71, s70, s71
    s_add_u32 s70, s70, 100352
    v_add_u32 v23, s70, v73
    v_xor_b32 v64, 8, v23
    s_add_u32 s71, s71, 100352
    v_add_u32 v71, s71, v73
    v_xor_b32 v72, 8, v71
    v_add_u32 v73, 16, v1
    v_and_b32 v73, 63, v73
    v_lshlrev_b32 v73, 2, v73
    s_waitcnt vmcnt(14)
    v_cmp_ne_u32_e64 vcc, s44, v65
    s_cbranch_vccnz ps_4
pb_5:
    s_barrier
    s_mul_i32 s9, s42, 11264
    s_min_u32 s9, s9, 31744
    s_mul_i32 s8, s45, 14336
    s_add_u32 s8, s8, s9
    s_add_u32 m0, s9, 0
    s_add_u32 s81, s8, 2899968
    buffer_load_dwordx4 v7, s[36:39], s81 offen offset:0 sc1 lds
    buffer_load_dwordx4 v7, s[36:39], s81 offen offset:1024 sc1 lds
    buffer_load_dwordx4 v7, s[36:39], s81 offen offset:2048 sc1 lds
    s_waitcnt vmcnt(15)
    ds_read_b32 v120, v66 offset:0
    ds_read_b32 v121, v66 offset:28672
    s_waitcnt vmcnt(13)
    ds_read_b32 v122, v66 offset:4096
    ds_read_b32 v123, v66 offset:32768
    s_waitcnt vmcnt(11)
    ds_read_b32 v124, v66 offset:8192
    ds_read_b32 v125, v66 offset:36864
    s_waitcnt vmcnt(9)
    ds_read_b32 v126, v66 offset:12288
    ds_read_b32 v127, v66 offset:40960
    s_waitcnt vmcnt(7)
    ds_read_b32 v128, v66 offset:16384
    ds_read_b32 v129, v66 offset:45056
    s_waitcnt vmcnt(5)
    ds_read_b32 v130, v66 offset:20480
    ds_read_b32 v131, v66 offset:49152
    s_waitcnt vmcnt(3)
    ds_read_b32 v132, v66 offset:24576
    ds_read_b32 v133, v66 offset:53248
    s_waitcnt lgkmcnt(11)
    v_bitop3_b32 v20, v120, v121, v122 bitop3:254
    s_waitcnt lgkmcnt(9)
    v_bitop3_b32 v20, v20, v123, v124 bitop3:254
    s_waitcnt lgkmcnt(7)
    v_bitop3_b32 v20, v20, v125, v126 bitop3:254
    s_waitcnt lgkmcnt(5)
    v_bitop3_b32 v20, v20, v127, v128 bitop3:254
    s_waitcnt lgkmcnt(3)
    v_bitop3_b32 v20, v20, v129, v130 bitop3:254
    s_waitcnt lgkmcnt(1)
    v_bitop3_b32 v20, v20, v131, v132 bitop3:254
    s_waitcnt lgkmcnt(0)
    v_bitop3_b32 v20, v20, v133, -2 bitop3:254
    v_cmp_eq_u32_e64 vcc, -1, v20
    s_cbranch_vccnz cs_6
cb_7:
    s_barrier
    ds_read_b64_tr_b16 v[88:89], v71 offset:0
    ds_read_b64_tr_b16 v[90:91], v71 offset:512
    ds_read_b64_tr_b16 v[92:93], v71 offset:2048
    ds_read_b64_tr_b16 v[94:95], v71 offset:2560
    ds_read_b64_tr_b16 v[96:97], v23 offset:0
    ds_read_b64_tr_b16 v[98:99], v23 offset:512
    ds_read_b64_tr_b16 v[100:101], v23 offset:2048
    ds_read_b64_tr_b16 v[102:103], v23 offset:2560
    ds_read_b64_tr_b16 v[104:105], v72 offset:0
    ds_read_b64_tr_b16 v[106:107], v72 offset:512
    ds_read_b64_tr_b16 v[108:109], v72 offset:2048
    ds_read_b64_tr_b16 v[110:111], v72 offset:2560
    ds_read_b64_tr_b16 v[112:113], v64 offset:0
    ds_read_b64_tr_b16 v[114:115], v64 offset:512
    s_add_u32 m0, s9, 3072
    s_add_u32 s81, s8, 2903040
    buffer_load_dwordx4 v7, s[36:39], s81 offen offset:0 sc1 lds
    ds_read_b64_tr_b16 v[116:117], v64 offset:2048
    ds_read_b64_tr_b16 v[118:119], v64 offset:2560
    s_waitcnt lgkmcnt(14)
    v_mfma_f32_16x16x32_bf16 v[144:147], v[88:91], v[56:59], v[144:147]
    ds_read_b64_tr_b16 v[88:89], v71 offset:4096
    ds_read_b64_tr_b16 v[90:91], v71 offset:4608
    s_waitcnt lgkmcnt(14)
    v_mfma_f32_16x16x32_bf16 v[144:147], v[92:95], v[60:63], v[144:147]
    ds_read_b64_tr_b16 v[92:93], v71 offset:6144
    ds_read_b64_tr_b16 v[94:95], v71 offset:6656
    s_waitcnt lgkmcnt(12)
    v_mfma_f32_16x16x32_bf16 v[200:203], v[96:99], v[48:51], v[200:203]
    ds_read_b64_tr_b16 v[96:97], v23 offset:4096
    ds_read_b64_tr_b16 v[98:99], v23 offset:4608
    buffer_load_dwordx4 v7, s[36:39], s81 offen offset:1024 sc1 lds
    v_mfma_f32_16x16x32_bf16 v[200:203], v[100:103], v[52:55], v[200:203]
    ds_read_b64_tr_b16 v[100:101], v23 offset:6144
    ds_read_b64_tr_b16 v[102:103], v23 offset:6656
    s_waitcnt lgkmcnt(12)
    v_mfma_f32_16x16x32_bf16 v[148:151], v[104:107], v[56:59], v[148:151]
    ds_read_b64_tr_b16 v[104:105], v72 offset:4096
    ds_read_b64_tr_b16 v[106:107], v72 offset:4608
    v_mfma_f32_16x16x32_bf16 v[148:151], v[108:111], v[60:63], v[148:151]
    ds_read_b64_tr_b16 v[108:109], v72 offset:6144
    ds_read_b64_tr_b16 v[110:111], v72 offset:6656
    s_waitcnt lgkmcnt(12)
    v_and_b32 v69, 31, v67
    v_mul_u32_u24 v69, 0x2080, v69
    v_and_b32 v69, 0x3ec00, v69
    v_xor_b32 v69, v69, v68
    v_add_u32 v67, v70, v67
    buffer_store_dwordx4 a[0:3], v69, s[36:39], s76 offen sc1
    v_mfma_f32_16x16x32_bf16 v[204:207], v[112:115], v[48:51], v[204:207]
    ds_read_b64_tr_b16 v[112:113], v64 offset:4096
    ds_read_b64_tr_b16 v[114:115], v64 offset:4608
    v_mfma_f32_16x16x32_bf16 v[204:207], v[116:119], v[52:55], v[204:207]
    ds_read_b64_tr_b16 v[116:117], v64 offset:6144
    ds_read_b64_tr_b16 v[118:119], v64 offset:6656
    s_waitcnt lgkmcnt(12)
    v_mfma_f32_16x16x32_bf16 v[152:155], v[88:91], v[56:59], v[152:155]
    ds_bpermute_b32 v74, v73, v144
    ds_read_b64_tr_b16 v[88:89], v71 offset:8192
    ds_read_b64_tr_b16 v[90:91], v71 offset:8704
    v_mfma_f32_16x16x32_bf16 v[152:155], v[92:95], v[60:63], v[152:155]
    buffer_load_dwordx4 v7, s[36:39], s81 offen offset:2048 sc1 lds
    ds_read_b64_tr_b16 v[92:93], v71 offset:10240
    ds_read_b64_tr_b16 v[94:95], v71 offset:10752
    s_waitcnt lgkmcnt(13)
    v_mfma_f32_16x16x32_bf16 v[208:211], v[96:99], v[48:51], v[208:211]
    ds_read_b64_tr_b16 v[96:97], v23 offset:8192
    ds_read_b64_tr_b16 v[98:99], v23 offset:8704
    v_mfma_f32_16x16x32_bf16 v[208:211], v[100:103], v[52:55], v[208:211]
    ds_read_b64_tr_b16 v[100:101], v23 offset:10240
    ds_read_b64_tr_b16 v[102:103], v23 offset:10752
    s_waitcnt lgkmcnt(13)
    v_mfma_f32_16x16x32_bf16 v[156:159], v[104:107], v[56:59], v[156:159]
    buffer_load_dwordx4 v7, s[36:39], s81 offen offset:3072 sc1 lds
    ds_read_b64_tr_b16 v[104:105], v72 offset:8192
    ds_read_b64_tr_b16 v[106:107], v72 offset:8704
    v_mfma_f32_16x16x32_bf16 v[156:159], v[108:111], v[60:63], v[156:159]
    ds_read_b64_tr_b16 v[108:109], v72 offset:10240
    ds_read_b64_tr_b16 v[110:111], v72 offset:10752
    s_waitcnt lgkmcnt(13)
    v_mfma_f32_16x16x32_bf16 v[212:215], v[112:115], v[48:51], v[212:215]
    ds_read_b64_tr_b16 v[112:113], v64 offset:8192
    ds_read_b64_tr_b16 v[114:115], v64 offset:8704
    v_mfma_f32_16x16x32_bf16 v[212:215], v[116:119], v[52:55], v[212:215]
    ds_read_b64_tr_b16 v[116:117], v64 offset:10240
    ds_read_b64_tr_b16 v[118:119], v64 offset:10752
    v_and_b32_e64 v69, 31, v67
    v_mul_u32_u24 v69, 0x2080, v69
    v_and_b32 v69, 0x3ec00, v69
    v_xor_b32 v69, v69, v68
    v_add_u32 v67, v70, v67
    buffer_store_dwordx4 a[4:7], v69, s[36:39], s76 offen sc1
    s_waitcnt lgkmcnt(12)
    v_mfma_f32_16x16x32_bf16 v[160:163], v[88:91], v[56:59], v[160:163]
    ds_read_b64_tr_b16 v[88:89], v71 offset:12288
    ds_read_b64_tr_b16 v[90:91], v71 offset:12800
    v_mfma_f32_16x16x32_bf16 v[160:163], v[92:95], v[60:63], v[160:163]
    ds_read_b64_tr_b16 v[92:93], v71 offset:14336
    ds_read_b64_tr_b16 v[94:95], v71 offset:14848
    s_waitcnt lgkmcnt(12)
    v_mfma_f32_16x16x32_bf16 v[216:219], v[96:99], v[48:51], v[216:219]
    ds_read_b64_tr_b16 v[96:97], v23 offset:12288
    ds_read_b64_tr_b16 v[98:99], v23 offset:12800
    s_add_u32 m0, s9, 7168
    s_add_u32 s81, s8, 2907136
    buffer_load_dwordx4 v7, s[36:39], s81 offen offset:0 sc1 lds
    v_mfma_f32_16x16x32_bf16 v[216:219], v[100:103], v[52:55], v[216:219]
    ds_read_b64_tr_b16 v[100:101], v23 offset:14336
    ds_read_b64_tr_b16 v[102:103], v23 offset:14848
    s_waitcnt lgkmcnt(12)
    v_mfma_f32_16x16x32_bf16 v[164:167], v[104:107], v[56:59], v[164:167]
    v_add_f32 v144, v74, v3
    v_cndmask_b32 v200, v200, v2, s[66:67]
    ds_read_b64_tr_b16 v[104:105], v72 offset:12288
    ds_read_b64_tr_b16 v[106:107], v72 offset:12800
    v_mfma_f32_16x16x32_bf16 v[164:167], v[108:111], v[60:63], v[164:167]
    ds_read_b64_tr_b16 v[108:109], v72 offset:14336
    ds_read_b64_tr_b16 v[110:111], v72 offset:14848
    buffer_load_dwordx4 v7, s[36:39], s81 offen offset:1024 sc1 lds
    s_waitcnt lgkmcnt(12)
    v_mfma_f32_16x16x32_bf16 v[220:223], v[112:115], v[48:51], v[220:223]
    ds_read_b64_tr_b16 v[112:113], v64 offset:12288
    ds_read_b64_tr_b16 v[114:115], v64 offset:12800
    v_mfma_f32_16x16x32_bf16 v[220:223], v[116:119], v[52:55], v[220:223]
    ds_read_b64_tr_b16 v[116:117], v64 offset:14336
    ds_read_b64_tr_b16 v[118:119], v64 offset:14848
    s_waitcnt lgkmcnt(12)
    v_mfma_f32_16x16x32_bf16 v[168:171], v[88:91], v[56:59], v[168:171]
    ds_read_b64_tr_b16 v[88:89], v71 offset:16384
    ds_read_b64_tr_b16 v[90:91], v71 offset:16896
    v_and_b32_e64 v69, 31, v67
    v_mul_u32_u24 v69, 0x2080, v69
    v_and_b32 v69, 0x3ec00, v69
    v_xor_b32 v69, v69, v68
    v_add_u32 v67, v70, v67
    buffer_store_dwordx4 a[8:11], v69, s[36:39], s76 offen sc1
    v_mfma_f32_16x16x32_bf16 v[168:171], v[92:95], v[60:63], v[168:171]
    ds_read_b64_tr_b16 v[92:93], v71 offset:18432
    ds_read_b64_tr_b16 v[94:95], v71 offset:18944
    s_waitcnt lgkmcnt(12)
    v_mfma_f32_16x16x32_bf16 v[224:227], v[96:99], v[48:51], v[224:227]
    ds_read_b64_tr_b16 v[96:97], v23 offset:16384
    ds_read_b64_tr_b16 v[98:99], v23 offset:16896
    v_mfma_f32_16x16x32_bf16 v[224:227], v[100:103], v[52:55], v[224:227]
    ds_read_b64_tr_b16 v[100:101], v23 offset:18432
    ds_read_b64_tr_b16 v[102:103], v23 offset:18944
    s_waitcnt lgkmcnt(12)
    v_mfma_f32_16x16x32_bf16 v[172:175], v[104:107], v[56:59], v[172:175]
    buffer_load_dwordx4 v7, s[36:39], s81 offen offset:2048 sc1 lds
    ds_read_b64_tr_b16 v[104:105], v72 offset:16384
    ds_read_b64_tr_b16 v[106:107], v72 offset:16896
    v_mfma_f32_16x16x32_bf16 v[172:175], v[108:111], v[60:63], v[172:175]
    ds_read_b64_tr_b16 v[108:109], v72 offset:18432
    ds_read_b64_tr_b16 v[110:111], v72 offset:18944
    s_waitcnt lgkmcnt(12)
    v_mfma_f32_16x16x32_bf16 v[228:231], v[112:115], v[48:51], v[228:231]
    ds_read_b64_tr_b16 v[112:113], v64 offset:16384
    ds_read_b64_tr_b16 v[114:115], v64 offset:16896
    v_mfma_f32_16x16x32_bf16 v[228:231], v[116:119], v[52:55], v[228:231]
    ds_read_b64_tr_b16 v[116:117], v64 offset:18432
    buffer_load_dwordx4 v7, s[36:39], s81 offen offset:3072 sc1 lds
    ds_read_b64_tr_b16 v[118:119], v64 offset:18944
    s_waitcnt lgkmcnt(12)
    v_mfma_f32_16x16x32_bf16 v[176:179], v[88:91], v[56:59], v[176:179]
    ds_read_b64_tr_b16 v[88:89], v71 offset:20480
    ds_read_b64_tr_b16 v[90:91], v71 offset:20992
    v_mfma_f32_16x16x32_bf16 v[176:179], v[92:95], v[60:63], v[176:179]
    ds_read_b64_tr_b16 v[92:93], v71 offset:22528
    ds_read_b64_tr_b16 v[94:95], v71 offset:23040
    s_waitcnt lgkmcnt(12)
    v_mfma_f32_16x16x32_bf16 v[232:235], v[96:99], v[48:51], v[232:235]
    ds_read_b64_tr_b16 v[96:97], v23 offset:20480
    ds_read_b64_tr_b16 v[98:99], v23 offset:20992
    v_and_b32 v69, 31, v67
    v_mul_u32_u24 v69, 0x2080, v69
    v_and_b32 v69, 0x3ec00, v69
    v_xor_b32 v69, v69, v68
    v_add_u32 v67, v70, v67
    buffer_store_dwordx4 a[12:15], v69, s[36:39], s76 offen sc1
    v_mfma_f32_16x16x32_bf16 v[232:235], v[100:103], v[52:55], v[232:235]
    ds_read_b64_tr_b16 v[100:101], v23 offset:22528
    ds_read_b64_tr_b16 v[102:103], v23 offset:23040
    s_waitcnt lgkmcnt(12)
    v_mfma_f32_16x16x32_bf16 v[180:183], v[104:107], v[56:59], v[180:183]
    ds_read_b64_tr_b16 v[104:105], v72 offset:20480
    ds_read_b64_tr_b16 v[106:107], v72 offset:20992
    v_mfma_f32_16x16x32_bf16 v[180:183], v[108:111], v[60:63], v[180:183]
    ds_read_b64_tr_b16 v[108:109], v72 offset:22528
    ds_read_b64_tr_b16 v[110:111], v72 offset:23040
    s_waitcnt lgkmcnt(12)
    s_mul_i32 s11, s42, 11264
    s_min_u32 s11, s11, 31744
    s_mul_i32 s10, s45, 14336
    s_add_u32 s10, s10, s11
    s_add_u32 m0, s11, 43008
    s_add_u32 s81, s10, 2942976
    buffer_load_dwordx4 v7, s[36:39], s81 offen offset:0 sc1 lds
    v_mfma_f32_16x16x32_bf16 v[236:239], v[112:115], v[48:51], v[236:239]
    ds_read_b64_tr_b16 v[112:113], v64 offset:20480
    ds_read_b64_tr_b16 v[114:115], v64 offset:20992
    v_mfma_f32_16x16x32_bf16 v[236:239], v[116:119], v[52:55], v[236:239]
    ds_read_b64_tr_b16 v[116:117], v64 offset:22528
    ds_read_b64_tr_b16 v[118:119], v64 offset:23040
    s_waitcnt lgkmcnt(12)
    v_mfma_f32_16x16x32_bf16 v[184:187], v[88:91], v[56:59], v[184:187]
    ds_read_b64_tr_b16 v[88:89], v71 offset:24576
    ds_read_b64_tr_b16 v[90:91], v71 offset:25088
    v_mfma_f32_16x16x32_bf16 v[184:187], v[92:95], v[60:63], v[184:187]
    ds_read_b64_tr_b16 v[92:93], v71 offset:26624
    buffer_load_dwordx4 v7, s[36:39], s81 offen offset:1024 sc1 lds
    ds_read_b64_tr_b16 v[94:95], v71 offset:27136
    s_waitcnt lgkmcnt(12)
    v_mfma_f32_16x16x32_bf16 v[240:243], v[96:99], v[48:51], v[240:243]
    ds_read_b64_tr_b16 v[96:97], v23 offset:24576
    ds_read_b64_tr_b16 v[98:99], v23 offset:25088
    v_mfma_f32_16x16x32_bf16 v[240:243], v[100:103], v[52:55], v[240:243]
    ds_read_b64_tr_b16 v[100:101], v23 offset:26624
    ds_read_b64_tr_b16 v[102:103], v23 offset:27136
    s_waitcnt lgkmcnt(12)
    v_mfma_f32_16x16x32_bf16 v[188:191], v[104:107], v[56:59], v[188:191]
    ds_read_b64_tr_b16 v[104:105], v72 offset:24576
    v_and_b32_e64 v69, 31, v67
    v_mul_u32_u24 v69, 0x2080, v69
    v_and_b32 v69, 0x3ec00, v69
    v_xor_b32 v69, v69, v68
    v_add_u32 v67, v70, v67
    buffer_store_dwordx4 a[16:19], v69, s[36:39], s76 offen sc1
    ds_read_b64_tr_b16 v[106:107], v72 offset:25088
    v_mfma_f32_16x16x32_bf16 v[188:191], v[108:111], v[60:63], v[188:191]
    ds_read_b64_tr_b16 v[108:109], v72 offset:26624
    ds_read_b64_tr_b16 v[110:111], v72 offset:27136
    s_waitcnt lgkmcnt(12)
    v_mfma_f32_16x16x32_bf16 v[244:247], v[112:115], v[48:51], v[244:247]
    ds_read_b64_tr_b16 v[112:113], v64 offset:24576
    ds_read_b64_tr_b16 v[114:115], v64 offset:25088
    v_mfma_f32_16x16x32_bf16 v[244:247], v[116:119], v[52:55], v[244:247]
    ds_read_b64_tr_b16 v[116:117], v64 offset:26624
    ds_read_b64_tr_b16 v[118:119], v64 offset:27136
    s_waitcnt lgkmcnt(12)
    buffer_load_dwordx4 v7, s[36:39], s81 offen offset:2048 sc1 lds
    v_mfma_f32_16x16x32_bf16 v[192:195], v[88:91], v[56:59], v[192:195]
    v_mfma_f32_16x16x32_bf16 v[192:195], v[92:95], v[60:63], v[192:195]
    s_waitcnt lgkmcnt(8)
    v_mfma_f32_16x16x32_bf16 v[248:251], v[96:99], v[48:51], v[248:251]
    v_mfma_f32_16x16x32_bf16 v[248:251], v[100:103], v[52:55], v[248:251]
    s_waitcnt lgkmcnt(4)
L_pad_1787:
    s_cbranch_execz L_ret_0
    v_mfma_f32_16x16x32_bf16 v[196:199], v[104:107], v[56:59], v[196:199]
    v_mfma_f32_16x16x32_bf16 v[196:199], v[108:111], v[60:63], v[196:199]
    s_waitcnt lgkmcnt(0)
    v_mfma_f32_16x16x32_bf16 v[252:255], v[112:115], v[48:51], v[252:255]
    v_mfma_f32_16x16x32_bf16 v[252:255], v[116:119], v[52:55], v[252:255]
    s_barrier
    s_or_b32 s70, s2, s42
    s_cbranch_scc1 nn_8
    s_nop 0
    buffer_store_dword v10, v21, s[36:39], 0 offen offset:0 sc1
nn_8:
    s_add_u32 m0, s11, 46080
    s_add_u32 s81, s10, 2946048
    buffer_load_dwordx4 v7, s[36:39], s81 offen offset:0 sc1 lds
    v_pk_add_f32 v[72:73], v[200:201], v[204:205]
    v_pk_mul_f32 v[76:77], v[200:201], v[200:201]
    v_pk_add_f32 v[74:75], v[202:203], v[206:207]
    v_pk_mul_f32 v[78:79], v[202:203], v[202:203]
    v_pk_fma_f32 v[76:77], v[204:205], v[204:205], v[76:77]
    v_pk_fma_f32 v[78:79], v[206:207], v[206:207], v[78:79]
    v_pk_add_f32 v[72:73], v[72:73], v[208:209]
    v_pk_fma_f32 v[76:77], v[208:209], v[208:209], v[76:77]
    v_pk_add_f32 v[74:75], v[74:75], v[210:211]
    v_pk_fma_f32 v[78:79], v[210:211], v[210:211], v[78:79]
    v_pk_add_f32 v[72:73], v[72:73], v[212:213]
    v_pk_fma_f32 v[76:77], v[212:213], v[212:213], v[76:77]
    v_pk_add_f32 v[74:75], v[74:75], v[214:215]
    v_pk_fma_f32 v[78:79], v[214:215], v[214:215], v[78:79]
    v_pk_add_f32 v[72:73], v[72:73], v[216:217]
    v_pk_fma_f32 v[76:77], v[216:217], v[216:217], v[76:77]
    v_and_b32_e64 v69, 31, v67
    v_mul_u32_u24 v69, 0x2080, v69
    v_and_b32 v69, 0x3ec00, v69
    v_xor_b32 v69, v69, v68
    v_add_u32 v67, v70, v67
    buffer_store_dwordx4 a[20:23], v69, s[36:39], s76 offen sc1
    v_pk_add_f32 v[74:75], v[74:75], v[218:219]
    v_pk_fma_f32 v[78:79], v[218:219], v[218:219], v[78:79]
    v_pk_add_f32 v[72:73], v[72:73], v[220:221]
    v_pk_fma_f32 v[76:77], v[220:221], v[220:221], v[76:77]
    v_pk_add_f32 v[74:75], v[74:75], v[222:223]
    v_pk_fma_f32 v[78:79], v[222:223], v[222:223], v[78:79]
    v_pk_add_f32 v[72:73], v[72:73], v[224:225]
    v_pk_fma_f32 v[76:77], v[224:225], v[224:225], v[76:77]
    v_pk_add_f32 v[74:75], v[74:75], v[226:227]
    v_pk_fma_f32 v[78:79], v[226:227], v[226:227], v[78:79]
    v_pk_add_f32 v[72:73], v[72:73], v[228:229]
    v_pk_fma_f32 v[76:77], v[228:229], v[228:229], v[76:77]
    v_pk_add_f32 v[74:75], v[74:75], v[230:231]
    v_pk_fma_f32 v[78:79], v[230:231], v[230:231], v[78:79]
    v_pk_add_f32 v[72:73], v[72:73], v[232:233]
    v_pk_fma_f32 v[76:77], v[232:233], v[232:233], v[76:77]
    buffer_load_dwordx4 v7, s[36:39], s81 offen offset:1024 sc1 lds
    v_pk_add_f32 v[74:75], v[74:75], v[234:235]
    v_pk_fma_f32 v[78:79], v[234:235], v[234:235], v[78:79]
    v_pk_add_f32 v[72:73], v[72:73], v[236:237]
    v_pk_fma_f32 v[76:77], v[236:237], v[236:237], v[76:77]
    v_pk_add_f32 v[74:75], v[74:75], v[238:239]
    v_pk_fma_f32 v[78:79], v[238:239], v[238:239], v[78:79]
    v_pk_add_f32 v[72:73], v[72:73], v[240:241]
    v_pk_fma_f32 v[76:77], v[240:241], v[240:241], v[76:77]
    v_pk_add_f32 v[74:75], v[74:75], v[242:243]
    v_pk_fma_f32 v[78:79], v[242:243], v[242:243], v[78:79]
    v_pk_add_f32 v[72:73], v[72:73], v[244:245]
    v_pk_fma_f32 v[76:77], v[244:245], v[244:245], v[76:77]
    v_pk_add_f32 v[74:75], v[74:75], v[246:247]
    v_pk_fma_f32 v[78:79], v[246:247], v[246:247], v[78:79]
    v_pk_add_f32 v[72:73], v[72:73], v[248:249]
    v_pk_fma_f32 v[76:77], v[248:249], v[248:249], v[76:77]
    buffer_load_dwordx4 v7, s[36:39], s81 offen offset:2048 sc1 lds
    v_pk_add_f32 v[74:75], v[74:75], v[250:251]
    v_pk_fma_f32 v[78:79], v[250:251], v[250:251], v[78:79]
    v_pk_add_f32 v[72:73], v[72:73], v[252:253]
    v_pk_fma_f32 v[76:77], v[252:253], v[252:253], v[76:77]
    v_pk_add_f32 v[74:75], v[74:75], v[254:255]
    v_pk_fma_f32 v[78:79], v[254:255], v[254:255], v[78:79]
    v_pk_add_f32 v[72:73], v[72:73], v[144:145]
    v_pk_fma_f32 v[76:77], v[144:145], v[144:145], v[76:77]
    v_pk_add_f32 v[74:75], v[74:75], v[146:147]
    v_pk_fma_f32 v[78:79], v[146:147], v[146:147], v[78:79]
    v_pk_add_f32 v[72:73], v[72:73], v[148:149]
    v_pk_fma_f32 v[76:77], v[148:149], v[148:149], v[76:77]
    v_pk_add_f32 v[74:75], v[74:75], v[150:151]
    v_pk_fma_f32 v[78:79], v[150:151], v[150:151], v[78:79]
    v_pk_add_f32 v[72:73], v[72:73], v[152:153]
    v_and_b32_e64 v69, 31, v67
    v_mul_u32_u24 v69, 0x2080, v69
    v_and_b32 v69, 0x3ec00, v69
    v_xor_b32 v69, v69, v68
    v_add_u32 v67, v70, v67
    buffer_store_dwordx4 a[24:27], v69, s[36:39], s76 offen sc1
    v_pk_fma_f32 v[76:77], v[152:153], v[152:153], v[76:77]
    v_pk_add_f32 v[74:75], v[74:75], v[154:155]
    v_pk_fma_f32 v[78:79], v[154:155], v[154:155], v[78:79]
    v_pk_add_f32 v[72:73], v[72:73], v[156:157]
    v_pk_fma_f32 v[76:77], v[156:157], v[156:157], v[76:77]
    v_pk_add_f32 v[74:75], v[74:75], v[158:159]
    v_pk_fma_f32 v[78:79], v[158:159], v[158:159], v[78:79]
    v_pk_add_f32 v[72:73], v[72:73], v[160:161]
    v_pk_fma_f32 v[76:77], v[160:161], v[160:161], v[76:77]
    v_pk_add_f32 v[74:75], v[74:75], v[162:163]
    v_pk_fma_f32 v[78:79], v[162:163], v[162:163], v[78:79]
    v_pk_add_f32 v[72:73], v[72:73], v[164:165]
    v_pk_fma_f32 v[76:77], v[164:165], v[164:165], v[76:77]
    v_pk_add_f32 v[74:75], v[74:75], v[166:167]
    v_pk_fma_f32 v[78:79], v[166:167], v[166:167], v[78:79]
    v_pk_add_f32 v[72:73], v[72:73], v[168:169]
    buffer_load_dwordx4 v7, s[36:39], s81 offen offset:3072 sc1 lds
    v_pk_fma_f32 v[76:77], v[168:169], v[168:169], v[76:77]
    v_pk_add_f32 v[74:75], v[74:75], v[170:171]
    v_pk_fma_f32 v[78:79], v[170:171], v[170:171], v[78:79]
    v_pk_add_f32 v[72:73], v[72:73], v[172:173]
    v_pk_fma_f32 v[76:77], v[172:173], v[172:173], v[76:77]
    v_pk_add_f32 v[74:75], v[74:75], v[174:175]
    v_pk_fma_f32 v[78:79], v[174:175], v[174:175], v[78:79]
    v_pk_add_f32 v[72:73], v[72:73], v[176:177]
    v_pk_fma_f32 v[76:77], v[176:177], v[176:177], v[76:77]
    v_pk_add_f32 v[74:75], v[74:75], v[178:179]
    v_pk_fma_f32 v[78:79], v[178:179], v[178:179], v[78:79]
    v_pk_add_f32 v[72:73], v[72:73], v[180:181]
    v_pk_fma_f32 v[76:77], v[180:181], v[180:181], v[76:77]
    v_pk_add_f32 v[74:75], v[74:75], v[182:183]
    v_pk_fma_f32 v[78:79], v[182:183], v[182:183], v[78:79]
    v_pk_add_f32 v[72:73], v[72:73], v[184:185]
    s_add_u32 m0, s11, 50176
    s_add_u32 s81, s10, 2950144
    buffer_load_dwordx4 v7, s[36:39], s81 offen offset:0 sc1 lds
    v_pk_fma_f32 v[76:77], v[184:185], v[184:185], v[76:77]
    v_pk_add_f32 v[74:75], v[74:75], v[186:187]
    v_pk_fma_f32 v[78:79], v[186:187], v[186:187], v[78:79]
    v_pk_add_f32 v[72:73], v[72:73], v[188:189]
    v_pk_fma_f32 v[76:77], v[188:189], v[188:189], v[76:77]
    v_pk_add_f32 v[74:75], v[74:75], v[190:191]
    v_pk_fma_f32 v[78:79], v[190:191], v[190:191], v[78:79]
    v_pk_add_f32 v[72:73], v[72:73], v[192:193]
    v_pk_fma_f32 v[76:77], v[192:193], v[192:193], v[76:77]
    v_pk_add_f32 v[74:75], v[74:75], v[194:195]
    v_pk_fma_f32 v[78:79], v[194:195], v[194:195], v[78:79]
    v_pk_add_f32 v[72:73], v[72:73], v[196:197]
    v_pk_fma_f32 v[76:77], v[196:197], v[196:197], v[76:77]
    v_pk_add_f32 v[74:75], v[74:75], v[198:199]
    v_pk_fma_f32 v[78:79], v[198:199], v[198:199], v[78:79]
    v_pk_add_f32 v[72:73], v[72:73], v[74:75]
    v_pk_add_f32 v[76:77], v[76:77], v[78:79]
    v_add_f32 v72, v72, v73
    v_add_f32 v76, v76, v77
    v_mov_b32 v2, v72
    v_mov_b32 v3, v76
    s_nop 0
    v_permlane32_swap_b32 v72, v2
    v_permlane32_swap_b32 v76, v3
    v_add_f32 v72, v72, v2
    v_add_f32 v76, v76, v3
    v_mov_b32 v2, v72
    v_mov_b32 v3, v76
    s_nop 0
    v_permlane16_swap_b32 v72, v2
    v_permlane16_swap_b32 v76, v3
    v_add_f32 v72, v72, v2
    v_add_f32 v76, v76, v3
    v_mul_f32 v72, 0x3b124925, v72
    v_mul_f32 v76, 0x3b124925, v76
    v_fma_f32 v76, -v72, v72, v76
    v_max_f32 v76, 0, v76
    v_add_f32 v76, s53, v76
    v_rsq_f32 v74, v76
    s_nop 0
    v_mul_f32_e64 v75, -v72, v74
    v_mov_b32 v3, v72
    v_mul_f32 v2, v76, v74
    v_and_b32_e64 v69, 31, v67
    v_mul_u32_u24 v69, 0x2080, v69
    v_and_b32 v69, 0x3ec00, v69
    v_xor_b32 v69, v69, v68
    v_add_u32 v67, v70, v67
    buffer_store_dwordx4 a[28:31], v69, s[36:39], s76 offen sc1
    v_pk_fma_f32 v[200:201], v[200:201], v[74:75], v[74:75] op_sel:[0,0,1] op_sel_hi:[1,0,1]
    v_pk_fma_f32 v[202:203], v[202:203], v[74:75], v[74:75] op_sel:[0,0,1] op_sel_hi:[1,0,1]
    v_pk_fma_f32 v[204:205], v[204:205], v[74:75], v[74:75] op_sel:[0,0,1] op_sel_hi:[1,0,1]
    v_pk_fma_f32 v[206:207], v[206:207], v[74:75], v[74:75] op_sel:[0,0,1] op_sel_hi:[1,0,1]
    v_pk_fma_f32 v[208:209], v[208:209], v[74:75], v[74:75] op_sel:[0,0,1] op_sel_hi:[1,0,1]
    v_pk_fma_f32 v[210:211], v[210:211], v[74:75], v[74:75] op_sel:[0,0,1] op_sel_hi:[1,0,1]
    v_pk_fma_f32 v[212:213], v[212:213], v[74:75], v[74:75] op_sel:[0,0,1] op_sel_hi:[1,0,1]
    v_pk_fma_f32 v[214:215], v[214:215], v[74:75], v[74:75] op_sel:[0,0,1] op_sel_hi:[1,0,1]
    v_pk_fma_f32 v[216:217], v[216:217], v[74:75], v[74:75] op_sel:[0,0,1] op_sel_hi:[1,0,1]
    v_pk_fma_f32 v[218:219], v[218:219], v[74:75], v[74:75] op_sel:[0,0,1] op_sel_hi:[1,0,1]
    v_pk_fma_f32 v[220:221], v[220:221], v[74:75], v[74:75] op_sel:[0,0,1] op_sel_hi:[1,0,1]
    v_pk_fma_f32 v[222:223], v[222:223], v[74:75], v[74:75] op_sel:[0,0,1] op_sel_hi:[1,0,1]
    v_pk_fma_f32 v[224:225], v[224:225], v[74:75], v[74:75] op_sel:[0,0,1] op_sel_hi:[1,0,1]
    v_pk_fma_f32 v[226:227], v[226:227], v[74:75], v[74:75] op_sel:[0,0,1] op_sel_hi:[1,0,1]
    v_pk_fma_f32 v[228:229], v[228:229], v[74:75], v[74:75] op_sel:[0,0,1] op_sel_hi:[1,0,1]
    v_pk_fma_f32 v[230:231], v[230:231], v[74:75], v[74:75] op_sel:[0,0,1] op_sel_hi:[1,0,1]
    v_pk_fma_f32 v[232:233], v[232:233], v[74:75], v[74:75] op_sel:[0,0,1] op_sel_hi:[1,0,1]
    s_add_u32 m0, s11, 51200
    s_add_u32 s81, s10, 2951168
    buffer_load_dwordx4 v7, s[36:39], s81 offen offset:0 sc1 lds
    v_pk_fma_f32 v[234:235], v[234:235], v[74:75], v[74:75] op_sel:[0,0,1] op_sel_hi:[1,0,1]
    v_pk_fma_f32 v[236:237], v[236:237], v[74:75], v[74:75] op_sel:[0,0,1] op_sel_hi:[1,0,1]
    v_pk_fma_f32 v[238:239], v[238:239], v[74:75], v[74:75] op_sel:[0,0,1] op_sel_hi:[1,0,1]
    v_pk_fma_f32 v[240:241], v[240:241], v[74:75], v[74:75] op_sel:[0,0,1] op_sel_hi:[1,0,1]
    v_pk_fma_f32 v[242:243], v[242:243], v[74:75], v[74:75] op_sel:[0,0,1] op_sel_hi:[1,0,1]
    v_pk_fma_f32 v[244:245], v[244:245], v[74:75], v[74:75] op_sel:[0,0,1] op_sel_hi:[1,0,1]
    v_pk_fma_f32 v[246:247], v[246:247], v[74:75], v[74:75] op_sel:[0,0,1] op_sel_hi:[1,0,1]
    v_pk_fma_f32 v[248:249], v[248:249], v[74:75], v[74:75] op_sel:[0,0,1] op_sel_hi:[1,0,1]
    v_pk_fma_f32 v[250:251], v[250:251], v[74:75], v[74:75] op_sel:[0,0,1] op_sel_hi:[1,0,1]
    v_pk_fma_f32 v[252:253], v[252:253], v[74:75], v[74:75] op_sel:[0,0,1] op_sel_hi:[1,0,1]
    v_pk_fma_f32 v[254:255], v[254:255], v[74:75], v[74:75] op_sel:[0,0,1] op_sel_hi:[1,0,1]
    v_cvt_pk_bf16_f32 v88, v200, v201
    v_cvt_pk_bf16_f32 v89, v202, v203
    v_cvt_pk_bf16_f32 v90, v204, v205
    v_cvt_pk_bf16_f32 v91, v206, v207
    v_cvt_pk_bf16_f32 v92, v208, v209
    buffer_load_dwordx4 v7, s[36:39], s81 offen offset:1024 sc1 lds
    v_cvt_pk_bf16_f32 v93, v210, v211
    v_cvt_pk_bf16_f32 v94, v212, v213
    v_cvt_pk_bf16_f32 v95, v214, v215
    v_cvt_pk_bf16_f32 v96, v216, v217
    v_cvt_pk_bf16_f32 v97, v218, v219
    v_cvt_pk_bf16_f32 v98, v220, v221
    v_cvt_pk_bf16_f32 v99, v222, v223
    v_cvt_pk_bf16_f32 v100, v224, v225
    v_cvt_pk_bf16_f32 v101, v226, v227
    v_cvt_pk_bf16_f32 v102, v228, v229
    v_cvt_pk_bf16_f32 v103, v230, v231
    v_cvt_pk_bf16_f32 v104, v232, v233
    v_cvt_pk_bf16_f32 v105, v234, v235
    v_cvt_pk_bf16_f32 v106, v236, v237
    v_cvt_pk_bf16_f32 v107, v238, v239
    v_cvt_pk_bf16_f32 v108, v240, v241
    s_add_u32 s78, s83, 20971520
    buffer_store_dwordx4 v[16:19], v15, s[36:39], s78 offen sc1
    v_cvt_pk_bf16_f32 v109, v242, v243
    v_cvt_pk_bf16_f32 v110, v244, v245
    v_cvt_pk_bf16_f32 v111, v246, v247
    v_cvt_pk_bf16_f32 v112, v248, v249
    v_cvt_pk_bf16_f32 v113, v250, v251
    v_cvt_pk_bf16_f32 v114, v252, v253
    v_cvt_pk_bf16_f32 v115, v254, v255
    v_pk_fma_f32 v[144:145], v[144:145], v[74:75], v[74:75] op_sel:[0,0,1] op_sel_hi:[1,0,1]
    v_pk_fma_f32 v[146:147], v[146:147], v[74:75], v[74:75] op_sel:[0,0,1] op_sel_hi:[1,0,1]
    v_pk_fma_f32 v[148:149], v[148:149], v[74:75], v[74:75] op_sel:[0,0,1] op_sel_hi:[1,0,1]
    v_pk_fma_f32 v[150:151], v[150:151], v[74:75], v[74:75] op_sel:[0,0,1] op_sel_hi:[1,0,1]
    v_pk_fma_f32 v[152:153], v[152:153], v[74:75], v[74:75] op_sel:[0,0,1] op_sel_hi:[1,0,1]
    v_pk_fma_f32 v[154:155], v[154:155], v[74:75], v[74:75] op_sel:[0,0,1] op_sel_hi:[1,0,1]
    v_pk_fma_f32 v[156:157], v[156:157], v[74:75], v[74:75] op_sel:[0,0,1] op_sel_hi:[1,0,1]
    v_pk_fma_f32 v[158:159], v[158:159], v[74:75], v[74:75] op_sel:[0,0,1] op_sel_hi:[1,0,1]
    buffer_load_dwordx4 v7, s[36:39], s81 offen offset:2048 sc1 lds
    v_pk_fma_f32 v[160:161], v[160:161], v[74:75], v[74:75] op_sel:[0,0,1] op_sel_hi:[1,0,1]
    v_pk_fma_f32 v[162:163], v[162:163], v[74:75], v[74:75] op_sel:[0,0,1] op_sel_hi:[1,0,1]
    v_pk_fma_f32 v[164:165], v[164:165], v[74:75], v[74:75] op_sel:[0,0,1] op_sel_hi:[1,0,1]
    v_pk_fma_f32 v[166:167], v[166:167], v[74:75], v[74:75] op_sel:[0,0,1] op_sel_hi:[1,0,1]
    v_pk_fma_f32 v[168:169], v[168:169], v[74:75], v[74:75] op_sel:[0,0,1] op_sel_hi:[1,0,1]
    v_pk_fma_f32 v[170:171], v[170:171], v[74:75], v[74:75] op_sel:[0,0,1] op_sel_hi:[1,0,1]
    v_pk_fma_f32 v[172:173], v[172:173], v[74:75], v[74:75] op_sel:[0,0,1] op_sel_hi:[1,0,1]
    v_pk_fma_f32 v[174:175], v[174:175], v[74:75], v[74:75] op_sel:[0,0,1] op_sel_hi:[1,0,1]
    v_pk_fma_f32 v[176:177], v[176:177], v[74:75], v[74:75] op_sel:[0,0,1] op_sel_hi:[1,0,1]
    v_pk_fma_f32 v[178:179], v[178:179], v[74:75], v[74:75] op_sel:[0,0,1] op_sel_hi:[1,0,1]
    v_pk_fma_f32 v[180:181], v[180:181], v[74:75], v[74:75] op_sel:[0,0,1] op_sel_hi:[1,0,1]
    v_pk_fma_f32 v[182:183], v[182:183], v[74:75], v[74:75] op_sel:[0,0,1] op_sel_hi:[1,0,1]
    v_pk_fma_f32 v[184:185], v[184:185], v[74:75], v[74:75] op_sel:[0,0,1] op_sel_hi:[1,0,1]
    v_pk_fma_f32 v[186:187], v[186:187], v[74:75], v[74:75] op_sel:[0,0,1] op_sel_hi:[1,0,1]
    v_pk_fma_f32 v[188:189], v[188:189], v[74:75], v[74:75] op_sel:[0,0,1] op_sel_hi:[1,0,1]
    v_pk_fma_f32 v[190:191], v[190:191], v[74:75], v[74:75] op_sel:[0,0,1] op_sel_hi:[1,0,1]
    s_mul_i32 s13, s42, 4096
    s_min_u32 s13, s13, 10240
    s_mul_i32 s12, s46, 14336
    s_add_u32 s12, s12, s13
    s_nop 0
    s_add_u32 m0, s13, 86016
    s_add_u32 s81, s12, 2899968
    buffer_load_dwordx4 v7, s[36:39], s81 offen offset:0 sc1 lds
    v_pk_fma_f32 v[192:193], v[192:193], v[74:75], v[74:75] op_sel:[0,0,1] op_sel_hi:[1,0,1]
    v_pk_fma_f32 v[194:195], v[194:195], v[74:75], v[74:75] op_sel:[0,0,1] op_sel_hi:[1,0,1]
    v_pk_fma_f32 v[196:197], v[196:197], v[74:75], v[74:75] op_sel:[0,0,1] op_sel_hi:[1,0,1]
    v_pk_fma_f32 v[198:199], v[198:199], v[74:75], v[74:75] op_sel:[0,0,1] op_sel_hi:[1,0,1]
    v_cvt_pk_bf16_f32 v116, v144, v199
    v_cvt_pk_bf16_f32 v117, v198, v197
    v_cvt_pk_bf16_f32 v118, v196, v195
    v_cvt_pk_bf16_f32 v119, v194, v193
    v_cvt_pk_bf16_f32 v120, v192, v191
    v_cvt_pk_bf16_f32 v121, v190, v189
    v_cvt_pk_bf16_f32 v122, v188, v187
    v_cvt_pk_bf16_f32 v123, v186, v185
    v_cvt_pk_bf16_f32 v124, v184, v183
    v_cvt_pk_bf16_f32 v125, v182, v181
    v_cvt_pk_bf16_f32 v126, v180, v179
    v_cvt_pk_bf16_f32 v127, v178, v177
    s_add_u32 s78, s83, 21102592
    buffer_store_dwordx4 v[16:19], v15, s[36:39], s78 offen sc1
    v_cvt_pk_bf16_f32 v128, v176, v175
    v_cvt_pk_bf16_f32 v129, v174, v173
    v_cvt_pk_bf16_f32 v130, v172, v171
    v_cvt_pk_bf16_f32 v131, v170, v169
    v_cvt_pk_bf16_f32 v132, v168, v167
    v_cvt_pk_bf16_f32 v133, v166, v165
    v_cvt_pk_bf16_f32 v134, v164, v163
    v_cvt_pk_bf16_f32 v135, v162, v161
    v_cvt_pk_bf16_f32 v136, v160, v159
    v_cvt_pk_bf16_f32 v137, v158, v157
    v_cvt_pk_bf16_f32 v138, v156, v155
    v_cvt_pk_bf16_f32 v139, v154, v153
    v_cvt_pk_bf16_f32 v140, v152, v151
    v_cvt_pk_bf16_f32 v141, v150, v149
    v_cvt_pk_bf16_f32 v142, v148, v147
    v_cvt_pk_bf16_f32 v143, v146, v145
    s_waitcnt vmcnt(19)
    s_barrier
    ds_read_b128 v[80:83], v7 offset:0
    ds_read_b128 v[84:87], v7 offset:1024
    ds_read_b128 v[200:203], v7 offset:2048
    ds_read_b128 v[204:207], v7 offset:3072
    ds_read_b128 v[208:211], v7 offset:4096
    ds_read_b128 v[212:215], v7 offset:5120
    ds_read_b128 v[216:219], v7 offset:6144
    ds_read_b128 v[220:223], v7 offset:7168
    ds_read_b128 v[224:227], v7 offset:8192
    s_add_u32 m0, s13, 87040
    s_add_u32 s81, s12, 2900992
    buffer_load_dwordx4 v7, s[36:39], s81 offen offset:0 sc1 lds
    ds_read_b128 v[228:231], v7 offset:9216
    s_waitcnt lgkmcnt(9)
    v_mfma_f32_16x16x32_bf16 v[172:175], v[88:91], v[80:83], 0
    ds_read_b128 v[80:83], v7 offset:10240
    s_waitcnt lgkmcnt(9)
    v_mfma_f32_16x16x32_bf16 v[172:175], v[92:95], v[84:87], v[172:175]
    ds_read_b128 v[84:87], v7 offset:11264
    s_waitcnt lgkmcnt(8)
    v_mfma_f32_16x16x32_bf16 v[172:175], v[96:99], v[200:203], v[172:175]
    ds_read_b128 v[200:203], v7 offset:12288
    v_mfma_f32_16x16x32_bf16 v[172:175], v[100:103], v[204:207], v[172:175]
    buffer_load_dwordx4 v7, s[36:39], s81 offen offset:1024 sc1 lds
    ds_read_b128 v[204:207], v7 offset:13312
    s_waitcnt lgkmcnt(8)
    v_mfma_f32_16x16x32_bf16 v[172:175], v[104:107], v[208:211], v[172:175]
    ds_read_b128 v[208:211], v7 offset:14336
    v_mfma_f32_16x16x32_bf16 v[172:175], v[108:111], v[212:215], v[172:175]
    ds_read_b128 v[212:215], v7 offset:15360
    s_waitcnt lgkmcnt(8)
    v_mfma_f32_16x16x32_bf16 v[172:175], v[112:115], v[216:219], v[172:175]
    s_add_u32 s78, s83, 21233664
    buffer_store_dwordx4 v[16:19], v15, s[36:39], s78 offen sc1
    ds_read_b128 v[216:219], v7 offset:16384
    v_mfma_f32_16x16x32_bf16 v[172:175], v[116:119], v[220:223], v[172:175]
    ds_read_b128 v[220:223], v7 offset:17408
    s_waitcnt lgkmcnt(8)
    v_mfma_f32_16x16x32_bf16 v[172:175], v[120:123], v[224:227], v[172:175]
    ds_read_b128 v[224:227], v7 offset:18432
    v_mfma_f32_16x16x32_bf16 v[172:175], v[124:127], v[228:231], v[172:175]
    ds_read_b128 v[228:231], v7 offset:19456
    buffer_load_dwordx4 v7, s[36:39], s81 offen offset:2048 sc1 lds
    s_waitcnt lgkmcnt(8)
    v_mfma_f32_16x16x32_bf16 v[172:175], v[128:131], v[80:83], v[172:175]
    ds_read_b128 v[80:83], v7 offset:20480
    v_mfma_f32_16x16x32_bf16 v[172:175], v[132:135], v[84:87], v[172:175]
    ds_read_b128 v[84:87], v7 offset:21504
    s_waitcnt lgkmcnt(8)
    v_mfma_f32_16x16x32_bf16 v[172:175], v[136:139], v[200:203], v[172:175]
    ds_read_b128 v[200:203], v7 offset:22528
    s_mul_i32 s9, s42, 14336
    s_mul_i32 s8, s45, 14336
    s_add_u32 s8, s8, s9
    s_add_u32 m0, s9, 100352
    s_add_u32 s81, s8, 2097152
    buffer_load_dwordx4 v7, s[36:39], s81 offen offset:0 sc1 lds
    v_mfma_f32_16x16x32_bf16 v[172:175], v[140:143], v[204:207], v[172:175]
    ds_read_b128 v[204:207], v7 offset:23552
    s_waitcnt lgkmcnt(8)
    v_mfma_f32_16x16x32_bf16 v[176:179], v[88:91], v[208:211], 0
    ds_read_b128 v[208:211], v7 offset:24576
    v_mfma_f32_16x16x32_bf16 v[176:179], v[92:95], v[212:215], v[176:179]
    ds_read_b128 v[212:215], v7 offset:25600
    s_waitcnt lgkmcnt(8)
    s_add_u32 s78, s84, 20971520
    s_mov_b32 exec_lo, 0xffff
    s_mov_b32 exec_hi, 0xffff
    buffer_store_dwordx4 v[16:19], v15, s[36:39], s78 offen sc1
    s_mov_b64 exec, -1
    v_mfma_f32_16x16x32_bf16 v[176:179], v[96:99], v[216:219], v[176:179]
    ds_read_b128 v[216:219], v7 offset:26624
    v_mfma_f32_16x16x32_bf16 v[176:179], v[100:103], v[220:223], v[176:179]
    ds_read_b128 v[220:223], v7 offset:27648
    s_waitcnt lgkmcnt(8)
    v_mfma_f32_16x16x32_bf16 v[176:179], v[104:107], v[224:227], v[176:179]
    ds_read_b128 v[224:227], v7 offset:28672
    v_mfma_f32_16x16x32_bf16 v[176:179], v[108:111], v[228:231], v[176:179]
    ds_read_b128 v[228:231], v7 offset:29696
    buffer_load_dwordx4 v7, s[36:39], s81 offen offset:1024 sc1 lds
    s_waitcnt lgkmcnt(8)
    v_mfma_f32_16x16x32_bf16 v[176:179], v[112:115], v[80:83], v[176:179]
    ds_read_b128 v[80:83], v7 offset:30720
    v_mfma_f32_16x16x32_bf16 v[176:179], v[116:119], v[84:87], v[176:179]
    ds_read_b128 v[84:87], v7 offset:31744
    s_waitcnt lgkmcnt(8)
    v_mfma_f32_16x16x32_bf16 v[176:179], v[120:123], v[200:203], v[176:179]
    ds_read_b128 v[200:203], v7 offset:32768
    buffer_load_dwordx4 v7, s[36:39], s81 offen offset:2048 sc1 lds
    v_mfma_f32_16x16x32_bf16 v[176:179], v[124:127], v[204:207], v[176:179]
    ds_read_b128 v[204:207], v7 offset:33792
    s_waitcnt lgkmcnt(8)
    v_mfma_f32_16x16x32_bf16 v[176:179], v[128:131], v[208:211], v[176:179]
    ds_read_b128 v[208:211], v7 offset:34816
    v_mfma_f32_16x16x32_bf16 v[176:179], v[132:135], v[212:215], v[176:179]
    ds_read_b128 v[212:215], v7 offset:35840
    s_waitcnt lgkmcnt(8)
    s_add_u32 s78, s85, 25165824
    buffer_store_dwordx4 v[16:19], v7, s[36:39], s78 offen sc1
    v_mfma_f32_16x16x32_bf16 v[176:179], v[136:139], v[216:219], v[176:179]
    ds_read_b128 v[216:219], v7 offset:36864
    v_mfma_f32_16x16x32_bf16 v[176:179], v[140:143], v[220:223], v[176:179]
    ds_read_b128 v[220:223], v7 offset:37888
    s_waitcnt lgkmcnt(8)
    v_mfma_f32_16x16x32_bf16 v[180:183], v[88:91], v[224:227], 0
    ds_read_b128 v[224:227], v7 offset:38912
    v_mfma_f32_16x16x32_bf16 v[180:183], v[92:95], v[228:231], v[180:183]
    buffer_load_dwordx4 v7, s[36:39], s81 offen offset:3072 sc1 lds
    ds_read_b128 v[228:231], v7 offset:39936
    s_waitcnt lgkmcnt(8)
    v_mfma_f32_16x16x32_bf16 v[180:183], v[96:99], v[80:83], v[180:183]
    ds_read_b128 v[80:83], v7 offset:40960
    v_mfma_f32_16x16x32_bf16 v[180:183], v[100:103], v[84:87], v[180:183]
    ds_read_b128 v[84:87], v7 offset:41984
    s_waitcnt lgkmcnt(8)
    v_mfma_f32_16x16x32_bf16 v[180:183], v[104:107], v[200:203], v[180:183]
    s_waitcnt vmcnt(6)
    s_waitcnt lgkmcnt(0)
    s_barrier
    s_lshl_b32 s70, s41, 5
    s_add_u32 s70, s70, s40
    s_lshl_b32 s70, s70, 7
    s_add_u32 s70, s70, 688128
    s_cmp_lg_u32 s42, 0
    s_cbranch_scc1 nf_9
    s_bfm_b64 exec, 32, 0
    buffer_store_dword v10, v21, s[36:39], s70 offen sc1
    s_mov_b64 exec, -1
nf_9:
    s_add_u32 m0, s9, 104448
    s_add_u32 s81, s8, 2101248
    buffer_load_dwordx4 v7, s[36:39], s81 offen offset:0 sc1 lds
    ds_read_b128 v[200:203], v7 offset:43008
    v_mfma_f32_16x16x32_bf16 v[180:183], v[108:111], v[204:207], v[180:183]
    ds_read_b128 v[204:207], v7 offset:44032
    v_mfma_f32_16x16x32_bf16 v[180:183], v[112:115], v[208:211], v[180:183]
    ds_read_b128 v[208:211], v7 offset:45056
    v_mfma_f32_16x16x32_bf16 v[180:183], v[116:119], v[212:215], v[180:183]
    ds_read_b128 v[212:215], v7 offset:46080
    s_add_u32 s78, s85, 25174016
    buffer_store_dwordx4 v[16:19], v7, s[36:39], s78 offen sc1
    v_mfma_f32_16x16x32_bf16 v[180:183], v[120:123], v[216:219], v[180:183]
    ds_read_b128 v[216:219], v7 offset:47104
    v_mfma_f32_16x16x32_bf16 v[180:183], v[124:127], v[220:223], v[180:183]
    ds_read_b128 v[220:223], v7 offset:48128
    v_mfma_f32_16x16x32_bf16 v[180:183], v[128:131], v[224:227], v[180:183]
    ds_read_b128 v[224:227], v7 offset:49152
    buffer_load_dwordx4 v7, s[36:39], s81 offen offset:1024 sc1 lds
    v_mfma_f32_16x16x32_bf16 v[180:183], v[132:135], v[228:231], v[180:183]
    ds_read_b128 v[228:231], v7 offset:50176
    v_mfma_f32_16x16x32_bf16 v[180:183], v[136:139], v[80:83], v[180:183]
    ds_read_b128 v[80:83], v7 offset:51200
    v_mfma_f32_16x16x32_bf16 v[180:183], v[140:143], v[84:87], v[180:183]
    ds_read_b128 v[84:87], v7 offset:52224
    buffer_load_dwordx4 v7, s[36:39], s81 offen offset:2048 sc1 lds
    s_waitcnt lgkmcnt(8)
    v_mfma_f32_16x16x32_bf16 v[184:187], v[88:91], v[200:203], 0
    ds_read_b128 v[200:203], v7 offset:53248
    v_mfma_f32_16x16x32_bf16 v[184:187], v[92:95], v[204:207], v[184:187]
    ds_read_b128 v[204:207], v7 offset:54272
    s_waitcnt lgkmcnt(8)
    v_mfma_f32_16x16x32_bf16 v[184:187], v[96:99], v[208:211], v[184:187]
    ds_read_b128 v[208:211], v7 offset:55296
    s_add_u32 s78, s85, 25182208
    buffer_store_dwordx4 v[16:19], v7, s[36:39], s78 offen sc1
    v_mfma_f32_16x16x32_bf16 v[184:187], v[100:103], v[212:215], v[184:187]
    ds_read_b128 v[212:215], v7 offset:56320
    s_waitcnt lgkmcnt(8)
    v_mfma_f32_16x16x32_bf16 v[184:187], v[104:107], v[216:219], v[184:187]
    ds_read_b128 v[216:219], v7 offset:57344
    v_mfma_f32_16x16x32_bf16 v[184:187], v[108:111], v[220:223], v[184:187]
    ds_read_b128 v[220:223], v7 offset:58368
    s_waitcnt lgkmcnt(8)
    buffer_load_dwordx4 v7, s[36:39], s81 offen offset:3072 sc1 lds
    v_mfma_f32_16x16x32_bf16 v[184:187], v[112:115], v[224:227], v[184:187]
    ds_read_b128 v[224:227], v7 offset:59392
    v_mfma_f32_16x16x32_bf16 v[184:187], v[116:119], v[228:231], v[184:187]
    ds_read_b128 v[228:231], v7 offset:60416
    s_waitcnt lgkmcnt(8)
    v_mfma_f32_16x16x32_bf16 v[184:187], v[120:123], v[80:83], v[184:187]
    ds_read_b128 v[80:83], v7 offset:61440
    s_add_u32 m0, s9, 108544
    s_add_u32 s81, s8, 2105344
    buffer_load_dwordx4 v7, s[36:39], s81 offen offset:0 sc1 lds
    v_mfma_f32_16x16x32_bf16 v[184:187], v[124:127], v[84:87], v[184:187]
    ds_read_b128 v[84:87], v7 offset:62464
    s_waitcnt lgkmcnt(8)
    v_mfma_f32_16x16x32_bf16 v[184:187], v[128:131], v[200:203], v[184:187]
    ds_read_b128 v[200:203], v7 offset:63488
    v_mfma_f32_16x16x32_bf16 v[184:187], v[132:135], v[204:207], v[184:187]
    ds_read_b128 v[204:207], v7 offset:64512
    s_waitcnt lgkmcnt(8)
    s_add_u32 s78, s86, 25165824
    buffer_store_dwordx2 v[16:17], v22, s[36:39], s78 offen sc1
    v_mfma_f32_16x16x32_bf16 v[184:187], v[136:139], v[208:211], v[184:187]
    ds_read_b128 v[208:211], v8 offset:0
    v_mfma_f32_16x16x32_bf16 v[184:187], v[140:143], v[212:215], v[184:187]
    ds_read_b128 v[212:215], v8 offset:1024
    s_waitcnt lgkmcnt(8)
    v_mfma_f32_16x16x32_bf16 v[188:191], v[88:91], v[216:219], 0
    ds_read_b128 v[216:219], v8 offset:2048
    v_mfma_f32_16x16x32_bf16 v[188:191], v[92:95], v[220:223], v[188:191]
    buffer_load_dwordx4 v7, s[36:39], s81 offen offset:1024 sc1 lds
    ds_read_b128 v[220:223], v8 offset:3072
    s_waitcnt lgkmcnt(8)
    v_mfma_f32_16x16x32_bf16 v[188:191], v[96:99], v[224:227], v[188:191]
    ds_read_b128 v[224:227], v8 offset:4096
    v_mfma_f32_16x16x32_bf16 v[188:191], v[100:103], v[228:231], v[188:191]
    ds_read_b128 v[228:231], v8 offset:5120
    s_waitcnt lgkmcnt(8)
    buffer_load_dwordx4 v7, s[36:39], s81 offen offset:2048 sc1 lds
    v_mfma_f32_16x16x32_bf16 v[188:191], v[104:107], v[80:83], v[188:191]
    ds_read_b128 v[80:83], v8 offset:6144
    v_mfma_f32_16x16x32_bf16 v[188:191], v[108:111], v[84:87], v[188:191]
    ds_read_b128 v[84:87], v8 offset:7168
    s_waitcnt lgkmcnt(8)
    v_mfma_f32_16x16x32_bf16 v[188:191], v[112:115], v[200:203], v[188:191]
    ds_read_b128 v[200:203], v8 offset:8192
    v_mfma_f32_16x16x32_bf16 v[188:191], v[116:119], v[204:207], v[188:191]
    s_add_u32 s78, s92, 16777216
    buffer_store_dwordx4 v[16:19], v7, s[36:39], s78 offen sc1
    ds_read_b128 v[204:207], v8 offset:9216
    s_waitcnt lgkmcnt(8)
    v_mfma_f32_16x16x32_bf16 v[188:191], v[120:123], v[208:211], v[188:191]
    ds_read_b128 v[208:211], v8 offset:10240
    v_mfma_f32_16x16x32_bf16 v[188:191], v[124:127], v[212:215], v[188:191]
    ds_read_b128 v[212:215], v8 offset:11264
    s_waitcnt lgkmcnt(8)
    v_mfma_f32_16x16x32_bf16 v[188:191], v[128:131], v[216:219], v[188:191]
    buffer_load_dwordx4 v7, s[36:39], s81 offen offset:3072 sc1 lds
    ds_read_b128 v[216:219], v8 offset:12288
    v_mfma_f32_16x16x32_bf16 v[188:191], v[132:135], v[220:223], v[188:191]
    ds_read_b128 v[220:223], v8 offset:13312
    s_waitcnt lgkmcnt(8)
    v_mfma_f32_16x16x32_bf16 v[188:191], v[136:139], v[224:227], v[188:191]
    ds_read_b128 v[224:227], v8 offset:14336
    v_mfma_f32_16x16x32_bf16 v[188:191], v[140:143], v[228:231], v[188:191]
    s_add_u32 m0, s9, 112640
    s_add_u32 s81, s8, 2109440
    buffer_load_dwordx4 v7, s[36:39], s81 offen offset:0 sc1 lds
    ds_read_b128 v[228:231], v8 offset:15360
    s_waitcnt lgkmcnt(8)
    v_mfma_f32_16x16x32_bf16 v[192:195], v[88:91], v[80:83], 0
    ds_read_b128 v[80:83], v8 offset:16384
    v_mfma_f32_16x16x32_bf16 v[192:195], v[92:95], v[84:87], v[192:195]
    ds_read_b128 v[84:87], v8 offset:17408
    s_waitcnt lgkmcnt(8)
    v_mfma_f32_16x16x32_bf16 v[192:195], v[96:99], v[200:203], v[192:195]
L_pad_2344:
    s_cbranch_execz L_ret_0
    s_add_u32 s78, s92, 16778240
    buffer_store_dwordx4 v[16:19], v7, s[36:39], s78 offen sc1
    ds_read_b128 v[200:203], v8 offset:18432
    v_mfma_f32_16x16x32_bf16 v[192:195], v[100:103], v[204:207], v[192:195]
    ds_read_b128 v[204:207], v8 offset:19456
    s_waitcnt lgkmcnt(8)
    v_mfma_f32_16x16x32_bf16 v[192:195], v[104:107], v[208:211], v[192:195]
    ds_read_b128 v[208:211], v8 offset:20480
    v_mfma_f32_16x16x32_bf16 v[192:195], v[108:111], v[212:215], v[192:195]
    ds_read_b128 v[212:215], v8 offset:21504
    buffer_load_dwordx4 v7, s[36:39], s81 offen offset:1024 sc1 lds
    s_waitcnt lgkmcnt(8)
    v_mfma_f32_16x16x32_bf16 v[192:195], v[112:115], v[216:219], v[192:195]
    ds_read_b128 v[216:219], v8 offset:22528
    v_mfma_f32_16x16x32_bf16 v[192:195], v[116:119], v[220:223], v[192:195]
    ds_read_b128 v[220:223], v8 offset:23552
    s_waitcnt lgkmcnt(8)
    v_mfma_f32_16x16x32_bf16 v[192:195], v[120:123], v[224:227], v[192:195]
    s_mul_i32 s11, s42, 7168
    s_mul_i32 s10, s45, 14336
    s_add_u32 s10, s10, s11
    s_add_u32 m0, s11, 0
    s_add_u32 s81, s10, 2154496
    buffer_load_dwordx4 v7, s[36:39], s81 offen offset:0 sc1 lds
    ds_read_b128 v[224:227], v8 offset:24576
    v_mfma_f32_16x16x32_bf16 v[192:195], v[124:127], v[228:231], v[192:195]
    ds_read_b128 v[228:231], v8 offset:25600
    s_waitcnt lgkmcnt(8)
    v_mfma_f32_16x16x32_bf16 v[192:195], v[128:131], v[80:83], v[192:195]
    ds_read_b128 v[80:83], v8 offset:26624
    v_mfma_f32_16x16x32_bf16 v[192:195], v[132:135], v[84:87], v[192:195]
    ds_read_b128 v[84:87], v8 offset:27648
    buffer_load_dwordx4 v7, s[36:39], s81 offen offset:1024 sc1 lds
    s_waitcnt lgkmcnt(8)
    v_mfma_f32_16x16x32_bf16 v[192:195], v[136:139], v[200:203], v[192:195]
    ds_read_b128 v[200:203], v8 offset:28672
    v_mfma_f32_16x16x32_bf16 v[192:195], v[140:143], v[204:207], v[192:195]
    ds_read_b128 v[204:207], v8 offset:29696
    s_waitcnt lgkmcnt(8)
    v_mfma_f32_16x16x32_bf16 v[196:199], v[88:91], v[208:211], 0
    ds_read_b128 v[208:211], v8 offset:30720
    buffer_load_dwordx4 v7, s[36:39], s81 offen offset:2048 sc1 lds
    v_mfma_f32_16x16x32_bf16 v[196:199], v[92:95], v[212:215], v[196:199]
    ds_read_b128 v[212:215], v8 offset:31744
    s_waitcnt lgkmcnt(8)
    v_mfma_f32_16x16x32_bf16 v[196:199], v[96:99], v[216:219], v[196:199]
    ds_read_b128 v[216:219], v8 offset:32768
    v_mfma_f32_16x16x32_bf16 v[196:199], v[100:103], v[220:223], v[196:199]
    ds_read_b128 v[220:223], v8 offset:33792
    buffer_load_dwordx4 v7, s[36:39], s81 offen offset:3072 sc1 lds
    s_waitcnt lgkmcnt(8)
    v_mfma_f32_16x16x32_bf16 v[196:199], v[104:107], v[224:227], v[196:199]
    v_mfma_f32_16x16x32_bf16 v[196:199], v[108:111], v[228:231], v[196:199]
    s_waitcnt lgkmcnt(6)
    v_mfma_f32_16x16x32_bf16 v[196:199], v[112:115], v[80:83], v[196:199]
    v_mfma_f32_16x16x32_bf16 v[196:199], v[116:119], v[84:87], v[196:199]
    s_waitcnt lgkmcnt(4)
    v_mfma_f32_16x16x32_bf16 v[196:199], v[120:123], v[200:203], v[196:199]
    s_add_u32 m0, s11, 4096
    s_add_u32 s81, s10, 2158592
    buffer_load_dwordx4 v7, s[36:39], s81 offen offset:0 sc1 lds
    v_mfma_f32_16x16x32_bf16 v[196:199], v[124:127], v[204:207], v[196:199]
    s_waitcnt lgkmcnt(2)
    v_mfma_f32_16x16x32_bf16 v[196:199], v[128:131], v[208:211], v[196:199]
    s_lshl_b32 s88, s40, 7
    s_add_u32 s88, s88, 688128
    v_lshlrev_b32 v20, 12, v1
    v_mov_b32 v23, s44
    s_bfm_b64 exec, 8, 0
    buffer_load_dword v23, v20, s[36:39], s88 offen sc1
    s_mov_b64 exec, -1
    v_mfma_f32_16x16x32_bf16 v[196:199], v[132:135], v[212:215], v[196:199]
    s_waitcnt lgkmcnt(0)
    v_mfma_f32_16x16x32_bf16 v[196:199], v[136:139], v[216:219], v[196:199]
    v_mfma_f32_16x16x32_bf16 v[196:199], v[140:143], v[220:223], v[196:199]
    s_lshl_b32 s77, s52, 11
    s_add_u32 s77, s77, 1048576
    s_lshl_b32 s71, s41, 8
    s_add_u32 s71, s71, s77
    s_nop 0
    s_add_u32 m0, s11, 5120
    s_add_u32 s81, s10, 2159616
    buffer_load_dwordx4 v7, s[36:39], s81 offen offset:0 sc1 lds
    v_pk_mul_f32 v[236:237], v[172:173], v[172:173]
    v_pk_mul_f32 v[238:239], v[174:175], v[174:175]
    v_pk_mul_f32 v[240:241], v[176:177], v[176:177]
    v_pk_mul_f32 v[242:243], v[178:179], v[178:179]
    v_pk_fma_f32 v[236:237], v[236:237], s[60:61], v[12:13]
    v_pk_fma_f32 v[238:239], v[238:239], s[60:61], v[12:13]
    v_pk_fma_f32 v[240:241], v[240:241], s[60:61], v[12:13]
    v_pk_fma_f32 v[242:243], v[242:243], s[60:61], v[12:13]
    v_pk_mul_f32 v[236:237], v[236:237], v[172:173]
    v_pk_mul_f32 v[238:239], v[238:239], v[174:175]
    v_pk_mul_f32 v[240:241], v[240:241], v[176:177]
    v_pk_mul_f32 v[242:243], v[242:243], v[178:179]
    v_exp_f32 v236, v236
    v_exp_f32 v237, v237
    v_exp_f32 v238, v238
    v_exp_f32 v239, v239
    v_exp_f32 v240, v240
    v_exp_f32 v241, v241
    buffer_load_dwordx4 v7, s[36:39], s81 offen offset:1024 sc1 lds
    v_exp_f32 v242, v242
    v_exp_f32 v243, v243
    v_pk_add_f32 v[236:237], v[236:237], 1.0 op_sel_hi:[1,0]
    v_pk_add_f32 v[238:239], v[238:239], 1.0 op_sel_hi:[1,0]
    v_pk_add_f32 v[240:241], v[240:241], 1.0 op_sel_hi:[1,0]
    v_pk_add_f32 v[242:243], v[242:243], 1.0 op_sel_hi:[1,0]
    v_rcp_f32 v236, v236
    v_rcp_f32 v237, v237
    v_rcp_f32 v238, v238
    v_rcp_f32 v239, v239
    v_rcp_f32 v240, v240
    v_rcp_f32 v241, v241
    v_rcp_f32 v242, v242
    v_rcp_f32 v243, v243
    v_pk_mul_f32 v[172:173], v[172:173], v[236:237]
    v_pk_mul_f32 v[174:175], v[174:175], v[238:239]
    v_pk_mul_f32 v[176:177], v[176:177], v[240:241]
    v_pk_mul_f32 v[178:179], v[178:179], v[242:243]
    s_mul_i32 s13, s42, 4096
    s_min_u32 s13, s13, 10240
    s_mul_i32 s12, s46, 14336
    s_add_u32 s12, s12, s13
    s_nop 0
    s_add_u32 m0, s13, 28672
    s_add_u32 s81, s12, 2097152
    buffer_load_dwordx4 v7, s[36:39], s81 offen offset:0 sc1 lds
    v_pk_mul_f32 v[236:237], v[180:181], v[180:181]
    v_pk_mul_f32 v[238:239], v[182:183], v[182:183]
    v_pk_mul_f32 v[240:241], v[184:185], v[184:185]
    v_pk_mul_f32 v[242:243], v[186:187], v[186:187]
    v_pk_fma_f32 v[236:237], v[236:237], s[60:61], v[12:13]
    v_pk_fma_f32 v[238:239], v[238:239], s[60:61], v[12:13]
    v_pk_fma_f32 v[240:241], v[240:241], s[60:61], v[12:13]
    v_pk_fma_f32 v[242:243], v[242:243], s[60:61], v[12:13]
    v_pk_mul_f32 v[236:237], v[236:237], v[180:181]
    v_pk_mul_f32 v[238:239], v[238:239], v[182:183]
    v_pk_mul_f32 v[240:241], v[240:241], v[184:185]
    v_pk_mul_f32 v[242:243], v[242:243], v[186:187]
    v_exp_f32 v236, v236
    v_exp_f32 v237, v237
    v_exp_f32 v238, v238
    v_exp_f32 v239, v239
    v_exp_f32_e64 v240, v240
    buffer_load_dwordx4 v7, s[36:39], s81 offen offset:1024 sc1 lds
    v_exp_f32 v241, v241
    v_exp_f32 v242, v242
    v_exp_f32_e64 v243, v243
    v_pk_add_f32 v[236:237], v[236:237], 1.0 op_sel_hi:[1,0]
    v_pk_add_f32 v[238:239], v[238:239], 1.0 op_sel_hi:[1,0]
    v_pk_add_f32 v[240:241], v[240:241], 1.0 op_sel_hi:[1,0]
    v_pk_add_f32 v[242:243], v[242:243], 1.0 op_sel_hi:[1,0]
    v_rcp_f32 v236, v236
    v_rcp_f32 v237, v237
    v_rcp_f32 v238, v238
    v_rcp_f32 v239, v239
    v_rcp_f32 v240, v240
    v_rcp_f32 v241, v241
    v_rcp_f32 v242, v242
    v_rcp_f32 v243, v243
    v_pk_mul_f32 v[180:181], v[180:181], v[236:237]
    v_pk_mul_f32 v[182:183], v[182:183], v[238:239]
    v_pk_mul_f32 v[184:185], v[184:185], v[240:241]
    buffer_load_dwordx4 v7, s[36:39], s81 offen offset:2048 sc1 lds
    v_pk_mul_f32 v[186:187], v[186:187], v[242:243]
    v_pk_mul_f32 v[236:237], v[188:189], v[188:189]
    v_pk_mul_f32 v[238:239], v[190:191], v[190:191]
    v_pk_mul_f32 v[240:241], v[192:193], v[192:193]
    v_pk_mul_f32 v[242:243], v[194:195], v[194:195]
    v_pk_fma_f32 v[236:237], v[236:237], s[60:61], v[12:13]
    v_pk_fma_f32 v[238:239], v[238:239], s[60:61], v[12:13]
    v_pk_fma_f32 v[240:241], v[240:241], s[60:61], v[12:13]
    v_pk_fma_f32 v[242:243], v[242:243], s[60:61], v[12:13]
    v_pk_mul_f32 v[236:237], v[236:237], v[188:189]
    v_pk_mul_f32 v[238:239], v[238:239], v[190:191]
    v_pk_mul_f32 v[240:241], v[240:241], v[192:193]
    v_pk_mul_f32 v[242:243], v[242:243], v[194:195]
    v_exp_f32 v236, v236
    v_exp_f32 v237, v237
    v_exp_f32 v238, v238
    v_exp_f32 v239, v239
    v_exp_f32_e64 v240, v240
    buffer_load_dwordx4 v7, s[36:39], s81 offen offset:3072 sc1 lds
    v_exp_f32 v241, v241
    v_exp_f32 v242, v242
    v_exp_f32_e64 v243, v243
    v_pk_add_f32 v[236:237], v[236:237], 1.0 op_sel_hi:[1,0]
    v_pk_add_f32 v[238:239], v[238:239], 1.0 op_sel_hi:[1,0]
    v_pk_add_f32 v[240:241], v[240:241], 1.0 op_sel_hi:[1,0]
    v_pk_add_f32 v[242:243], v[242:243], 1.0 op_sel_hi:[1,0]
    v_rcp_f32 v236, v236
    v_rcp_f32 v237, v237
    v_rcp_f32 v238, v238
    v_rcp_f32 v239, v239
    v_rcp_f32 v240, v240
    v_rcp_f32 v241, v241
    v_rcp_f32 v242, v242
    v_rcp_f32 v243, v243
    v_pk_mul_f32 v[188:189], v[188:189], v[236:237]
    v_pk_mul_f32 v[190:191], v[190:191], v[238:239]
    s_waitcnt vmcnt(6)
    v_cmp_ne_u32 vcc, s44, v23
    s_cbranch_vccnz ps_10
pb_11:
    s_lshl_b32 s8, s52, 16
    s_add_u32 s81, s8, 6291456
    buffer_load_dwordx4 a[0:3], v7, s[36:39], s81 offen offset:0 sc1
    v_pk_mul_f32 v[192:193], v[192:193], v[240:241]
    v_pk_mul_f32 v[194:195], v[194:195], v[242:243]
    v_pk_mul_f32 v[236:237], v[196:197], v[196:197]
    v_pk_mul_f32 v[238:239], v[198:199], v[198:199]
    v_pk_fma_f32 v[236:237], v[236:237], s[60:61], v[12:13]
    v_pk_fma_f32 v[238:239], v[238:239], s[60:61], v[12:13]
    buffer_load_dwordx4 a[4:7], v7, s[36:39], s81 offen offset:1024 sc1
    v_pk_mul_f32 v[236:237], v[236:237], v[196:197]
    v_pk_mul_f32 v[238:239], v[238:239], v[198:199]
    v_exp_f32 v236, v236
    v_exp_f32 v237, v237
    v_exp_f32 v238, v238
    v_exp_f32 v239, v239
    buffer_load_dwordx4 a[8:11], v7, s[36:39], s81 offen offset:2048 sc1
    v_pk_add_f32 v[236:237], v[236:237], 1.0 op_sel_hi:[1,0]
    v_pk_add_f32 v[238:239], v[238:239], 1.0 op_sel_hi:[1,0]
    v_rcp_f32 v236, v236
    v_rcp_f32 v237, v237
    v_rcp_f32 v238, v238
    v_rcp_f32 v239, v239
    buffer_load_dwordx4 a[12:15], v7, s[36:39], s81 offen offset:3072 sc1
    v_pk_mul_f32 v[196:197], v[196:197], v[236:237]
    v_pk_mul_f32 v[198:199], v[198:199], v[238:239]
    v_pk_add_f32 v[64:65], v[172:173], v[176:177]
    v_pk_mul_f32 v[68:69], v[172:173], v[172:173]
    v_pk_add_f32 v[66:67], v[174:175], v[178:179]
    s_add_u32 s81, s8, 6295552
    buffer_load_dwordx4 a[16:19], v7, s[36:39], s81 offen offset:0 sc1
    v_pk_mul_f32 v[70:71], v[174:175], v[174:175]
    v_pk_fma_f32 v[68:69], v[176:177], v[176:177], v[68:69]
    v_pk_fma_f32 v[70:71], v[178:179], v[178:179], v[70:71]
    v_pk_add_f32 v[64:65], v[64:65], v[180:181]
    v_pk_fma_f32 v[68:69], v[180:181], v[180:181], v[68:69]
    v_pk_add_f32 v[66:67], v[66:67], v[182:183]
    buffer_load_dwordx4 a[20:23], v7, s[36:39], s81 offen offset:1024 sc1
    v_pk_fma_f32 v[70:71], v[182:183], v[182:183], v[70:71]
    v_pk_add_f32 v[64:65], v[64:65], v[184:185]
    v_pk_fma_f32 v[68:69], v[184:185], v[184:185], v[68:69]
    v_pk_add_f32 v[66:67], v[66:67], v[186:187]
    v_pk_fma_f32 v[70:71], v[186:187], v[186:187], v[70:71]
    v_pk_add_f32 v[64:65], v[64:65], v[188:189]
    buffer_load_dwordx4 a[24:27], v7, s[36:39], s81 offen offset:2048 sc1
    v_pk_fma_f32 v[68:69], v[188:189], v[188:189], v[68:69]
    v_pk_add_f32 v[66:67], v[66:67], v[190:191]
    v_pk_fma_f32 v[70:71], v[190:191], v[190:191], v[70:71]
    v_pk_add_f32 v[64:65], v[64:65], v[192:193]
    v_pk_fma_f32 v[68:69], v[192:193], v[192:193], v[68:69]
    v_pk_add_f32 v[66:67], v[66:67], v[194:195]
    buffer_load_dwordx4 a[28:31], v7, s[36:39], s81 offen offset:3072 sc1
    v_pk_fma_f32 v[70:71], v[194:195], v[194:195], v[70:71]
    v_pk_add_f32 v[64:65], v[64:65], v[196:197]
    v_pk_fma_f32 v[68:69], v[196:197], v[196:197], v[68:69]
    v_pk_add_f32 v[66:67], v[66:67], v[198:199]
    v_pk_fma_f32 v[70:71], v[198:199], v[198:199], v[70:71]
    v_add_f32_dpp v72, v64, v64 row_ror:8 row_mask:0xf bank_mask:0x3
    v_add_f32_dpp v73, v68, v68 row_ror:8 row_mask:0xf bank_mask:0x3
    v_add_f32_dpp v74, v65, v65 row_ror:8 row_mask:0xf bank_mask:0x3
    v_add_f32_dpp v75, v69, v69 row_ror:8 row_mask:0xf bank_mask:0x3
    v_add_f32_dpp v72, v66, v66 row_ror:8 row_mask:0xf bank_mask:0xc
    v_add_f32_dpp v73, v70, v70 row_ror:8 row_mask:0xf bank_mask:0xc
    v_add_f32_dpp v74, v67, v67 row_ror:8 row_mask:0xf bank_mask:0xc
    v_add_f32_dpp v75, v71, v71 row_ror:8 row_mask:0xf bank_mask:0xc
    v_add_f32_dpp v64, v72, v72 row_half_mirror row_mask:0xf bank_mask:0x5
    v_add_f32_dpp v65, v73, v73 row_half_mirror row_mask:0xf bank_mask:0x5
    s_nop 0
    v_add_f32_dpp v64, v74, v74 row_half_mirror row_mask:0xf bank_mask:0xa
    v_add_f32_dpp v65, v75, v75 row_half_mirror row_mask:0xf bank_mask:0xa
    s_nop 0
    v_add_f32_dpp v64, v64, v64 quad_perm:[1,0,3,2] row_mask:0xf bank_mask:0xf
    v_add_f32_dpp v65, v65, v65 quad_perm:[1,0,3,2] row_mask:0xf bank_mask:0xf
    s_nop 0
    v_add_f32_dpp v64, v64, v64 quad_perm:[2,3,0,1] row_mask:0xf bank_mask:0xf
    v_add_f32_dpp v65, v65, v65 quad_perm:[2,3,0,1] row_mask:0xf bank_mask:0xf
    v_cndmask_b32 v64, v64, v65, s[62:63]
    v_cndmask_b32 v64, v64, v10, s[64:65]
    buffer_store_dword v64, v21, s[36:39], s71 offen sc1
    s_waitcnt vmcnt(9)
    s_barrier
    ds_read_b128 v[80:83], v8 offset:34816
    ds_read_b128 v[84:87], v8 offset:35840
    ds_read_b128 v[200:203], v8 offset:36864
    ds_read_b128 v[204:207], v8 offset:37888
    ds_read_b128 v[208:211], v8 offset:38912
    ds_read_b128 v[212:215], v8 offset:39936
    ds_read_b128 v[216:219], v8 offset:40960
    ds_read_b128 v[220:223], v8 offset:41984
    ds_read_b128 v[224:227], v8 offset:43008
    s_lshl_b32 s70, s41, 5
    s_add_u32 s70, s70, s40
    s_lshl_b32 s70, s70, 7
    s_add_u32 s70, s70, 720896
    s_cmp_lg_u32 s42, 0
    s_cbranch_scc1 nf_12
    s_bfm_b64 exec, 32, 0
    buffer_store_dword v10, v21, s[36:39], s70 offen sc1
    s_mov_b64 exec, -1
nf_12:
    v_and_b32_e64 v232, 3, v4
    v_lshl_add_u32 v232, v5, 2, v232
    v_lshlrev_b32 v232, 4, v232
    v_lshrrev_b32 v233, 2, v4
    v_lshl_add_u32 v233, v233, 8, v232
    s_add_u32 s81, s8, 6299648
    buffer_load_dwordx4 a[32:35], v7, s[36:39], s81 offen offset:0 sc1
    ds_read_b128 v[228:231], v8 offset:44032
    s_waitcnt lgkmcnt(9)
    v_mfma_f32_16x16x32_bf16 v[144:147], v[80:83], v[88:91], 0
    ds_read_b128 v[80:83], v8 offset:45056
    s_waitcnt lgkmcnt(9)
    v_mfma_f32_16x16x32_bf16 v[144:147], v[84:87], v[92:95], v[144:147]
    ds_read_b128 v[84:87], v8 offset:46080
    s_waitcnt lgkmcnt(8)
    v_mfma_f32_16x16x32_bf16 v[144:147], v[200:203], v[96:99], v[144:147]
    ds_read_b128 v[200:203], v8 offset:47104
    v_mfma_f32_16x16x32_bf16 v[144:147], v[204:207], v[100:103], v[144:147]
    buffer_load_dwordx4 a[36:39], v7, s[36:39], s81 offen offset:1024 sc1
    ds_read_b128 v[204:207], v8 offset:48128
    s_waitcnt lgkmcnt(8)
    v_mfma_f32_16x16x32_bf16 v[144:147], v[208:211], v[104:107], v[144:147]
    ds_read_b128 v[208:211], v8 offset:49152
    v_mfma_f32_16x16x32_bf16 v[144:147], v[212:215], v[108:111], v[144:147]
    ds_read_b128 v[212:215], v8 offset:50176
    s_waitcnt lgkmcnt(8)
    v_mfma_f32_16x16x32_bf16 v[144:147], v[216:219], v[112:115], v[144:147]
    buffer_load_dwordx4 a[40:43], v7, s[36:39], s81 offen offset:2048 sc1
    ds_read_b128 v[216:219], v8 offset:51200
    v_mfma_f32_16x16x32_bf16 v[144:147], v[220:223], v[116:119], v[144:147]
    ds_read_b128 v[220:223], v8 offset:52224
    s_waitcnt lgkmcnt(8)
    v_mfma_f32_16x16x32_bf16 v[144:147], v[224:227], v[120:123], v[144:147]
    ds_read_b128 v[224:227], v8 offset:53248
    v_mfma_f32_16x16x32_bf16 v[144:147], v[228:231], v[124:127], v[144:147]
    ds_read_b128 v[228:231], v8 offset:54272
    s_waitcnt lgkmcnt(8)
    buffer_load_dwordx4 a[44:47], v7, s[36:39], s81 offen offset:3072 sc1
    v_mfma_f32_16x16x32_bf16 v[144:147], v[80:83], v[128:131], v[144:147]
    ds_read_b128 v[80:83], v8 offset:55296
    v_mfma_f32_16x16x32_bf16 v[144:147], v[84:87], v[132:135], v[144:147]
    ds_read_b128 v[84:87], v8 offset:56320
    s_waitcnt lgkmcnt(8)
    v_mfma_f32_16x16x32_bf16 v[144:147], v[200:203], v[136:139], v[144:147]
    ds_read_b128 v[200:203], v8 offset:57344
    v_mfma_f32_16x16x32_bf16 v[144:147], v[204:207], v[140:143], v[144:147]
    s_add_u32 s81, s8, 6303744
    buffer_load_dwordx4 a[48:51], v7, s[36:39], s81 offen offset:0 sc1
    ds_read_b128 v[204:207], v8 offset:58368
    s_waitcnt lgkmcnt(8)
    v_mfma_f32_16x16x32_bf16 v[148:151], v[208:211], v[88:91], 0
    ds_read_b128 v[208:211], v8 offset:59392
    v_mfma_f32_16x16x32_bf16 v[148:151], v[212:215], v[92:95], v[148:151]
    ds_read_b128 v[212:215], v8 offset:60416
    s_waitcnt lgkmcnt(8)
    v_mfma_f32_16x16x32_bf16 v[148:151], v[216:219], v[96:99], v[148:151]
    buffer_load_dwordx4 a[52:55], v7, s[36:39], s81 offen offset:1024 sc1
    ds_read_b128 v[216:219], v8 offset:61440
    v_mfma_f32_16x16x32_bf16 v[148:151], v[220:223], v[100:103], v[148:151]
    ds_read_b128 v[220:223], v8 offset:62464
    s_waitcnt lgkmcnt(8)
    v_mfma_f32_16x16x32_bf16 v[148:151], v[224:227], v[104:107], v[148:151]
    ds_read_b128 v[224:227], v8 offset:63488
    v_mfma_f32_16x16x32_bf16 v[148:151], v[228:231], v[108:111], v[148:151]
    ds_read_b128 v[228:231], v8 offset:64512
    s_waitcnt lgkmcnt(8)
    buffer_load_dwordx4 a[56:59], v7, s[36:39], s81 offen offset:2048 sc1
    v_mfma_f32_16x16x32_bf16 v[148:151], v[80:83], v[112:115], v[148:151]
    ds_read_b128 v[80:83], v9 offset:0
    v_mfma_f32_16x16x32_bf16 v[148:151], v[84:87], v[116:119], v[148:151]
    ds_read_b128 v[84:87], v9 offset:1024
    s_waitcnt lgkmcnt(8)
    v_mfma_f32_16x16x32_bf16 v[148:151], v[200:203], v[120:123], v[148:151]
    ds_read_b128 v[200:203], v9 offset:2048
    v_mfma_f32_16x16x32_bf16 v[148:151], v[204:207], v[124:127], v[148:151]
    buffer_load_dwordx4 a[60:63], v7, s[36:39], s81 offen offset:3072 sc1
    ds_read_b128 v[204:207], v9 offset:3072
    s_waitcnt lgkmcnt(8)
    v_mfma_f32_16x16x32_bf16 v[148:151], v[208:211], v[128:131], v[148:151]
    ds_read_b128 v[208:211], v9 offset:4096
    v_mfma_f32_16x16x32_bf16 v[148:151], v[212:215], v[132:135], v[148:151]
    ds_read_b128 v[212:215], v9 offset:5120
    s_waitcnt lgkmcnt(8)
    v_mfma_f32_16x16x32_bf16 v[148:151], v[216:219], v[136:139], v[148:151]
    ds_read_b128 v[216:219], v9 offset:6144
    s_add_u32 s81, s8, 6307840
    buffer_load_dwordx4 a[64:67], v7, s[36:39], s81 offen offset:0 sc1
    v_mfma_f32_16x16x32_bf16 v[148:151], v[220:223], v[140:143], v[148:151]
    ds_read_b128 v[220:223], v9 offset:7168
    s_waitcnt lgkmcnt(8)
    v_mfma_f32_16x16x32_bf16 v[152:155], v[224:227], v[88:91], 0
    ds_read_b128 v[224:227], v9 offset:8192
    v_mfma_f32_16x16x32_bf16 v[152:155], v[228:231], v[92:95], v[152:155]
    ds_read_b128 v[228:231], v9 offset:9216
    s_waitcnt lgkmcnt(8)
    buffer_load_dwordx4 a[68:71], v7, s[36:39], s81 offen offset:1024 sc1
    v_mfma_f32_16x16x32_bf16 v[152:155], v[80:83], v[96:99], v[152:155]
    ds_read_b128 v[80:83], v9 offset:10240
    v_mfma_f32_16x16x32_bf16 v[152:155], v[84:87], v[100:103], v[152:155]
    ds_read_b128 v[84:87], v9 offset:11264
    s_waitcnt lgkmcnt(8)
    v_mfma_f32_16x16x32_bf16 v[152:155], v[200:203], v[104:107], v[152:155]
    ds_read_b128 v[200:203], v9 offset:12288
    v_mfma_f32_16x16x32_bf16 v[152:155], v[204:207], v[108:111], v[152:155]
    buffer_load_dwordx4 a[72:75], v7, s[36:39], s81 offen offset:2048 sc1
    ds_read_b128 v[204:207], v9 offset:13312
    s_waitcnt lgkmcnt(8)
    v_mfma_f32_16x16x32_bf16 v[152:155], v[208:211], v[112:115], v[152:155]
    ds_read_b128 v[208:211], v9 offset:14336
    v_mfma_f32_16x16x32_bf16 v[152:155], v[212:215], v[116:119], v[152:155]
    ds_read_b128 v[212:215], v9 offset:15360
    s_waitcnt lgkmcnt(8)
    v_mfma_f32_16x16x32_bf16 v[152:155], v[216:219], v[120:123], v[152:155]
    ds_read_b128 v[216:219], v9 offset:16384
    buffer_load_dwordx4 a[76:79], v7, s[36:39], s81 offen offset:3072 sc1
    v_mfma_f32_16x16x32_bf16 v[152:155], v[220:223], v[124:127], v[152:155]
    ds_read_b128 v[220:223], v9 offset:17408
    s_waitcnt lgkmcnt(8)
    v_mfma_f32_16x16x32_bf16 v[152:155], v[224:227], v[128:131], v[152:155]
    ds_read_b128 v[224:227], v9 offset:18432
    v_mfma_f32_16x16x32_bf16 v[152:155], v[228:231], v[132:135], v[152:155]
    ds_read_b128 v[228:231], v9 offset:19456
    s_waitcnt lgkmcnt(8)
    s_add_u32 s81, s8, 6311936
    buffer_load_dwordx4 a[80:83], v7, s[36:39], s81 offen offset:0 sc1
    v_mfma_f32_16x16x32_bf16 v[152:155], v[80:83], v[136:139], v[152:155]
    ds_read_b128 v[80:83], v9 offset:20480
    v_mfma_f32_16x16x32_bf16 v[152:155], v[84:87], v[140:143], v[152:155]
    ds_read_b128 v[84:87], v9 offset:21504
    s_waitcnt lgkmcnt(8)
    v_mfma_f32_16x16x32_bf16 v[156:159], v[200:203], v[88:91], 0
    ds_read_b128 v[200:203], v9 offset:22528
    v_mfma_f32_16x16x32_bf16 v[156:159], v[204:207], v[92:95], v[156:159]
    ds_read_b128 v[204:207], v9 offset:23552
    buffer_load_dwordx4 a[84:87], v7, s[36:39], s81 offen offset:1024 sc1
    s_waitcnt lgkmcnt(8)
    v_mfma_f32_16x16x32_bf16 v[156:159], v[208:211], v[96:99], v[156:159]
    ds_read_b128 v[208:211], v9 offset:24576
    v_mfma_f32_16x16x32_bf16 v[156:159], v[212:215], v[100:103], v[156:159]
    ds_read_b128 v[212:215], v9 offset:25600
    s_waitcnt lgkmcnt(8)
    v_mfma_f32_16x16x32_bf16 v[156:159], v[216:219], v[104:107], v[156:159]
    ds_read_b128 v[216:219], v7 offset:0
    buffer_load_dwordx4 a[88:91], v7, s[36:39], s81 offen offset:2048 sc1
    v_mfma_f32_16x16x32_bf16 v[156:159], v[220:223], v[108:111], v[156:159]
    ds_read_b128 v[220:223], v7 offset:1024
    s_waitcnt lgkmcnt(8)
    v_mfma_f32_16x16x32_bf16 v[156:159], v[224:227], v[112:115], v[156:159]
    ds_read_b128 v[224:227], v7 offset:2048
    v_mfma_f32_16x16x32_bf16 v[156:159], v[228:231], v[116:119], v[156:159]
    ds_read_b128 v[228:231], v7 offset:3072
    s_waitcnt lgkmcnt(8)
    buffer_load_dwordx4 v[72:75], v233, s[36:39], s77 offen sc1
    buffer_load_dwordx4 v[76:79], v233, s[36:39], s77 offen offset:1024 sc1
    s_add_u32 s81, s8, 6315008
    buffer_load_dwordx4 a[92:95], v7, s[36:39], s81 offen offset:0 sc1
    v_mfma_f32_16x16x32_bf16 v[156:159], v[80:83], v[120:123], v[156:159]
    ds_read_b128 v[80:83], v7 offset:4096
    v_mfma_f32_16x16x32_bf16 v[156:159], v[84:87], v[124:127], v[156:159]
    ds_read_b128 v[84:87], v7 offset:5120
    s_waitcnt lgkmcnt(8)
    v_mfma_f32_16x16x32_bf16 v[156:159], v[200:203], v[128:131], v[156:159]
    ds_read_b128 v[200:203], v7 offset:6144
    buffer_load_dwordx4 a[96:99], v7, s[36:39], s81 offen offset:1024 sc1
    v_mfma_f32_16x16x32_bf16 v[156:159], v[204:207], v[132:135], v[156:159]
    ds_read_b128 v[204:207], v7 offset:7168
    s_waitcnt lgkmcnt(8)
    v_mfma_f32_16x16x32_bf16 v[156:159], v[208:211], v[136:139], v[156:159]
    ds_read_b128 v[208:211], v7 offset:8192
    v_mfma_f32_16x16x32_bf16 v[156:159], v[212:215], v[140:143], v[156:159]
    buffer_load_dwordx4 a[100:103], v7, s[36:39], s81 offen offset:2048 sc1
    ds_read_b128 v[212:215], v7 offset:9216
    s_waitcnt lgkmcnt(8)
    v_mfma_f32_16x16x32_bf16 v[160:163], v[216:219], v[88:91], 0
    ds_read_b128 v[216:219], v7 offset:10240
    v_mfma_f32_16x16x32_bf16 v[160:163], v[220:223], v[92:95], v[160:163]
    ds_read_b128 v[220:223], v7 offset:11264
    s_waitcnt lgkmcnt(8)
    buffer_load_dwordx4 a[104:107], v7, s[36:39], s81 offen offset:3072 sc1
    v_mfma_f32_16x16x32_bf16 v[160:163], v[224:227], v[96:99], v[160:163]
    ds_read_b128 v[224:227], v7 offset:12288
    v_mfma_f32_16x16x32_bf16 v[160:163], v[228:231], v[100:103], v[160:163]
    ds_read_b128 v[228:231], v7 offset:13312
    s_waitcnt lgkmcnt(8)
    v_mfma_f32_16x16x32_bf16 v[160:163], v[80:83], v[104:107], v[160:163]
    s_add_u32 s81, s8, 6319104
    buffer_load_dwordx4 a[108:111], v7, s[36:39], s81 offen offset:0 sc1
    ds_read_b128 v[80:83], v7 offset:14336
    v_mfma_f32_16x16x32_bf16 v[160:163], v[84:87], v[108:111], v[160:163]
    ds_read_b128 v[84:87], v7 offset:15360
    s_waitcnt lgkmcnt(8)
    v_mfma_f32_16x16x32_bf16 v[160:163], v[200:203], v[112:115], v[160:163]
    ds_read_b128 v[200:203], v7 offset:16384
    v_mfma_f32_16x16x32_bf16 v[160:163], v[204:207], v[116:119], v[160:163]
    buffer_load_dwordx4 a[112:115], v7, s[36:39], s81 offen offset:1024 sc1
    ds_read_b128 v[204:207], v7 offset:17408
    s_waitcnt lgkmcnt(8)
    v_mfma_f32_16x16x32_bf16 v[160:163], v[208:211], v[120:123], v[160:163]
    ds_read_b128 v[208:211], v7 offset:18432
    v_mfma_f32_16x16x32_bf16 v[160:163], v[212:215], v[124:127], v[160:163]
    ds_read_b128 v[212:215], v7 offset:19456
    buffer_load_dwordx4 a[116:119], v7, s[36:39], s81 offen offset:2048 sc1
    s_waitcnt lgkmcnt(8)
    v_mfma_f32_16x16x32_bf16 v[160:163], v[216:219], v[128:131], v[160:163]
    ds_read_b128 v[216:219], v7 offset:20480
    v_mfma_f32_16x16x32_bf16 v[160:163], v[220:223], v[132:135], v[160:163]
    ds_read_b128 v[220:223], v7 offset:21504
    s_waitcnt lgkmcnt(8)
    buffer_load_dwordx4 a[120:123], v7, s[36:39], s81 offen offset:3072 sc1
    v_mfma_f32_16x16x32_bf16 v[160:163], v[224:227], v[136:139], v[160:163]
    ds_read_b128 v[224:227], v7 offset:22528
    v_mfma_f32_16x16x32_bf16 v[160:163], v[228:231], v[140:143], v[160:163]
    ds_read_b128 v[228:231], v7 offset:23552
    s_waitcnt lgkmcnt(8)
    v_mfma_f32_16x16x32_bf16 v[164:167], v[80:83], v[88:91], 0
    ds_read_b128 v[80:83], v7 offset:24576
    s_add_u32 s81, s8, 6323200
    buffer_load_dwordx4 a[124:127], v7, s[36:39], s81 offen offset:0 sc1
    v_mfma_f32_16x16x32_bf16 v[164:167], v[84:87], v[92:95], v[164:167]
    ds_read_b128 v[84:87], v7 offset:25600
    s_waitcnt lgkmcnt(8)
    v_mfma_f32_16x16x32_bf16 v[164:167], v[200:203], v[96:99], v[164:167]
    ds_read_b128 v[200:203], v7 offset:26624
    v_mfma_f32_16x16x32_bf16 v[164:167], v[204:207], v[100:103], v[164:167]
    buffer_load_dwordx4 a[128:131], v7, s[36:39], s81 offen offset:1024 sc1
    ds_read_b128 v[204:207], v7 offset:27648
    s_waitcnt lgkmcnt(8)
    v_mfma_f32_16x16x32_bf16 v[164:167], v[208:211], v[104:107], v[164:167]
    ds_read_b128 v[208:211], v7 offset:28672
    v_mfma_f32_16x16x32_bf16 v[164:167], v[212:215], v[108:111], v[164:167]
    ds_read_b128 v[212:215], v7 offset:29696
    s_waitcnt lgkmcnt(8)
    buffer_load_dwordx4 a[132:135], v7, s[36:39], s81 offen offset:2048 sc1
    v_mfma_f32_16x16x32_bf16 v[164:167], v[216:219], v[112:115], v[164:167]
    ds_read_b128 v[216:219], v7 offset:30720
    v_mfma_f32_16x16x32_bf16 v[164:167], v[220:223], v[116:119], v[164:167]
    ds_read_b128 v[220:223], v7 offset:31744
    s_waitcnt lgkmcnt(8)
    v_mfma_f32_16x16x32_bf16 v[164:167], v[224:227], v[120:123], v[164:167]
    buffer_load_dwordx4 a[136:139], v7, s[36:39], s81 offen offset:3072 sc1
    ds_read_b128 v[224:227], v7 offset:32768
    v_mfma_f32_16x16x32_bf16 v[164:167], v[228:231], v[124:127], v[164:167]
    ds_read_b128 v[228:231], v7 offset:33792
    s_waitcnt lgkmcnt(8)
    v_mfma_f32_16x16x32_bf16 v[164:167], v[80:83], v[128:131], v[164:167]
    ds_read_b128 v[80:83], v7 offset:34816
    s_add_u32 s81, s8, 6327296
    buffer_load_dwordx4 a[140:143], v7, s[36:39], s81 offen offset:0 sc1
    v_mfma_f32_16x16x32_bf16 v[164:167], v[84:87], v[132:135], v[164:167]
    ds_read_b128 v[84:87], v7 offset:35840
    s_waitcnt lgkmcnt(8)
    v_mfma_f32_16x16x32_bf16 v[164:167], v[200:203], v[136:139], v[164:167]
    ds_read_b128 v[200:203], v7 offset:36864
    v_mfma_f32_16x16x32_bf16 v[164:167], v[204:207], v[140:143], v[164:167]
    ds_read_b128 v[204:207], v7 offset:37888
    buffer_load_dwordx4 a[144:147], v7, s[36:39], s81 offen offset:1024 sc1
    s_waitcnt lgkmcnt(8)
    v_mfma_f32_16x16x32_bf16 v[168:171], v[208:211], v[88:91], 0
    ds_read_b128 v[208:211], v7 offset:38912
    v_mfma_f32_16x16x32_bf16 v[168:171], v[212:215], v[92:95], v[168:171]
    ds_read_b128 v[212:215], v7 offset:39936
    s_waitcnt lgkmcnt(8)
    buffer_load_dwordx4 a[148:151], v7, s[36:39], s81 offen offset:2048 sc1
    v_mfma_f32_16x16x32_bf16 v[168:171], v[216:219], v[96:99], v[168:171]
    ds_read_b128 v[216:219], v7 offset:40960
    v_mfma_f32_16x16x32_bf16 v[168:171], v[220:223], v[100:103], v[168:171]
    ds_read_b128 v[220:223], v7 offset:41984
    s_waitcnt lgkmcnt(8)
    v_mfma_f32_16x16x32_bf16 v[168:171], v[224:227], v[104:107], v[168:171]
    v_mfma_f32_16x16x32_bf16 v[168:171], v[228:231], v[108:111], v[168:171]
    buffer_load_dwordx4 a[152:155], v7, s[36:39], s81 offen offset:3072 sc1
    s_waitcnt lgkmcnt(6)
    v_mfma_f32_16x16x32_bf16 v[168:171], v[80:83], v[112:115], v[168:171]
    v_mfma_f32_16x16x32_bf16 v[168:171], v[84:87], v[116:119], v[168:171]
    s_waitcnt lgkmcnt(4)
    v_mfma_f32_16x16x32_bf16 v[168:171], v[200:203], v[120:123], v[168:171]
    v_mfma_f32_16x16x32_bf16 v[168:171], v[204:207], v[124:127], v[168:171]
    s_add_u32 s81, s8, 6331392
    buffer_load_dwordx4 a[156:159], v7, s[36:39], s81 offen offset:0 sc1
    s_waitcnt lgkmcnt(2)
    v_mfma_f32_16x16x32_bf16 v[168:171], v[208:211], v[128:131], v[168:171]
L_pad_2931:
    s_cbranch_execz L_ret_1
    v_mfma_f32_16x16x32_bf16 v[168:171], v[212:215], v[132:135], v[168:171]
    s_waitcnt lgkmcnt(0)
    v_mfma_f32_16x16x32_bf16 v[168:171], v[216:219], v[136:139], v[168:171]
    v_mfma_f32_16x16x32_bf16 v[168:171], v[220:223], v[140:143], v[168:171]
    s_lshl2_add_u32 s88, s41, s42
    s_lshl_b32 s88, s88, 10
    s_add_u32 s88, s88, 720896
    v_lshlrev_b32 v20, 7, v1
    v_mov_b32 v23, s44
    s_bfm_b64 exec, 8, 0
    buffer_load_dword v23, v20, s[36:39], s88 offen sc1
    s_mov_b64 exec, -1
    s_waitcnt vmcnt(19)
    v_cmp_ne_u32 vcc, s44, v74
    s_waitcnt vmcnt(18)
    v_cmp_ne_u32 s[70:71], s44, v78
    s_or_b64 vcc, vcc, s[70:71]
    s_cbranch_scc1 ss_13
sb_14:
    v_pk_add_f32 v[72:73], v[72:73], v[76:77]
    s_nop 1
    v_add_f32_dpp v72, v72, v72 row_ror:4 row_mask:0xf bank_mask:0xf
    v_add_f32_dpp v73, v73, v73 row_ror:4 row_mask:0xf bank_mask:0xf
    s_nop 0
    v_add_f32_dpp v72, v72, v72 row_ror:8 row_mask:0xf bank_mask:0xf
    v_add_f32_dpp v73, v73, v73 row_ror:8 row_mask:0xf bank_mask:0xf
    v_mul_f32 v72, 0x3a924925, v72
    v_mul_f32 v73, 0x3a924925, v73
    v_fma_f32 v73, -v72, v72, v73
    v_max_f32 v73, 0, v73
    v_add_f32 v73, s53, v73
    v_rsq_f32 v74, v73
    s_nop 0
    v_mul_f32_e64 v75, -v72, v74
    v_mov_b32_dpp v64, v74 quad_perm:[0,0,0,0] row_mask:0xf bank_mask:0xf
    v_mov_b32_dpp v65, v74 quad_perm:[1,1,1,1] row_mask:0xf bank_mask:0xf
    v_mov_b32_dpp v66, v74 quad_perm:[2,2,2,2] row_mask:0xf bank_mask:0xf
    v_mov_b32_dpp v67, v74 quad_perm:[3,3,3,3] row_mask:0xf bank_mask:0xf
    v_mov_b32_dpp v68, v75 quad_perm:[0,0,0,0] row_mask:0xf bank_mask:0xf
    v_mov_b32_dpp v69, v75 quad_perm:[1,1,1,1] row_mask:0xf bank_mask:0xf
    v_mov_b32_dpp v70, v75 quad_perm:[2,2,2,2] row_mask:0xf bank_mask:0xf
    v_mov_b32_dpp v71, v75 quad_perm:[3,3,3,3] row_mask:0xf bank_mask:0xf
    v_pk_fma_f32 v[172:173], v[172:173], v[64:65], v[68:69]
    v_pk_fma_f32 v[174:175], v[174:175], v[66:67], v[70:71]
    v_cvt_pk_bf16_f32 v72, v172, v173
    v_cvt_pk_bf16_f32 v73, v174, v175
    v_pk_fma_f32 v[176:177], v[176:177], v[64:65], v[68:69]
    v_pk_fma_f32 v[178:179], v[178:179], v[66:67], v[70:71]
    v_cvt_pk_bf16_f32 v74, v176, v177
    v_cvt_pk_bf16_f32 v75, v178, v179
    s_nop 0
    v_permlane16_swap_b32 v72, v74
    v_permlane16_swap_b32 v73, v75
    v_and_b32 v72, -2, v72
    s_add_u32 s78, s83, 20971520
    buffer_store_dwordx4 v[72:75], v15, s[36:39], s78 offen sc1
    v_pk_fma_f32 v[180:181], v[180:181], v[64:65], v[68:69]
    v_pk_fma_f32 v[182:183], v[182:183], v[66:67], v[70:71]
    v_cvt_pk_bf16_f32 v76, v180, v181
    v_cvt_pk_bf16_f32 v77, v182, v183
    v_pk_fma_f32 v[184:185], v[184:185], v[64:65], v[68:69]
    v_pk_fma_f32 v[186:187], v[186:187], v[66:67], v[70:71]
    v_cvt_pk_bf16_f32 v78, v184, v185
    v_cvt_pk_bf16_f32 v79, v186, v187
    s_nop 0
    v_permlane16_swap_b32 v76, v78
    v_permlane16_swap_b32 v77, v79
    v_and_b32 v76, -2, v76
    s_add_u32 s78, s83, 21102592
    buffer_store_dwordx4 v[76:79], v15, s[36:39], s78 offen sc1
    v_pk_fma_f32 v[188:189], v[188:189], v[64:65], v[68:69]
    v_pk_fma_f32 v[190:191], v[190:191], v[66:67], v[70:71]
    v_cvt_pk_bf16_f32 v72, v188, v189
    v_cvt_pk_bf16_f32 v73, v190, v191
    v_pk_fma_f32 v[192:193], v[192:193], v[64:65], v[68:69]
    v_pk_fma_f32 v[194:195], v[194:195], v[66:67], v[70:71]
    v_cvt_pk_bf16_f32 v74, v192, v193
    v_cvt_pk_bf16_f32 v75, v194, v195
    s_nop 0
    v_permlane16_swap_b32 v72, v74
    v_permlane16_swap_b32 v73, v75
    v_and_b32 v72, -2, v72
    s_add_u32 s78, s83, 21233664
    buffer_store_dwordx4 v[72:75], v15, s[36:39], s78 offen sc1
    v_pk_fma_f32 v[196:197], v[196:197], v[64:65], v[68:69]
    v_pk_fma_f32 v[198:199], v[198:199], v[66:67], v[70:71]
    v_cvt_pk_bf16_f32 v76, v196, v197
    v_cvt_pk_bf16_f32 v77, v198, v199
    s_nop 0
    v_permlane16_swap_b32 v76, v78
    v_permlane16_swap_b32 v77, v79
    v_and_b32 v76, -2, v76
    s_add_u32 s78, s84, 20971520
    s_mov_b32 exec_lo, 0xffff
    s_mov_b32 exec_hi, 0xffff
    buffer_store_dwordx4 v[76:79], v15, s[36:39], s78 offen sc1
    s_mov_b64 exec, -1
    s_barrier
    s_lshl_b32 s70, s42, 11
    s_add_u32 s70, s70, 32768
    v_lshl_add_u32 v64, v4, 4, s70
    v_add_u32_e64 v65, s70, v7
    s_cmp_lt_u32 s89, 3
    s_cbranch_scc1 x1n_16
    s_cmp_lt_u32 s89, 5
    s_cbranch_scc1 x1n_17
    s_cmp_lt_u32 s89, 6
    s_cbranch_scc1 x1n_18
    s_lshl_b64 exec, s[66:67], 16
    ds_write_b128 v64, v[140:143] offset:0
    s_lshl_b64 exec, s[66:67], 0
    ds_write_b128 v64, v[116:119] offset:256
    ds_write_b128 v64, v[120:123] offset:512
    ds_write_b128 v64, v[124:127] offset:768
    ds_write_b128 v64, v[128:131] offset:1024
    ds_write_b128 v64, v[132:135] offset:1280
    ds_write_b128 v64, v[136:139] offset:1536
    ds_write_b128 v64, v[140:143] offset:1792
    s_branch x1d_15
x1n_18:
    s_lshl_b64 exec, s[66:67], 32
    ds_write_b128 v64, v[136:139] offset:0
    ds_write_b128 v64, v[140:143] offset:256
    s_lshl_b64 exec, s[66:67], 16
    ds_write_b128 v64, v[116:119] offset:512
    ds_write_b128 v64, v[120:123] offset:768
    ds_write_b128 v64, v[124:127] offset:1024
    ds_write_b128 v64, v[128:131] offset:1280
    ds_write_b128 v64, v[132:135] offset:1536
    ds_write_b128 v64, v[136:139] offset:1792
    s_branch x1d_15
x1n_17:
    s_cmp_lt_u32 s89, 4
    s_cbranch_scc1 x1n_19
    s_lshl_b64 exec, s[66:67], 48
    ds_write_b128 v64, v[132:135] offset:0
    ds_write_b128 v64, v[136:139] offset:256
    ds_write_b128 v64, v[140:143] offset:512
    s_lshl_b64 exec, s[66:67], 32
    ds_write_b128 v64, v[116:119] offset:768
    ds_write_b128 v64, v[120:123] offset:1024
    ds_write_b128 v64, v[124:127] offset:1280
    ds_write_b128 v64, v[128:131] offset:1536
    ds_write_b128 v64, v[132:135] offset:1792
    s_branch x1d_15
x1n_19:
    s_lshl_b64 exec, s[66:67], 48
    ds_write_b128 v64, v[100:103] offset:0
    ds_write_b128 v64, v[104:107] offset:256
    ds_write_b128 v64, v[108:111] offset:512
    ds_write_b128 v64, v[112:115] offset:768
    s_lshl_b64 exec, s[66:67], 48
    ds_write_b128 v64, v[116:119] offset:1024
    ds_write_b128 v64, v[120:123] offset:1280
    ds_write_b128 v64, v[124:127] offset:1536
    ds_write_b128 v64, v[128:131] offset:1792
    s_branch x1d_15
x1n_16:
    s_cmp_lt_u32 s89, 1
    s_cbranch_scc1 x1n_20
    s_cmp_lt_u32 s89, 2
    s_cbranch_scc1 x1n_21
    s_lshl_b64 exec, s[66:67], 32
    ds_write_b128 v64, v[96:99] offset:0
    ds_write_b128 v64, v[100:103] offset:256
    ds_write_b128 v64, v[104:107] offset:512
    ds_write_b128 v64, v[108:111] offset:768
    ds_write_b128 v64, v[112:115] offset:1024
    s_lshl_b64 exec, s[66:67], 48
    ds_write_b128 v64, v[88:91] offset:1280
    ds_write_b128 v64, v[92:95] offset:1536
    ds_write_b128 v64, v[96:99] offset:1792
    s_branch x1d_15
x1n_21:
    s_lshl_b64 exec, s[66:67], 16
    ds_write_b128 v64, v[92:95] offset:0
    ds_write_b128 v64, v[96:99] offset:256
    ds_write_b128 v64, v[100:103] offset:512
    ds_write_b128 v64, v[104:107] offset:768
    ds_write_b128 v64, v[108:111] offset:1024
    ds_write_b128 v64, v[112:115] offset:1280
    s_lshl_b64 exec, s[66:67], 32
    ds_write_b128 v64, v[88:91] offset:1536
    ds_write_b128 v64, v[92:95] offset:1792
    s_branch x1d_15
x1n_20:
    s_lshl_b64 exec, s[66:67], 0
    ds_write_b128 v64, v[88:91] offset:0
    ds_write_b128 v64, v[92:95] offset:256
    ds_write_b128 v64, v[96:99] offset:512
    ds_write_b128 v64, v[100:103] offset:768
    ds_write_b128 v64, v[104:107] offset:1024
    ds_write_b128 v64, v[108:111] offset:1280
    ds_write_b128 v64, v[112:115] offset:1536
    s_lshl_b64 exec, s[66:67], 16
    ds_write_b128 v64, v[88:91] offset:1792
x1d_15:
    s_mov_b64 exec, -1
    ds_read_b128 v[236:239], v65 offset:0
    ds_read_b128 v[240:243], v65 offset:1024
    s_add_u32 s81, s8, 6332416
    buffer_load_dwordx4 a[160:163], v7, s[36:39], s81 offen offset:0 sc1
    v_pk_mul_f32 v[64:65], v[144:145], v[144:145]
    v_pk_mul_f32 v[66:67], v[146:147], v[146:147]
    v_pk_mul_f32 v[68:69], v[148:149], v[148:149]
    v_pk_mul_f32 v[70:71], v[150:151], v[150:151]
    v_pk_fma_f32 v[64:65], v[64:65], s[60:61], v[12:13]
    v_pk_fma_f32 v[66:67], v[66:67], s[60:61], v[12:13]
    buffer_load_dwordx4 a[164:167], v7, s[36:39], s81 offen offset:1024 sc1
    v_pk_fma_f32 v[68:69], v[68:69], s[60:61], v[12:13]
    v_pk_fma_f32 v[70:71], v[70:71], s[60:61], v[12:13]
    v_pk_mul_f32 v[64:65], v[64:65], v[144:145]
    v_pk_mul_f32 v[66:67], v[66:67], v[146:147]
    v_pk_mul_f32 v[68:69], v[68:69], v[148:149]
    buffer_load_dwordx4 a[168:171], v7, s[36:39], s81 offen offset:2048 sc1
    v_pk_mul_f32 v[70:71], v[70:71], v[150:151]
    v_exp_f32 v64, v64
    v_exp_f32 v65, v65
    v_exp_f32 v66, v66
    v_exp_f32 v67, v67
    buffer_load_dwordx4 a[172:175], v7, s[36:39], s81 offen offset:3072 sc1
    v_exp_f32 v68, v68
    v_exp_f32 v69, v69
    v_exp_f32 v70, v70
    v_exp_f32 v71, v71
    v_pk_add_f32 v[64:65], v[64:65], 1.0 op_sel_hi:[1,0]
    s_add_u32 s81, s8, 6336512
    buffer_load_dwordx4 a[176:179], v7, s[36:39], s81 offen offset:0 sc1
    v_pk_add_f32 v[66:67], v[66:67], 1.0 op_sel_hi:[1,0]
    v_pk_add_f32 v[68:69], v[68:69], 1.0 op_sel_hi:[1,0]
    v_pk_add_f32 v[70:71], v[70:71], 1.0 op_sel_hi:[1,0]
    v_rcp_f32 v64, v64
    v_rcp_f32 v65, v65
    v_rcp_f32_e64 v66, v66
    buffer_load_dwordx4 a[180:183], v7, s[36:39], s81 offen offset:1024 sc1
    v_rcp_f32 v67, v67
    v_rcp_f32 v68, v68
    v_rcp_f32 v69, v69
    v_rcp_f32 v70, v70
    v_rcp_f32_e64 v71, v71
    buffer_load_dwordx4 a[184:187], v7, s[36:39], s81 offen offset:2048 sc1
    v_pk_mul_f32 v[144:145], v[144:145], v[64:65]
    v_pk_mul_f32 v[146:147], v[146:147], v[66:67]
    v_pk_mul_f32 v[148:149], v[148:149], v[68:69]
    v_pk_mul_f32 v[150:151], v[150:151], v[70:71]
    v_pk_mul_f32 v[64:65], v[152:153], v[152:153]
    buffer_load_dwordx4 a[188:191], v7, s[36:39], s81 offen offset:3072 sc1
    v_pk_mul_f32 v[66:67], v[154:155], v[154:155]
    v_pk_mul_f32 v[68:69], v[156:157], v[156:157]
    v_pk_mul_f32 v[70:71], v[158:159], v[158:159]
    v_pk_fma_f32 v[64:65], v[64:65], s[60:61], v[12:13]
    v_pk_fma_f32 v[66:67], v[66:67], s[60:61], v[12:13]
    s_add_u32 s81, s8, 6340608
    buffer_load_dwordx4 a[192:195], v7, s[36:39], s81 offen offset:0 sc1
    v_pk_fma_f32 v[68:69], v[68:69], s[60:61], v[12:13]
    v_pk_fma_f32 v[70:71], v[70:71], s[60:61], v[12:13]
    v_pk_mul_f32 v[64:65], v[64:65], v[152:153]
    v_pk_mul_f32 v[66:67], v[66:67], v[154:155]
    v_pk_mul_f32 v[68:69], v[68:69], v[156:157]
    v_pk_mul_f32 v[70:71], v[70:71], v[158:159]
    buffer_load_dwordx4 a[196:199], v7, s[36:39], s81 offen offset:1024 sc1
    v_exp_f32 v64, v64
    v_exp_f32 v65, v65
    v_exp_f32 v66, v66
    v_exp_f32 v67, v67
    v_exp_f32_e64 v68, v68
    buffer_load_dwordx4 a[200:203], v7, s[36:39], s81 offen offset:2048 sc1
    v_exp_f32 v69, v69
    v_exp_f32 v70, v70
    v_exp_f32_e64 v71, v71
    v_pk_add_f32 v[64:65], v[64:65], 1.0 op_sel_hi:[1,0]
    v_pk_add_f32 v[66:67], v[66:67], 1.0 op_sel_hi:[1,0]
    buffer_load_dwordx4 a[204:207], v7, s[36:39], s81 offen offset:3072 sc1
    v_pk_add_f32 v[68:69], v[68:69], 1.0 op_sel_hi:[1,0]
    v_pk_add_f32 v[70:71], v[70:71], 1.0 op_sel_hi:[1,0]
    v_rcp_f32 v64, v64
    v_rcp_f32 v65, v65
    v_rcp_f32_e64 v66, v66
    s_add_u32 s81, s8, 6344704
    buffer_load_dwordx4 a[208:211], v7, s[36:39], s81 offen offset:0 sc1
    v_rcp_f32 v67, v67
    v_rcp_f32 v68, v68
    v_rcp_f32 v69, v69
    v_rcp_f32 v70, v70
    v_rcp_f32_e64 v71, v71
    v_pk_mul_f32 v[152:153], v[152:153], v[64:65]
    buffer_load_dwordx4 a[212:215], v7, s[36:39], s81 offen offset:1024 sc1
    v_pk_mul_f32 v[154:155], v[154:155], v[66:67]
    v_pk_mul_f32 v[156:157], v[156:157], v[68:69]
    v_pk_mul_f32 v[158:159], v[158:159], v[70:71]
    v_pk_mul_f32 v[64:65], v[160:161], v[160:161]
    v_pk_mul_f32 v[66:67], v[162:163], v[162:163]
    buffer_load_dwordx4 a[216:219], v7, s[36:39], s81 offen offset:2048 sc1
    v_pk_mul_f32 v[68:69], v[164:165], v[164:165]
    v_pk_mul_f32 v[70:71], v[166:167], v[166:167]
    v_pk_fma_f32 v[64:65], v[64:65], s[60:61], v[12:13]
    v_pk_fma_f32 v[66:67], v[66:67], s[60:61], v[12:13]
    v_pk_fma_f32 v[68:69], v[68:69], s[60:61], v[12:13]
    buffer_load_dwordx4 a[220:223], v7, s[36:39], s81 offen offset:3072 sc1
    v_pk_fma_f32 v[70:71], v[70:71], s[60:61], v[12:13]
    v_pk_mul_f32 v[64:65], v[64:65], v[160:161]
    v_pk_mul_f32 v[66:67], v[66:67], v[162:163]
    v_pk_mul_f32 v[68:69], v[68:69], v[164:165]
    v_pk_mul_f32 v[70:71], v[70:71], v[166:167]
    s_add_u32 s81, s8, 6348800
    buffer_load_dwordx4 a[224:227], v7, s[36:39], s81 offen offset:0 sc1
    v_exp_f32 v64, v64
    v_exp_f32 v65, v65
    v_exp_f32 v66, v66
    v_exp_f32 v67, v67
    v_exp_f32 v68, v68
    v_exp_f32 v69, v69
    buffer_load_dwordx4 a[228:231], v7, s[36:39], s81 offen offset:1024 sc1
    v_exp_f32 v70, v70
    v_exp_f32 v71, v71
    v_pk_add_f32 v[64:65], v[64:65], 1.0 op_sel_hi:[1,0]
    v_pk_add_f32 v[66:67], v[66:67], 1.0 op_sel_hi:[1,0]
    v_pk_add_f32 v[68:69], v[68:69], 1.0 op_sel_hi:[1,0]
    buffer_load_dwordx4 a[232:235], v7, s[36:39], s81 offen offset:2048 sc1
    v_pk_add_f32 v[70:71], v[70:71], 1.0 op_sel_hi:[1,0]
    v_rcp_f32 v64, v64
    v_rcp_f32 v65, v65
    v_rcp_f32 v66, v66
    v_rcp_f32 v67, v67
    buffer_load_dwordx4 a[236:239], v7, s[36:39], s81 offen offset:3072 sc1
    v_rcp_f32 v68, v68
    v_rcp_f32 v69, v69
    v_rcp_f32 v70, v70
    v_rcp_f32 v71, v71
    v_pk_mul_f32 v[160:161], v[160:161], v[64:65]
    s_add_u32 s81, s8, 6352896
    buffer_load_dwordx4 a[240:243], v7, s[36:39], s81 offen offset:0 sc1
    v_pk_mul_f32 v[162:163], v[162:163], v[66:67]
    v_pk_mul_f32 v[164:165], v[164:165], v[68:69]
    v_pk_mul_f32 v[166:167], v[166:167], v[70:71]
    v_pk_mul_f32 v[64:65], v[168:169], v[168:169]
    v_pk_mul_f32 v[66:67], v[170:171], v[170:171]
    v_pk_fma_f32 v[64:65], v[64:65], s[60:61], v[12:13]
    buffer_load_dwordx4 a[244:247], v7, s[36:39], s81 offen offset:1024 sc1
    v_pk_fma_f32 v[66:67], v[66:67], s[60:61], v[12:13]
    v_pk_mul_f32 v[64:65], v[64:65], v[168:169]
    v_pk_mul_f32 v[66:67], v[66:67], v[170:171]
    v_exp_f32 v64, v64
    v_exp_f32 v65, v65
    buffer_load_dwordx4 a[248:251], v7, s[36:39], s81 offen offset:2048 sc1
    v_exp_f32 v66, v66
    v_exp_f32 v67, v67
    v_pk_add_f32 v[64:65], v[64:65], 1.0 op_sel_hi:[1,0]
    v_pk_add_f32 v[66:67], v[66:67], 1.0 op_sel_hi:[1,0]
    v_rcp_f32_e64 v64, v64
    buffer_load_dwordx4 a[252:255], v7, s[36:39], s81 offen offset:3072 sc1
    v_rcp_f32 v65, v65
    v_rcp_f32 v66, v66
    v_rcp_f32_e64 v67, v67
    v_pk_mul_f32 v[168:169], v[168:169], v[64:65]
    v_pk_mul_f32 v[170:171], v[170:171], v[66:67]
    s_waitcnt vmcnt(28)
    v_cmp_ne_u32 vcc, s44, v23
    s_cbranch_vccnz ps_22
pb_23:
    s_lshl_b32 s70, s42, 12
    v_add_u32_e64 v66, s70, v7
    v_xor_b32 v23, 4096, v66
    v_xor_b32 v64, 8192, v66
    v_xor_b32 v65, 12288, v66
    s_lshl_b32 s70, s42, 14
    s_add_u32 s70, s70, 20971520
    s_lshl_b32 s73, s45, 16
    s_add_u32 s73, s73, s70
    s_lshl_b32 s74, s46, 16
    s_add_u32 s74, s74, s70
    s_mul_i32 s75, s52, 28672
    s_waitcnt vmcnt(24)
    s_add_u32 s77, s73, 0
    s_nop 0
    buffer_load_dwordx4 v[68:71], v7, s[36:39], s77 offen offset:0 sc1
    buffer_load_dwordx4 v[72:75], v7, s[36:39], s77 offen offset:1024 sc1
    buffer_load_dwordx4 v[76:79], v7, s[36:39], s77 offen offset:2048 sc1
    buffer_load_dwordx4 v[80:83], v7, s[36:39], s77 offen offset:3072 sc1
    s_add_u32 s77, s73, 4096
    buffer_load_dwordx4 v[84:87], v7, s[36:39], s77 offen offset:0 sc1
    buffer_load_dwordx4 v[88:91], v7, s[36:39], s77 offen offset:1024 sc1
    buffer_load_dwordx4 v[92:95], v7, s[36:39], s77 offen offset:2048 sc1
    buffer_load_dwordx4 v[96:99], v7, s[36:39], s77 offen offset:3072 sc1
    s_add_u32 s77, s73, 8192
    buffer_load_dwordx4 v[100:103], v7, s[36:39], s77 offen offset:0 sc1
    buffer_load_dwordx4 v[104:107], v7, s[36:39], s77 offen offset:1024 sc1
    buffer_load_dwordx4 v[108:111], v7, s[36:39], s77 offen offset:2048 sc1
    s_mov_b64 exec, 0
    s_cmp_eq_u32 s42, 0
    s_cbranch_scc1 L_pad_9258
    s_cmp_eq_u32 s42, 1
    s_cbranch_scc1 L_pad_9495
    s_cmp_eq_u32 s42, 2
    s_cbranch_scc1 L_pad_4733
    s_branch L_pad_5334
L_ret_2:
    s_mov_b64 exec, -1
    s_waitcnt vmcnt(7)
    v_bitop3_b32 v20, v68, v72, v76 bitop3:254
    v_bitop3_b32 v20, v20, v80, -2 bitop3:254
    v_cmp_eq_u32 vcc, -1, v20
    s_cbranch_vccnz cs_24
cb_25:
    v_mfma_f32_16x16x32_bf16 v[204:207], v[68:71], a[0:3], 0
    buffer_load_dwordx4 v[112:115], v7, s[36:39], s77 offen offset:3072 sc1
    v_mfma_f32_16x16x32_bf16 v[204:207], v[72:75], a[16:19], v[204:207]
    s_add_u32 s77, s73, 12288
    v_mfma_f32_16x16x32_bf16 v[208:211], v[72:75], a[20:23], 0
    buffer_load_dwordx4 v[116:119], v7, s[36:39], s77 offen offset:0 sc1
    v_mfma_f32_16x16x32_bf16 v[208:211], v[68:71], a[4:7], v[208:211]
    v_mfma_f32_16x16x32_bf16 v[212:215], v[68:71], a[8:11], 0
    buffer_load_dwordx4 v[120:123], v7, s[36:39], s77 offen offset:1024 sc1
    v_mfma_f32_16x16x32_bf16 v[212:215], v[72:75], a[24:27], v[212:215]
    v_mfma_f32_16x16x32_bf16 v[216:219], v[72:75], a[28:31], 0
    v_mfma_f32_16x16x32_bf16 v[216:219], v[68:71], a[12:15], v[216:219]
    v_mfma_f32_16x16x32_bf16 v[216:219], v[76:79], a[44:47], v[216:219]
    buffer_load_dwordx4 v[124:127], v7, s[36:39], s77 offen offset:2048 sc1
    v_mfma_f32_16x16x32_bf16 v[216:219], v[80:83], a[60:63], v[216:219]
    v_mfma_f32_16x16x32_bf16 v[212:215], v[80:83], a[56:59], v[212:215]
    v_mfma_f32_16x16x32_bf16 v[212:215], v[76:79], a[40:43], v[212:215]
    v_mfma_f32_16x16x32_bf16 v[208:211], v[76:79], a[36:39], v[208:211]
    buffer_load_dwordx4 v[128:131], v7, s[36:39], s77 offen offset:3072 sc1
    v_mfma_f32_16x16x32_bf16 v[208:211], v[80:83], a[52:55], v[208:211]
    s_waitcnt vmcnt(8)
    v_bitop3_b32 v20, v84, v88, v92 bitop3:254
    v_mfma_f32_16x16x32_bf16 v[204:207], v[80:83], a[48:51], v[204:207]
    v_bitop3_b32 v20, v20, v96, -2 bitop3:254
    v_cmp_eq_u32 vcc, -1, v20
    v_mfma_f32_16x16x32_bf16 v[204:207], v[76:79], a[32:35], v[204:207]
    s_cbranch_vccnz cs_26
cb_27:
    s_nop 0
    v_mfma_f32_16x16x32_bf16 v[204:207], v[84:87], a[64:67], v[204:207]
    s_add_u32 s77, s73, 65536
    buffer_load_dwordx4 v[68:71], v7, s[36:39], s77 offen offset:0 sc1
    v_mfma_f32_16x16x32_bf16 v[204:207], v[88:91], a[80:83], v[204:207]
    v_mfma_f32_16x16x32_bf16 v[208:211], v[88:91], a[84:87], v[208:211]
    buffer_load_dwordx4 v[72:75], v7, s[36:39], s77 offen offset:1024 sc1
    v_mfma_f32_16x16x32_bf16 v[208:211], v[84:87], a[68:71], v[208:211]
    v_mfma_f32_16x16x32_bf16 v[212:215], v[84:87], a[72:75], v[212:215]
    buffer_load_dwordx4 v[76:79], v7, s[36:39], s77 offen offset:2048 sc1
    v_mfma_f32_16x16x32_bf16 v[212:215], v[88:91], a[88:91], v[212:215]
    v_mfma_f32_16x16x32_bf16 v[216:219], v[88:91], a[92:95], v[216:219]
    v_mfma_f32_16x16x32_bf16 v[216:219], v[84:87], a[76:79], v[216:219]
    v_mfma_f32_16x16x32_bf16 v[216:219], v[92:95], a[108:111], v[216:219]
    buffer_load_dwordx4 v[80:83], v7, s[36:39], s77 offen offset:3072 sc1
    v_mfma_f32_16x16x32_bf16 v[216:219], v[96:99], a[124:127], v[216:219]
    v_mfma_f32_16x16x32_bf16 v[212:215], v[96:99], a[120:123], v[212:215]
    v_mfma_f32_16x16x32_bf16 v[212:215], v[92:95], a[104:107], v[212:215]
    v_mfma_f32_16x16x32_bf16 v[208:211], v[92:95], a[100:103], v[208:211]
    s_add_u32 s77, s73, 69632
    buffer_load_dwordx4 v[84:87], v7, s[36:39], s77 offen offset:0 sc1
    v_mfma_f32_16x16x32_bf16 v[208:211], v[96:99], a[116:119], v[208:211]
    s_waitcnt vmcnt(9)
    v_bitop3_b32 v20, v100, v104, v108 bitop3:254
    v_mfma_f32_16x16x32_bf16 v[204:207], v[96:99], a[112:115], v[204:207]
    v_bitop3_b32 v20, v20, v112, -2 bitop3:254
    v_cmp_eq_u32 vcc, -1, v20
    v_mfma_f32_16x16x32_bf16 v[204:207], v[92:95], a[96:99], v[204:207]
    s_cbranch_vccnz cs_28
cb_29:
    s_nop 0
    v_mfma_f32_16x16x32_bf16 v[204:207], v[100:103], a[128:131], v[204:207]
    buffer_load_dwordx4 v[88:91], v7, s[36:39], s77 offen offset:1024 sc1
    v_mfma_f32_16x16x32_bf16 v[204:207], v[104:107], a[144:147], v[204:207]
    v_mfma_f32_16x16x32_bf16 v[208:211], v[104:107], a[148:151], v[208:211]
    buffer_load_dwordx4 v[92:95], v7, s[36:39], s77 offen offset:2048 sc1
    v_mfma_f32_16x16x32_bf16 v[208:211], v[100:103], a[132:135], v[208:211]
    v_mfma_f32_16x16x32_bf16 v[212:215], v[100:103], a[136:139], v[212:215]
    buffer_load_dwordx4 v[96:99], v7, s[36:39], s77 offen offset:3072 sc1
    v_mfma_f32_16x16x32_bf16 v[212:215], v[104:107], a[152:155], v[212:215]
    v_mfma_f32_16x16x32_bf16 v[216:219], v[104:107], a[156:159], v[216:219]
    v_mfma_f32_16x16x32_bf16 v[216:219], v[100:103], a[140:143], v[216:219]
    v_mfma_f32_16x16x32_bf16 v[216:219], v[108:111], a[172:175], v[216:219]
    s_add_u32 s77, s73, 73728
    buffer_load_dwordx4 v[100:103], v7, s[36:39], s77 offen offset:0 sc1
    v_mfma_f32_16x16x32_bf16 v[216:219], v[112:115], a[188:191], v[216:219]
    v_mfma_f32_16x16x32_bf16 v[212:215], v[112:115], a[184:187], v[212:215]
    v_mfma_f32_16x16x32_bf16 v[212:215], v[108:111], a[168:171], v[212:215]
    v_mfma_f32_16x16x32_bf16 v[208:211], v[108:111], a[164:167], v[208:211]
    buffer_load_dwordx4 v[104:107], v7, s[36:39], s77 offen offset:1024 sc1
    v_mfma_f32_16x16x32_bf16 v[208:211], v[112:115], a[180:183], v[208:211]
    s_waitcnt vmcnt(10)
    v_bitop3_b32 v20, v116, v120, v124 bitop3:254
    v_mfma_f32_16x16x32_bf16 v[204:207], v[112:115], a[176:179], v[204:207]
    v_bitop3_b32 v20, v20, v128, -2 bitop3:254
    v_cmp_eq_u32 vcc, -1, v20
    v_mfma_f32_16x16x32_bf16 v[204:207], v[108:111], a[160:163], v[204:207]
    s_cbranch_vccnz cs_30
cb_31:
    s_nop 0
    v_mfma_f32_16x16x32_bf16 v[204:207], v[116:119], a[192:195], v[204:207]
    buffer_load_dwordx4 v[108:111], v7, s[36:39], s77 offen offset:2048 sc1
    v_mfma_f32_16x16x32_bf16 v[204:207], v[120:123], a[208:211], v[204:207]
    v_mfma_f32_16x16x32_bf16 v[208:211], v[120:123], a[212:215], v[208:211]
    v_mfma_f32_16x16x32_bf16 v[208:211], v[116:119], a[196:199], v[208:211]
    v_mfma_f32_16x16x32_bf16 v[212:215], v[116:119], a[200:203], v[212:215]
    buffer_load_dwordx4 v[112:115], v7, s[36:39], s77 offen offset:3072 sc1
    v_mfma_f32_16x16x32_bf16 v[212:215], v[120:123], a[216:219], v[212:215]
    v_mfma_f32_16x16x32_bf16 v[216:219], v[120:123], a[220:223], v[216:219]
    v_mfma_f32_16x16x32_bf16 v[216:219], v[116:119], a[204:207], v[216:219]
    v_mfma_f32_16x16x32_bf16 v[216:219], v[124:127], a[236:239], v[216:219]
    s_add_u32 s77, s73, 77824
    buffer_load_dwordx4 v[116:119], v7, s[36:39], s77 offen offset:0 sc1
    v_mfma_f32_16x16x32_bf16 v[216:219], v[128:131], a[252:255], v[216:219]
    v_mfma_f32_16x16x32_bf16 v[212:215], v[128:131], a[248:251], v[212:215]
    v_mfma_f32_16x16x32_bf16 v[212:215], v[124:127], a[232:235], v[212:215]
    v_mfma_f32_16x16x32_bf16 v[208:211], v[124:127], a[228:231], v[208:211]
    buffer_load_dwordx4 v[120:123], v7, s[36:39], s77 offen offset:1024 sc1
    v_mfma_f32_16x16x32_bf16 v[208:211], v[128:131], a[244:247], v[208:211]
    s_waitcnt vmcnt(10)
    v_bitop3_b32 v20, v68, v72, v76 bitop3:254
    v_mfma_f32_16x16x32_bf16 v[204:207], v[128:131], a[240:243], v[204:207]
    v_bitop3_b32 v20, v20, v80, -2 bitop3:254
    v_cmp_eq_u32 vcc, -1, v20
    v_mfma_f32_16x16x32_bf16 v[204:207], v[124:127], a[224:227], v[204:207]
    s_cbranch_vccnz cs_32
cb_33:
    s_nop 0
    v_mfma_f32_16x16x32_bf16 v[220:223], v[68:71], a[0:3], 0
    buffer_load_dwordx4 v[124:127], v7, s[36:39], s77 offen offset:2048 sc1
    v_mfma_f32_16x16x32_bf16 v[220:223], v[72:75], a[16:19], v[220:223]
    v_mfma_f32_16x16x32_bf16 v[224:227], v[72:75], a[20:23], 0
    v_mfma_f32_16x16x32_bf16 v[224:227], v[68:71], a[4:7], v[224:227]
    v_mfma_f32_16x16x32_bf16 v[228:231], v[68:71], a[8:11], 0
    buffer_load_dwordx4 v[128:131], v7, s[36:39], s77 offen offset:3072 sc1
    v_mfma_f32_16x16x32_bf16 v[228:231], v[72:75], a[24:27], v[228:231]
    ds_write_b128 v23, v[208:211] offset:0
    v_mfma_f32_16x16x32_bf16 v[232:235], v[72:75], a[28:31], 0
    v_mfma_f32_16x16x32_bf16 v[232:235], v[68:71], a[12:15], v[232:235]
    ds_write_b128 v64, v[212:215] offset:1024
    v_mfma_f32_16x16x32_bf16 v[232:235], v[76:79], a[44:47], v[232:235]
    s_add_u32 s77, s73, 131072
    buffer_load_dwordx4 v[68:71], v7, s[36:39], s77 offen offset:0 sc1
    v_mfma_f32_16x16x32_bf16 v[232:235], v[80:83], a[60:63], v[232:235]
    ds_write_b128 v65, v[216:219] offset:2048
    v_mfma_f32_16x16x32_bf16 v[228:231], v[80:83], a[56:59], v[228:231]
    v_add_f32 v172, v11, v204
    v_add_f32 v173, v11, v205
    v_mfma_f32_16x16x32_bf16 v[228:231], v[76:79], a[40:43], v[228:231]
    v_add_f32 v174, v11, v206
    v_add_f32 v175, v11, v207
    v_mfma_f32_16x16x32_bf16 v[224:227], v[76:79], a[36:39], v[224:227]
    buffer_load_dwordx4 v[72:75], v7, s[36:39], s77 offen offset:1024 sc1
    v_mfma_f32_16x16x32_bf16 v[224:227], v[80:83], a[52:55], v[224:227]
    s_waitcnt vmcnt(10)
    v_bitop3_b32 v20, v84, v88, v92 bitop3:254
    v_mfma_f32_16x16x32_bf16 v[220:223], v[80:83], a[48:51], v[220:223]
    v_bitop3_b32 v20, v20, v96, -2 bitop3:254
    v_cmp_eq_u32 vcc, -1, v20
    v_mfma_f32_16x16x32_bf16 v[220:223], v[76:79], a[32:35], v[220:223]
    s_cbranch_vccnz cs_34
cb_35:
    v_mfma_f32_16x16x32_bf16 v[220:223], v[84:87], a[64:67], v[220:223]
    buffer_load_dwordx4 v[76:79], v7, s[36:39], s77 offen offset:2048 sc1
    v_mfma_f32_16x16x32_bf16 v[220:223], v[88:91], a[80:83], v[220:223]
    s_waitcnt lgkmcnt(0)
    s_barrier
    s_nop 0
    v_mfma_f32_16x16x32_bf16 v[224:227], v[88:91], a[84:87], v[224:227]
    ds_read_b128 v[176:179], v66 offset:0
    v_mfma_f32_16x16x32_bf16 v[224:227], v[84:87], a[68:71], v[224:227]
    ds_read_b128 v[180:183], v66 offset:1024
    v_mfma_f32_16x16x32_bf16 v[228:231], v[84:87], a[72:75], v[228:231]
    buffer_load_dwordx4 v[80:83], v7, s[36:39], s77 offen offset:3072 sc1
    v_mfma_f32_16x16x32_bf16 v[228:231], v[88:91], a[88:91], v[228:231]
    ds_read_b128 v[184:187], v66 offset:2048
    v_mfma_f32_16x16x32_bf16 v[232:235], v[88:91], a[92:95], v[232:235]
    v_mfma_f32_16x16x32_bf16 v[232:235], v[84:87], a[76:79], v[232:235]
    v_mfma_f32_16x16x32_bf16 v[232:235], v[92:95], a[108:111], v[232:235]
    s_add_u32 s77, s73, 135168
    buffer_load_dwordx4 v[84:87], v7, s[36:39], s77 offen offset:0 sc1
    v_mfma_f32_16x16x32_bf16 v[232:235], v[96:99], a[124:127], v[232:235]
    s_mul_i32 s9, s89, 114688
    s_mul_i32 s10, s42, 14336
    s_add_u32 s9, s9, s10
    s_add_u32 m0, s10, 43008
    s_add_u32 s81, s9, 4194304
    v_mfma_f32_16x16x32_bf16 v[228:231], v[96:99], a[120:123], v[228:231]
    buffer_load_dwordx4 v7, s[36:39], s81 offen offset:0 sc1 lds
    v_mfma_f32_16x16x32_bf16 v[228:231], v[92:95], a[104:107], v[228:231]
    v_mfma_f32_16x16x32_bf16 v[224:227], v[92:95], a[100:103], v[224:227]
    buffer_load_dwordx4 v[88:91], v7, s[36:39], s77 offen offset:1024 sc1
    v_mfma_f32_16x16x32_bf16 v[224:227], v[96:99], a[116:119], v[224:227]
    s_waitcnt vmcnt(11)
    v_bitop3_b32 v20, v100, v104, v108 bitop3:254
    v_mfma_f32_16x16x32_bf16 v[220:223], v[96:99], a[112:115], v[220:223]
    v_bitop3_b32 v20, v20, v112, -2 bitop3:254
    v_cmp_eq_u32_e64 vcc, -1, v20
    v_mfma_f32_16x16x32_bf16 v[220:223], v[92:95], a[96:99], v[220:223]
    s_cbranch_vccnz cs_36
cb_37:
    v_mfma_f32_16x16x32_bf16 v[220:223], v[100:103], a[128:131], v[220:223]
    buffer_load_dwordx4 v[92:95], v7, s[36:39], s77 offen offset:2048 sc1
    v_mfma_f32_16x16x32_bf16 v[220:223], v[104:107], a[144:147], v[220:223]
    s_waitcnt lgkmcnt(2)
    v_add_f32 v172, v172, v176
    v_add_f32 v173, v173, v177
    v_mfma_f32_16x16x32_bf16 v[224:227], v[104:107], a[148:151], v[224:227]
    v_add_f32 v174, v174, v178
    v_add_f32 v175, v175, v179
    v_mfma_f32_16x16x32_bf16 v[224:227], v[100:103], a[132:135], v[224:227]
    s_waitcnt lgkmcnt(0)
    v_add_f32 v180, v180, v184
    v_add_f32_e64 v181, v181, v185
    v_mfma_f32_16x16x32_bf16 v[228:231], v[100:103], a[136:139], v[228:231]
    buffer_load_dwordx4 v[96:99], v7, s[36:39], s77 offen offset:3072 sc1
    v_mfma_f32_16x16x32_bf16 v[228:231], v[104:107], a[152:155], v[228:231]
    v_add_f32 v182, v182, v186
    v_add_f32 v183, v183, v187
    v_mfma_f32_16x16x32_bf16 v[232:235], v[104:107], a[156:159], v[232:235]
    buffer_load_dwordx4 v7, s[36:39], s81 offen offset:1024 sc1 lds
    v_mfma_f32_16x16x32_bf16 v[232:235], v[100:103], a[140:143], v[232:235]
    v_add_f32 v172, v172, v180
    v_add_f32 v173, v173, v181
    v_mfma_f32_16x16x32_bf16 v[232:235], v[108:111], a[172:175], v[232:235]
    s_add_u32 s77, s73, 139264
    buffer_load_dwordx4 v[100:103], v7, s[36:39], s77 offen offset:0 sc1
L_pad_3542:
    s_cbranch_execz L_ret_1
    v_mfma_f32_16x16x32_bf16 v[232:235], v[112:115], a[188:191], v[232:235]
    v_add_f32 v174, v174, v182
    v_add_f32_e64 v175, v175, v183
    v_mfma_f32_16x16x32_bf16 v[228:231], v[112:115], a[184:187], v[228:231]
    v_mul_f32 v172, v172, v144
    v_mul_f32 v173, v173, v145
    v_mfma_f32_16x16x32_bf16 v[228:231], v[108:111], a[168:171], v[228:231]
    v_mul_f32 v174, v174, v146
    v_mul_f32 v175, v175, v147
    v_mfma_f32_16x16x32_bf16 v[224:227], v[108:111], a[164:167], v[224:227]
    buffer_load_dwordx4 v[104:107], v7, s[36:39], s77 offen offset:1024 sc1
    v_mfma_f32_16x16x32_bf16 v[224:227], v[112:115], a[180:183], v[224:227]
    s_waitcnt vmcnt(12)
    v_bitop3_b32 v20, v116, v120, v124 bitop3:254
    v_mfma_f32_16x16x32_bf16 v[220:223], v[112:115], a[176:179], v[220:223]
    v_bitop3_b32 v20, v20, v128, -2 bitop3:254
    v_cmp_eq_u32 vcc, -1, v20
    v_mfma_f32_16x16x32_bf16 v[220:223], v[108:111], a[160:163], v[220:223]
    s_cbranch_vccnz cs_38
cb_39:
    s_nop 0
    v_mfma_f32_16x16x32_bf16 v[220:223], v[116:119], a[192:195], v[220:223]
    buffer_load_dwordx4 v[108:111], v7, s[36:39], s77 offen offset:2048 sc1
    v_mfma_f32_16x16x32_bf16 v[220:223], v[120:123], a[208:211], v[220:223]
    v_cvt_pk_bf16_f32 v132, v172, v173
    v_cvt_pk_bf16_f32 v133, v174, v175
    v_mfma_f32_16x16x32_bf16 v[224:227], v[120:123], a[212:215], v[224:227]
    v_mfma_f32_16x16x32_bf16 v[224:227], v[116:119], a[196:199], v[224:227]
    v_mfma_f32_16x16x32_bf16 v[228:231], v[116:119], a[200:203], v[228:231]
    buffer_load_dwordx4 v[112:115], v7, s[36:39], s77 offen offset:3072 sc1
    v_mfma_f32_16x16x32_bf16 v[228:231], v[120:123], a[216:219], v[228:231]
    v_mfma_f32_16x16x32_bf16 v[232:235], v[120:123], a[220:223], v[232:235]
    buffer_load_dwordx4 v7, s[36:39], s81 offen offset:2048 sc1 lds
    v_mfma_f32_16x16x32_bf16 v[232:235], v[116:119], a[204:207], v[232:235]
    v_mfma_f32_16x16x32_bf16 v[232:235], v[124:127], a[236:239], v[232:235]
    s_add_u32 s77, s73, 143360
    buffer_load_dwordx4 v[116:119], v7, s[36:39], s77 offen offset:0 sc1
    v_mfma_f32_16x16x32_bf16 v[232:235], v[128:131], a[252:255], v[232:235]
    v_mfma_f32_16x16x32_bf16 v[228:231], v[128:131], a[248:251], v[228:231]
    v_mfma_f32_16x16x32_bf16 v[228:231], v[124:127], a[232:235], v[228:231]
    v_mfma_f32_16x16x32_bf16 v[224:227], v[124:127], a[228:231], v[224:227]
    buffer_load_dwordx4 v[120:123], v7, s[36:39], s77 offen offset:1024 sc1
    v_mfma_f32_16x16x32_bf16 v[224:227], v[128:131], a[244:247], v[224:227]
    s_waitcnt vmcnt(13)
    v_bitop3_b32 v20, v68, v72, v76 bitop3:254
    v_mfma_f32_16x16x32_bf16 v[220:223], v[128:131], a[240:243], v[220:223]
    v_bitop3_b32 v20, v20, v80, -2 bitop3:254
    v_cmp_eq_u32 vcc, -1, v20
    v_mfma_f32_16x16x32_bf16 v[220:223], v[124:127], a[224:227], v[220:223]
    s_cbranch_vccnz cs_40
cb_41:
    s_nop 0
    v_mfma_f32_16x16x32_bf16 v[204:207], v[68:71], a[0:3], 0
    buffer_load_dwordx4 v[124:127], v7, s[36:39], s77 offen offset:2048 sc1
    v_mfma_f32_16x16x32_bf16 v[204:207], v[72:75], a[16:19], v[204:207]
    v_mfma_f32_16x16x32_bf16 v[208:211], v[72:75], a[20:23], 0
    v_mfma_f32_16x16x32_bf16 v[208:211], v[68:71], a[4:7], v[208:211]
    v_mfma_f32_16x16x32_bf16 v[212:215], v[68:71], a[8:11], 0
    buffer_load_dwordx4 v[128:131], v7, s[36:39], s77 offen offset:3072 sc1
    v_mfma_f32_16x16x32_bf16 v[212:215], v[72:75], a[24:27], v[212:215]
    ds_write_b128 v23, v[224:227] offset:16384
    v_mfma_f32_16x16x32_bf16 v[216:219], v[72:75], a[28:31], 0
    buffer_load_dwordx4 v7, s[36:39], s81 offen offset:3072 sc1 lds
    v_mfma_f32_16x16x32_bf16 v[216:219], v[68:71], a[12:15], v[216:219]
    ds_write_b128 v64, v[228:231] offset:17408
    v_mfma_f32_16x16x32_bf16 v[216:219], v[76:79], a[44:47], v[216:219]
    s_add_u32 s77, s73, 196608
    buffer_load_dwordx4 v[68:71], v7, s[36:39], s77 offen offset:0 sc1
    v_mfma_f32_16x16x32_bf16 v[216:219], v[80:83], a[60:63], v[216:219]
    ds_write_b128 v65, v[232:235] offset:18432
    v_mfma_f32_16x16x32_bf16 v[212:215], v[80:83], a[56:59], v[212:215]
    v_add_f32 v172, v11, v220
    v_add_f32 v173, v11, v221
    v_mfma_f32_16x16x32_bf16 v[212:215], v[76:79], a[40:43], v[212:215]
    v_add_f32 v174, v11, v222
    v_add_f32 v175, v11, v223
    v_mfma_f32_16x16x32_bf16 v[208:211], v[76:79], a[36:39], v[208:211]
    buffer_load_dwordx4 v[72:75], v7, s[36:39], s77 offen offset:1024 sc1
    v_mfma_f32_16x16x32_bf16 v[208:211], v[80:83], a[52:55], v[208:211]
    s_waitcnt vmcnt(13)
    v_bitop3_b32 v20, v84, v88, v92 bitop3:254
    v_mfma_f32_16x16x32_bf16 v[204:207], v[80:83], a[48:51], v[204:207]
    v_bitop3_b32 v20, v20, v96, -2 bitop3:254
    v_cmp_eq_u32 vcc, -1, v20
    v_mfma_f32_16x16x32_bf16 v[204:207], v[76:79], a[32:35], v[204:207]
    s_cbranch_vccnz cs_42
cb_43:
    v_mfma_f32_16x16x32_bf16 v[204:207], v[84:87], a[64:67], v[204:207]
    buffer_load_dwordx4 v[76:79], v7, s[36:39], s77 offen offset:2048 sc1
    v_mfma_f32_16x16x32_bf16 v[204:207], v[88:91], a[80:83], v[204:207]
    s_waitcnt lgkmcnt(0)
    s_barrier
    s_nop 0
    v_mfma_f32_16x16x32_bf16 v[208:211], v[88:91], a[84:87], v[208:211]
    ds_read_b128 v[176:179], v66 offset:16384
    v_mfma_f32_16x16x32_bf16 v[208:211], v[84:87], a[68:71], v[208:211]
    ds_read_b128 v[180:183], v66 offset:17408
    v_mfma_f32_16x16x32_bf16 v[212:215], v[84:87], a[72:75], v[212:215]
    buffer_load_dwordx4 v[80:83], v7, s[36:39], s77 offen offset:3072 sc1
    v_mfma_f32_16x16x32_bf16 v[212:215], v[88:91], a[88:91], v[212:215]
    ds_read_b128 v[184:187], v66 offset:18432
    v_mfma_f32_16x16x32_bf16 v[216:219], v[88:91], a[92:95], v[216:219]
    v_mfma_f32_16x16x32_bf16 v[216:219], v[84:87], a[76:79], v[216:219]
    v_mfma_f32_16x16x32_bf16 v[216:219], v[92:95], a[108:111], v[216:219]
    s_add_u32 s77, s73, 200704
    buffer_load_dwordx4 v[84:87], v7, s[36:39], s77 offen offset:0 sc1
    v_mfma_f32_16x16x32_bf16 v[216:219], v[96:99], a[124:127], v[216:219]
    s_add_u32 m0, s10, 47104
    s_add_u32 s81, s9, 4198400
    v_mfma_f32_16x16x32_bf16 v[212:215], v[96:99], a[120:123], v[212:215]
    buffer_load_dwordx4 v7, s[36:39], s81 offen offset:0 sc1 lds
    v_mfma_f32_16x16x32_bf16 v[212:215], v[92:95], a[104:107], v[212:215]
    v_mfma_f32_16x16x32_bf16 v[208:211], v[92:95], a[100:103], v[208:211]
    buffer_load_dwordx4 v[88:91], v7, s[36:39], s77 offen offset:1024 sc1
    v_mfma_f32_16x16x32_bf16 v[208:211], v[96:99], a[116:119], v[208:211]
    s_waitcnt vmcnt(13)
    v_bitop3_b32 v20, v100, v104, v108 bitop3:254
    v_mfma_f32_16x16x32_bf16 v[204:207], v[96:99], a[112:115], v[204:207]
    v_bitop3_b32 v20, v20, v112, -2 bitop3:254
    v_cmp_eq_u32 vcc, -1, v20
    v_mfma_f32_16x16x32_bf16 v[204:207], v[92:95], a[96:99], v[204:207]
    s_cbranch_vccnz cs_44
cb_45:
    v_mfma_f32_16x16x32_bf16 v[204:207], v[100:103], a[128:131], v[204:207]
    buffer_load_dwordx4 v[92:95], v7, s[36:39], s77 offen offset:2048 sc1
    v_mfma_f32_16x16x32_bf16 v[204:207], v[104:107], a[144:147], v[204:207]
    s_waitcnt lgkmcnt(2)
    v_add_f32 v172, v172, v176
    v_add_f32 v173, v173, v177
    v_mfma_f32_16x16x32_bf16 v[208:211], v[104:107], a[148:151], v[208:211]
    v_add_f32 v174, v174, v178
    v_add_f32 v175, v175, v179
    v_mfma_f32_16x16x32_bf16 v[208:211], v[100:103], a[132:135], v[208:211]
    s_waitcnt lgkmcnt(0)
    v_add_f32 v180, v180, v184
    v_add_f32_e64 v181, v181, v185
    v_mfma_f32_16x16x32_bf16 v[212:215], v[100:103], a[136:139], v[212:215]
    buffer_load_dwordx4 v[96:99], v7, s[36:39], s77 offen offset:3072 sc1
    v_mfma_f32_16x16x32_bf16 v[212:215], v[104:107], a[152:155], v[212:215]
    v_add_f32 v182, v182, v186
    v_add_f32 v183, v183, v187
    v_mfma_f32_16x16x32_bf16 v[216:219], v[104:107], a[156:159], v[216:219]
    buffer_load_dwordx4 v7, s[36:39], s81 offen offset:1024 sc1 lds
    v_mfma_f32_16x16x32_bf16 v[216:219], v[100:103], a[140:143], v[216:219]
    v_add_f32 v172, v172, v180
    v_add_f32 v173, v173, v181
    v_mfma_f32_16x16x32_bf16 v[216:219], v[108:111], a[172:175], v[216:219]
    s_add_u32 s77, s73, 204800
    buffer_load_dwordx4 v[100:103], v7, s[36:39], s77 offen offset:0 sc1
    v_mfma_f32_16x16x32_bf16 v[216:219], v[112:115], a[188:191], v[216:219]
    v_add_f32 v174, v174, v182
    v_add_f32 v175, v175, v183
    v_mfma_f32_16x16x32_bf16 v[212:215], v[112:115], a[184:187], v[212:215]
    v_mul_f32 v172, v172, v148
    v_mul_f32 v173, v173, v149
    v_mfma_f32_16x16x32_bf16 v[212:215], v[108:111], a[168:171], v[212:215]
    v_mul_f32 v174, v174, v150
    v_mul_f32 v175, v175, v151
    v_mfma_f32_16x16x32_bf16 v[208:211], v[108:111], a[164:167], v[208:211]
    buffer_load_dwordx4 v[104:107], v7, s[36:39], s77 offen offset:1024 sc1
    v_mfma_f32_16x16x32_bf16 v[208:211], v[112:115], a[180:183], v[208:211]
    s_waitcnt vmcnt(13)
    v_bitop3_b32 v20, v116, v120, v124 bitop3:254
    v_mfma_f32_16x16x32_bf16 v[204:207], v[112:115], a[176:179], v[204:207]
    v_bitop3_b32 v20, v20, v128, -2 bitop3:254
    v_cmp_eq_u32 vcc, -1, v20
    v_mfma_f32_16x16x32_bf16 v[204:207], v[108:111], a[160:163], v[204:207]
    s_cbranch_vccnz cs_46
cb_47:
    v_mfma_f32_16x16x32_bf16 v[204:207], v[116:119], a[192:195], v[204:207]
    buffer_load_dwordx4 v[108:111], v7, s[36:39], s77 offen offset:2048 sc1
    v_mfma_f32_16x16x32_bf16 v[204:207], v[120:123], a[208:211], v[204:207]
    v_cvt_pk_bf16_f32 v134, v172, v173
    v_cvt_pk_bf16_f32 v135, v174, v175
    v_mfma_f32_16x16x32_bf16 v[208:211], v[120:123], a[212:215], v[208:211]
    v_and_b32 v132, -2, v132
    s_add_u32 s78, s85, 25165824
    buffer_store_dwordx4 v[132:135], v7, s[36:39], s78 offen sc1
    v_mfma_f32_16x16x32_bf16 v[208:211], v[116:119], a[196:199], v[208:211]
    v_mfma_f32_16x16x32_bf16 v[212:215], v[116:119], a[200:203], v[212:215]
    buffer_load_dwordx4 v[112:115], v7, s[36:39], s77 offen offset:3072 sc1
    v_mfma_f32_16x16x32_bf16 v[212:215], v[120:123], a[216:219], v[212:215]
    v_mfma_f32_16x16x32_bf16 v[216:219], v[120:123], a[220:223], v[216:219]
    buffer_load_dwordx4 v7, s[36:39], s81 offen offset:2048 sc1 lds
    v_mfma_f32_16x16x32_bf16 v[216:219], v[116:119], a[204:207], v[216:219]
    v_mfma_f32_16x16x32_bf16 v[216:219], v[124:127], a[236:239], v[216:219]
    s_add_u32 s77, s73, 208896
    buffer_load_dwordx4 v[116:119], v7, s[36:39], s77 offen offset:0 sc1
    v_mfma_f32_16x16x32_bf16 v[216:219], v[128:131], a[252:255], v[216:219]
    v_mfma_f32_16x16x32_bf16 v[212:215], v[128:131], a[248:251], v[212:215]
    v_mfma_f32_16x16x32_bf16 v[212:215], v[124:127], a[232:235], v[212:215]
    v_mfma_f32_16x16x32_bf16 v[208:211], v[124:127], a[228:231], v[208:211]
    buffer_load_dwordx4 v[120:123], v7, s[36:39], s77 offen offset:1024 sc1
    v_mfma_f32_16x16x32_bf16 v[208:211], v[128:131], a[244:247], v[208:211]
    s_waitcnt vmcnt(14)
    v_bitop3_b32 v20, v68, v72, v76 bitop3:254
    v_mfma_f32_16x16x32_bf16 v[204:207], v[128:131], a[240:243], v[204:207]
    v_bitop3_b32 v20, v20, v80, -2 bitop3:254
    v_cmp_eq_u32 vcc, -1, v20
    v_mfma_f32_16x16x32_bf16 v[204:207], v[124:127], a[224:227], v[204:207]
    s_cbranch_vccnz cs_48
cb_49:
    s_nop 0
    v_mfma_f32_16x16x32_bf16 v[220:223], v[68:71], a[0:3], 0
    buffer_load_dwordx4 v[124:127], v7, s[36:39], s77 offen offset:2048 sc1
    v_mfma_f32_16x16x32_bf16 v[220:223], v[72:75], a[16:19], v[220:223]
    v_mfma_f32_16x16x32_bf16 v[224:227], v[72:75], a[20:23], 0
    v_mfma_f32_16x16x32_bf16 v[224:227], v[68:71], a[4:7], v[224:227]
    v_mfma_f32_16x16x32_bf16 v[228:231], v[68:71], a[8:11], 0
    buffer_load_dwordx4 v[128:131], v7, s[36:39], s77 offen offset:3072 sc1
    v_mfma_f32_16x16x32_bf16 v[228:231], v[72:75], a[24:27], v[228:231]
    ds_write_b128 v23, v[208:211] offset:0
    v_mfma_f32_16x16x32_bf16 v[232:235], v[72:75], a[28:31], 0
    buffer_load_dwordx4 v7, s[36:39], s81 offen offset:3072 sc1 lds
    v_mfma_f32_16x16x32_bf16 v[232:235], v[68:71], a[12:15], v[232:235]
    ds_write_b128 v64, v[212:215] offset:1024
    v_mfma_f32_16x16x32_bf16 v[232:235], v[76:79], a[44:47], v[232:235]
    s_add_u32 s77, s73, 262144
    buffer_load_dwordx4 v[68:71], v7, s[36:39], s77 offen offset:0 sc1
    v_mfma_f32_16x16x32_bf16 v[232:235], v[80:83], a[60:63], v[232:235]
    ds_write_b128 v65, v[216:219] offset:2048
    v_mfma_f32_16x16x32_bf16 v[228:231], v[80:83], a[56:59], v[228:231]
    v_add_f32 v172, v11, v204
    v_add_f32 v173, v11, v205
    v_mfma_f32_16x16x32_bf16 v[228:231], v[76:79], a[40:43], v[228:231]
    v_add_f32 v174, v11, v206
    v_add_f32 v175, v11, v207
    v_mfma_f32_16x16x32_bf16 v[224:227], v[76:79], a[36:39], v[224:227]
    buffer_load_dwordx4 v[72:75], v7, s[36:39], s77 offen offset:1024 sc1
    v_mfma_f32_16x16x32_bf16 v[224:227], v[80:83], a[52:55], v[224:227]
    s_waitcnt vmcnt(14)
    v_bitop3_b32 v20, v84, v88, v92 bitop3:254
    v_mfma_f32_16x16x32_bf16 v[220:223], v[80:83], a[48:51], v[220:223]
    v_bitop3_b32 v20, v20, v96, -2 bitop3:254
    v_cmp_eq_u32 vcc, -1, v20
    v_mfma_f32_16x16x32_bf16 v[220:223], v[76:79], a[32:35], v[220:223]
    s_cbranch_vccnz cs_50
cb_51:
    v_mfma_f32_16x16x32_bf16 v[220:223], v[84:87], a[64:67], v[220:223]
    buffer_load_dwordx4 v[76:79], v7, s[36:39], s77 offen offset:2048 sc1
    v_mfma_f32_16x16x32_bf16 v[220:223], v[88:91], a[80:83], v[220:223]
    s_waitcnt lgkmcnt(0)
    s_barrier
    s_nop 0
    v_mfma_f32_16x16x32_bf16 v[224:227], v[88:91], a[84:87], v[224:227]
    ds_read_b128 v[176:179], v66 offset:0
    v_mfma_f32_16x16x32_bf16 v[224:227], v[84:87], a[68:71], v[224:227]
    ds_read_b128 v[180:183], v66 offset:1024
    v_mfma_f32_16x16x32_bf16 v[228:231], v[84:87], a[72:75], v[228:231]
    buffer_load_dwordx4 v[80:83], v7, s[36:39], s77 offen offset:3072 sc1
    v_mfma_f32_16x16x32_bf16 v[228:231], v[88:91], a[88:91], v[228:231]
    ds_read_b128 v[184:187], v66 offset:2048
    v_mfma_f32_16x16x32_bf16 v[232:235], v[88:91], a[92:95], v[232:235]
    v_mfma_f32_16x16x32_bf16 v[232:235], v[84:87], a[76:79], v[232:235]
    v_mfma_f32_16x16x32_bf16 v[232:235], v[92:95], a[108:111], v[232:235]
    s_add_u32 s77, s73, 266240
    buffer_load_dwordx4 v[84:87], v7, s[36:39], s77 offen offset:0 sc1
    v_mfma_f32_16x16x32_bf16 v[232:235], v[96:99], a[124:127], v[232:235]
    s_add_u32 m0, s10, 51200
    s_add_u32 s81, s9, 4202496
    v_mfma_f32_16x16x32_bf16 v[228:231], v[96:99], a[120:123], v[228:231]
    buffer_load_dwordx4 v7, s[36:39], s81 offen offset:0 sc1 lds
    v_mfma_f32_16x16x32_bf16 v[228:231], v[92:95], a[104:107], v[228:231]
    v_mfma_f32_16x16x32_bf16 v[224:227], v[92:95], a[100:103], v[224:227]
    buffer_load_dwordx4 v[88:91], v7, s[36:39], s77 offen offset:1024 sc1
    v_mfma_f32_16x16x32_bf16 v[224:227], v[96:99], a[116:119], v[224:227]
    s_waitcnt vmcnt(13)
    v_bitop3_b32 v20, v100, v104, v108 bitop3:254
    v_mfma_f32_16x16x32_bf16 v[220:223], v[96:99], a[112:115], v[220:223]
    v_bitop3_b32 v20, v20, v112, -2 bitop3:254
    v_cmp_eq_u32 vcc, -1, v20
    v_mfma_f32_16x16x32_bf16 v[220:223], v[92:95], a[96:99], v[220:223]
    s_cbranch_vccnz cs_52
cb_53:
    v_mfma_f32_16x16x32_bf16 v[220:223], v[100:103], a[128:131], v[220:223]
    buffer_load_dwordx4 v[92:95], v7, s[36:39], s77 offen offset:2048 sc1
    v_mfma_f32_16x16x32_bf16 v[220:223], v[104:107], a[144:147], v[220:223]
    s_waitcnt lgkmcnt(2)
    v_add_f32 v172, v172, v176
    v_add_f32 v173, v173, v177
    v_mfma_f32_16x16x32_bf16 v[224:227], v[104:107], a[148:151], v[224:227]
    v_add_f32 v174, v174, v178
    v_add_f32 v175, v175, v179
    v_mfma_f32_16x16x32_bf16 v[224:227], v[100:103], a[132:135], v[224:227]
    s_waitcnt lgkmcnt(0)
    v_add_f32 v180, v180, v184
    v_add_f32_e64 v181, v181, v185
    v_mfma_f32_16x16x32_bf16 v[228:231], v[100:103], a[136:139], v[228:231]
    buffer_load_dwordx4 v[96:99], v7, s[36:39], s77 offen offset:3072 sc1
    v_mfma_f32_16x16x32_bf16 v[228:231], v[104:107], a[152:155], v[228:231]
    v_add_f32 v182, v182, v186
    v_add_f32 v183, v183, v187
    v_mfma_f32_16x16x32_bf16 v[232:235], v[104:107], a[156:159], v[232:235]
    buffer_load_dwordx4 v7, s[36:39], s81 offen offset:1024 sc1 lds
    v_mfma_f32_16x16x32_bf16 v[232:235], v[100:103], a[140:143], v[232:235]
    v_add_f32 v172, v172, v180
    v_add_f32 v173, v173, v181
    v_mfma_f32_16x16x32_bf16 v[232:235], v[108:111], a[172:175], v[232:235]
    s_add_u32 s77, s73, 270336
    buffer_load_dwordx4 v[100:103], v7, s[36:39], s77 offen offset:0 sc1
    v_mfma_f32_16x16x32_bf16 v[232:235], v[112:115], a[188:191], v[232:235]
    v_add_f32 v174, v174, v182
    v_add_f32 v175, v175, v183
    v_mfma_f32_16x16x32_bf16 v[228:231], v[112:115], a[184:187], v[228:231]
    v_mul_f32 v172, v172, v152
    v_mul_f32 v173, v173, v153
    v_mfma_f32_16x16x32_bf16 v[228:231], v[108:111], a[168:171], v[228:231]
    v_mul_f32 v174, v174, v154
    v_mul_f32 v175, v175, v155
    v_mfma_f32_16x16x32_bf16 v[224:227], v[108:111], a[164:167], v[224:227]
    buffer_load_dwordx4 v[104:107], v7, s[36:39], s77 offen offset:1024 sc1
    v_mfma_f32_16x16x32_bf16 v[224:227], v[112:115], a[180:183], v[224:227]
    s_waitcnt vmcnt(13)
    v_bitop3_b32 v20, v116, v120, v124 bitop3:254
    v_mfma_f32_16x16x32_bf16 v[220:223], v[112:115], a[176:179], v[220:223]
    v_bitop3_b32 v20, v20, v128, -2 bitop3:254
    v_cmp_eq_u32 vcc, -1, v20
    v_mfma_f32_16x16x32_bf16 v[220:223], v[108:111], a[160:163], v[220:223]
    s_cbranch_vccnz cs_54
cb_55:
    s_nop 0
    v_mfma_f32_16x16x32_bf16 v[220:223], v[116:119], a[192:195], v[220:223]
    buffer_load_dwordx4 v[108:111], v7, s[36:39], s77 offen offset:2048 sc1
    v_mfma_f32_16x16x32_bf16 v[220:223], v[120:123], a[208:211], v[220:223]
    v_cvt_pk_bf16_f32 v136, v172, v173
    v_cvt_pk_bf16_f32 v137, v174, v175
    v_mfma_f32_16x16x32_bf16 v[224:227], v[120:123], a[212:215], v[224:227]
    v_mfma_f32_16x16x32_bf16 v[224:227], v[116:119], a[196:199], v[224:227]
    v_mfma_f32_16x16x32_bf16 v[228:231], v[116:119], a[200:203], v[228:231]
    buffer_load_dwordx4 v[112:115], v7, s[36:39], s77 offen offset:3072 sc1
    v_mfma_f32_16x16x32_bf16 v[228:231], v[120:123], a[216:219], v[228:231]
    v_mfma_f32_16x16x32_bf16 v[232:235], v[120:123], a[220:223], v[232:235]
    buffer_load_dwordx4 v7, s[36:39], s81 offen offset:2048 sc1 lds
    v_mfma_f32_16x16x32_bf16 v[232:235], v[116:119], a[204:207], v[232:235]
    v_mfma_f32_16x16x32_bf16 v[232:235], v[124:127], a[236:239], v[232:235]
    s_add_u32 s77, s73, 274432
    buffer_load_dwordx4 v[116:119], v7, s[36:39], s77 offen offset:0 sc1
    v_mfma_f32_16x16x32_bf16 v[232:235], v[128:131], a[252:255], v[232:235]
    v_mfma_f32_16x16x32_bf16 v[228:231], v[128:131], a[248:251], v[228:231]
    v_mfma_f32_16x16x32_bf16 v[228:231], v[124:127], a[232:235], v[228:231]
    v_mfma_f32_16x16x32_bf16 v[224:227], v[124:127], a[228:231], v[224:227]
    buffer_load_dwordx4 v[120:123], v7, s[36:39], s77 offen offset:1024 sc1
    v_mfma_f32_16x16x32_bf16 v[224:227], v[128:131], a[244:247], v[224:227]
    s_waitcnt vmcnt(13)
    v_bitop3_b32 v20, v68, v72, v76 bitop3:254
    v_mfma_f32_16x16x32_bf16 v[220:223], v[128:131], a[240:243], v[220:223]
    v_bitop3_b32 v20, v20, v80, -2 bitop3:254
    v_cmp_eq_u32 vcc, -1, v20
    v_mfma_f32_16x16x32_bf16 v[220:223], v[124:127], a[224:227], v[220:223]
    s_cbranch_vccnz cs_56
cb_57:
    s_nop 0
    v_mfma_f32_16x16x32_bf16 v[204:207], v[68:71], a[0:3], 0
    buffer_load_dwordx4 v[124:127], v7, s[36:39], s77 offen offset:2048 sc1
    v_mfma_f32_16x16x32_bf16 v[204:207], v[72:75], a[16:19], v[204:207]
    v_mfma_f32_16x16x32_bf16 v[208:211], v[72:75], a[20:23], 0
    v_mfma_f32_16x16x32_bf16 v[208:211], v[68:71], a[4:7], v[208:211]
    v_mfma_f32_16x16x32_bf16 v[212:215], v[68:71], a[8:11], 0
    buffer_load_dwordx4 v[128:131], v7, s[36:39], s77 offen offset:3072 sc1
    v_mfma_f32_16x16x32_bf16 v[212:215], v[72:75], a[24:27], v[212:215]
    ds_write_b128 v23, v[224:227] offset:16384
    v_mfma_f32_16x16x32_bf16 v[216:219], v[72:75], a[28:31], 0
    buffer_load_dwordx4 v7, s[36:39], s81 offen offset:3072 sc1 lds
    v_mfma_f32_16x16x32_bf16 v[216:219], v[68:71], a[12:15], v[216:219]
    ds_write_b128 v64, v[228:231] offset:17408
    v_mfma_f32_16x16x32_bf16 v[216:219], v[76:79], a[44:47], v[216:219]
    s_add_u32 s77, s73, 327680
    buffer_load_dwordx4 v[68:71], v7, s[36:39], s77 offen offset:0 sc1
    v_mfma_f32_16x16x32_bf16 v[216:219], v[80:83], a[60:63], v[216:219]
    ds_write_b128 v65, v[232:235] offset:18432
    v_mfma_f32_16x16x32_bf16 v[212:215], v[80:83], a[56:59], v[212:215]
    v_add_f32 v172, v11, v220
    v_add_f32 v173, v11, v221
    v_mfma_f32_16x16x32_bf16 v[212:215], v[76:79], a[40:43], v[212:215]
    v_add_f32 v174, v11, v222
    v_add_f32 v175, v11, v223
    v_mfma_f32_16x16x32_bf16 v[208:211], v[76:79], a[36:39], v[208:211]
    buffer_load_dwordx4 v[72:75], v7, s[36:39], s77 offen offset:1024 sc1
    v_mfma_f32_16x16x32_bf16 v[208:211], v[80:83], a[52:55], v[208:211]
    s_waitcnt vmcnt(13)
    v_bitop3_b32 v20, v84, v88, v92 bitop3:254
    v_mfma_f32_16x16x32_bf16 v[204:207], v[80:83], a[48:51], v[204:207]
    v_bitop3_b32 v20, v20, v96, -2 bitop3:254
    v_cmp_eq_u32 vcc, -1, v20
    v_mfma_f32_16x16x32_bf16 v[204:207], v[76:79], a[32:35], v[204:207]
    s_cbranch_vccnz cs_58
cb_59:
    v_mfma_f32_16x16x32_bf16 v[204:207], v[84:87], a[64:67], v[204:207]
    buffer_load_dwordx4 v[76:79], v7, s[36:39], s77 offen offset:2048 sc1
    v_mfma_f32_16x16x32_bf16 v[204:207], v[88:91], a[80:83], v[204:207]
    s_waitcnt lgkmcnt(0)
    s_barrier
    s_nop 0
    v_mfma_f32_16x16x32_bf16 v[208:211], v[88:91], a[84:87], v[208:211]
    ds_read_b128 v[176:179], v66 offset:16384
    v_mfma_f32_16x16x32_bf16 v[208:211], v[84:87], a[68:71], v[208:211]
    ds_read_b128 v[180:183], v66 offset:17408
    v_mfma_f32_16x16x32_bf16 v[212:215], v[84:87], a[72:75], v[212:215]
    buffer_load_dwordx4 v[80:83], v7, s[36:39], s77 offen offset:3072 sc1
    v_mfma_f32_16x16x32_bf16 v[212:215], v[88:91], a[88:91], v[212:215]
    ds_read_b128 v[184:187], v66 offset:18432
    v_mfma_f32_16x16x32_bf16 v[216:219], v[88:91], a[92:95], v[216:219]
    v_mfma_f32_16x16x32_bf16 v[216:219], v[84:87], a[76:79], v[216:219]
    v_mfma_f32_16x16x32_bf16 v[216:219], v[92:95], a[108:111], v[216:219]
    s_add_u32 s77, s73, 331776
    buffer_load_dwordx4 v[84:87], v7, s[36:39], s77 offen offset:0 sc1
    v_mfma_f32_16x16x32_bf16 v[216:219], v[96:99], a[124:127], v[216:219]
    s_add_u32 m0, s10, 55296
    s_add_u32 s81, s9, 4206592
    v_mfma_f32_16x16x32_bf16 v[212:215], v[96:99], a[120:123], v[212:215]
    buffer_load_dwordx4 v7, s[36:39], s81 offen offset:0 sc1 lds
    v_mfma_f32_16x16x32_bf16 v[212:215], v[92:95], a[104:107], v[212:215]
    v_mfma_f32_16x16x32_bf16 v[208:211], v[92:95], a[100:103], v[208:211]
    buffer_load_dwordx4 v[88:91], v7, s[36:39], s77 offen offset:1024 sc1
    v_mfma_f32_16x16x32_bf16 v[208:211], v[96:99], a[116:119], v[208:211]
    s_waitcnt vmcnt(13)
    v_bitop3_b32 v20, v100, v104, v108 bitop3:254
    v_mfma_f32_16x16x32_bf16 v[204:207], v[96:99], a[112:115], v[204:207]
    v_bitop3_b32 v20, v20, v112, -2 bitop3:254
    v_cmp_eq_u32 vcc, -1, v20
    v_mfma_f32_16x16x32_bf16 v[204:207], v[92:95], a[96:99], v[204:207]
    s_cbranch_vccnz cs_60
cb_61:
    v_mfma_f32_16x16x32_bf16 v[204:207], v[100:103], a[128:131], v[204:207]
    buffer_load_dwordx4 v[92:95], v7, s[36:39], s77 offen offset:2048 sc1
    v_mfma_f32_16x16x32_bf16 v[204:207], v[104:107], a[144:147], v[204:207]
    s_waitcnt lgkmcnt(2)
    v_add_f32 v172, v172, v176
    v_add_f32 v173, v173, v177
    v_mfma_f32_16x16x32_bf16 v[208:211], v[104:107], a[148:151], v[208:211]
    v_add_f32 v174, v174, v178
    v_add_f32 v175, v175, v179
    v_mfma_f32_16x16x32_bf16 v[208:211], v[100:103], a[132:135], v[208:211]
    s_waitcnt lgkmcnt(0)
    v_add_f32 v180, v180, v184
    v_add_f32_e64 v181, v181, v185
    v_mfma_f32_16x16x32_bf16 v[212:215], v[100:103], a[136:139], v[212:215]
    buffer_load_dwordx4 v[96:99], v7, s[36:39], s77 offen offset:3072 sc1
    v_mfma_f32_16x16x32_bf16 v[212:215], v[104:107], a[152:155], v[212:215]
    v_add_f32 v182, v182, v186
    v_add_f32 v183, v183, v187
    v_mfma_f32_16x16x32_bf16 v[216:219], v[104:107], a[156:159], v[216:219]
    buffer_load_dwordx4 v7, s[36:39], s81 offen offset:1024 sc1 lds
    v_mfma_f32_16x16x32_bf16 v[216:219], v[100:103], a[140:143], v[216:219]
    v_add_f32 v172, v172, v180
    v_add_f32 v173, v173, v181
    v_mfma_f32_16x16x32_bf16 v[216:219], v[108:111], a[172:175], v[216:219]
    s_add_u32 s77, s73, 335872
    buffer_load_dwordx4 v[100:103], v7, s[36:39], s77 offen offset:0 sc1
    v_mfma_f32_16x16x32_bf16 v[216:219], v[112:115], a[188:191], v[216:219]
    v_add_f32 v174, v174, v182
    v_add_f32 v175, v175, v183
    v_mfma_f32_16x16x32_bf16 v[212:215], v[112:115], a[184:187], v[212:215]
    v_mul_f32 v172, v172, v156
    v_mul_f32 v173, v173, v157
    v_mfma_f32_16x16x32_bf16 v[212:215], v[108:111], a[168:171], v[212:215]
    v_mul_f32 v174, v174, v158
    v_mul_f32 v175, v175, v159
    v_mfma_f32_16x16x32_bf16 v[208:211], v[108:111], a[164:167], v[208:211]
    buffer_load_dwordx4 v[104:107], v7, s[36:39], s77 offen offset:1024 sc1
    v_mfma_f32_16x16x32_bf16 v[208:211], v[112:115], a[180:183], v[208:211]
    s_waitcnt vmcnt(13)
    v_bitop3_b32 v20, v116, v120, v124 bitop3:254
    v_mfma_f32_16x16x32_bf16 v[204:207], v[112:115], a[176:179], v[204:207]
    v_bitop3_b32 v20, v20, v128, -2 bitop3:254
    v_cmp_eq_u32 vcc, -1, v20
    v_mfma_f32_16x16x32_bf16 v[204:207], v[108:111], a[160:163], v[204:207]
    s_cbranch_vccnz cs_62
cb_63:
    v_mfma_f32_16x16x32_bf16 v[204:207], v[116:119], a[192:195], v[204:207]
    buffer_load_dwordx4 v[108:111], v7, s[36:39], s77 offen offset:2048 sc1
    v_mfma_f32_16x16x32_bf16 v[204:207], v[120:123], a[208:211], v[204:207]
    v_cvt_pk_bf16_f32 v138, v172, v173
    v_cvt_pk_bf16_f32 v139, v174, v175
    v_mfma_f32_16x16x32_bf16 v[208:211], v[120:123], a[212:215], v[208:211]
    v_and_b32 v136, -2, v136
    s_add_u32 s78, s85, 25174016
    buffer_store_dwordx4 v[136:139], v7, s[36:39], s78 offen sc1
    v_mfma_f32_16x16x32_bf16 v[208:211], v[116:119], a[196:199], v[208:211]
    v_mfma_f32_16x16x32_bf16 v[212:215], v[116:119], a[200:203], v[212:215]
    buffer_load_dwordx4 v[112:115], v7, s[36:39], s77 offen offset:3072 sc1
    v_mfma_f32_16x16x32_bf16 v[212:215], v[120:123], a[216:219], v[212:215]
    s_mul_i32 s11, s89, 114688
    s_mul_i32 s12, s42, 14336
    s_add_u32 s11, s11, s12
    s_nop 0
    s_add_u32 m0, s12, 100352
    s_add_u32 s81, s11, 4251648
    v_mfma_f32_16x16x32_bf16 v[216:219], v[120:123], a[220:223], v[216:219]
    buffer_load_dwordx4 v7, s[36:39], s81 offen offset:0 sc1 lds
    v_mfma_f32_16x16x32_bf16 v[216:219], v[116:119], a[204:207], v[216:219]
    v_mfma_f32_16x16x32_bf16 v[216:219], v[124:127], a[236:239], v[216:219]
    s_add_u32 s77, s73, 339968
    buffer_load_dwordx4 v[116:119], v7, s[36:39], s77 offen offset:0 sc1
    v_mfma_f32_16x16x32_bf16 v[216:219], v[128:131], a[252:255], v[216:219]
    v_mfma_f32_16x16x32_bf16 v[212:215], v[128:131], a[248:251], v[212:215]
    v_mfma_f32_16x16x32_bf16 v[212:215], v[124:127], a[232:235], v[212:215]
    v_mfma_f32_16x16x32_bf16 v[208:211], v[124:127], a[228:231], v[208:211]
    buffer_load_dwordx4 v[120:123], v7, s[36:39], s77 offen offset:1024 sc1
    v_mfma_f32_16x16x32_bf16 v[208:211], v[128:131], a[244:247], v[208:211]
    s_waitcnt vmcnt(14)
    v_bitop3_b32 v20, v68, v72, v76 bitop3:254
    v_mfma_f32_16x16x32_bf16 v[204:207], v[128:131], a[240:243], v[204:207]
    v_bitop3_b32 v20, v20, v80, -2 bitop3:254
    v_cmp_eq_u32 vcc, -1, v20
    v_mfma_f32_16x16x32_bf16 v[204:207], v[124:127], a[224:227], v[204:207]
    s_cbranch_vccnz cs_64
cb_65:
    s_nop 0
    v_mfma_f32_16x16x32_bf16 v[220:223], v[68:71], a[0:3], 0
    buffer_load_dwordx4 v[124:127], v7, s[36:39], s77 offen offset:2048 sc1
    v_mfma_f32_16x16x32_bf16 v[220:223], v[72:75], a[16:19], v[220:223]
    v_mfma_f32_16x16x32_bf16 v[224:227], v[72:75], a[20:23], 0
    v_mfma_f32_16x16x32_bf16 v[224:227], v[68:71], a[4:7], v[224:227]
    v_mfma_f32_16x16x32_bf16 v[228:231], v[68:71], a[8:11], 0
    buffer_load_dwordx4 v[128:131], v7, s[36:39], s77 offen offset:3072 sc1
    v_mfma_f32_16x16x32_bf16 v[228:231], v[72:75], a[24:27], v[228:231]
    ds_write_b128 v23, v[208:211] offset:0
    v_mfma_f32_16x16x32_bf16 v[232:235], v[72:75], a[28:31], 0
    buffer_load_dwordx4 v7, s[36:39], s81 offen offset:1024 sc1 lds
    v_mfma_f32_16x16x32_bf16 v[232:235], v[68:71], a[12:15], v[232:235]
    ds_write_b128 v64, v[212:215] offset:1024
    v_mfma_f32_16x16x32_bf16 v[232:235], v[76:79], a[44:47], v[232:235]
    s_add_u32 s77, s74, 0
    buffer_load_dwordx4 v[68:71], v7, s[36:39], s77 offen offset:0 sc1
    v_mfma_f32_16x16x32_bf16 v[232:235], v[80:83], a[60:63], v[232:235]
    ds_write_b128 v65, v[216:219] offset:2048
    v_mfma_f32_16x16x32_bf16 v[228:231], v[80:83], a[56:59], v[228:231]
    v_add_f32 v172, v11, v204
    v_add_f32_e64 v173, v11, v205
    v_mfma_f32_16x16x32_bf16 v[228:231], v[76:79], a[40:43], v[228:231]
    v_add_f32 v174, v11, v206
    v_add_f32 v175, v11, v207
    v_mfma_f32_16x16x32_bf16 v[224:227], v[76:79], a[36:39], v[224:227]
    buffer_load_dwordx4 v[72:75], v7, s[36:39], s77 offen offset:1024 sc1
    v_mfma_f32_16x16x32_bf16 v[224:227], v[80:83], a[52:55], v[224:227]
    s_waitcnt vmcnt(14)
    v_bitop3_b32 v20, v84, v88, v92 bitop3:254
    v_mfma_f32_16x16x32_bf16 v[220:223], v[80:83], a[48:51], v[220:223]
    v_bitop3_b32 v20, v20, v96, -2 bitop3:254
    v_cmp_eq_u32 vcc, -1, v20
    v_mfma_f32_16x16x32_bf16 v[220:223], v[76:79], a[32:35], v[220:223]
    s_cbranch_vccnz cs_66
cb_67:
    v_mfma_f32_16x16x32_bf16 v[220:223], v[84:87], a[64:67], v[220:223]
    buffer_load_dwordx4 v[76:79], v7, s[36:39], s77 offen offset:2048 sc1
    v_mfma_f32_16x16x32_bf16 v[220:223], v[88:91], a[80:83], v[220:223]
    s_waitcnt lgkmcnt(0)
    s_barrier
    s_nop 0
    v_mfma_f32_16x16x32_bf16 v[224:227], v[88:91], a[84:87], v[224:227]
    ds_read_b128 v[176:179], v66 offset:0
    v_mfma_f32_16x16x32_bf16 v[224:227], v[84:87], a[68:71], v[224:227]
    ds_read_b128 v[180:183], v66 offset:1024
    v_mfma_f32_16x16x32_bf16 v[228:231], v[84:87], a[72:75], v[228:231]
    buffer_load_dwordx4 v[80:83], v7, s[36:39], s77 offen offset:3072 sc1
    v_mfma_f32_16x16x32_bf16 v[228:231], v[88:91], a[88:91], v[228:231]
    ds_read_b128 v[184:187], v66 offset:2048
    v_mfma_f32_16x16x32_bf16 v[232:235], v[88:91], a[92:95], v[232:235]
    v_mfma_f32_16x16x32_bf16 v[232:235], v[84:87], a[76:79], v[232:235]
    v_mfma_f32_16x16x32_bf16 v[232:235], v[92:95], a[108:111], v[232:235]
    s_add_u32 s77, s74, 4096
    buffer_load_dwordx4 v[84:87], v7, s[36:39], s77 offen offset:0 sc1
    v_mfma_f32_16x16x32_bf16 v[232:235], v[96:99], a[124:127], v[232:235]
    v_mfma_f32_16x16x32_bf16 v[228:231], v[96:99], a[120:123], v[228:231]
    buffer_load_dwordx4 v7, s[36:39], s81 offen offset:2048 sc1 lds
    v_mfma_f32_16x16x32_bf16 v[228:231], v[92:95], a[104:107], v[228:231]
    v_mfma_f32_16x16x32_bf16 v[224:227], v[92:95], a[100:103], v[224:227]
    buffer_load_dwordx4 v[88:91], v7, s[36:39], s77 offen offset:1024 sc1
    v_mfma_f32_16x16x32_bf16 v[224:227], v[96:99], a[116:119], v[224:227]
    s_waitcnt vmcnt(13)
    v_bitop3_b32 v20, v100, v104, v108 bitop3:254
    v_mfma_f32_16x16x32_bf16 v[220:223], v[96:99], a[112:115], v[220:223]
    v_bitop3_b32 v20, v20, v112, -2 bitop3:254
    v_cmp_eq_u32 vcc, -1, v20
    v_mfma_f32_16x16x32_bf16 v[220:223], v[92:95], a[96:99], v[220:223]
    s_cbranch_vccnz cs_68
cb_69:
    v_mfma_f32_16x16x32_bf16 v[220:223], v[100:103], a[128:131], v[220:223]
    buffer_load_dwordx4 v[92:95], v7, s[36:39], s77 offen offset:2048 sc1
    v_mfma_f32_16x16x32_bf16 v[220:223], v[104:107], a[144:147], v[220:223]
    s_waitcnt lgkmcnt(2)
    v_add_f32 v172, v172, v176
    v_add_f32 v173, v173, v177
    v_mfma_f32_16x16x32_bf16 v[224:227], v[104:107], a[148:151], v[224:227]
    v_add_f32 v174, v174, v178
    v_add_f32 v175, v175, v179
    v_mfma_f32_16x16x32_bf16 v[224:227], v[100:103], a[132:135], v[224:227]
    s_waitcnt lgkmcnt(0)
    v_add_f32 v180, v180, v184
    v_add_f32_e64 v181, v181, v185
    v_mfma_f32_16x16x32_bf16 v[228:231], v[100:103], a[136:139], v[228:231]
    buffer_load_dwordx4 v[96:99], v7, s[36:39], s77 offen offset:3072 sc1
    v_mfma_f32_16x16x32_bf16 v[228:231], v[104:107], a[152:155], v[228:231]
    v_add_f32 v182, v182, v186
    v_add_f32 v183, v183, v187
    v_mfma_f32_16x16x32_bf16 v[232:235], v[104:107], a[156:159], v[232:235]
    buffer_load_dwordx4 v7, s[36:39], s81 offen offset:3072 sc1 lds
    v_mfma_f32_16x16x32_bf16 v[232:235], v[100:103], a[140:143], v[232:235]
    v_add_f32 v172, v172, v180
    v_add_f32 v173, v173, v181
    v_mfma_f32_16x16x32_bf16 v[232:235], v[108:111], a[172:175], v[232:235]
    s_add_u32 s77, s74, 8192
    buffer_load_dwordx4 v[100:103], v7, s[36:39], s77 offen offset:0 sc1
L_pad_4147:
    s_cbranch_execz L_ret_1
    v_mfma_f32_16x16x32_bf16 v[232:235], v[112:115], a[188:191], v[232:235]
    v_add_f32 v174, v174, v182
    v_add_f32_e64 v175, v175, v183
    v_mfma_f32_16x16x32_bf16 v[228:231], v[112:115], a[184:187], v[228:231]
    v_mul_f32 v172, v172, v160
    v_mul_f32 v173, v173, v161
    v_mfma_f32_16x16x32_bf16 v[228:231], v[108:111], a[168:171], v[228:231]
    v_mul_f32 v174, v174, v162
    v_mul_f32 v175, v175, v163
    v_mfma_f32_16x16x32_bf16 v[224:227], v[108:111], a[164:167], v[224:227]
    buffer_load_dwordx4 v[104:107], v7, s[36:39], s77 offen offset:1024 sc1
    v_mfma_f32_16x16x32_bf16 v[224:227], v[112:115], a[180:183], v[224:227]
    s_waitcnt vmcnt(13)
    v_bitop3_b32 v20, v116, v120, v124 bitop3:254
    v_mfma_f32_16x16x32_bf16 v[220:223], v[112:115], a[176:179], v[220:223]
    v_bitop3_b32 v20, v20, v128, -2 bitop3:254
    v_cmp_eq_u32 vcc, -1, v20
    v_mfma_f32_16x16x32_bf16 v[220:223], v[108:111], a[160:163], v[220:223]
    s_cbranch_vccnz cs_70
cb_71:
    s_nop 0
    v_mfma_f32_16x16x32_bf16 v[220:223], v[116:119], a[192:195], v[220:223]
    buffer_load_dwordx4 v[108:111], v7, s[36:39], s77 offen offset:2048 sc1
    v_mfma_f32_16x16x32_bf16 v[220:223], v[120:123], a[208:211], v[220:223]
    v_cvt_pk_bf16_f32 v132, v172, v173
    v_cvt_pk_bf16_f32 v133, v174, v175
    v_mfma_f32_16x16x32_bf16 v[224:227], v[120:123], a[212:215], v[224:227]
    v_mfma_f32_16x16x32_bf16 v[224:227], v[116:119], a[196:199], v[224:227]
    v_mfma_f32_16x16x32_bf16 v[228:231], v[116:119], a[200:203], v[228:231]
    buffer_load_dwordx4 v[112:115], v7, s[36:39], s77 offen offset:3072 sc1
    v_mfma_f32_16x16x32_bf16 v[228:231], v[120:123], a[216:219], v[228:231]
    s_add_u32 m0, s12, 104448
    s_add_u32 s81, s11, 4255744
    v_mfma_f32_16x16x32_bf16 v[232:235], v[120:123], a[220:223], v[232:235]
    buffer_load_dwordx4 v7, s[36:39], s81 offen offset:0 sc1 lds
    v_mfma_f32_16x16x32_bf16 v[232:235], v[116:119], a[204:207], v[232:235]
    v_mfma_f32_16x16x32_bf16 v[232:235], v[124:127], a[236:239], v[232:235]
    s_add_u32 s77, s74, 12288
    buffer_load_dwordx4 v[116:119], v7, s[36:39], s77 offen offset:0 sc1
    v_mfma_f32_16x16x32_bf16 v[232:235], v[128:131], a[252:255], v[232:235]
    v_mfma_f32_16x16x32_bf16 v[228:231], v[128:131], a[248:251], v[228:231]
    v_mfma_f32_16x16x32_bf16 v[228:231], v[124:127], a[232:235], v[228:231]
    v_mfma_f32_16x16x32_bf16 v[224:227], v[124:127], a[228:231], v[224:227]
    buffer_load_dwordx4 v[120:123], v7, s[36:39], s77 offen offset:1024 sc1
    v_mfma_f32_16x16x32_bf16 v[224:227], v[128:131], a[244:247], v[224:227]
    s_waitcnt vmcnt(13)
    v_bitop3_b32 v20, v68, v72, v76 bitop3:254
    v_mfma_f32_16x16x32_bf16 v[220:223], v[128:131], a[240:243], v[220:223]
    v_bitop3_b32 v20, v20, v80, -2 bitop3:254
    v_cmp_eq_u32 vcc, -1, v20
    v_mfma_f32_16x16x32_bf16 v[220:223], v[124:127], a[224:227], v[220:223]
    s_cbranch_vccnz cs_72
cb_73:
    s_nop 0
    v_mfma_f32_16x16x32_bf16 v[204:207], v[68:71], a[0:3], 0
    buffer_load_dwordx4 v[124:127], v7, s[36:39], s77 offen offset:2048 sc1
    v_mfma_f32_16x16x32_bf16 v[204:207], v[72:75], a[16:19], v[204:207]
    v_mfma_f32_16x16x32_bf16 v[208:211], v[72:75], a[20:23], 0
    v_mfma_f32_16x16x32_bf16 v[208:211], v[68:71], a[4:7], v[208:211]
    v_mfma_f32_16x16x32_bf16 v[212:215], v[68:71], a[8:11], 0
    buffer_load_dwordx4 v[128:131], v7, s[36:39], s77 offen offset:3072 sc1
    v_mfma_f32_16x16x32_bf16 v[212:215], v[72:75], a[24:27], v[212:215]
    ds_write_b128 v23, v[224:227] offset:16384
    v_mfma_f32_16x16x32_bf16 v[216:219], v[72:75], a[28:31], 0
    v_mfma_f32_16x16x32_bf16 v[216:219], v[68:71], a[12:15], v[216:219]
    ds_write_b128 v64, v[228:231] offset:17408
    v_mfma_f32_16x16x32_bf16 v[216:219], v[76:79], a[44:47], v[216:219]
    s_add_u32 s77, s75, 25165824
    buffer_load_dwordx4 v[68:71], v7, s[36:39], s77 offen offset:0 sc1
    v_mfma_f32_16x16x32_bf16 v[216:219], v[80:83], a[60:63], v[216:219]
    ds_write_b128 v65, v[232:235] offset:18432
    v_mfma_f32_16x16x32_bf16 v[212:215], v[80:83], a[56:59], v[212:215]
    v_add_f32 v172, v11, v220
    v_add_f32 v173, v11, v221
    v_mfma_f32_16x16x32_bf16 v[212:215], v[76:79], a[40:43], v[212:215]
    v_add_f32 v174, v11, v222
    v_add_f32 v175, v11, v223
    v_mfma_f32_16x16x32_bf16 v[208:211], v[76:79], a[36:39], v[208:211]
    buffer_load_dwordx4 v[72:75], v7, s[36:39], s77 offen offset:1024 sc1
    v_mfma_f32_16x16x32_bf16 v[208:211], v[80:83], a[52:55], v[208:211]
    s_waitcnt vmcnt(12)
    v_bitop3_b32 v20, v84, v88, v92 bitop3:254
    v_mfma_f32_16x16x32_bf16 v[204:207], v[80:83], a[48:51], v[204:207]
    v_bitop3_b32 v20, v20, v96, -2 bitop3:254
    v_cmp_eq_u32 vcc, -1, v20
    v_mfma_f32_16x16x32_bf16 v[204:207], v[76:79], a[32:35], v[204:207]
    s_cbranch_vccnz cs_74
cb_75:
    v_mfma_f32_16x16x32_bf16 v[204:207], v[84:87], a[64:67], v[204:207]
    buffer_load_dwordx4 v[76:79], v7, s[36:39], s77 offen offset:2048 sc1
    v_mfma_f32_16x16x32_bf16 v[204:207], v[88:91], a[80:83], v[204:207]
    s_waitcnt lgkmcnt(0)
    s_barrier
    v_mfma_f32_16x16x32_bf16 v[208:211], v[88:91], a[84:87], v[208:211]
    ds_read_b128 v[176:179], v66 offset:16384
    v_mfma_f32_16x16x32_bf16 v[208:211], v[84:87], a[68:71], v[208:211]
    ds_read_b128 v[180:183], v66 offset:17408
    v_mfma_f32_16x16x32_bf16 v[212:215], v[84:87], a[72:75], v[212:215]
    buffer_load_dwordx4 v[80:83], v7, s[36:39], s77 offen offset:3072 sc1
    v_mfma_f32_16x16x32_bf16 v[212:215], v[88:91], a[88:91], v[212:215]
    ds_read_b128 v[184:187], v66 offset:18432
    v_mfma_f32_16x16x32_bf16 v[216:219], v[88:91], a[92:95], v[216:219]
    s_waitcnt lgkmcnt(2)
    v_add_f32 v172, v172, v176
    v_add_f32 v173, v173, v177
    v_mfma_f32_16x16x32_bf16 v[216:219], v[84:87], a[76:79], v[216:219]
    v_add_f32 v174, v174, v178
    v_add_f32 v175, v175, v179
    v_mfma_f32_16x16x32_bf16 v[216:219], v[92:95], a[108:111], v[216:219]
    s_add_u32 s77, s75, 25169920
    buffer_load_dwordx4 v[84:87], v7, s[36:39], s77 offen offset:0 sc1
    v_mfma_f32_16x16x32_bf16 v[216:219], v[96:99], a[124:127], v[216:219]
    s_waitcnt lgkmcnt(0)
    v_add_f32 v180, v180, v184
    v_add_f32_e64 v181, v181, v185
    v_mfma_f32_16x16x32_bf16 v[212:215], v[96:99], a[120:123], v[212:215]
    v_add_f32 v182, v182, v186
    v_add_f32 v183, v183, v187
    v_mfma_f32_16x16x32_bf16 v[212:215], v[92:95], a[104:107], v[212:215]
    v_add_f32 v172, v172, v180
    v_add_f32 v173, v173, v181
    v_mfma_f32_16x16x32_bf16 v[208:211], v[92:95], a[100:103], v[208:211]
    buffer_load_dwordx4 v[88:91], v7, s[36:39], s77 offen offset:1024 sc1
    v_mfma_f32_16x16x32_bf16 v[208:211], v[96:99], a[116:119], v[208:211]
    s_waitcnt vmcnt(11)
    v_bitop3_b32 v20, v100, v104, v108 bitop3:254
    v_mfma_f32_16x16x32_bf16 v[204:207], v[96:99], a[112:115], v[204:207]
    v_bitop3_b32 v20, v20, v112, -2 bitop3:254
    v_cmp_eq_u32 vcc, -1, v20
    v_mfma_f32_16x16x32_bf16 v[204:207], v[92:95], a[96:99], v[204:207]
    s_cbranch_vccnz cs_76
cb_77:
    v_mfma_f32_16x16x32_bf16 v[204:207], v[100:103], a[128:131], v[204:207]
    buffer_load_dwordx4 v[92:95], v7, s[36:39], s77 offen offset:2048 sc1
    v_mfma_f32_16x16x32_bf16 v[204:207], v[104:107], a[144:147], v[204:207]
    v_add_f32 v174, v174, v182
    v_add_f32_e64 v175, v175, v183
    v_mfma_f32_16x16x32_bf16 v[208:211], v[104:107], a[148:151], v[208:211]
    v_mul_f32 v172, v172, v164
    v_mul_f32 v173, v173, v165
    v_mfma_f32_16x16x32_bf16 v[208:211], v[100:103], a[132:135], v[208:211]
    v_mul_f32 v174, v174, v166
    v_mul_f32 v175, v175, v167
    v_mfma_f32_16x16x32_bf16 v[212:215], v[100:103], a[136:139], v[212:215]
    buffer_load_dwordx4 v[96:99], v7, s[36:39], s77 offen offset:3072 sc1
    v_mfma_f32_16x16x32_bf16 v[212:215], v[104:107], a[152:155], v[212:215]
    v_cvt_pk_bf16_f32 v134, v172, v173
    v_cvt_pk_bf16_f32 v135, v174, v175
    v_mfma_f32_16x16x32_bf16 v[216:219], v[104:107], a[156:159], v[216:219]
    v_and_b32_e64 v132, -2, v132
    s_add_u32 s78, s85, 25182208
    buffer_store_dwordx4 v[132:135], v7, s[36:39], s78 offen sc1
    v_mfma_f32_16x16x32_bf16 v[216:219], v[100:103], a[140:143], v[216:219]
    v_lshlrev_b32_e64 v220, 16, v236
    v_and_b32 v221, 0xffff0000, v236
    v_mfma_f32_16x16x32_bf16 v[216:219], v[108:111], a[172:175], v[216:219]
    s_add_u32 s77, s75, 25174016
    buffer_load_dwordx4 v[100:103], v7, s[36:39], s77 offen offset:0 sc1
    v_mfma_f32_16x16x32_bf16 v[216:219], v[112:115], a[188:191], v[216:219]
    v_lshlrev_b32_e64 v222, 16, v237
    v_and_b32 v223, 0xffff0000, v237
    v_mfma_f32_16x16x32_bf16 v[212:215], v[112:115], a[184:187], v[212:215]
    v_lshlrev_b32_e64 v224, 16, v238
    v_and_b32 v225, 0xffff0000, v238
    v_mfma_f32_16x16x32_bf16 v[212:215], v[108:111], a[168:171], v[212:215]
    v_lshlrev_b32_e64 v226, 16, v239
    v_and_b32 v227, 0xffff0000, v239
    v_mfma_f32_16x16x32_bf16 v[208:211], v[108:111], a[164:167], v[208:211]
    buffer_load_dwordx4 v7, s[36:39], s81 offen offset:1024 sc1 lds
    v_mfma_f32_16x16x32_bf16 v[208:211], v[112:115], a[180:183], v[208:211]
    s_waitcnt vmcnt(11)
    v_bitop3_b32 v20, v116, v120, v124 bitop3:254
    v_mfma_f32_16x16x32_bf16 v[204:207], v[112:115], a[176:179], v[204:207]
    v_bitop3_b32 v20, v20, v128, -2 bitop3:254
    v_cmp_eq_u32 vcc, -1, v20
    v_mfma_f32_16x16x32_bf16 v[204:207], v[108:111], a[160:163], v[204:207]
    s_cbranch_vccnz cs_78
cb_79:
    v_mfma_f32_16x16x32_bf16 v[204:207], v[116:119], a[192:195], v[204:207]
    buffer_load_dwordx4 v[104:107], v7, s[36:39], s77 offen offset:1024 sc1
    v_mfma_f32_16x16x32_bf16 v[204:207], v[120:123], a[208:211], v[204:207]
    v_lshlrev_b32 v228, 16, v240
    v_and_b32 v229, 0xffff0000, v240
    v_mfma_f32_16x16x32_bf16 v[208:211], v[120:123], a[212:215], v[208:211]
    v_lshlrev_b32_e64 v230, 16, v241
    v_and_b32 v231, 0xffff0000, v241
    v_mfma_f32_16x16x32_bf16 v[208:211], v[116:119], a[196:199], v[208:211]
    v_lshlrev_b32_e64 v232, 16, v242
    v_and_b32 v233, 0xffff0000, v242
    v_mfma_f32_16x16x32_bf16 v[212:215], v[116:119], a[200:203], v[212:215]
    buffer_load_dwordx4 v7, s[36:39], s81 offen offset:2048 sc1 lds
    v_mfma_f32_16x16x32_bf16 v[212:215], v[120:123], a[216:219], v[212:215]
    v_lshlrev_b32_e64 v234, 16, v243
    v_and_b32 v235, 0xffff0000, v243
    v_mfma_f32_16x16x32_bf16 v[216:219], v[120:123], a[220:223], v[216:219]
    v_fma_f32 v220, v220, v2, v3
    v_fma_f32 v221, v221, v2, v3
    v_mfma_f32_16x16x32_bf16 v[216:219], v[116:119], a[204:207], v[216:219]
    v_fma_f32 v222, v222, v2, v3
    v_fma_f32 v223, v223, v2, v3
    v_mfma_f32_16x16x32_bf16 v[216:219], v[124:127], a[236:239], v[216:219]
    buffer_load_dwordx4 v[108:111], v7, s[36:39], s77 offen offset:2048 sc1
    v_mfma_f32_16x16x32_bf16 v[216:219], v[128:131], a[252:255], v[216:219]
    v_fma_f32 v224, v224, v2, v3
    v_fma_f32 v225, v225, v2, v3
    v_mfma_f32_16x16x32_bf16 v[212:215], v[128:131], a[248:251], v[212:215]
    v_fma_f32 v226, v226, v2, v3
    v_fma_f32 v227, v227, v2, v3
    v_mfma_f32_16x16x32_bf16 v[212:215], v[124:127], a[232:235], v[212:215]
    v_fma_f32 v228, v228, v2, v3
    v_fma_f32 v229, v229, v2, v3
    v_mfma_f32_16x16x32_bf16 v[208:211], v[124:127], a[228:231], v[208:211]
    buffer_load_dwordx4 v7, s[36:39], s81 offen offset:3072 sc1 lds
    v_mfma_f32_16x16x32_bf16 v[208:211], v[128:131], a[244:247], v[208:211]
    v_fma_f32 v230, v230, v2, v3
    v_fma_f32 v231, v231, v2, v3
    v_mfma_f32_16x16x32_bf16 v[204:207], v[128:131], a[240:243], v[204:207]
    v_fma_f32 v232, v232, v2, v3
    v_fma_f32 v233, v233, v2, v3
    v_mfma_f32_16x16x32_bf16 v[204:207], v[124:127], a[224:227], v[204:207]
    v_fma_f32 v234, v234, v2, v3
    v_fma_f32 v235, v235, v2, v3
    ds_write_b128 v23, v[208:211] offset:0
    ds_write_b128 v64, v[212:215] offset:1024
    ds_write_b128 v65, v[216:219] offset:2048
    s_nop 2
    v_add_f32 v172, v11, v204
    v_add_f32 v173, v11, v205
    v_add_f32 v174, v11, v206
    v_add_f32_e64 v175, v11, v207
    buffer_load_dwordx4 v[112:115], v7, s[36:39], s77 offen offset:3072 sc1
    s_add_u32 m0, s12, 108544
    s_add_u32 s81, s11, 4259840
    buffer_load_dwordx4 v7, s[36:39], s81 offen offset:0 sc1 lds
    s_waitcnt lgkmcnt(0)
    s_barrier
    ds_read_b128 v[176:179], v66 offset:0
    ds_read_b128 v[180:183], v66 offset:1024
    ds_read_b128 v[184:187], v66 offset:2048
    ds_read_b128 v[144:147], v7 offset:43008
    ds_read_b128 v[148:151], v7 offset:47104
    ds_read_b128 v[152:155], v7 offset:48128
    ds_read_b128 v[156:159], v7 offset:44032
    ds_read_b128 v[160:163], v7 offset:45056
    ds_read_b128 v[164:167], v7 offset:49152
    ds_read_b128 v[188:191], v7 offset:50176
    ds_read_b128 v[192:195], v7 offset:46080
    ds_read_b128 v[196:199], v7 offset:54272
    s_waitcnt lgkmcnt(11)
    v_pk_add_f32 v[172:173], v[172:173], v[176:177]
    v_pk_add_f32 v[174:175], v[174:175], v[178:179]
    s_waitcnt lgkmcnt(9)
    v_pk_add_f32 v[180:181], v[180:181], v[184:185]
    v_pk_add_f32 v[182:183], v[182:183], v[186:187]
    v_pk_add_f32 v[172:173], v[172:173], v[180:181]
    v_pk_add_f32 v[174:175], v[174:175], v[182:183]
    v_pk_mul_f32 v[172:173], v[172:173], v[168:169]
    v_pk_mul_f32 v[174:175], v[174:175], v[170:171]
    v_cvt_pk_bf16_f32 v136, v172, v173
    v_cvt_pk_bf16_f32 v137, v174, v175
    v_and_b32_e64 v136, -2, v136
    s_add_u32 s78, s86, 25165824
    buffer_store_dwordx2 v[136:137], v22, s[36:39], s78 offen sc1
    s_cmp_eq_u32 s41, 7
    s_cbranch_scc1 L_helper2
    ds_read_b128 v[200:203], v7 offset:58368
    s_add_u32 s77, s75, 25178112
    buffer_load_dwordx4 v[116:119], v7, s[36:39], s77 offen offset:0 sc1
    s_waitcnt vmcnt(15)
    v_bitop3_b32 v20, v68, v72, v76 bitop3:254
    v_bitop3_b32 v20, v20, v80, -2 bitop3:254
    v_cmp_eq_u32 vcc, -1, v20
    s_cbranch_vccnz cs_80
cb_81:
    s_waitcnt lgkmcnt(9)
    v_mfma_f32_16x16x32_bf16 v[220:223], v[144:147], v[68:71], v[220:223]
    ds_read_b128 v[144:147], v7 offset:57344
    s_waitcnt lgkmcnt(9)
    v_mfma_f32_16x16x32_bf16 v[220:223], v[148:151], v[72:75], v[220:223]
    ds_read_b128 v[148:151], v7 offset:53248
    s_waitcnt lgkmcnt(8)
    s_add_u32 m0, s12, 109568
    s_add_u32 s81, s11, 4260864
    buffer_load_dwordx4 v7, s[36:39], s81 offen offset:0 sc1 lds
    v_mfma_f32_16x16x32_bf16 v[224:227], v[152:155], v[72:75], v[224:227]
    ds_read_b128 v[152:155], v7 offset:52224
    v_mfma_f32_16x16x32_bf16 v[224:227], v[156:159], v[68:71], v[224:227]
    ds_read_b128 v[156:159], v7 offset:56320
    s_waitcnt lgkmcnt(8)
    buffer_load_dwordx4 v7, s[36:39], s81 offen offset:1024 sc1 lds
    v_mfma_f32_16x16x32_bf16 v[228:231], v[160:163], v[68:71], v[228:231]
    ds_read_b128 v[160:163], v7 offset:55296
    v_mfma_f32_16x16x32_bf16 v[228:231], v[164:167], v[72:75], v[228:231]
    ds_read_b128 v[164:167], v7 offset:51200
    s_waitcnt lgkmcnt(8)
    buffer_load_dwordx4 v7, s[36:39], s81 offen offset:2048 sc1 lds
    v_mfma_f32_16x16x32_bf16 v[232:235], v[188:191], v[72:75], v[232:235]
    ds_read_b128 v[188:191], v7 offset:59392
    v_mfma_f32_16x16x32_bf16 v[232:235], v[192:195], v[68:71], v[232:235]
    ds_read_b128 v[192:195], v7 offset:63488
    s_waitcnt lgkmcnt(8)
    buffer_load_dwordx4 v[120:123], v7, s[36:39], s77 offen offset:1024 sc1
    v_mfma_f32_16x16x32_bf16 v[232:235], v[196:199], v[76:79], v[232:235]
    ds_read_b128 v[196:199], v7 offset:64512
    v_mfma_f32_16x16x32_bf16 v[232:235], v[200:203], v[80:83], v[232:235]
    ds_read_b128 v[200:203], v7 offset:60416
    s_waitcnt lgkmcnt(8)
    buffer_load_dwordx4 v7, s[36:39], s81 offen offset:3072 sc1 lds
    v_mfma_f32_16x16x32_bf16 v[228:231], v[144:147], v[80:83], v[228:231]
    ds_read_b128 v[144:147], v7 offset:61440
    v_mfma_f32_16x16x32_bf16 v[228:231], v[148:151], v[76:79], v[228:231]
    ds_read_b128 v[148:151], v8 offset:0
    s_waitcnt lgkmcnt(8)
    s_add_u32 m0, s12, 113664
    s_add_u32 s81, s11, 4264960
    buffer_load_dwordx4 v7, s[36:39], s81 offen offset:0 sc1 lds
    v_mfma_f32_16x16x32_bf16 v[224:227], v[152:155], v[76:79], v[224:227]
    ds_read_b128 v[152:155], v8 offset:1024
    v_mfma_f32_16x16x32_bf16 v[224:227], v[156:159], v[80:83], v[224:227]
    ds_read_b128 v[156:159], v7 offset:62464
    s_waitcnt lgkmcnt(8)
    v_mfma_f32_16x16x32_bf16 v[220:223], v[160:163], v[80:83], v[220:223]
    ds_read_b128 v[160:163], v8 offset:5120
    v_mfma_f32_16x16x32_bf16 v[220:223], v[164:167], v[76:79], v[220:223]
    ds_read_b128 v[164:167], v8 offset:9216
    s_waitcnt lgkmcnt(8)
    buffer_load_dwordx4 v[124:127], v7, s[36:39], s77 offen offset:2048 sc1
    s_waitcnt vmcnt(18)
    v_bitop3_b32 v20, v84, v88, v92 bitop3:254
    v_bitop3_b32 v20, v20, v96, -2 bitop3:254
    v_cmp_eq_u32 vcc, -1, v20
    s_cbranch_vccnz cs_82
cb_83:
    v_mfma_f32_16x16x32_bf16 v[220:223], v[188:191], v[84:87], v[220:223]
    ds_read_b128 v[188:191], v8 offset:8192
    v_mfma_f32_16x16x32_bf16 v[220:223], v[192:195], v[88:91], v[220:223]
    ds_read_b128 v[192:195], v8 offset:4096
    s_waitcnt lgkmcnt(8)
    v_mfma_f32_16x16x32_bf16 v[224:227], v[196:199], v[88:91], v[224:227]
    ds_read_b128 v[196:199], v8 offset:3072
    v_mfma_f32_16x16x32_bf16 v[224:227], v[200:203], v[84:87], v[224:227]
    ds_read_b128 v[200:203], v8 offset:7168
    s_waitcnt lgkmcnt(8)
    buffer_load_dwordx4 v[128:131], v7, s[36:39], s77 offen offset:3072 sc1
    v_mfma_f32_16x16x32_bf16 v[228:231], v[144:147], v[84:87], v[228:231]
    ds_read_b128 v[144:147], v8 offset:6144
    v_mfma_f32_16x16x32_bf16 v[228:231], v[148:151], v[88:91], v[228:231]
    ds_read_b128 v[148:151], v8 offset:2048
    s_waitcnt lgkmcnt(8)
    v_mfma_f32_16x16x32_bf16 v[232:235], v[152:155], v[88:91], v[232:235]
    ds_read_b128 v[152:155], v8 offset:10240
    v_mfma_f32_16x16x32_bf16 v[232:235], v[156:159], v[84:87], v[232:235]
    ds_read_b128 v[156:159], v8 offset:14336
    s_waitcnt lgkmcnt(8)
    s_add_u32 s77, s75, 25182208
    buffer_load_dwordx4 v[68:71], v7, s[36:39], s77 offen offset:0 sc1
    v_mfma_f32_16x16x32_bf16 v[232:235], v[160:163], v[92:95], v[232:235]
    ds_read_b128 v[160:163], v8 offset:15360
    v_mfma_f32_16x16x32_bf16 v[232:235], v[164:167], v[96:99], v[232:235]
    ds_read_b128 v[164:167], v8 offset:11264
    s_waitcnt lgkmcnt(8)
    v_mfma_f32_16x16x32_bf16 v[228:231], v[188:191], v[96:99], v[228:231]
    ds_read_b128 v[188:191], v8 offset:12288
    v_mfma_f32_16x16x32_bf16 v[228:231], v[192:195], v[92:95], v[228:231]
    ds_read_b128 v[192:195], v8 offset:16384
    s_waitcnt lgkmcnt(8)
    buffer_load_dwordx4 v[72:75], v7, s[36:39], s77 offen offset:1024 sc1
    v_mfma_f32_16x16x32_bf16 v[224:227], v[196:199], v[92:95], v[224:227]
    ds_read_b128 v[196:199], v8 offset:17408
    v_mfma_f32_16x16x32_bf16 v[224:227], v[200:203], v[96:99], v[224:227]
    ds_read_b128 v[200:203], v8 offset:13312
    s_waitcnt lgkmcnt(8)
    v_mfma_f32_16x16x32_bf16 v[220:223], v[144:147], v[96:99], v[220:223]
    ds_read_b128 v[144:147], v8 offset:21504
    v_mfma_f32_16x16x32_bf16 v[220:223], v[148:151], v[92:95], v[220:223]
    ds_read_b128 v[148:151], v8 offset:25600
    s_waitcnt lgkmcnt(8)
    buffer_load_dwordx4 v[76:79], v7, s[36:39], s77 offen offset:2048 sc1
    s_waitcnt vmcnt(14)
    v_bitop3_b32 v20, v100, v104, v108 bitop3:254
    v_bitop3_b32 v20, v20, v112, -2 bitop3:254
    v_cmp_eq_u32_e64 vcc, -1, v20
    s_cbranch_vccnz cs_84
cb_85:
    v_mfma_f32_16x16x32_bf16 v[220:223], v[152:155], v[100:103], v[220:223]
    ds_read_b128 v[152:155], v8 offset:24576
    v_mfma_f32_16x16x32_bf16 v[220:223], v[156:159], v[104:107], v[220:223]
    ds_read_b128 v[156:159], v8 offset:20480
    s_waitcnt lgkmcnt(8)
    v_mfma_f32_16x16x32_bf16 v[224:227], v[160:163], v[104:107], v[224:227]
    ds_read_b128 v[160:163], v8 offset:19456
    v_mfma_f32_16x16x32_bf16 v[224:227], v[164:167], v[100:103], v[224:227]
    ds_read_b128 v[164:167], v8 offset:23552
    s_waitcnt lgkmcnt(8)
    buffer_load_dwordx4 v[80:83], v7, s[36:39], s77 offen offset:3072 sc1
    v_mfma_f32_16x16x32_bf16 v[228:231], v[188:191], v[100:103], v[228:231]
    ds_read_b128 v[188:191], v8 offset:22528
    v_mfma_f32_16x16x32_bf16 v[228:231], v[192:195], v[104:107], v[228:231]
    ds_read_b128 v[192:195], v8 offset:18432
    s_waitcnt lgkmcnt(8)
    v_mfma_f32_16x16x32_bf16 v[232:235], v[196:199], v[104:107], v[232:235]
    ds_read_b128 v[196:199], v8 offset:26624
    v_mfma_f32_16x16x32_bf16 v[232:235], v[200:203], v[100:103], v[232:235]
    ds_read_b128 v[200:203], v8 offset:30720
    s_waitcnt lgkmcnt(8)
    s_add_u32 s77, s75, 25186304
    buffer_load_dwordx4 v[84:87], v7, s[36:39], s77 offen offset:0 sc1
    v_mfma_f32_16x16x32_bf16 v[232:235], v[144:147], v[108:111], v[232:235]
    ds_read_b128 v[144:147], v8 offset:31744
    v_mfma_f32_16x16x32_bf16 v[232:235], v[148:151], v[112:115], v[232:235]
    ds_read_b128 v[148:151], v8 offset:27648
    s_waitcnt lgkmcnt(8)
    v_mfma_f32_16x16x32_bf16 v[228:231], v[152:155], v[112:115], v[228:231]
    ds_read_b128 v[152:155], v8 offset:28672
    v_mfma_f32_16x16x32_bf16 v[228:231], v[156:159], v[108:111], v[228:231]
    ds_read_b128 v[156:159], v8 offset:32768
    s_waitcnt lgkmcnt(8)
    buffer_load_dwordx4 v[88:91], v7, s[36:39], s77 offen offset:1024 sc1
    v_mfma_f32_16x16x32_bf16 v[224:227], v[160:163], v[108:111], v[224:227]
    ds_read_b128 v[160:163], v8 offset:33792
    v_mfma_f32_16x16x32_bf16 v[224:227], v[164:167], v[112:115], v[224:227]
    ds_read_b128 v[164:167], v8 offset:29696
    s_waitcnt lgkmcnt(8)
    v_mfma_f32_16x16x32_bf16 v[220:223], v[188:191], v[112:115], v[220:223]
    s_waitcnt vmcnt(8)
    s_waitcnt lgkmcnt(0)
    s_barrier
    ds_read_b128 v[188:191], v8 offset:37888
    v_mfma_f32_16x16x32_bf16 v[220:223], v[192:195], v[108:111], v[220:223]
    ds_read_b128 v[192:195], v8 offset:41984
    buffer_load_dwordx4 v[92:95], v7, s[36:39], s77 offen offset:2048 sc1
    s_waitcnt vmcnt(7)
    v_bitop3_b32 v20, v116, v120, v124 bitop3:254
    v_bitop3_b32 v20, v20, v128, -2 bitop3:254
    v_cmp_eq_u32_e64 vcc, -1, v20
    s_cbranch_vccnz cs_86
cb_87:
    v_mfma_f32_16x16x32_bf16 v[220:223], v[196:199], v[116:119], v[220:223]
    ds_read_b128 v[196:199], v8 offset:40960
    v_mfma_f32_16x16x32_bf16 v[220:223], v[200:203], v[120:123], v[220:223]
    ds_read_b128 v[200:203], v8 offset:36864
    v_mfma_f32_16x16x32_bf16 v[224:227], v[144:147], v[120:123], v[224:227]
    ds_read_b128 v[144:147], v8 offset:35840
    v_mfma_f32_16x16x32_bf16 v[224:227], v[148:151], v[116:119], v[224:227]
    ds_read_b128 v[148:151], v8 offset:39936
    buffer_load_dwordx4 v[96:99], v7, s[36:39], s77 offen offset:3072 sc1
    v_mfma_f32_16x16x32_bf16 v[228:231], v[152:155], v[116:119], v[228:231]
    ds_read_b128 v[152:155], v8 offset:38912
    v_mfma_f32_16x16x32_bf16 v[228:231], v[156:159], v[120:123], v[228:231]
    ds_read_b128 v[156:159], v8 offset:34816
    v_mfma_f32_16x16x32_bf16 v[232:235], v[160:163], v[120:123], v[232:235]
    ds_read_b128 v[160:163], v8 offset:43008
    v_mfma_f32_16x16x32_bf16 v[232:235], v[164:167], v[116:119], v[232:235]
    ds_read_b128 v[164:167], v8 offset:47104
    s_waitcnt lgkmcnt(8)
    s_add_u32 s77, s75, 25190400
    buffer_load_dwordx2 v[100:101], v22, s[36:39], s77 offen offset:0 sc1
    buffer_load_dwordx2 v[102:103], v22, s[36:39], s77 offen offset:512 sc1
    v_mfma_f32_16x16x32_bf16 v[232:235], v[188:191], v[124:127], v[232:235]
    ds_read_b128 v[188:191], v8 offset:48128
    v_mfma_f32_16x16x32_bf16 v[232:235], v[192:195], v[128:131], v[232:235]
    ds_read_b128 v[192:195], v8 offset:44032
    s_waitcnt lgkmcnt(8)
    v_mfma_f32_16x16x32_bf16 v[228:231], v[196:199], v[128:131], v[228:231]
    ds_read_b128 v[196:199], v8 offset:45056
    v_mfma_f32_16x16x32_bf16 v[228:231], v[200:203], v[124:127], v[228:231]
    ds_read_b128 v[200:203], v8 offset:49152
    s_waitcnt lgkmcnt(8)
    buffer_load_dwordx2 v[104:105], v22, s[36:39], s77 offen offset:1024 sc1
    buffer_load_dwordx2 v[106:107], v22, s[36:39], s77 offen offset:1536 sc1
    v_mfma_f32_16x16x32_bf16 v[224:227], v[144:147], v[124:127], v[224:227]
    ds_read_b128 v[144:147], v8 offset:50176
    v_mfma_f32_16x16x32_bf16 v[224:227], v[148:151], v[128:131], v[224:227]
    ds_read_b128 v[148:151], v8 offset:46080
    s_waitcnt lgkmcnt(8)
    v_mfma_f32_16x16x32_bf16 v[220:223], v[152:155], v[128:131], v[220:223]
    ds_read_b128 v[152:155], v8 offset:54272
    v_mfma_f32_16x16x32_bf16 v[220:223], v[156:159], v[124:127], v[220:223]
    ds_read_b128 v[156:159], v8 offset:58368
    s_waitcnt lgkmcnt(8)
    buffer_load_dwordx2 v[108:109], v22, s[36:39], s77 offen offset:2048 sc1
    buffer_load_dwordx2 v[110:111], v22, s[36:39], s77 offen offset:2560 sc1
    s_waitcnt vmcnt(10)
    v_bitop3_b32 v20, v68, v72, v76 bitop3:254
    v_bitop3_b32 v20, v20, v80, -2 bitop3:254
    v_cmp_eq_u32 vcc, -1, v20
    s_cbranch_vccnz cs_88
cb_89:
    v_mfma_f32_16x16x32_bf16 v[220:223], v[160:163], v[68:71], v[220:223]
    ds_read_b128 v[160:163], v8 offset:57344
    v_mfma_f32_16x16x32_bf16 v[220:223], v[164:167], v[72:75], v[220:223]
    ds_read_b128 v[164:167], v8 offset:53248
    s_waitcnt lgkmcnt(8)
    v_mfma_f32_16x16x32_bf16 v[224:227], v[188:191], v[72:75], v[224:227]
    ds_read_b128 v[188:191], v8 offset:52224
    v_mfma_f32_16x16x32_bf16 v[224:227], v[192:195], v[68:71], v[224:227]
    ds_read_b128 v[192:195], v8 offset:56320
    s_waitcnt lgkmcnt(8)
    buffer_load_dwordx2 v[112:113], v22, s[36:39], s77 offen offset:3072 sc1
    buffer_load_dwordx2 v[114:115], v22, s[36:39], s77 offen offset:3584 sc1
    v_mfma_f32_16x16x32_bf16 v[228:231], v[196:199], v[68:71], v[228:231]
    ds_read_b128 v[196:199], v8 offset:55296
    v_mfma_f32_16x16x32_bf16 v[228:231], v[200:203], v[72:75], v[228:231]
    ds_read_b128 v[200:203], v8 offset:51200
    s_waitcnt lgkmcnt(8)
    v_mfma_f32_16x16x32_bf16 v[232:235], v[144:147], v[72:75], v[232:235]
    ds_read_b128 v[144:147], v8 offset:59392
    v_mfma_f32_16x16x32_bf16 v[232:235], v[148:151], v[68:71], v[232:235]
    ds_read_b128 v[148:151], v8 offset:63488
    s_waitcnt lgkmcnt(8)
    v_mfma_f32_16x16x32_bf16 v[232:235], v[152:155], v[76:79], v[232:235]
    ds_read_b128 v[152:155], v8 offset:64512
    v_mfma_f32_16x16x32_bf16 v[232:235], v[156:159], v[80:83], v[232:235]
    ds_read_b128 v[156:159], v8 offset:60416
    s_waitcnt lgkmcnt(8)
    v_mfma_f32_16x16x32_bf16 v[228:231], v[160:163], v[80:83], v[228:231]
    ds_read_b128 v[160:163], v8 offset:61440
    v_mfma_f32_16x16x32_bf16 v[228:231], v[164:167], v[76:79], v[228:231]
    ds_read_b128 v[164:167], v9 offset:0
    s_waitcnt lgkmcnt(8)
    v_mfma_f32_16x16x32_bf16 v[224:227], v[188:191], v[76:79], v[224:227]
    ds_read_b128 v[188:191], v9 offset:1024
    v_mfma_f32_16x16x32_bf16 v[224:227], v[192:195], v[80:83], v[224:227]
    ds_read_b128 v[192:195], v8 offset:62464
    s_waitcnt lgkmcnt(8)
    v_mfma_f32_16x16x32_bf16 v[220:223], v[196:199], v[80:83], v[220:223]
    ds_read_b128 v[196:199], v9 offset:5120
    v_mfma_f32_16x16x32_bf16 v[220:223], v[200:203], v[76:79], v[220:223]
    ds_read_b128 v[200:203], v9 offset:9216
    s_waitcnt lgkmcnt(8)
    s_waitcnt vmcnt(8)
    v_bitop3_b32 v20, v84, v88, v92 bitop3:254
    v_bitop3_b32 v20, v20, v96, -2 bitop3:254
    v_cmp_eq_u32_e64 vcc, -1, v20
    s_cbranch_vccnz cs_90
cb_91:
    v_mfma_f32_16x16x32_bf16 v[220:223], v[144:147], v[84:87], v[220:223]
    ds_read_b128 v[144:147], v9 offset:8192
    v_mfma_f32_16x16x32_bf16 v[220:223], v[148:151], v[88:91], v[220:223]
    ds_read_b128 v[148:151], v9 offset:4096
    s_waitcnt lgkmcnt(8)
    v_mfma_f32_16x16x32_bf16 v[224:227], v[152:155], v[88:91], v[224:227]
    ds_read_b128 v[152:155], v9 offset:3072
    v_mfma_f32_16x16x32_bf16 v[224:227], v[156:159], v[84:87], v[224:227]
    ds_read_b128 v[156:159], v9 offset:7168
    s_waitcnt lgkmcnt(8)
    v_mfma_f32_16x16x32_bf16 v[228:231], v[160:163], v[84:87], v[228:231]
    ds_read_b128 v[160:163], v9 offset:6144
    v_mfma_f32_16x16x32_bf16 v[228:231], v[164:167], v[88:91], v[228:231]
    ds_read_b128 v[164:167], v9 offset:2048
    s_waitcnt lgkmcnt(8)
    v_mfma_f32_16x16x32_bf16 v[232:235], v[188:191], v[88:91], v[232:235]
    ds_read_b128 v[188:191], v9 offset:10240
    v_mfma_f32_16x16x32_bf16 v[232:235], v[192:195], v[84:87], v[232:235]
    ds_read_b128 v[192:195], v9 offset:14336
    s_waitcnt lgkmcnt(8)
    v_mfma_f32_16x16x32_bf16 v[232:235], v[196:199], v[92:95], v[232:235]
    ds_read_b128 v[196:199], v9 offset:15360
    v_mfma_f32_16x16x32_bf16 v[232:235], v[200:203], v[96:99], v[232:235]
    ds_read_b128 v[200:203], v9 offset:11264
    s_waitcnt lgkmcnt(8)
    v_mfma_f32_16x16x32_bf16 v[228:231], v[144:147], v[96:99], v[228:231]
    ds_read_b128 v[144:147], v9 offset:12288
    v_mfma_f32_16x16x32_bf16 v[228:231], v[148:151], v[92:95], v[228:231]
    ds_read_b128 v[148:151], v9 offset:16384
    s_waitcnt lgkmcnt(8)
    v_mfma_f32_16x16x32_bf16 v[224:227], v[152:155], v[92:95], v[224:227]
    ds_read_b128 v[152:155], v9 offset:17408
    v_mfma_f32_16x16x32_bf16 v[224:227], v[156:159], v[96:99], v[224:227]
    ds_read_b128 v[156:159], v9 offset:13312
    s_waitcnt lgkmcnt(8)
    v_mfma_f32_16x16x32_bf16 v[220:223], v[160:163], v[96:99], v[220:223]
    ds_read_b128 v[160:163], v9 offset:21504
    v_mfma_f32_16x16x32_bf16 v[220:223], v[164:167], v[92:95], v[220:223]
    ds_read_b128 v[164:167], v9 offset:25600
    s_waitcnt lgkmcnt(8)
    s_waitcnt vmcnt(0)
    v_bitop3_b32 v20, v100, v104, v108 bitop3:254
    v_bitop3_b32 v20, v20, v112, v102 bitop3:254
    v_bitop3_b32 v20, v20, v106, v110 bitop3:254
    v_bitop3_b32 v20, v20, v114, -2 bitop3:254
    v_cmp_eq_u32_e64 vcc, -1, v20
    s_cbranch_vccnz cs_92
cb_93:
    v_mfma_f32_16x16x32_bf16 v[220:223], v[188:191], v[100:103], v[220:223]
L_pad_4733:
    s_cbranch_execz L_ret_2
    ds_read_b128 v[188:191], v9 offset:24576
    v_mfma_f32_16x16x32_bf16 v[220:223], v[192:195], v[104:107], v[220:223]
    ds_read_b128 v[192:195], v9 offset:20480
    s_waitcnt lgkmcnt(8)
    v_mfma_f32_16x16x32_bf16 v[224:227], v[196:199], v[104:107], v[224:227]
    ds_read_b128 v[196:199], v9 offset:19456
    v_mfma_f32_16x16x32_bf16 v[224:227], v[200:203], v[100:103], v[224:227]
    ds_read_b128 v[200:203], v9 offset:23552
    s_waitcnt lgkmcnt(8)
    v_mfma_f32_16x16x32_bf16 v[228:231], v[144:147], v[100:103], v[228:231]
    ds_read_b128 v[144:147], v9 offset:22528
    v_mfma_f32_16x16x32_bf16 v[228:231], v[148:151], v[104:107], v[228:231]
    ds_read_b128 v[148:151], v9 offset:18432
    s_waitcnt lgkmcnt(8)
    v_mfma_f32_16x16x32_bf16 v[232:235], v[152:155], v[104:107], v[232:235]
    v_mfma_f32_16x16x32_bf16 v[232:235], v[156:159], v[100:103], v[232:235]
    s_waitcnt lgkmcnt(6)
    v_mfma_f32_16x16x32_bf16 v[232:235], v[160:163], v[108:111], v[232:235]
    v_mfma_f32_16x16x32_bf16 v[232:235], v[164:167], v[112:115], v[232:235]
    s_waitcnt lgkmcnt(4)
    v_mfma_f32_16x16x32_bf16 v[228:231], v[188:191], v[112:115], v[228:231]
    v_mfma_f32_16x16x32_bf16 v[228:231], v[192:195], v[108:111], v[228:231]
    s_waitcnt lgkmcnt(2)
    v_mfma_f32_16x16x32_bf16 v[224:227], v[196:199], v[108:111], v[224:227]
    v_mfma_f32_16x16x32_bf16 v[224:227], v[200:203], v[112:115], v[224:227]
    s_waitcnt lgkmcnt(0)
    v_mfma_f32_16x16x32_bf16 v[220:223], v[144:147], v[112:115], v[220:223]
    v_mfma_f32_16x16x32_bf16 v[220:223], v[148:151], v[108:111], v[220:223]
    s_nop 7
    v_cvt_pk_bf16_f32 v236, v220, v221
    v_cvt_pk_bf16_f32 v237, v222, v223
    v_cvt_pk_bf16_f32 v238, v224, v225
    v_cvt_pk_bf16_f32 v239, v226, v227
    v_and_b32 v236, -2, v236
    s_add_u32 s78, s92, 16777216
    buffer_store_dwordx4 v[236:239], v7, s[36:39], s78 offen sc1
    v_cvt_pk_bf16_f32 v240, v228, v229
    v_cvt_pk_bf16_f32 v241, v230, v231
    v_cvt_pk_bf16_f32 v242, v232, v233
    v_cvt_pk_bf16_f32 v243, v234, v235
    v_and_b32_e64 v240, -2, v240
    s_add_u32 s78, s92, 16778240
    buffer_store_dwordx4 v[240:243], v7, s[36:39], s78 offen sc1
    v_pk_add_f32 v[132:133], v[220:221], v[224:225]
    v_pk_mul_f32 v[136:137], v[220:221], v[220:221]
    v_pk_add_f32 v[134:135], v[222:223], v[226:227]
    v_pk_mul_f32 v[138:139], v[222:223], v[222:223]
    v_pk_fma_f32 v[136:137], v[224:225], v[224:225], v[136:137]
    v_pk_fma_f32 v[138:139], v[226:227], v[226:227], v[138:139]
    v_pk_add_f32 v[132:133], v[132:133], v[228:229]
    v_pk_fma_f32 v[136:137], v[228:229], v[228:229], v[136:137]
    v_pk_add_f32 v[134:135], v[134:135], v[230:231]
    v_pk_fma_f32 v[138:139], v[230:231], v[230:231], v[138:139]
    v_pk_add_f32 v[132:133], v[132:133], v[232:233]
    v_pk_fma_f32 v[136:137], v[232:233], v[232:233], v[136:137]
    v_pk_add_f32 v[134:135], v[134:135], v[234:235]
    v_pk_fma_f32 v[138:139], v[234:235], v[234:235], v[138:139]
    v_pk_add_f32 v[132:133], v[132:133], v[134:135]
    v_pk_add_f32 v[136:137], v[136:137], v[138:139]
    s_lshl3_add_u32 s70, s52, s41
    s_lshl_b32 s70, s70, 8
    s_add_u32 s70, s70, 1572864
    v_add_f32 v132, v132, v133
    v_add_f32 v133, v136, v137
    v_mov_b32 v134, s44
    v_mov_b32 v135, s44
    v_mov_b32 v2, v132
    v_mov_b32 v3, v133
    s_nop 0
    v_permlane32_swap_b32 v132, v2
    v_permlane32_swap_b32 v133, v3
    v_add_f32 v132, v132, v2
    v_add_f32 v133, v133, v3
    v_mov_b32 v2, v132
    v_mov_b32 v3, v133
    s_nop 0
    v_permlane16_swap_b32 v132, v2
    v_permlane16_swap_b32 v133, v3
    v_add_f32 v132, v132, v2
    v_add_f32_e64 v133, v133, v3
    s_mov_b64 exec, s[66:67]
    buffer_store_dwordx4 v[132:135], v7, s[36:39], s70 offen sc1
    s_mov_b64 exec, -1
    s_sub_u32 s74, 32, s40
    s_and_b32 s74, s74, 31
    s_cmp_eq_u32 s51, 0
    s_cselect_b32 s74, s40, s74
    s_lshl2_add_u32 s74, s74, s42
    v_mul_u32_u24 v2, 1792, v5
    v_sub_u32 v3, 12544, v2
    v_lshl_add_u32 v2, v4, 4, v2
    v_lshl_add_u32 v3, v4, 4, v3
    v_and_b32_e64 v64, 3, v4
    v_lshl_add_u32 v64, v5, 2, v64
    v_lshlrev_b32 v64, 4, v64
    v_lshrrev_b32 v23, 2, v4
    v_lshl_add_u32 v23, v23, 8, v64
    v_mov_b32 v68, 0
    v_mov_b32 v69, 0
    v_mov_b32 v70, s44
    s_lshl_b32 s77, s74, 11
    s_add_u32 s77, s77, 1572864
    s_lshr_b32 s70, s40, 1
    s_xor_b32 s70, s70, s42
    s_and_b32 s70, s70, 1
    s_lshl1_add_u32 s70, s89, s70
    s_lshl_b32 s70, s70, 2
    v_lshrrev_b32 v72, 2, v4
    v_and_b32_e64 v73, 3, v4
    v_mad_u32_u24 v72, v72, 56, v73
    v_add_u32 v72, s70, v72
    v_cmp_eq_u32 vcc, 0, v72
    v_mov_b32 v74, 224
    s_and_b32 s70, s42, 2
    v_cndmask_b32 v72, v72, v74, vcc
    v_mad_u32_u24 v73, v72, v5, s70
    v_and_b32 v73, 7, v73
    v_cvt_f32_u32 v73, v73
    v_cvt_f32_u32_e64 v72, v72
    v_mul_f32 v73, 0x3e000000, v73
    v_mul_f32 v76, 0x3c924925, v72
    v_mul_f32 v72, 0x3b124925, v72
    v_cos_f32_e64 v76, v76
    s_mul_i32 s70, s42, 14336
    s_add_u32 s70, s70, 43008
    v_add_u32 v74, s70, v7
    v_add_f32 v76, v76, v76
    v_cos_f32 v80, v73
    v_add_f32 v73, v73, v72
    v_cos_f32 v81, v73
    v_add_f32 v73, v73, v72
    v_cos_f32_e64 v82, v73
    s_mul_i32 s9, s42, 11264
    s_min_u32 s9, s9, 31744
    s_mul_i32 s8, s45, 14336
    s_add_u32 s8, s8, s9
    s_add_u32 m0, s9, 0
    s_add_u32 s81, s8, 2899968
    buffer_load_dwordx4 v7, s[36:39], s81 offen offset:0 sc1 lds
    v_add_f32 v73, v73, v72
    v_cos_f32 v83, v73
    v_add_f32 v73, v73, v72
    v_cos_f32 v84, v73
    v_add_f32 v73, v73, v72
    v_cos_f32 v85, v73
    v_add_f32 v73, v73, v72
    v_cos_f32 v86, v73
    v_add_f32 v73, v73, v72
    v_cos_f32 v87, v73
    v_add_f32_e64 v73, v73, v72
    v_cvt_pk_bf16_f32 v104, v80, v81
    v_cvt_pk_bf16_f32 v105, v82, v83
    v_cvt_pk_bf16_f32 v106, v84, v85
    v_cvt_pk_bf16_f32 v107, v86, v87
    buffer_load_dwordx4 v7, s[36:39], s81 offen offset:1024 sc1 lds
    ds_write_b128 v74, v[104:107] offset:0
    v_cos_f32 v88, v73
    v_add_f32 v73, v73, v72
    v_cos_f32 v89, v73
    v_add_f32 v73, v73, v72
    v_cos_f32 v90, v73
    v_add_f32 v73, v73, v72
    v_cos_f32 v91, v73
    v_add_f32 v73, v73, v72
    v_cos_f32 v92, v73
    v_add_f32 v73, v73, v72
    v_cos_f32 v93, v73
    v_add_f32 v73, v73, v72
    v_cos_f32_e64 v94, v73
    buffer_load_dwordx4 v7, s[36:39], s81 offen offset:2048 sc1 lds
    v_add_f32 v73, v73, v72
    v_cos_f32 v95, v73
    v_add_f32_e64 v73, v73, v72
    v_cvt_pk_bf16_f32 v108, v88, v87
    v_cvt_pk_bf16_f32 v109, v86, v85
    v_cvt_pk_bf16_f32 v110, v84, v83
    v_cvt_pk_bf16_f32 v111, v82, v81
    ds_write_b128 v74, v[108:111] offset:13312
    v_cvt_pk_bf16_f32 v104, v88, v89
    v_cvt_pk_bf16_f32 v105, v90, v91
    v_cvt_pk_bf16_f32 v106, v92, v93
    v_cvt_pk_bf16_f32 v107, v94, v95
    ds_write_b128 v74, v[104:107] offset:1024
    v_pk_fma_f32 v[96:97], v[88:89], v[76:77], v[80:81] op_sel_hi:[1,0,1] neg_lo:[0,0,1] neg_hi:[0,0,1]
    v_pk_fma_f32 v[98:99], v[90:91], v[76:77], v[82:83] op_sel_hi:[1,0,1] neg_lo:[0,0,1] neg_hi:[0,0,1]
    buffer_load_dwordx4 v7, s[36:39], s81 offen offset:3072 sc1 lds
    v_pk_fma_f32 v[100:101], v[92:93], v[76:77], v[84:85] op_sel_hi:[1,0,1] neg_lo:[0,0,1] neg_hi:[0,0,1]
    v_pk_fma_f32 v[102:103], v[94:95], v[76:77], v[86:87] op_sel_hi:[1,0,1] neg_lo:[0,0,1] neg_hi:[0,0,1]
    v_cvt_pk_bf16_f32 v108, v96, v95
    v_cvt_pk_bf16_f32 v109, v94, v93
    v_cvt_pk_bf16_f32 v110, v92, v91
    v_cvt_pk_bf16_f32 v111, v90, v89
    ds_write_b128 v74, v[108:111] offset:12288
    v_cvt_pk_bf16_f32 v104, v96, v97
    v_cvt_pk_bf16_f32 v105, v98, v99
    v_cvt_pk_bf16_f32 v106, v100, v101
    v_cvt_pk_bf16_f32 v107, v102, v103
    ds_write_b128 v74, v[104:107] offset:2048
    v_pk_fma_f32 v[80:81], v[96:97], v[76:77], v[88:89] op_sel_hi:[1,0,1] neg_lo:[0,0,1] neg_hi:[0,0,1]
    v_pk_fma_f32 v[82:83], v[98:99], v[76:77], v[90:91] op_sel_hi:[1,0,1] neg_lo:[0,0,1] neg_hi:[0,0,1]
    s_waitcnt vmcnt(5)
    s_nop 0
    s_mul_i32 s88, s74, 14336
    s_add_u32 s88, s88, 16777216
    buffer_load_dwordx4 v[200:203], v2, s[36:39], s88 offen offset:0 sc1
    v_pk_fma_f32 v[84:85], v[100:101], v[76:77], v[92:93] op_sel_hi:[1,0,1] neg_lo:[0,0,1] neg_hi:[0,0,1]
    v_pk_fma_f32 v[86:87], v[102:103], v[76:77], v[94:95] op_sel_hi:[1,0,1] neg_lo:[0,0,1] neg_hi:[0,0,1]
    v_cvt_pk_bf16_f32 v108, v80, v103
    v_cvt_pk_bf16_f32 v109, v102, v101
    buffer_load_dwordx4 v[204:207], v2, s[36:39], s88 offen offset:256 sc1
    v_cvt_pk_bf16_f32 v110, v100, v99
    v_cvt_pk_bf16_f32 v111, v98, v97
    ds_write_b128 v74, v[108:111] offset:11264
    v_cvt_pk_bf16_f32 v104, v80, v81
    buffer_load_dwordx4 v[208:211], v2, s[36:39], s88 offen offset:512 sc1
    v_cvt_pk_bf16_f32 v105, v82, v83
    v_cvt_pk_bf16_f32 v106, v84, v85
    v_cvt_pk_bf16_f32 v107, v86, v87
    ds_write_b128 v74, v[104:107] offset:3072
    buffer_load_dwordx4 v[212:215], v2, s[36:39], s88 offen offset:768 sc1
    v_pk_fma_f32 v[88:89], v[80:81], v[76:77], v[96:97] op_sel_hi:[1,0,1] neg_lo:[0,0,1] neg_hi:[0,0,1]
    v_pk_fma_f32 v[90:91], v[82:83], v[76:77], v[98:99] op_sel_hi:[1,0,1] neg_lo:[0,0,1] neg_hi:[0,0,1]
    v_pk_fma_f32 v[92:93], v[84:85], v[76:77], v[100:101] op_sel_hi:[1,0,1] neg_lo:[0,0,1] neg_hi:[0,0,1]
    buffer_load_dwordx4 v[216:219], v2, s[36:39], s88 offen offset:1024 sc1
    v_pk_fma_f32 v[94:95], v[86:87], v[76:77], v[102:103] op_sel_hi:[1,0,1] neg_lo:[0,0,1] neg_hi:[0,0,1]
    v_cvt_pk_bf16_f32 v108, v88, v87
    v_cvt_pk_bf16_f32 v109, v86, v85
    v_cvt_pk_bf16_f32 v110, v84, v83
    buffer_load_dwordx4 v[220:223], v2, s[36:39], s88 offen offset:1280 sc1
    v_cvt_pk_bf16_f32 v111, v82, v81
    ds_write_b128 v74, v[108:111] offset:10240
    v_cvt_pk_bf16_f32 v104, v88, v89
    v_cvt_pk_bf16_f32 v105, v90, v91
    buffer_load_dwordx4 v[224:227], v2, s[36:39], s88 offen offset:1536 sc1
    v_cvt_pk_bf16_f32 v106, v92, v93
    v_cvt_pk_bf16_f32 v107, v94, v95
    ds_write_b128 v74, v[104:107] offset:4096
    v_pk_fma_f32 v[96:97], v[88:89], v[76:77], v[80:81] op_sel_hi:[1,0,1] neg_lo:[0,0,1] neg_hi:[0,0,1]
    buffer_load_dwordx4 v[228:231], v3, s[36:39], s88 offen offset:0 sc1
    v_pk_fma_f32 v[98:99], v[90:91], v[76:77], v[82:83] op_sel_hi:[1,0,1] neg_lo:[0,0,1] neg_hi:[0,0,1]
    v_pk_fma_f32 v[100:101], v[92:93], v[76:77], v[84:85] op_sel_hi:[1,0,1] neg_lo:[0,0,1] neg_hi:[0,0,1]
    v_pk_fma_f32 v[102:103], v[94:95], v[76:77], v[86:87] op_sel_hi:[1,0,1] neg_lo:[0,0,1] neg_hi:[0,0,1]
    buffer_load_dwordx4 v[232:235], v3, s[36:39], s88 offen offset:256 sc1
    v_cvt_pk_bf16_f32 v108, v96, v95
    v_cvt_pk_bf16_f32 v109, v94, v93
    v_cvt_pk_bf16_f32 v110, v92, v91
    v_cvt_pk_bf16_f32 v111, v90, v89
    buffer_load_dwordx4 v[236:239], v3, s[36:39], s88 offen offset:512 sc1
    ds_write_b128 v74, v[108:111] offset:9216
    v_cvt_pk_bf16_f32 v104, v96, v97
    v_cvt_pk_bf16_f32 v105, v98, v99
    v_cvt_pk_bf16_f32 v106, v100, v101
    buffer_load_dwordx4 v[240:243], v3, s[36:39], s88 offen offset:768 sc1
    v_cvt_pk_bf16_f32 v107, v102, v103
    ds_write_b128 v74, v[104:107] offset:5120
    v_pk_fma_f32 v[80:81], v[96:97], v[76:77], v[88:89] op_sel_hi:[1,0,1] neg_lo:[0,0,1] neg_hi:[0,0,1]
    v_pk_fma_f32 v[82:83], v[98:99], v[76:77], v[90:91] op_sel_hi:[1,0,1] neg_lo:[0,0,1] neg_hi:[0,0,1]
    buffer_load_dwordx4 v[244:247], v3, s[36:39], s88 offen offset:1024 sc1
    v_pk_fma_f32 v[84:85], v[100:101], v[76:77], v[92:93] op_sel_hi:[1,0,1] neg_lo:[0,0,1] neg_hi:[0,0,1]
    v_pk_fma_f32 v[86:87], v[102:103], v[76:77], v[94:95] op_sel_hi:[1,0,1] neg_lo:[0,0,1] neg_hi:[0,0,1]
    v_cvt_pk_bf16_f32 v108, v80, v103
    buffer_load_dwordx4 v[248:251], v3, s[36:39], s88 offen offset:1280 sc1
    v_cvt_pk_bf16_f32 v109, v102, v101
    v_cvt_pk_bf16_f32 v110, v100, v99
    v_cvt_pk_bf16_f32 v111, v98, v97
    ds_write_b128 v74, v[108:111] offset:8192
    buffer_load_dwordx4 v[252:255], v3, s[36:39], s88 offen offset:1536 sc1
    v_cvt_pk_bf16_f32 v104, v80, v81
    v_cvt_pk_bf16_f32 v105, v82, v83
    v_cvt_pk_bf16_f32 v106, v84, v85
    v_cvt_pk_bf16_f32 v107, v86, v87
    buffer_load_dwordx4 v[64:67], v23, s[36:39], s77 offen sc1
    ds_write_b128 v74, v[104:107] offset:6144
    v_pk_fma_f32 v[88:89], v[80:81], v[76:77], v[96:97] op_sel_hi:[1,0,1] neg_lo:[0,0,1] neg_hi:[0,0,1]
    v_cvt_pk_bf16_f32 v108, v88, v87
    v_cvt_pk_bf16_f32 v109, v86, v85
    s_mov_b32 exec_lo, 0x0fff0fff
    s_mov_b32 exec_hi, 0x0fff0fff
    buffer_load_dwordx4 v[68:71], v23, s[36:39], s77 offen offset:1024 sc1
    s_mov_b64 exec, -1
    v_cvt_pk_bf16_f32 v110, v84, v83
    v_cvt_pk_bf16_f32 v111, v82, v81
    ds_write_b128 v74, v[108:111] offset:7168
    s_lshl_b32 s70, s51, 10
    s_lshl3_add_u32 s70, s50, s70
    s_add_u32 s70, s70, 143360
    s_lshl_b32 s71, s42, 11
    s_add_u32 s71, s71, 151552
    v_add_u32 v100, s70, v7
    v_add_u32 v103, s71, v7
    v_lshl_add_u32 v101, v4, 7, s71
    v_lshl_add_u32 v101, v6, 4, v101
    v_xor_b32_e64 v102, 64, v101
    s_waitcnt lgkmcnt(0)
    s_barrier
    ds_read_b128 v[104:107], v7 offset:43008
    ds_read_b128 v[108:111], v7 offset:44032
    ds_read_b128 v[112:115], v7 offset:58368
    ds_read_b128 v[116:119], v7 offset:57344
    ds_read_b128 v[120:123], v8 offset:6144
    ds_read_b128 v[124:127], v8 offset:7168
    ds_read_b128 v[128:131], v8 offset:21504
    ds_read_b128 v[132:135], v8 offset:20480
    s_waitcnt vmcnt(13)
    v_bitop3_b32 v20, v200, v204, v208 bitop3:254
    s_waitcnt vmcnt(12)
    v_bitop3_b32 v20, v20, v212, -2 bitop3:254
    v_cmp_eq_u32_e64 vcc, -1, v20
    s_cbranch_vccnz cs_94
cb_95:
    s_waitcnt lgkmcnt(7)
    v_mfma_f32_16x16x32_bf16 v[76:79], v[200:203], v[104:107], 0
    ds_read_b128 v[104:107], v8 offset:22528
    s_waitcnt lgkmcnt(7)
    v_mfma_f32_16x16x32_bf16 v[76:79], v[204:207], v[108:111], v[76:79]
    ds_read_b128 v[108:111], v8 offset:23552
    s_waitcnt lgkmcnt(6)
    v_mfma_f32_16x16x32_bf16 v[80:83], v[204:207], v[112:115], 0
    ds_read_b128 v[112:115], v8 offset:9216
    v_mfma_f32_16x16x32_bf16 v[80:83], v[200:203], v[116:119], v[80:83]
    ds_read_b128 v[116:119], v8 offset:8192
    s_waitcnt lgkmcnt(6)
    v_mfma_f32_16x16x32_bf16 v[84:87], v[200:203], v[120:123], 0
    ds_read_b128 v[120:123], v7 offset:59392
    v_mfma_f32_16x16x32_bf16 v[84:87], v[204:207], v[124:127], v[84:87]
    ds_read_b128 v[124:127], v7 offset:60416
    s_waitcnt lgkmcnt(6)
    v_mfma_f32_16x16x32_bf16 v[88:91], v[204:207], v[128:131], 0
    ds_read_b128 v[128:131], v7 offset:46080
    v_mfma_f32_16x16x32_bf16 v[88:91], v[200:203], v[132:135], v[88:91]
    ds_read_b128 v[132:135], v7 offset:45056
    s_waitcnt lgkmcnt(6)
    v_mfma_f32_16x16x32_bf16 v[88:91], v[208:211], v[104:107], v[88:91]
    ds_read_b128 v[104:107], v7 offset:47104
    v_mfma_f32_16x16x32_bf16 v[88:91], v[212:215], v[108:111], v[88:91]
    ds_read_b128 v[108:111], v7 offset:48128
    s_waitcnt lgkmcnt(6)
    v_mfma_f32_16x16x32_bf16 v[84:87], v[212:215], v[112:115], v[84:87]
    ds_read_b128 v[112:115], v7 offset:62464
    s_add_u32 m0, s9, 4096
    s_add_u32 s81, s8, 2904064
    buffer_load_dwordx4 v7, s[36:39], s81 offen offset:0 sc1 lds
    v_mfma_f32_16x16x32_bf16 v[84:87], v[208:211], v[116:119], v[84:87]
    ds_read_b128 v[116:119], v7 offset:61440
    s_waitcnt lgkmcnt(6)
    v_mfma_f32_16x16x32_bf16 v[80:83], v[208:211], v[120:123], v[80:83]
    ds_read_b128 v[120:123], v8 offset:10240
    v_mfma_f32_16x16x32_bf16 v[80:83], v[212:215], v[124:127], v[80:83]
    ds_read_b128 v[124:127], v8 offset:11264
    s_waitcnt lgkmcnt(6)
    v_mfma_f32_16x16x32_bf16 v[76:79], v[212:215], v[128:131], v[76:79]
    ds_read_b128 v[128:131], v8 offset:25600
    v_mfma_f32_16x16x32_bf16 v[76:79], v[208:211], v[132:135], v[76:79]
    ds_read_b128 v[132:135], v8 offset:24576
    s_waitcnt lgkmcnt(6)
    s_waitcnt vmcnt(10)
    v_bitop3_b32 v20, v216, v220, v224 bitop3:254
    s_waitcnt vmcnt(9)
    v_bitop3_b32 v20, v20, v228, -2 bitop3:254
    v_cmp_eq_u32_e64 vcc, -1, v20
    s_cbranch_vccnz cs_96
cb_97:
    v_mfma_f32_16x16x32_bf16 v[76:79], v[216:219], v[104:107], v[76:79]
    ds_read_b128 v[104:107], v8 offset:26624
    v_mfma_f32_16x16x32_bf16 v[76:79], v[220:223], v[108:111], v[76:79]
    buffer_load_dwordx4 v7, s[36:39], s81 offen offset:1024 sc1 lds
    ds_read_b128 v[108:111], v8 offset:27648
    s_waitcnt lgkmcnt(6)
    v_mfma_f32_16x16x32_bf16 v[80:83], v[220:223], v[112:115], v[80:83]
    ds_read_b128 v[112:115], v8 offset:13312
    v_mfma_f32_16x16x32_bf16 v[80:83], v[216:219], v[116:119], v[80:83]
    ds_read_b128 v[116:119], v8 offset:12288
    s_waitcnt lgkmcnt(6)
    v_mfma_f32_16x16x32_bf16 v[84:87], v[216:219], v[120:123], v[84:87]
    ds_read_b128 v[120:123], v7 offset:63488
    v_mfma_f32_16x16x32_bf16 v[84:87], v[220:223], v[124:127], v[84:87]
    ds_read_b128 v[124:127], v7 offset:64512
    s_waitcnt lgkmcnt(6)
    v_mfma_f32_16x16x32_bf16 v[88:91], v[220:223], v[128:131], v[88:91]
    ds_read_b128 v[128:131], v7 offset:50176
    v_mfma_f32_16x16x32_bf16 v[88:91], v[216:219], v[132:135], v[88:91]
    ds_read_b128 v[132:135], v7 offset:49152
    s_waitcnt lgkmcnt(6)
    v_mfma_f32_16x16x32_bf16 v[88:91], v[224:227], v[104:107], v[88:91]
    ds_read_b128 v[104:107], v7 offset:51200
    v_mfma_f32_16x16x32_bf16 v[96:99], v[228:231], v[108:111], 0
    buffer_load_dwordx4 v7, s[36:39], s81 offen offset:2048 sc1 lds
    ds_read_b128 v[108:111], v7 offset:52224
    s_waitcnt lgkmcnt(6)
    v_mfma_f32_16x16x32_bf16 v[92:95], v[228:231], v[112:115], 0
    ds_read_b128 v[112:115], v8 offset:1024
    v_mfma_f32_16x16x32_bf16 v[84:87], v[224:227], v[116:119], v[84:87]
    ds_read_b128 v[116:119], v8 offset:0
    s_waitcnt lgkmcnt(6)
    v_mfma_f32_16x16x32_bf16 v[80:83], v[224:227], v[120:123], v[80:83]
    ds_read_b128 v[120:123], v8 offset:14336
    v_mfma_f32_16x16x32_bf16 v[80:83], v[228:231], v[124:127], v[80:83]
    ds_read_b128 v[124:127], v8 offset:15360
    s_waitcnt lgkmcnt(6)
    v_mfma_f32_16x16x32_bf16 v[76:79], v[228:231], v[128:131], v[76:79]
    ds_read_b128 v[128:131], v8 offset:29696
    v_mfma_f32_16x16x32_bf16 v[76:79], v[224:227], v[132:135], v[76:79]
    ds_read_b128 v[132:135], v8 offset:28672
    s_waitcnt lgkmcnt(6)
    s_or_b32 s70, s41, s42
    s_cbranch_scc1 ht_98
    s_lshl_b32 s70, s40, 7
    s_add_u32 s70, s70, 671744
    s_bfm_b64 exec, 32, 0
    buffer_store_dword v10, v21, s[36:39], s70 offen sc1
    s_mov_b64 exec, -1
ht_98:
    buffer_load_dwordx4 v7, s[36:39], s81 offen offset:3072 sc1 lds
    s_waitcnt vmcnt(9)
    v_bitop3_b32 v20, v232, v236, v240 bitop3:254
    s_waitcnt vmcnt(7)
    v_bitop3_b32 v20, v20, v244, v248 bitop3:254
    s_waitcnt vmcnt(6)
    v_bitop3_b32 v20, v20, v252, -2 bitop3:254
    v_cmp_eq_u32 vcc, -1, v20
    s_cbranch_vccnz cs_99
cb_100:
    v_mfma_f32_16x16x32_bf16 v[76:79], v[232:235], v[104:107], v[76:79]
    ds_read_b128 v[104:107], v8 offset:30720
    v_mfma_f32_16x16x32_bf16 v[76:79], v[236:239], v[108:111], v[76:79]
    ds_read_b128 v[108:111], v8 offset:31744
    s_waitcnt lgkmcnt(6)
    v_mfma_f32_16x16x32_bf16 v[80:83], v[236:239], v[112:115], v[80:83]
    ds_read_b128 v[112:115], v8 offset:17408
    v_mfma_f32_16x16x32_bf16 v[80:83], v[232:235], v[116:119], v[80:83]
    ds_read_b128 v[116:119], v8 offset:16384
    s_waitcnt lgkmcnt(6)
    s_add_u32 m0, s9, 8192
    s_add_u32 s81, s8, 2908160
    buffer_load_dwordx4 v7, s[36:39], s81 offen offset:0 sc1 lds
    v_mfma_f32_16x16x32_bf16 v[92:95], v[232:235], v[120:123], v[92:95]
    ds_read_b128 v[120:123], v8 offset:2048
    v_mfma_f32_16x16x32_bf16 v[92:95], v[236:239], v[124:127], v[92:95]
    ds_read_b128 v[124:127], v8 offset:3072
    s_waitcnt lgkmcnt(6)
    v_mfma_f32_16x16x32_bf16 v[96:99], v[236:239], v[128:131], v[96:99]
    ds_read_b128 v[128:131], v7 offset:54272
    v_mfma_f32_16x16x32_bf16 v[96:99], v[232:235], v[132:135], v[96:99]
    ds_read_b128 v[132:135], v7 offset:53248
    s_waitcnt lgkmcnt(6)
    v_mfma_f32_16x16x32_bf16 v[96:99], v[240:243], v[104:107], v[96:99]
    ds_read_b128 v[104:107], v7 offset:55296
    v_mfma_f32_16x16x32_bf16 v[96:99], v[244:247], v[108:111], v[96:99]
    ds_read_b128 v[108:111], v7 offset:56320
    s_waitcnt lgkmcnt(6)
    v_mfma_f32_16x16x32_bf16 v[92:95], v[244:247], v[112:115], v[92:95]
    ds_read_b128 v[112:115], v8 offset:5120
    v_mfma_f32_16x16x32_bf16 v[92:95], v[240:243], v[116:119], v[92:95]
    ds_read_b128 v[116:119], v8 offset:4096
    s_waitcnt lgkmcnt(6)
    v_mfma_f32_16x16x32_bf16 v[80:83], v[240:243], v[120:123], v[80:83]
    buffer_load_dwordx4 v7, s[36:39], s81 offen offset:1024 sc1 lds
    ds_read_b128 v[120:123], v8 offset:18432
    v_mfma_f32_16x16x32_bf16 v[80:83], v[244:247], v[124:127], v[80:83]
    ds_read_b128 v[124:127], v8 offset:19456
    s_waitcnt lgkmcnt(6)
    v_mfma_f32_16x16x32_bf16 v[76:79], v[244:247], v[128:131], v[76:79]
    ds_read_b128 v[128:131], v8 offset:33792
    v_mfma_f32_16x16x32_bf16 v[76:79], v[240:243], v[132:135], v[76:79]
    ds_read_b128 v[132:135], v8 offset:32768
    s_waitcnt lgkmcnt(6)
    v_mfma_f32_16x16x32_bf16 v[76:79], v[248:251], v[104:107], v[76:79]
    v_mfma_f32_16x16x32_bf16 v[76:79], v[252:255], v[108:111], v[76:79]
    s_waitcnt lgkmcnt(4)
    v_mfma_f32_16x16x32_bf16 v[80:83], v[252:255], v[112:115], v[80:83]
    v_mfma_f32_16x16x32_bf16 v[80:83], v[248:251], v[116:119], v[80:83]
    s_waitcnt lgkmcnt(2)
    v_mfma_f32_16x16x32_bf16 v[92:95], v[248:251], v[120:123], v[92:95]
    v_mfma_f32_16x16x32_bf16 v[92:95], v[252:255], v[124:127], v[92:95]
    s_waitcnt lgkmcnt(0)
    v_mfma_f32_16x16x32_bf16 v[96:99], v[252:255], v[128:131], v[96:99]
    v_mfma_f32_16x16x32_bf16 v[96:99], v[248:251], v[132:135], v[96:99]
    s_waitcnt vmcnt(7)
    v_cmp_ne_u32 vcc, s44, v66
    s_waitcnt vmcnt(6)
    v_cmp_ne_u32 s[70:71], s44, v70
    s_or_b64 vcc, vcc, s[70:71]
    s_cbranch_scc1 ss_101
sb_102:
    v_pk_add_f32 v[64:65], v[64:65], v[68:69]
    s_nop 1
    v_add_f32_dpp v64, v64, v64 row_ror:4 row_mask:0xf bank_mask:0xf
    v_add_f32_dpp v65, v65, v65 row_ror:4 row_mask:0xf bank_mask:0xf
    s_nop 0
    v_add_f32_dpp v64, v64, v64 row_ror:8 row_mask:0xf bank_mask:0xf
    v_add_f32_dpp v65, v65, v65 row_ror:8 row_mask:0xf bank_mask:0xf
    v_mul_f32 v64, 0x3b124925, v64
    v_mul_f32 v65, 0x3b124925, v65
    v_fma_f32 v65, -v64, v64, v65
    v_max_f32 v65, 0, v65
    v_add_f32 v65, s53, v65
    v_rsq_f32 v66, v65
    s_nop 1
    v_mov_b32_dpp v72, v66 quad_perm:[0,0,0,0] row_mask:0xf bank_mask:0xf
    v_mov_b32_dpp v73, v66 quad_perm:[1,1,1,1] row_mask:0xf bank_mask:0xf
    v_mov_b32_dpp v74, v66 quad_perm:[2,2,2,2] row_mask:0xf bank_mask:0xf
    v_mov_b32_dpp v75, v66 quad_perm:[3,3,3,3] row_mask:0xf bank_mask:0xf
    v_pk_mul_f32 v[76:77], v[76:77], v[72:73]
    v_pk_mul_f32 v[78:79], v[78:79], v[74:75]
    v_cvt_pk_bf16_f32 v76, v76, v77
    v_cvt_pk_bf16_f32 v77, v78, v79
    ds_write_b64 v100, v[76:77] offset:0
    v_pk_mul_f32 v[80:81], v[80:81], v[72:73]
    v_pk_mul_f32 v[82:83], v[82:83], v[74:75]
    v_cvt_pk_bf16_f32 v80, v80, v81
    v_cvt_pk_bf16_f32 v81, v82, v83
    ds_write_b64 v100, v[80:81] offset:2048
    v_pk_add_f32 v[84:85], v[84:85], v[92:93] neg_lo:[0,1] neg_hi:[0,1]
    v_pk_add_f32 v[86:87], v[86:87], v[94:95] neg_lo:[0,1] neg_hi:[0,1]
    v_pk_mul_f32 v[84:85], v[84:85], v[72:73]
    v_pk_mul_f32 v[86:87], v[86:87], v[74:75]
    v_cvt_pk_bf16_f32 v84, v84, v85
    v_cvt_pk_bf16_f32 v85, v86, v87
    ds_write_b64 v100, v[84:85] offset:4096
    v_pk_add_f32 v[88:89], v[88:89], v[96:97] neg_lo:[0,1] neg_hi:[0,1]
    v_pk_add_f32 v[90:91], v[90:91], v[98:99] neg_lo:[0,1] neg_hi:[0,1]
    v_pk_mul_f32 v[88:89], v[88:89], v[72:73]
    v_pk_mul_f32 v[90:91], v[90:91], v[74:75]
    v_cvt_pk_bf16_f32 v88, v88, v89
    v_cvt_pk_bf16_f32 v89, v90, v91
    ds_write_b64 v100, v[88:89] offset:6144
    s_waitcnt lgkmcnt(0)
    s_barrier
    ds_read_b128 v[168:171], v9 offset:12288
    ds_read_b128 v[172:175], v9 offset:14336
    ds_read_b128 v[176:179], v9 offset:16384
    ds_read_b128 v[180:183], v9 offset:18432
    ds_read_b128 v[184:187], v9 offset:13312
    ds_read_b128 v[188:191], v9 offset:15360
    ds_read_b128 v[192:195], v9 offset:17408
    ds_read_b128 v[196:199], v9 offset:19456
    s_add_u32 m0, s9, 10240
    s_add_u32 s81, s8, 2910208
    buffer_load_dwordx4 v7, s[36:39], s81 offen offset:0 sc1 lds
    s_mul_i32 s11, s42, 11264
    s_min_u32 s11, s11, 31744
    s_mul_i32 s10, s45, 14336
    s_add_u32 s10, s10, s11
    s_add_u32 m0, s11, 100352
    s_add_u32 s81, s10, 2942976
    buffer_load_dwordx4 v7, s[36:39], s81 offen offset:0 sc1 lds
    s_waitcnt lgkmcnt(7)
    v_mfma_f32_16x16x32_bf16 v[76:79], v[168:171], v[24:27], 0
    s_waitcnt lgkmcnt(6)
    v_mfma_f32_16x16x32_bf16 v[80:83], v[172:175], v[24:27], 0
    v_mfma_f32_16x16x32_bf16 v[84:87], v[168:171], v[40:43], 0
    v_mfma_f32_16x16x32_bf16 v[88:91], v[172:175], v[40:43], 0
    s_waitcnt lgkmcnt(5)
    v_mfma_f32_16x16x32_bf16 v[76:79], v[176:179], v[32:35], v[76:79]
    s_waitcnt lgkmcnt(4)
    v_mfma_f32_16x16x32_bf16 v[80:83], v[180:183], v[32:35], v[80:83]
    v_mfma_f32_16x16x32_bf16 v[84:87], v[176:179], v[24:27], v[84:87]
    v_mfma_f32_16x16x32_bf16 v[88:91], v[180:183], v[24:27], v[88:91]
    s_waitcnt lgkmcnt(3)
    v_mfma_f32_16x16x32_bf16 v[76:79], v[184:187], v[28:31], v[76:79]
    s_waitcnt lgkmcnt(2)
    v_mfma_f32_16x16x32_bf16 v[80:83], v[188:191], v[28:31], v[80:83]
    v_mfma_f32_16x16x32_bf16 v[84:87], v[184:187], v[44:47], v[84:87]
    v_mfma_f32_16x16x32_bf16 v[88:91], v[188:191], v[44:47], v[88:91]
    s_waitcnt lgkmcnt(1)
    v_mfma_f32_16x16x32_bf16 v[76:79], v[192:195], v[36:39], v[76:79]
    s_waitcnt lgkmcnt(0)
    v_mfma_f32_16x16x32_bf16 v[80:83], v[196:199], v[36:39], v[80:83]
    v_mfma_f32_16x16x32_bf16 v[84:87], v[192:195], v[28:31], v[84:87]
    v_mfma_f32_16x16x32_bf16 v[88:91], v[196:199], v[28:31], v[88:91]
    s_nop 3
    v_cvt_pk_bf16_f32 v168, v76, v77
    v_cvt_pk_bf16_f32 v169, v78, v79
    v_cvt_pk_bf16_f32 v170, v80, v81
    v_cvt_pk_bf16_f32 v171, v82, v83
    v_or_b32_e64 v168, 1, v168
    ds_write_b128 v101, v[168:171]
    v_cvt_pk_bf16_f32 v172, v84, v85
    v_cvt_pk_bf16_f32 v173, v86, v87
    v_cvt_pk_bf16_f32 v174, v88, v89
    v_cvt_pk_bf16_f32 v175, v90, v91
    v_or_b32_e64 v172, 1, v172
    ds_write_b128 v102, v[172:175]
    ds_read_b128 v[176:179], v103 offset:0
    ds_read_b128 v[180:183], v103 offset:1024
    s_add_u32 s78, s82, 14680064
    s_waitcnt lgkmcnt(1)
    buffer_store_dwordx4 v[176:179], v14, s[36:39], s78 offen sc1
    s_add_u32 s78, s82, 14909440
    s_waitcnt lgkmcnt(0)
    buffer_store_dwordx4 v[180:183], v14, s[36:39], s78 offen sc1
    s_cmp_eq_u32 s51, 0
    s_cbranch_scc1 xs_103
L_join1:
    s_mul_i32 s88, s52, 14336
    s_add_u32 s88, s88, 16777216
    buffer_load_dwordx4 v[200:203], v2, s[36:39], s88 offen offset:0 sc1
    buffer_load_dwordx4 v[204:207], v2, s[36:39], s88 offen offset:256 sc1
    buffer_load_dwordx4 v[208:211], v2, s[36:39], s88 offen offset:512 sc1
    buffer_load_dwordx4 v[212:215], v2, s[36:39], s88 offen offset:768 sc1
L_pad_5334:
    s_cbranch_execz L_ret_2
    buffer_load_dwordx4 v[216:219], v2, s[36:39], s88 offen offset:1024 sc1
    buffer_load_dwordx4 v[220:223], v2, s[36:39], s88 offen offset:1280 sc1
    buffer_load_dwordx4 v[224:227], v2, s[36:39], s88 offen offset:1536 sc1
    buffer_load_dwordx4 v[228:231], v3, s[36:39], s88 offen offset:0 sc1
    buffer_load_dwordx4 v[232:235], v3, s[36:39], s88 offen offset:256 sc1
    buffer_load_dwordx4 v[236:239], v3, s[36:39], s88 offen offset:512 sc1
    buffer_load_dwordx4 v[240:243], v3, s[36:39], s88 offen offset:768 sc1
    buffer_load_dwordx4 v[244:247], v3, s[36:39], s88 offen offset:1024 sc1
    buffer_load_dwordx4 v[248:251], v3, s[36:39], s88 offen offset:1280 sc1
    buffer_load_dwordx4 v[252:255], v3, s[36:39], s88 offen offset:1536 sc1
xs_103:
    s_lshl_b32 s72, s42, 10
    s_mul_i32 s73, s48, 28672
    s_add_u32 s73, s73, s72
    s_mul_i32 s74, s49, 28672
    s_add_u32 s74, s74, s72
    s_add_u32 s72, s72, 43008
    v_add_u32_e64 v25, s72, v7
    s_add_u32 m0, s11, 101376
    s_add_u32 s81, s10, 2944000
    buffer_load_dwordx4 v7, s[36:39], s81 offen offset:0 sc1 lds
    buffer_load_dwordx4 v7, s[36:39], s81 offen offset:1024 sc1 lds
    s_mov_b64 exec, 0
    s_cmp_eq_u32 s42, 0
    s_cbranch_scc1 L_pad_5880
    s_cmp_eq_u32 s42, 1
    s_cbranch_scc1 L_pad_6454
    s_cmp_eq_u32 s42, 2
    s_cbranch_scc1 L_pad_7050
    s_branch L_pad_7653
L_ret_3:
    s_mov_b64 exec, -1
    v_lshrrev_b32 v30, 5, v1
    v_lshlrev_b32 v30, 10, v30
    v_and_b32 v31, 31, v1
    v_lshl_add_u32 v30, v31, 4, v30
    v_and_b32_e64 v31, 1, v5
    v_lshl_add_u32 v30, v31, 3, v30
    s_mul_i32 s70, s51, 28672
    s_sub_u32 s71, 28672, s70
    s_cmp_eq_u32 s40, 0
    s_cselect_b32 s71, s70, s71
    s_add_u32 s70, s70, 43008
    v_add_u32 v26, s70, v30
    v_xor_b32 v27, 8, v26
    s_add_u32 s71, s71, 43008
    v_add_u32 v28, s71, v30
    v_xor_b32 v29, 8, v28
    v_add_u32 v30, 16, v1
    v_and_b32 v30, 63, v30
    v_lshlrev_b32_e64 v30, 2, v30
    s_waitcnt vmcnt(2)
    s_add_u32 m0, s72, 0
    s_add_u32 s88, s73, 14680064
    buffer_load_dwordx4 v7, s[36:39], s88 offen sc1 lds
    s_add_u32 m0, s72, 28672
    s_add_u32 s88, s74, 14680064
    buffer_load_dwordx4 v7, s[36:39], s88 offen sc1 lds
    s_add_u32 m0, s72, 4096
    s_add_u32 s88, s73, 14684160
    buffer_load_dwordx4 v7, s[36:39], s88 offen sc1 lds
    s_add_u32 m0, s72, 32768
    s_add_u32 s88, s74, 14684160
    buffer_load_dwordx4 v7, s[36:39], s88 offen sc1 lds
    s_add_u32 m0, s72, 8192
    s_add_u32 s88, s73, 14688256
    buffer_load_dwordx4 v7, s[36:39], s88 offen sc1 lds
    s_add_u32 m0, s72, 36864
    s_add_u32 s88, s74, 14688256
    buffer_load_dwordx4 v7, s[36:39], s88 offen sc1 lds
    s_add_u32 m0, s72, 12288
    s_add_u32 s88, s73, 14692352
    buffer_load_dwordx4 v7, s[36:39], s88 offen sc1 lds
    s_add_u32 m0, s72, 40960
    s_add_u32 s88, s74, 14692352
    buffer_load_dwordx4 v7, s[36:39], s88 offen sc1 lds
    s_add_u32 m0, s72, 16384
    s_add_u32 s88, s73, 14696448
    buffer_load_dwordx4 v7, s[36:39], s88 offen sc1 lds
    s_add_u32 m0, s72, 45056
    s_add_u32 s88, s74, 14696448
    buffer_load_dwordx4 v7, s[36:39], s88 offen sc1 lds
    s_add_u32 m0, s72, 20480
    s_add_u32 s88, s73, 14700544
    buffer_load_dwordx4 v7, s[36:39], s88 offen sc1 lds
    s_add_u32 m0, s72, 49152
    s_add_u32 s88, s74, 14700544
    buffer_load_dwordx4 v7, s[36:39], s88 offen sc1 lds
    s_add_u32 m0, s72, 24576
    s_add_u32 s88, s73, 14704640
    buffer_load_dwordx4 v7, s[36:39], s88 offen sc1 lds
    s_add_u32 m0, s72, 53248
    s_add_u32 s88, s74, 14704640
    buffer_load_dwordx4 v7, s[36:39], s88 offen sc1 lds
    v_bitop3_b32 v20, v200, v204, v208 bitop3:254
    v_bitop3_b32 v20, v20, v212, v216 bitop3:254
    v_bitop3_b32 v20, v20, v220, v224 bitop3:254
    v_bitop3_b32 v20, v20, v228, v232 bitop3:254
    v_bitop3_b32 v20, v20, v236, v240 bitop3:254
    v_bitop3_b32 v20, v20, v244, v248 bitop3:254
    v_bitop3_b32 v20, v20, v252, -2 bitop3:254
    v_cmp_eq_u32 vcc, -1, v20
    s_cbranch_vccnz cs_106
cb_107:
    v_lshlrev_b32_e64 v144, 16, v200
    v_and_b32 v145, 0xffff0000, v200
    v_lshlrev_b32_e64 v146, 16, v201
    v_and_b32 v147, 0xffff0000, v201
    v_lshlrev_b32_e64 v148, 16, v202
    v_and_b32 v149, 0xffff0000, v202
    v_lshlrev_b32_e64 v150, 16, v203
    v_and_b32 v151, 0xffff0000, v203
    v_lshlrev_b32_e64 v152, 16, v204
    v_and_b32 v153, 0xffff0000, v204
    v_lshlrev_b32_e64 v154, 16, v205
    v_and_b32 v155, 0xffff0000, v205
    v_lshlrev_b32_e64 v156, 16, v206
    v_and_b32 v157, 0xffff0000, v206
    v_lshlrev_b32_e64 v158, 16, v207
    v_and_b32 v159, 0xffff0000, v207
    v_lshlrev_b32_e64 v160, 16, v208
    v_and_b32 v161, 0xffff0000, v208
    v_lshlrev_b32_e64 v162, 16, v209
    v_and_b32 v163, 0xffff0000, v209
    v_lshlrev_b32_e64 v164, 16, v210
    v_and_b32 v165, 0xffff0000, v210
    v_lshlrev_b32_e64 v166, 16, v211
    v_and_b32 v167, 0xffff0000, v211
    v_lshlrev_b32_e64 v168, 16, v212
    v_and_b32 v169, 0xffff0000, v212
    v_lshlrev_b32_e64 v170, 16, v213
    v_and_b32 v171, 0xffff0000, v213
    v_lshlrev_b32_e64 v172, 16, v214
    v_and_b32 v173, 0xffff0000, v214
    v_lshlrev_b32_e64 v174, 16, v215
    v_and_b32 v175, 0xffff0000, v215
    v_lshlrev_b32_e64 v176, 16, v216
    v_and_b32 v177, 0xffff0000, v216
    v_lshlrev_b32_e64 v178, 16, v217
    v_and_b32 v179, 0xffff0000, v217
    v_lshlrev_b32_e64 v180, 16, v218
    v_and_b32 v181, 0xffff0000, v218
    v_lshlrev_b32_e64 v182, 16, v219
    v_and_b32 v183, 0xffff0000, v219
    v_lshlrev_b32_e64 v184, 16, v220
    v_and_b32 v185, 0xffff0000, v220
    v_lshlrev_b32_e64 v186, 16, v221
    v_and_b32 v187, 0xffff0000, v221
    v_lshlrev_b32_e64 v188, 16, v222
    v_and_b32 v189, 0xffff0000, v222
    v_lshlrev_b32_e64 v190, 16, v223
    v_and_b32 v191, 0xffff0000, v223
    v_lshlrev_b32_e64 v192, 16, v224
    v_and_b32 v193, 0xffff0000, v224
    v_lshlrev_b32_e64 v194, 16, v225
    v_and_b32 v195, 0xffff0000, v225
    v_lshlrev_b32_e64 v196, 16, v226
    v_and_b32 v197, 0xffff0000, v226
    v_lshlrev_b32_e64 v198, 16, v227
    v_and_b32 v199, 0xffff0000, v227
    v_lshlrev_b32_e64 v24, 16, v228
    v_and_b32 v143, 0xffff0000, v228
    v_lshlrev_b32_e64 v142, 16, v229
    v_and_b32 v141, 0xffff0000, v229
    v_lshlrev_b32_e64 v140, 16, v230
    v_and_b32 v139, 0xffff0000, v230
    v_lshlrev_b32_e64 v138, 16, v231
    v_and_b32 v137, 0xffff0000, v231
    v_lshlrev_b32_e64 v136, 16, v232
    v_and_b32 v135, 0xffff0000, v232
    v_lshlrev_b32_e64 v134, 16, v233
    v_and_b32 v133, 0xffff0000, v233
    v_lshlrev_b32_e64 v132, 16, v234
    v_and_b32 v131, 0xffff0000, v234
    v_lshlrev_b32_e64 v130, 16, v235
    v_and_b32 v129, 0xffff0000, v235
    v_lshlrev_b32_e64 v128, 16, v236
    v_and_b32 v127, 0xffff0000, v236
    v_lshlrev_b32_e64 v126, 16, v237
    v_and_b32 v125, 0xffff0000, v237
    v_lshlrev_b32_e64 v124, 16, v238
    v_and_b32 v123, 0xffff0000, v238
    v_lshlrev_b32_e64 v122, 16, v239
    v_and_b32 v121, 0xffff0000, v239
    v_lshlrev_b32_e64 v120, 16, v240
    v_and_b32 v119, 0xffff0000, v240
    v_lshlrev_b32_e64 v118, 16, v241
    v_and_b32 v117, 0xffff0000, v241
    v_lshlrev_b32_e64 v116, 16, v242
    v_and_b32 v115, 0xffff0000, v242
    v_lshlrev_b32_e64 v114, 16, v243
    v_and_b32 v113, 0xffff0000, v243
    v_lshlrev_b32_e64 v112, 16, v244
    v_and_b32 v111, 0xffff0000, v244
    v_lshlrev_b32_e64 v110, 16, v245
    v_and_b32 v109, 0xffff0000, v245
    v_lshlrev_b32_e64 v108, 16, v246
    v_and_b32 v107, 0xffff0000, v246
    v_lshlrev_b32_e64 v106, 16, v247
    v_and_b32 v105, 0xffff0000, v247
    v_lshlrev_b32_e64 v104, 16, v248
    v_and_b32 v103, 0xffff0000, v248
    v_lshlrev_b32_e64 v102, 16, v249
    v_and_b32 v101, 0xffff0000, v249
    v_lshlrev_b32_e64 v100, 16, v250
    v_and_b32 v99, 0xffff0000, v250
    v_lshlrev_b32_e64 v98, 16, v251
    v_and_b32 v97, 0xffff0000, v251
    v_lshlrev_b32_e64 v96, 16, v252
    v_and_b32 v95, 0xffff0000, v252
    v_lshlrev_b32_e64 v94, 16, v253
    v_and_b32 v93, 0xffff0000, v253
    v_lshlrev_b32_e64 v92, 16, v254
    v_and_b32 v91, 0xffff0000, v254
    v_lshlrev_b32_e64 v90, 16, v255
    v_and_b32 v89, 0xffff0000, v255
    v_mov_b32 v88, 0
    v_mov_b32_e64 v23, v144
    s_waitcnt vmcnt(12)
    ds_read_b32 v232, v25 offset:0
    ds_read_b32 v233, v25 offset:28672
    s_waitcnt vmcnt(10)
    ds_read_b32 v234, v25 offset:4096
    ds_read_b32 v235, v25 offset:32768
    s_waitcnt vmcnt(8)
    ds_read_b32 v236, v25 offset:8192
    ds_read_b32 v237, v25 offset:36864
    s_waitcnt vmcnt(6)
    ds_read_b32 v238, v25 offset:12288
    ds_read_b32 v239, v25 offset:40960
    s_waitcnt vmcnt(4)
    ds_read_b32 v240, v25 offset:16384
    ds_read_b32 v241, v25 offset:45056
    s_waitcnt vmcnt(2)
    ds_read_b32 v242, v25 offset:20480
    ds_read_b32 v243, v25 offset:49152
    s_waitcnt vmcnt(0)
    ds_read_b32 v244, v25 offset:24576
    ds_read_b32 v245, v25 offset:53248
    s_waitcnt lgkmcnt(11)
    v_bitop3_b32 v20, v232, v233, v234 bitop3:128
    s_waitcnt lgkmcnt(9)
    v_bitop3_b32 v20, v20, v235, v236 bitop3:128
    s_waitcnt lgkmcnt(7)
    v_bitop3_b32 v20, v20, v237, v238 bitop3:128
    s_waitcnt lgkmcnt(5)
    v_bitop3_b32 v20, v20, v239, v240 bitop3:128
    s_waitcnt lgkmcnt(3)
    v_bitop3_b32 v20, v20, v241, v242 bitop3:128
    s_waitcnt lgkmcnt(1)
    v_bitop3_b32 v20, v20, v243, v244 bitop3:128
    s_waitcnt lgkmcnt(0)
    v_bitop3_b32 v20, v20, v245, 1 bitop3:128
    v_cmp_eq_u32 vcc, 0, v20
    s_cbranch_vccnz cs_108
cb_109:
    s_barrier
    ds_read_b64_tr_b16 v[200:201], v28 offset:0
    ds_read_b64_tr_b16 v[202:203], v28 offset:512
    ds_read_b64_tr_b16 v[204:205], v28 offset:2048
    ds_read_b64_tr_b16 v[206:207], v28 offset:2560
    ds_read_b64_tr_b16 v[208:209], v26 offset:0
    ds_read_b64_tr_b16 v[210:211], v26 offset:512
    ds_read_b64_tr_b16 v[212:213], v26 offset:2048
    ds_read_b64_tr_b16 v[214:215], v26 offset:2560
    ds_read_b64_tr_b16 v[216:217], v29 offset:0
    ds_read_b64_tr_b16 v[218:219], v29 offset:512
    ds_read_b64_tr_b16 v[220:221], v29 offset:2048
    ds_read_b64_tr_b16 v[222:223], v29 offset:2560
    ds_read_b64_tr_b16 v[224:225], v27 offset:0
    ds_read_b64_tr_b16 v[226:227], v27 offset:512
    s_add_u32 m0, s11, 103424
    s_add_u32 s81, s10, 2946048
    buffer_load_dwordx4 v7, s[36:39], s81 offen offset:0 sc1 lds
    ds_read_b64_tr_b16 v[228:229], v27 offset:2048
    ds_read_b64_tr_b16 v[230:231], v27 offset:2560
    s_waitcnt lgkmcnt(14)
    v_mfma_f32_16x16x32_bf16 v[88:91], v[200:203], v[56:59], v[88:91]
    ds_read_b64_tr_b16 v[200:201], v28 offset:4096
    ds_read_b64_tr_b16 v[202:203], v28 offset:4608
    s_waitcnt lgkmcnt(14)
    v_mfma_f32_16x16x32_bf16 v[88:91], v[204:207], v[60:63], v[88:91]
    ds_read_b64_tr_b16 v[204:205], v28 offset:6144
    ds_read_b64_tr_b16 v[206:207], v28 offset:6656
    s_waitcnt lgkmcnt(12)
    v_mfma_f32_16x16x32_bf16 v[144:147], v[208:211], v[48:51], v[144:147]
    ds_read_b64_tr_b16 v[208:209], v26 offset:4096
    ds_read_b64_tr_b16 v[210:211], v26 offset:4608
    v_mfma_f32_16x16x32_bf16 v[144:147], v[212:215], v[52:55], v[144:147]
    ds_read_b64_tr_b16 v[212:213], v26 offset:6144
    ds_read_b64_tr_b16 v[214:215], v26 offset:6656
    s_waitcnt lgkmcnt(12)
    s_add_u32 s78, s83, 35651584
    buffer_store_dwordx4 v[16:19], v15, s[36:39], s78 offen sc1
    v_mfma_f32_16x16x32_bf16 v[92:95], v[216:219], v[56:59], v[92:95]
    ds_read_b64_tr_b16 v[216:217], v29 offset:4096
    ds_read_b64_tr_b16 v[218:219], v29 offset:4608
    v_mfma_f32_16x16x32_bf16 v[92:95], v[220:223], v[60:63], v[92:95]
    ds_read_b64_tr_b16 v[220:221], v29 offset:6144
    ds_read_b64_tr_b16 v[222:223], v29 offset:6656
    s_waitcnt lgkmcnt(12)
    v_mfma_f32_16x16x32_bf16 v[148:151], v[224:227], v[48:51], v[148:151]
    ds_read_b64_tr_b16 v[224:225], v27 offset:4096
    ds_read_b64_tr_b16 v[226:227], v27 offset:4608
    v_mfma_f32_16x16x32_bf16 v[148:151], v[228:231], v[52:55], v[148:151]
    ds_read_b64_tr_b16 v[228:229], v27 offset:6144
    ds_read_b64_tr_b16 v[230:231], v27 offset:6656
    s_waitcnt lgkmcnt(12)
    v_mfma_f32_16x16x32_bf16 v[96:99], v[200:203], v[56:59], v[96:99]
    buffer_load_dwordx4 v7, s[36:39], s81 offen offset:1024 sc1 lds
    ds_bpermute_b32 v31, v30, v88
    ds_read_b64_tr_b16 v[200:201], v28 offset:8192
    ds_read_b64_tr_b16 v[202:203], v28 offset:8704
    v_mfma_f32_16x16x32_bf16 v[96:99], v[204:207], v[60:63], v[96:99]
    ds_read_b64_tr_b16 v[204:205], v28 offset:10240
    ds_read_b64_tr_b16 v[206:207], v28 offset:10752
    s_waitcnt lgkmcnt(13)
    v_mfma_f32_16x16x32_bf16 v[152:155], v[208:211], v[48:51], v[152:155]
    ds_read_b64_tr_b16 v[208:209], v26 offset:8192
    ds_read_b64_tr_b16 v[210:211], v26 offset:8704
    v_mfma_f32_16x16x32_bf16 v[152:155], v[212:215], v[52:55], v[152:155]
    ds_read_b64_tr_b16 v[212:213], v26 offset:10240
    ds_read_b64_tr_b16 v[214:215], v26 offset:10752
    s_waitcnt lgkmcnt(13)
    v_mfma_f32_16x16x32_bf16 v[100:103], v[216:219], v[56:59], v[100:103]
    s_add_u32 s78, s83, 35782656
    buffer_store_dwordx4 v[16:19], v15, s[36:39], s78 offen sc1
    ds_read_b64_tr_b16 v[216:217], v29 offset:8192
    ds_read_b64_tr_b16 v[218:219], v29 offset:8704
    v_mfma_f32_16x16x32_bf16 v[100:103], v[220:223], v[60:63], v[100:103]
    ds_read_b64_tr_b16 v[220:221], v29 offset:10240
    ds_read_b64_tr_b16 v[222:223], v29 offset:10752
    s_waitcnt lgkmcnt(13)
    v_mfma_f32_16x16x32_bf16 v[156:159], v[224:227], v[48:51], v[156:159]
    ds_read_b64_tr_b16 v[224:225], v27 offset:8192
    ds_read_b64_tr_b16 v[226:227], v27 offset:8704
    v_mfma_f32_16x16x32_bf16 v[156:159], v[228:231], v[52:55], v[156:159]
    ds_read_b64_tr_b16 v[228:229], v27 offset:10240
    ds_read_b64_tr_b16 v[230:231], v27 offset:10752
    s_waitcnt lgkmcnt(12)
    v_mfma_f32_16x16x32_bf16 v[104:107], v[200:203], v[56:59], v[104:107]
    ds_read_b64_tr_b16 v[200:201], v28 offset:12288
    ds_read_b64_tr_b16 v[202:203], v28 offset:12800
    buffer_load_dwordx4 v7, s[36:39], s81 offen offset:2048 sc1 lds
    v_mfma_f32_16x16x32_bf16 v[104:107], v[204:207], v[60:63], v[104:107]
    ds_read_b64_tr_b16 v[204:205], v28 offset:14336
    ds_read_b64_tr_b16 v[206:207], v28 offset:14848
    s_waitcnt lgkmcnt(12)
    v_mfma_f32_16x16x32_bf16 v[160:163], v[208:211], v[48:51], v[160:163]
    ds_read_b64_tr_b16 v[208:209], v26 offset:12288
    ds_read_b64_tr_b16 v[210:211], v26 offset:12800
    v_mfma_f32_16x16x32_bf16 v[160:163], v[212:215], v[52:55], v[160:163]
    ds_read_b64_tr_b16 v[212:213], v26 offset:14336
    ds_read_b64_tr_b16 v[214:215], v26 offset:14848
    s_waitcnt lgkmcnt(12)
    v_mfma_f32_16x16x32_bf16 v[108:111], v[216:219], v[56:59], v[108:111]
    v_add_f32_e64 v88, v31, v24
    v_cndmask_b32 v144, v144, v23, s[66:67]
    ds_read_b64_tr_b16 v[216:217], v29 offset:12288
    s_add_u32 s78, s83, 35913728
    buffer_store_dwordx4 v[16:19], v15, s[36:39], s78 offen sc1
    ds_read_b64_tr_b16 v[218:219], v29 offset:12800
    v_mfma_f32_16x16x32_bf16 v[108:111], v[220:223], v[60:63], v[108:111]
    ds_read_b64_tr_b16 v[220:221], v29 offset:14336
    ds_read_b64_tr_b16 v[222:223], v29 offset:14848
    s_waitcnt lgkmcnt(12)
    v_mfma_f32_16x16x32_bf16 v[164:167], v[224:227], v[48:51], v[164:167]
    ds_read_b64_tr_b16 v[224:225], v27 offset:12288
    ds_read_b64_tr_b16 v[226:227], v27 offset:12800
    v_mfma_f32_16x16x32_bf16 v[164:167], v[228:231], v[52:55], v[164:167]
    ds_read_b64_tr_b16 v[228:229], v27 offset:14336
    ds_read_b64_tr_b16 v[230:231], v27 offset:14848
    s_waitcnt lgkmcnt(12)
    v_mfma_f32_16x16x32_bf16 v[112:115], v[200:203], v[56:59], v[112:115]
    ds_read_b64_tr_b16 v[200:201], v28 offset:16384
    ds_read_b64_tr_b16 v[202:203], v28 offset:16896
    buffer_load_dwordx4 v7, s[36:39], s81 offen offset:3072 sc1 lds
    v_mfma_f32_16x16x32_bf16 v[112:115], v[204:207], v[60:63], v[112:115]
    ds_read_b64_tr_b16 v[204:205], v28 offset:18432
    ds_read_b64_tr_b16 v[206:207], v28 offset:18944
    s_waitcnt lgkmcnt(12)
    v_mfma_f32_16x16x32_bf16 v[168:171], v[208:211], v[48:51], v[168:171]
    ds_read_b64_tr_b16 v[208:209], v26 offset:16384
    ds_read_b64_tr_b16 v[210:211], v26 offset:16896
    v_mfma_f32_16x16x32_bf16 v[168:171], v[212:215], v[52:55], v[168:171]
    ds_read_b64_tr_b16 v[212:213], v26 offset:18432
    ds_read_b64_tr_b16 v[214:215], v26 offset:18944
    s_waitcnt lgkmcnt(12)
    v_mfma_f32_16x16x32_bf16 v[116:119], v[216:219], v[56:59], v[116:119]
    ds_read_b64_tr_b16 v[216:217], v29 offset:16384
    ds_read_b64_tr_b16 v[218:219], v29 offset:16896
    v_mfma_f32_16x16x32_bf16 v[116:119], v[220:223], v[60:63], v[116:119]
    ds_read_b64_tr_b16 v[220:221], v29 offset:18432
    s_add_u32 s78, s84, 35651584
    s_mov_b32 exec_lo, 0xffff
    s_mov_b32 exec_hi, 0xffff
    buffer_store_dwordx4 v[16:19], v15, s[36:39], s78 offen sc1
    s_mov_b64 exec, -1
    ds_read_b64_tr_b16 v[222:223], v29 offset:18944
    s_waitcnt lgkmcnt(12)
    v_mfma_f32_16x16x32_bf16 v[172:175], v[224:227], v[48:51], v[172:175]
    ds_read_b64_tr_b16 v[224:225], v27 offset:16384
    ds_read_b64_tr_b16 v[226:227], v27 offset:16896
    v_mfma_f32_16x16x32_bf16 v[172:175], v[228:231], v[52:55], v[172:175]
    ds_read_b64_tr_b16 v[228:229], v27 offset:18432
    ds_read_b64_tr_b16 v[230:231], v27 offset:18944
    s_waitcnt lgkmcnt(12)
    v_mfma_f32_16x16x32_bf16 v[120:123], v[200:203], v[56:59], v[120:123]
    ds_read_b64_tr_b16 v[200:201], v28 offset:20480
    ds_read_b64_tr_b16 v[202:203], v28 offset:20992
    v_mfma_f32_16x16x32_bf16 v[120:123], v[204:207], v[60:63], v[120:123]
    ds_read_b64_tr_b16 v[204:205], v28 offset:22528
    ds_read_b64_tr_b16 v[206:207], v28 offset:23040
    s_add_u32 m0, s11, 107520
    s_add_u32 s81, s10, 2950144
    buffer_load_dwordx4 v7, s[36:39], s81 offen offset:0 sc1 lds
    s_waitcnt lgkmcnt(12)
    v_mfma_f32_16x16x32_bf16 v[176:179], v[208:211], v[48:51], v[176:179]
    ds_read_b64_tr_b16 v[208:209], v26 offset:20480
    ds_read_b64_tr_b16 v[210:211], v26 offset:20992
    v_mfma_f32_16x16x32_bf16 v[176:179], v[212:215], v[52:55], v[176:179]
    ds_read_b64_tr_b16 v[212:213], v26 offset:22528
    ds_read_b64_tr_b16 v[214:215], v26 offset:23040
    s_waitcnt lgkmcnt(12)
    v_mfma_f32_16x16x32_bf16 v[124:127], v[216:219], v[56:59], v[124:127]
    ds_read_b64_tr_b16 v[216:217], v29 offset:20480
    ds_read_b64_tr_b16 v[218:219], v29 offset:20992
    v_mfma_f32_16x16x32_bf16 v[124:127], v[220:223], v[60:63], v[124:127]
    ds_read_b64_tr_b16 v[220:221], v29 offset:22528
    ds_read_b64_tr_b16 v[222:223], v29 offset:23040
    s_waitcnt lgkmcnt(12)
    buffer_load_dwordx4 v7, s[36:39], s81 offen offset:1024 sc1 lds
    v_mfma_f32_16x16x32_bf16 v[180:183], v[224:227], v[48:51], v[180:183]
    ds_read_b64_tr_b16 v[224:225], v27 offset:20480
    ds_read_b64_tr_b16 v[226:227], v27 offset:20992
    v_mfma_f32_16x16x32_bf16 v[180:183], v[228:231], v[52:55], v[180:183]
    ds_read_b64_tr_b16 v[228:229], v27 offset:22528
    ds_read_b64_tr_b16 v[230:231], v27 offset:23040
    s_waitcnt lgkmcnt(12)
    v_mfma_f32_16x16x32_bf16 v[128:131], v[200:203], v[56:59], v[128:131]
    ds_read_b64_tr_b16 v[200:201], v28 offset:24576
    ds_read_b64_tr_b16 v[202:203], v28 offset:25088
    v_mfma_f32_16x16x32_bf16 v[128:131], v[204:207], v[60:63], v[128:131]
    ds_read_b64_tr_b16 v[204:205], v28 offset:26624
    ds_read_b64_tr_b16 v[206:207], v28 offset:27136
    s_waitcnt lgkmcnt(12)
    v_mfma_f32_16x16x32_bf16 v[184:187], v[208:211], v[48:51], v[184:187]
    ds_read_b64_tr_b16 v[208:209], v26 offset:24576
    buffer_load_dwordx4 v7, s[36:39], s81 offen offset:2048 sc1 lds
    ds_read_b64_tr_b16 v[210:211], v26 offset:25088
    v_mfma_f32_16x16x32_bf16 v[184:187], v[212:215], v[52:55], v[184:187]
    ds_read_b64_tr_b16 v[212:213], v26 offset:26624
    ds_read_b64_tr_b16 v[214:215], v26 offset:27136
    s_waitcnt lgkmcnt(12)
    v_mfma_f32_16x16x32_bf16 v[132:135], v[216:219], v[56:59], v[132:135]
    ds_read_b64_tr_b16 v[216:217], v29 offset:24576
    ds_read_b64_tr_b16 v[218:219], v29 offset:25088
    v_mfma_f32_16x16x32_bf16 v[132:135], v[220:223], v[60:63], v[132:135]
    ds_read_b64_tr_b16 v[220:221], v29 offset:26624
    ds_read_b64_tr_b16 v[222:223], v29 offset:27136
    s_waitcnt lgkmcnt(12)
    v_mfma_f32_16x16x32_bf16 v[188:191], v[224:227], v[48:51], v[188:191]
    ds_read_b64_tr_b16 v[224:225], v27 offset:24576
    ds_read_b64_tr_b16 v[226:227], v27 offset:25088
    buffer_load_dwordx4 v7, s[36:39], s81 offen offset:3072 sc1 lds
    v_mfma_f32_16x16x32_bf16 v[188:191], v[228:231], v[52:55], v[188:191]
    ds_read_b64_tr_b16 v[228:229], v27 offset:26624
    ds_read_b64_tr_b16 v[230:231], v27 offset:27136
    s_waitcnt lgkmcnt(12)
    v_mfma_f32_16x16x32_bf16 v[136:139], v[200:203], v[56:59], v[136:139]
    v_mfma_f32_16x16x32_bf16 v[136:139], v[204:207], v[60:63], v[136:139]
    s_waitcnt lgkmcnt(8)
    v_mfma_f32_16x16x32_bf16 v[192:195], v[208:211], v[48:51], v[192:195]
    v_mfma_f32_16x16x32_bf16 v[192:195], v[212:215], v[52:55], v[192:195]
    s_waitcnt lgkmcnt(4)
    v_mfma_f32_16x16x32_bf16 v[140:143], v[216:219], v[56:59], v[140:143]
    v_mfma_f32_16x16x32_bf16 v[140:143], v[220:223], v[60:63], v[140:143]
    s_waitcnt lgkmcnt(0)
    v_mfma_f32_16x16x32_bf16 v[196:199], v[224:227], v[48:51], v[196:199]
    v_mfma_f32_16x16x32_bf16 v[196:199], v[228:231], v[52:55], v[196:199]
    s_barrier
    s_mul_i32 s9, s42, 4096
    s_min_u32 s9, s9, 10240
    s_mul_i32 s8, s46, 14336
    s_add_u32 s8, s8, s9
    s_add_u32 m0, s9, 143360
    s_add_u32 s81, s8, 2899968
    buffer_load_dwordx4 v7, s[36:39], s81 offen offset:0 sc1 lds
    v_pk_add_f32 v[24:25], v[144:145], v[148:149]
    v_pk_mul_f32 v[28:29], v[144:145], v[144:145]
    v_pk_add_f32 v[26:27], v[146:147], v[150:151]
    v_pk_mul_f32 v[30:31], v[146:147], v[146:147]
    v_pk_fma_f32 v[28:29], v[148:149], v[148:149], v[28:29]
    v_pk_fma_f32 v[30:31], v[150:151], v[150:151], v[30:31]
    v_pk_add_f32 v[24:25], v[24:25], v[152:153]
    v_pk_fma_f32 v[28:29], v[152:153], v[152:153], v[28:29]
    v_pk_add_f32 v[26:27], v[26:27], v[154:155]
    v_pk_fma_f32 v[30:31], v[154:155], v[154:155], v[30:31]
    v_pk_add_f32 v[24:25], v[24:25], v[156:157]
    v_pk_fma_f32 v[28:29], v[156:157], v[156:157], v[28:29]
    v_pk_add_f32 v[26:27], v[26:27], v[158:159]
    v_pk_fma_f32 v[30:31], v[158:159], v[158:159], v[30:31]
    v_pk_add_f32 v[24:25], v[24:25], v[160:161]
    v_pk_fma_f32 v[28:29], v[160:161], v[160:161], v[28:29]
    v_pk_add_f32 v[26:27], v[26:27], v[162:163]
    v_pk_fma_f32 v[30:31], v[162:163], v[162:163], v[30:31]
    v_pk_add_f32 v[24:25], v[24:25], v[164:165]
    v_pk_fma_f32 v[28:29], v[164:165], v[164:165], v[28:29]
    v_pk_add_f32 v[26:27], v[26:27], v[166:167]
    v_pk_fma_f32 v[30:31], v[166:167], v[166:167], v[30:31]
    buffer_load_dwordx4 v7, s[36:39], s81 offen offset:1024 sc1 lds
    v_pk_add_f32 v[24:25], v[24:25], v[168:169]
    v_pk_fma_f32 v[28:29], v[168:169], v[168:169], v[28:29]
    v_pk_add_f32 v[26:27], v[26:27], v[170:171]
    v_pk_fma_f32 v[30:31], v[170:171], v[170:171], v[30:31]
    v_pk_add_f32 v[24:25], v[24:25], v[172:173]
    v_pk_fma_f32 v[28:29], v[172:173], v[172:173], v[28:29]
    v_pk_add_f32 v[26:27], v[26:27], v[174:175]
    v_pk_fma_f32 v[30:31], v[174:175], v[174:175], v[30:31]
    v_pk_add_f32 v[24:25], v[24:25], v[176:177]
    v_pk_fma_f32 v[28:29], v[176:177], v[176:177], v[28:29]
    v_pk_add_f32 v[26:27], v[26:27], v[178:179]
    v_pk_fma_f32 v[30:31], v[178:179], v[178:179], v[30:31]
    v_pk_add_f32 v[24:25], v[24:25], v[180:181]
    v_pk_fma_f32 v[28:29], v[180:181], v[180:181], v[28:29]
    v_pk_add_f32 v[26:27], v[26:27], v[182:183]
    v_pk_fma_f32 v[30:31], v[182:183], v[182:183], v[30:31]
    v_pk_add_f32 v[24:25], v[24:25], v[184:185]
    v_pk_fma_f32 v[28:29], v[184:185], v[184:185], v[28:29]
    v_pk_add_f32 v[26:27], v[26:27], v[186:187]
    v_pk_fma_f32 v[30:31], v[186:187], v[186:187], v[30:31]
    v_pk_add_f32 v[24:25], v[24:25], v[188:189]
    v_pk_fma_f32 v[28:29], v[188:189], v[188:189], v[28:29]
    buffer_load_dwordx4 v7, s[36:39], s81 offen offset:2048 sc1 lds
    v_pk_add_f32 v[26:27], v[26:27], v[190:191]
    v_pk_fma_f32 v[30:31], v[190:191], v[190:191], v[30:31]
    v_pk_add_f32 v[24:25], v[24:25], v[192:193]
    v_pk_fma_f32 v[28:29], v[192:193], v[192:193], v[28:29]
    v_pk_add_f32 v[26:27], v[26:27], v[194:195]
    v_pk_fma_f32 v[30:31], v[194:195], v[194:195], v[30:31]
    v_pk_add_f32 v[24:25], v[24:25], v[196:197]
    v_pk_fma_f32 v[28:29], v[196:197], v[196:197], v[28:29]
    v_pk_add_f32 v[26:27], v[26:27], v[198:199]
    v_pk_fma_f32 v[30:31], v[198:199], v[198:199], v[30:31]
    v_pk_add_f32 v[24:25], v[24:25], v[88:89]
    v_pk_fma_f32 v[28:29], v[88:89], v[88:89], v[28:29]
    v_pk_add_f32 v[26:27], v[26:27], v[90:91]
    v_pk_fma_f32 v[30:31], v[90:91], v[90:91], v[30:31]
    v_pk_add_f32 v[24:25], v[24:25], v[92:93]
    v_pk_fma_f32 v[28:29], v[92:93], v[92:93], v[28:29]
    v_pk_add_f32 v[26:27], v[26:27], v[94:95]
    v_pk_fma_f32 v[30:31], v[94:95], v[94:95], v[30:31]
    v_pk_add_f32 v[24:25], v[24:25], v[96:97]
    v_pk_fma_f32 v[28:29], v[96:97], v[96:97], v[28:29]
L_pad_5880:
    s_cbranch_execz L_ret_3
    s_nop 0
    v_pk_add_f32 v[26:27], v[26:27], v[98:99]
    v_pk_fma_f32 v[30:31], v[98:99], v[98:99], v[30:31]
    buffer_load_dwordx4 v7, s[36:39], s81 offen offset:3072 sc1 lds
    v_pk_add_f32 v[24:25], v[24:25], v[100:101]
    v_pk_fma_f32 v[28:29], v[100:101], v[100:101], v[28:29]
    v_pk_add_f32 v[26:27], v[26:27], v[102:103]
    v_pk_fma_f32 v[30:31], v[102:103], v[102:103], v[30:31]
    v_pk_add_f32 v[24:25], v[24:25], v[104:105]
    v_pk_fma_f32 v[28:29], v[104:105], v[104:105], v[28:29]
    v_pk_add_f32 v[26:27], v[26:27], v[106:107]
    v_pk_fma_f32 v[30:31], v[106:107], v[106:107], v[30:31]
    v_pk_add_f32 v[24:25], v[24:25], v[108:109]
    v_pk_fma_f32 v[28:29], v[108:109], v[108:109], v[28:29]
    v_pk_add_f32 v[26:27], v[26:27], v[110:111]
    v_pk_fma_f32 v[30:31], v[110:111], v[110:111], v[30:31]
    v_pk_add_f32 v[24:25], v[24:25], v[112:113]
    v_pk_fma_f32 v[28:29], v[112:113], v[112:113], v[28:29]
    v_pk_add_f32 v[26:27], v[26:27], v[114:115]
    v_pk_fma_f32 v[30:31], v[114:115], v[114:115], v[30:31]
    v_pk_add_f32 v[24:25], v[24:25], v[116:117]
    v_pk_fma_f32 v[28:29], v[116:117], v[116:117], v[28:29]
    v_pk_add_f32 v[26:27], v[26:27], v[118:119]
    v_pk_fma_f32 v[30:31], v[118:119], v[118:119], v[30:31]
    v_pk_add_f32 v[24:25], v[24:25], v[120:121]
    v_pk_fma_f32 v[28:29], v[120:121], v[120:121], v[28:29]
    s_mul_i32 s11, s42, 14336
    s_mul_i32 s10, s45, 14336
    s_add_u32 s10, s10, s11
    s_nop 0
    s_add_u32 m0, s11, 43008
    s_add_u32 s81, s10, 2097152
    buffer_load_dwordx4 v7, s[36:39], s81 offen offset:0 sc1 lds
    v_pk_add_f32 v[26:27], v[26:27], v[122:123]
    v_pk_fma_f32 v[30:31], v[122:123], v[122:123], v[30:31]
    v_pk_add_f32 v[24:25], v[24:25], v[124:125]
    v_pk_fma_f32 v[28:29], v[124:125], v[124:125], v[28:29]
    v_pk_add_f32 v[26:27], v[26:27], v[126:127]
    v_pk_fma_f32 v[30:31], v[126:127], v[126:127], v[30:31]
    v_pk_add_f32 v[24:25], v[24:25], v[128:129]
    v_pk_fma_f32 v[28:29], v[128:129], v[128:129], v[28:29]
    v_pk_add_f32 v[26:27], v[26:27], v[130:131]
    v_pk_fma_f32 v[30:31], v[130:131], v[130:131], v[30:31]
    v_pk_add_f32 v[24:25], v[24:25], v[132:133]
    v_pk_fma_f32 v[28:29], v[132:133], v[132:133], v[28:29]
    v_pk_add_f32 v[26:27], v[26:27], v[134:135]
    v_pk_fma_f32 v[30:31], v[134:135], v[134:135], v[30:31]
    v_pk_add_f32 v[24:25], v[24:25], v[136:137]
    v_pk_fma_f32 v[28:29], v[136:137], v[136:137], v[28:29]
    v_pk_add_f32 v[26:27], v[26:27], v[138:139]
    v_pk_fma_f32 v[30:31], v[138:139], v[138:139], v[30:31]
    v_pk_add_f32 v[24:25], v[24:25], v[140:141]
    v_pk_fma_f32 v[28:29], v[140:141], v[140:141], v[28:29]
    v_pk_add_f32 v[26:27], v[26:27], v[142:143]
    v_pk_fma_f32 v[30:31], v[142:143], v[142:143], v[30:31]
    v_pk_add_f32 v[24:25], v[24:25], v[26:27]
    v_pk_add_f32 v[28:29], v[28:29], v[30:31]
    v_add_f32 v24, v24, v25
    v_add_f32 v28, v28, v29
    v_mov_b32 v2, v24
    v_mov_b32 v3, v28
    s_nop 0
    v_permlane32_swap_b32 v24, v2
    v_permlane32_swap_b32 v28, v3
    v_add_f32 v24, v24, v2
    v_add_f32 v28, v28, v3
    v_mov_b32 v2, v24
    v_mov_b32 v3, v28
    s_nop 0
    v_permlane16_swap_b32 v24, v2
    v_permlane16_swap_b32 v28, v3
    v_add_f32 v24, v24, v2
    v_add_f32 v28, v28, v3
    v_mul_f32 v24, 0x3b124925, v24
    v_mul_f32 v28, 0x3b124925, v28
    v_fma_f32 v28, -v24, v24, v28
    v_max_f32 v28, 0, v28
    v_add_f32 v28, s53, v28
    v_rsq_f32 v26, v28
    s_nop 0
    v_mul_f32_e64 v27, -v24, v26
    v_mov_b32 v3, v24
    v_mul_f32 v2, v28, v26
    s_add_u32 m0, s11, 44032
    s_add_u32 s81, s10, 2098176
    buffer_load_dwordx4 v7, s[36:39], s81 offen offset:0 sc1 lds
    v_pk_fma_f32 v[144:145], v[144:145], v[26:27], v[26:27] op_sel:[0,0,1] op_sel_hi:[1,0,1]
    v_pk_fma_f32 v[146:147], v[146:147], v[26:27], v[26:27] op_sel:[0,0,1] op_sel_hi:[1,0,1]
    v_pk_fma_f32 v[148:149], v[148:149], v[26:27], v[26:27] op_sel:[0,0,1] op_sel_hi:[1,0,1]
    v_pk_fma_f32 v[150:151], v[150:151], v[26:27], v[26:27] op_sel:[0,0,1] op_sel_hi:[1,0,1]
    v_pk_fma_f32 v[152:153], v[152:153], v[26:27], v[26:27] op_sel:[0,0,1] op_sel_hi:[1,0,1]
    v_pk_fma_f32 v[154:155], v[154:155], v[26:27], v[26:27] op_sel:[0,0,1] op_sel_hi:[1,0,1]
    v_pk_fma_f32 v[156:157], v[156:157], v[26:27], v[26:27] op_sel:[0,0,1] op_sel_hi:[1,0,1]
    v_pk_fma_f32 v[158:159], v[158:159], v[26:27], v[26:27] op_sel:[0,0,1] op_sel_hi:[1,0,1]
    v_pk_fma_f32 v[160:161], v[160:161], v[26:27], v[26:27] op_sel:[0,0,1] op_sel_hi:[1,0,1]
    v_pk_fma_f32 v[162:163], v[162:163], v[26:27], v[26:27] op_sel:[0,0,1] op_sel_hi:[1,0,1]
    v_pk_fma_f32 v[164:165], v[164:165], v[26:27], v[26:27] op_sel:[0,0,1] op_sel_hi:[1,0,1]
    v_pk_fma_f32 v[166:167], v[166:167], v[26:27], v[26:27] op_sel:[0,0,1] op_sel_hi:[1,0,1]
    v_pk_fma_f32 v[168:169], v[168:169], v[26:27], v[26:27] op_sel:[0,0,1] op_sel_hi:[1,0,1]
    v_pk_fma_f32 v[170:171], v[170:171], v[26:27], v[26:27] op_sel:[0,0,1] op_sel_hi:[1,0,1]
    v_pk_fma_f32 v[172:173], v[172:173], v[26:27], v[26:27] op_sel:[0,0,1] op_sel_hi:[1,0,1]
    v_pk_fma_f32 v[174:175], v[174:175], v[26:27], v[26:27] op_sel:[0,0,1] op_sel_hi:[1,0,1]
    v_pk_fma_f32 v[176:177], v[176:177], v[26:27], v[26:27] op_sel:[0,0,1] op_sel_hi:[1,0,1]
    v_pk_fma_f32 v[178:179], v[178:179], v[26:27], v[26:27] op_sel:[0,0,1] op_sel_hi:[1,0,1]
    v_pk_fma_f32 v[180:181], v[180:181], v[26:27], v[26:27] op_sel:[0,0,1] op_sel_hi:[1,0,1]
    v_pk_fma_f32 v[182:183], v[182:183], v[26:27], v[26:27] op_sel:[0,0,1] op_sel_hi:[1,0,1]
    v_pk_fma_f32 v[184:185], v[184:185], v[26:27], v[26:27] op_sel:[0,0,1] op_sel_hi:[1,0,1]
    v_pk_fma_f32 v[186:187], v[186:187], v[26:27], v[26:27] op_sel:[0,0,1] op_sel_hi:[1,0,1]
    v_pk_fma_f32 v[188:189], v[188:189], v[26:27], v[26:27] op_sel:[0,0,1] op_sel_hi:[1,0,1]
    buffer_load_dwordx4 v7, s[36:39], s81 offen offset:1024 sc1 lds
    v_pk_fma_f32 v[190:191], v[190:191], v[26:27], v[26:27] op_sel:[0,0,1] op_sel_hi:[1,0,1]
    v_pk_fma_f32 v[192:193], v[192:193], v[26:27], v[26:27] op_sel:[0,0,1] op_sel_hi:[1,0,1]
    v_pk_fma_f32 v[194:195], v[194:195], v[26:27], v[26:27] op_sel:[0,0,1] op_sel_hi:[1,0,1]
    v_pk_fma_f32 v[196:197], v[196:197], v[26:27], v[26:27] op_sel:[0,0,1] op_sel_hi:[1,0,1]
    v_pk_fma_f32 v[198:199], v[198:199], v[26:27], v[26:27] op_sel:[0,0,1] op_sel_hi:[1,0,1]
    v_cvt_pk_bf16_f32 v200, v144, v145
    v_cvt_pk_bf16_f32 v201, v146, v147
    v_cvt_pk_bf16_f32 v202, v148, v149
    v_cvt_pk_bf16_f32 v203, v150, v151
    v_cvt_pk_bf16_f32 v204, v152, v153
    v_cvt_pk_bf16_f32 v205, v154, v155
    v_cvt_pk_bf16_f32 v206, v156, v157
    v_cvt_pk_bf16_f32 v207, v158, v159
    v_cvt_pk_bf16_f32 v208, v160, v161
    v_cvt_pk_bf16_f32 v209, v162, v163
    v_cvt_pk_bf16_f32 v210, v164, v165
    v_cvt_pk_bf16_f32 v211, v166, v167
    v_cvt_pk_bf16_f32 v212, v168, v169
    v_cvt_pk_bf16_f32 v213, v170, v171
    v_cvt_pk_bf16_f32 v214, v172, v173
    v_cvt_pk_bf16_f32 v215, v174, v175
    v_cvt_pk_bf16_f32 v216, v176, v177
    v_cvt_pk_bf16_f32 v217, v178, v179
    buffer_load_dwordx4 v7, s[36:39], s81 offen offset:2048 sc1 lds
    v_cvt_pk_bf16_f32 v218, v180, v181
    v_cvt_pk_bf16_f32 v219, v182, v183
    v_cvt_pk_bf16_f32 v220, v184, v185
    v_cvt_pk_bf16_f32 v221, v186, v187
    v_cvt_pk_bf16_f32 v222, v188, v189
    v_cvt_pk_bf16_f32 v223, v190, v191
    v_cvt_pk_bf16_f32 v224, v192, v193
    v_cvt_pk_bf16_f32 v225, v194, v195
    v_cvt_pk_bf16_f32 v226, v196, v197
    v_cvt_pk_bf16_f32 v227, v198, v199
    v_pk_fma_f32 v[88:89], v[88:89], v[26:27], v[26:27] op_sel:[0,0,1] op_sel_hi:[1,0,1]
    v_pk_fma_f32 v[90:91], v[90:91], v[26:27], v[26:27] op_sel:[0,0,1] op_sel_hi:[1,0,1]
    v_pk_fma_f32 v[92:93], v[92:93], v[26:27], v[26:27] op_sel:[0,0,1] op_sel_hi:[1,0,1]
    v_pk_fma_f32 v[94:95], v[94:95], v[26:27], v[26:27] op_sel:[0,0,1] op_sel_hi:[1,0,1]
    v_pk_fma_f32 v[96:97], v[96:97], v[26:27], v[26:27] op_sel:[0,0,1] op_sel_hi:[1,0,1]
    v_pk_fma_f32 v[98:99], v[98:99], v[26:27], v[26:27] op_sel:[0,0,1] op_sel_hi:[1,0,1]
    v_pk_fma_f32 v[100:101], v[100:101], v[26:27], v[26:27] op_sel:[0,0,1] op_sel_hi:[1,0,1]
    v_pk_fma_f32 v[102:103], v[102:103], v[26:27], v[26:27] op_sel:[0,0,1] op_sel_hi:[1,0,1]
    v_pk_fma_f32 v[104:105], v[104:105], v[26:27], v[26:27] op_sel:[0,0,1] op_sel_hi:[1,0,1]
    v_pk_fma_f32 v[106:107], v[106:107], v[26:27], v[26:27] op_sel:[0,0,1] op_sel_hi:[1,0,1]
    v_pk_fma_f32 v[108:109], v[108:109], v[26:27], v[26:27] op_sel:[0,0,1] op_sel_hi:[1,0,1]
    buffer_load_dwordx4 v7, s[36:39], s81 offen offset:3072 sc1 lds
    v_pk_fma_f32 v[110:111], v[110:111], v[26:27], v[26:27] op_sel:[0,0,1] op_sel_hi:[1,0,1]
    v_pk_fma_f32 v[112:113], v[112:113], v[26:27], v[26:27] op_sel:[0,0,1] op_sel_hi:[1,0,1]
    v_pk_fma_f32 v[114:115], v[114:115], v[26:27], v[26:27] op_sel:[0,0,1] op_sel_hi:[1,0,1]
    v_pk_fma_f32 v[116:117], v[116:117], v[26:27], v[26:27] op_sel:[0,0,1] op_sel_hi:[1,0,1]
    v_pk_fma_f32 v[118:119], v[118:119], v[26:27], v[26:27] op_sel:[0,0,1] op_sel_hi:[1,0,1]
    v_pk_fma_f32 v[120:121], v[120:121], v[26:27], v[26:27] op_sel:[0,0,1] op_sel_hi:[1,0,1]
    v_pk_fma_f32 v[122:123], v[122:123], v[26:27], v[26:27] op_sel:[0,0,1] op_sel_hi:[1,0,1]
    v_pk_fma_f32 v[124:125], v[124:125], v[26:27], v[26:27] op_sel:[0,0,1] op_sel_hi:[1,0,1]
    v_pk_fma_f32 v[126:127], v[126:127], v[26:27], v[26:27] op_sel:[0,0,1] op_sel_hi:[1,0,1]
    v_pk_fma_f32 v[128:129], v[128:129], v[26:27], v[26:27] op_sel:[0,0,1] op_sel_hi:[1,0,1]
    v_pk_fma_f32 v[130:131], v[130:131], v[26:27], v[26:27] op_sel:[0,0,1] op_sel_hi:[1,0,1]
    v_pk_fma_f32 v[132:133], v[132:133], v[26:27], v[26:27] op_sel:[0,0,1] op_sel_hi:[1,0,1]
    v_pk_fma_f32 v[134:135], v[134:135], v[26:27], v[26:27] op_sel:[0,0,1] op_sel_hi:[1,0,1]
    v_pk_fma_f32 v[136:137], v[136:137], v[26:27], v[26:27] op_sel:[0,0,1] op_sel_hi:[1,0,1]
    v_pk_fma_f32 v[138:139], v[138:139], v[26:27], v[26:27] op_sel:[0,0,1] op_sel_hi:[1,0,1]
    v_pk_fma_f32 v[140:141], v[140:141], v[26:27], v[26:27] op_sel:[0,0,1] op_sel_hi:[1,0,1]
    v_pk_fma_f32 v[142:143], v[142:143], v[26:27], v[26:27] op_sel:[0,0,1] op_sel_hi:[1,0,1]
    v_cvt_pk_bf16_f32 v228, v88, v143
    v_cvt_pk_bf16_f32 v229, v142, v141
    v_cvt_pk_bf16_f32 v230, v140, v139
    v_cvt_pk_bf16_f32 v231, v138, v137
    v_cvt_pk_bf16_f32 v232, v136, v135
    v_cvt_pk_bf16_f32 v233, v134, v133
    s_add_u32 m0, s11, 48128
    s_add_u32 s81, s10, 2102272
    buffer_load_dwordx4 v7, s[36:39], s81 offen offset:0 sc1 lds
    v_cvt_pk_bf16_f32 v234, v132, v131
    v_cvt_pk_bf16_f32 v235, v130, v129
    v_cvt_pk_bf16_f32 v236, v128, v127
    v_cvt_pk_bf16_f32 v237, v126, v125
    v_cvt_pk_bf16_f32 v238, v124, v123
    v_cvt_pk_bf16_f32 v239, v122, v121
    v_cvt_pk_bf16_f32 v240, v120, v119
    v_cvt_pk_bf16_f32 v241, v118, v117
    v_cvt_pk_bf16_f32 v242, v116, v115
    v_cvt_pk_bf16_f32 v243, v114, v113
    v_cvt_pk_bf16_f32 v244, v112, v111
    v_cvt_pk_bf16_f32 v245, v110, v109
    v_cvt_pk_bf16_f32 v246, v108, v107
    v_cvt_pk_bf16_f32 v247, v106, v105
    v_cvt_pk_bf16_f32 v248, v104, v103
    v_cvt_pk_bf16_f32 v249, v102, v101
    v_cvt_pk_bf16_f32 v250, v100, v99
    v_cvt_pk_bf16_f32 v251, v98, v97
    v_cvt_pk_bf16_f32 v252, v96, v95
    v_cvt_pk_bf16_f32 v253, v94, v93
    v_cvt_pk_bf16_f32 v254, v92, v91
    v_cvt_pk_bf16_f32 v255, v90, v89
    ds_read_b128 v[32:35], v7 offset:0
    ds_read_b128 v[36:39], v7 offset:1024
    ds_read_b128 v[40:43], v7 offset:2048
    ds_read_b128 v[44:47], v7 offset:3072
    ds_read_b128 v[64:67], v7 offset:4096
    ds_read_b128 v[68:71], v7 offset:5120
    ds_read_b128 v[72:75], v7 offset:6144
    ds_read_b128 v[76:79], v7 offset:7168
    ds_read_b128 v[80:83], v7 offset:8192
    s_add_u32 m0, s11, 49152
    s_add_u32 s81, s10, 2103296
    buffer_load_dwordx4 v7, s[36:39], s81 offen offset:0 sc1 lds
    ds_read_b128 v[84:87], v7 offset:9216
    s_waitcnt lgkmcnt(9)
    v_mfma_f32_16x16x32_bf16 v[172:175], v[200:203], v[32:35], 0
    ds_read_b128 v[32:35], v7 offset:10240
    s_waitcnt lgkmcnt(9)
    v_mfma_f32_16x16x32_bf16 v[172:175], v[204:207], v[36:39], v[172:175]
    ds_read_b128 v[36:39], v7 offset:11264
    s_waitcnt lgkmcnt(8)
    v_mfma_f32_16x16x32_bf16 v[172:175], v[208:211], v[40:43], v[172:175]
    ds_read_b128 v[40:43], v7 offset:12288
    v_mfma_f32_16x16x32_bf16 v[172:175], v[212:215], v[44:47], v[172:175]
    ds_read_b128 v[44:47], v7 offset:13312
    s_waitcnt lgkmcnt(8)
    buffer_load_dwordx4 v7, s[36:39], s81 offen offset:1024 sc1 lds
    v_mfma_f32_16x16x32_bf16 v[172:175], v[216:219], v[64:67], v[172:175]
    ds_read_b128 v[64:67], v7 offset:14336
    v_mfma_f32_16x16x32_bf16 v[172:175], v[220:223], v[68:71], v[172:175]
    ds_read_b128 v[68:71], v7 offset:15360
    s_waitcnt lgkmcnt(8)
    v_mfma_f32_16x16x32_bf16 v[172:175], v[224:227], v[72:75], v[172:175]
    ds_read_b128 v[72:75], v7 offset:16384
    v_mfma_f32_16x16x32_bf16 v[172:175], v[228:231], v[76:79], v[172:175]
    ds_read_b128 v[76:79], v7 offset:17408
    s_waitcnt lgkmcnt(8)
    buffer_load_dwordx4 v7, s[36:39], s81 offen offset:2048 sc1 lds
    v_mfma_f32_16x16x32_bf16 v[172:175], v[232:235], v[80:83], v[172:175]
    ds_read_b128 v[80:83], v7 offset:18432
    v_mfma_f32_16x16x32_bf16 v[172:175], v[236:239], v[84:87], v[172:175]
    ds_read_b128 v[84:87], v7 offset:19456
    s_waitcnt lgkmcnt(8)
    v_mfma_f32_16x16x32_bf16 v[172:175], v[240:243], v[32:35], v[172:175]
    ds_read_b128 v[32:35], v7 offset:20480
    v_mfma_f32_16x16x32_bf16 v[172:175], v[244:247], v[36:39], v[172:175]
    ds_read_b128 v[36:39], v7 offset:21504
    s_waitcnt lgkmcnt(8)
    buffer_load_dwordx4 v7, s[36:39], s81 offen offset:3072 sc1 lds
    v_mfma_f32_16x16x32_bf16 v[172:175], v[248:251], v[40:43], v[172:175]
    ds_read_b128 v[40:43], v7 offset:22528
    v_mfma_f32_16x16x32_bf16 v[172:175], v[252:255], v[44:47], v[172:175]
    ds_read_b128 v[44:47], v7 offset:23552
    s_waitcnt lgkmcnt(8)
    v_mfma_f32_16x16x32_bf16 v[176:179], v[200:203], v[64:67], 0
    ds_read_b128 v[64:67], v7 offset:24576
    v_mfma_f32_16x16x32_bf16 v[176:179], v[204:207], v[68:71], v[176:179]
    ds_read_b128 v[68:71], v7 offset:25600
    s_waitcnt lgkmcnt(8)
    s_add_u32 m0, s11, 53248
    s_add_u32 s81, s10, 2107392
    buffer_load_dwordx4 v7, s[36:39], s81 offen offset:0 sc1 lds
    v_mfma_f32_16x16x32_bf16 v[176:179], v[208:211], v[72:75], v[176:179]
    ds_read_b128 v[72:75], v7 offset:26624
    v_mfma_f32_16x16x32_bf16 v[176:179], v[212:215], v[76:79], v[176:179]
    ds_read_b128 v[76:79], v7 offset:27648
    s_waitcnt lgkmcnt(8)
    v_mfma_f32_16x16x32_bf16 v[176:179], v[216:219], v[80:83], v[176:179]
    ds_read_b128 v[80:83], v7 offset:28672
    v_mfma_f32_16x16x32_bf16 v[176:179], v[220:223], v[84:87], v[176:179]
    ds_read_b128 v[84:87], v7 offset:29696
    s_waitcnt lgkmcnt(8)
    v_mfma_f32_16x16x32_bf16 v[176:179], v[224:227], v[32:35], v[176:179]
    buffer_load_dwordx4 v7, s[36:39], s81 offen offset:1024 sc1 lds
    ds_read_b128 v[32:35], v7 offset:30720
    v_mfma_f32_16x16x32_bf16 v[176:179], v[228:231], v[36:39], v[176:179]
    ds_read_b128 v[36:39], v7 offset:31744
    s_waitcnt lgkmcnt(8)
    v_mfma_f32_16x16x32_bf16 v[176:179], v[232:235], v[40:43], v[176:179]
    ds_read_b128 v[40:43], v7 offset:32768
    v_mfma_f32_16x16x32_bf16 v[176:179], v[236:239], v[44:47], v[176:179]
    ds_read_b128 v[44:47], v7 offset:33792
    s_waitcnt lgkmcnt(8)
    v_mfma_f32_16x16x32_bf16 v[176:179], v[240:243], v[64:67], v[176:179]
    buffer_load_dwordx4 v7, s[36:39], s81 offen offset:2048 sc1 lds
    ds_read_b128 v[64:67], v7 offset:34816
    v_mfma_f32_16x16x32_bf16 v[176:179], v[244:247], v[68:71], v[176:179]
    ds_read_b128 v[68:71], v7 offset:35840
    s_waitcnt lgkmcnt(8)
    v_mfma_f32_16x16x32_bf16 v[176:179], v[248:251], v[72:75], v[176:179]
    ds_read_b128 v[72:75], v7 offset:36864
    v_mfma_f32_16x16x32_bf16 v[176:179], v[252:255], v[76:79], v[176:179]
    ds_read_b128 v[76:79], v7 offset:37888
    s_waitcnt lgkmcnt(8)
    v_mfma_f32_16x16x32_bf16 v[180:183], v[200:203], v[80:83], 0
    buffer_load_dwordx4 v7, s[36:39], s81 offen offset:3072 sc1 lds
    ds_read_b128 v[80:83], v7 offset:38912
    v_mfma_f32_16x16x32_bf16 v[180:183], v[204:207], v[84:87], v[180:183]
    ds_read_b128 v[84:87], v7 offset:39936
    s_waitcnt lgkmcnt(8)
    v_mfma_f32_16x16x32_bf16 v[180:183], v[208:211], v[32:35], v[180:183]
    ds_read_b128 v[32:35], v7 offset:40960
    v_mfma_f32_16x16x32_bf16 v[180:183], v[212:215], v[36:39], v[180:183]
    ds_read_b128 v[36:39], v7 offset:41984
    s_waitcnt lgkmcnt(8)
    v_mfma_f32_16x16x32_bf16 v[180:183], v[216:219], v[40:43], v[180:183]
    s_waitcnt vmcnt(14)
    s_waitcnt lgkmcnt(0)
    s_barrier
    s_lshl_b32 s70, s41, 5
    s_add_u32 s70, s70, s40
    s_lshl_b32 s70, s70, 7
    s_add_u32 s70, s70, 753664
    s_cmp_lg_u32 s42, 0
    s_cbranch_scc1 nf_110
    s_bfm_b64 exec, 32, 0
    buffer_store_dword v10, v21, s[36:39], s70 offen sc1
    s_mov_b64 exec, -1
nf_110:
    s_mul_i32 s9, s42, 7168
    s_mul_i32 s8, s45, 14336
    s_add_u32 s8, s8, s9
    s_add_u32 m0, s9, 0
    s_add_u32 s81, s8, 2154496
    buffer_load_dwordx4 v7, s[36:39], s81 offen offset:0 sc1 lds
    ds_read_b128 v[40:43], v8 offset:34816
    v_mfma_f32_16x16x32_bf16 v[180:183], v[220:223], v[44:47], v[180:183]
    ds_read_b128 v[44:47], v8 offset:35840
    v_mfma_f32_16x16x32_bf16 v[180:183], v[224:227], v[64:67], v[180:183]
    ds_read_b128 v[64:67], v8 offset:36864
    v_mfma_f32_16x16x32_bf16 v[180:183], v[228:231], v[68:71], v[180:183]
    ds_read_b128 v[68:71], v8 offset:37888
    v_mfma_f32_16x16x32_bf16 v[180:183], v[232:235], v[72:75], v[180:183]
    ds_read_b128 v[72:75], v8 offset:38912
    v_mfma_f32_16x16x32_bf16 v[180:183], v[236:239], v[76:79], v[180:183]
    ds_read_b128 v[76:79], v8 offset:39936
    buffer_load_dwordx4 v7, s[36:39], s81 offen offset:1024 sc1 lds
    v_mfma_f32_16x16x32_bf16 v[180:183], v[240:243], v[80:83], v[180:183]
    ds_read_b128 v[80:83], v8 offset:40960
    v_mfma_f32_16x16x32_bf16 v[180:183], v[244:247], v[84:87], v[180:183]
    ds_read_b128 v[84:87], v8 offset:41984
    v_mfma_f32_16x16x32_bf16 v[180:183], v[248:251], v[32:35], v[180:183]
    ds_read_b128 v[32:35], v8 offset:43008
    v_mfma_f32_16x16x32_bf16 v[180:183], v[252:255], v[36:39], v[180:183]
    ds_read_b128 v[36:39], v8 offset:44032
    s_waitcnt lgkmcnt(8)
    v_mfma_f32_16x16x32_bf16 v[184:187], v[200:203], v[40:43], 0
    ds_read_b128 v[40:43], v8 offset:45056
    v_mfma_f32_16x16x32_bf16 v[184:187], v[204:207], v[44:47], v[184:187]
    ds_read_b128 v[44:47], v8 offset:46080
    buffer_load_dwordx4 v7, s[36:39], s81 offen offset:2048 sc1 lds
    s_waitcnt lgkmcnt(8)
    v_mfma_f32_16x16x32_bf16 v[184:187], v[208:211], v[64:67], v[184:187]
    ds_read_b128 v[64:67], v8 offset:47104
    v_mfma_f32_16x16x32_bf16 v[184:187], v[212:215], v[68:71], v[184:187]
    ds_read_b128 v[68:71], v8 offset:48128
    s_waitcnt lgkmcnt(8)
    v_mfma_f32_16x16x32_bf16 v[184:187], v[216:219], v[72:75], v[184:187]
    ds_read_b128 v[72:75], v8 offset:49152
    v_mfma_f32_16x16x32_bf16 v[184:187], v[220:223], v[76:79], v[184:187]
    ds_read_b128 v[76:79], v8 offset:50176
    s_waitcnt lgkmcnt(8)
    v_mfma_f32_16x16x32_bf16 v[184:187], v[224:227], v[80:83], v[184:187]
    ds_read_b128 v[80:83], v8 offset:51200
    v_mfma_f32_16x16x32_bf16 v[184:187], v[228:231], v[84:87], v[184:187]
    buffer_load_dwordx4 v7, s[36:39], s81 offen offset:3072 sc1 lds
    ds_read_b128 v[84:87], v8 offset:52224
    s_waitcnt lgkmcnt(8)
    v_mfma_f32_16x16x32_bf16 v[184:187], v[232:235], v[32:35], v[184:187]
    ds_read_b128 v[32:35], v8 offset:53248
    v_mfma_f32_16x16x32_bf16 v[184:187], v[236:239], v[36:39], v[184:187]
    ds_read_b128 v[36:39], v8 offset:54272
    s_waitcnt lgkmcnt(8)
    v_mfma_f32_16x16x32_bf16 v[184:187], v[240:243], v[40:43], v[184:187]
    ds_read_b128 v[40:43], v8 offset:55296
    v_mfma_f32_16x16x32_bf16 v[184:187], v[244:247], v[44:47], v[184:187]
    ds_read_b128 v[44:47], v8 offset:56320
    s_waitcnt lgkmcnt(8)
    v_mfma_f32_16x16x32_bf16 v[184:187], v[248:251], v[64:67], v[184:187]
    ds_read_b128 v[64:67], v8 offset:57344
    s_add_u32 m0, s9, 4096
    s_add_u32 s81, s8, 2158592
    buffer_load_dwordx4 v7, s[36:39], s81 offen offset:0 sc1 lds
    v_mfma_f32_16x16x32_bf16 v[184:187], v[252:255], v[68:71], v[184:187]
    ds_read_b128 v[68:71], v8 offset:58368
    s_waitcnt lgkmcnt(8)
    v_mfma_f32_16x16x32_bf16 v[188:191], v[200:203], v[72:75], 0
    ds_read_b128 v[72:75], v8 offset:59392
    v_mfma_f32_16x16x32_bf16 v[188:191], v[204:207], v[76:79], v[188:191]
    ds_read_b128 v[76:79], v8 offset:60416
    s_waitcnt lgkmcnt(8)
    v_mfma_f32_16x16x32_bf16 v[188:191], v[208:211], v[80:83], v[188:191]
    ds_read_b128 v[80:83], v8 offset:61440
    v_mfma_f32_16x16x32_bf16 v[188:191], v[212:215], v[84:87], v[188:191]
    ds_read_b128 v[84:87], v8 offset:62464
    s_waitcnt lgkmcnt(8)
    v_mfma_f32_16x16x32_bf16 v[188:191], v[216:219], v[32:35], v[188:191]
    buffer_load_dwordx4 v7, s[36:39], s81 offen offset:1024 sc1 lds
    ds_read_b128 v[32:35], v8 offset:63488
    v_mfma_f32_16x16x32_bf16 v[188:191], v[220:223], v[36:39], v[188:191]
    ds_read_b128 v[36:39], v8 offset:64512
    s_waitcnt lgkmcnt(8)
    v_mfma_f32_16x16x32_bf16 v[188:191], v[224:227], v[40:43], v[188:191]
    ds_read_b128 v[40:43], v9 offset:0
    v_mfma_f32_16x16x32_bf16 v[188:191], v[228:231], v[44:47], v[188:191]
    ds_read_b128 v[44:47], v9 offset:1024
    s_waitcnt lgkmcnt(8)
    v_mfma_f32_16x16x32_bf16 v[188:191], v[232:235], v[64:67], v[188:191]
    ds_read_b128 v[64:67], v9 offset:2048
    v_mfma_f32_16x16x32_bf16 v[188:191], v[236:239], v[68:71], v[188:191]
    ds_read_b128 v[68:71], v9 offset:3072
    s_waitcnt lgkmcnt(8)
    buffer_load_dwordx4 v7, s[36:39], s81 offen offset:2048 sc1 lds
    v_mfma_f32_16x16x32_bf16 v[188:191], v[240:243], v[72:75], v[188:191]
    ds_read_b128 v[72:75], v9 offset:4096
    v_mfma_f32_16x16x32_bf16 v[188:191], v[244:247], v[76:79], v[188:191]
    ds_read_b128 v[76:79], v9 offset:5120
    s_waitcnt lgkmcnt(8)
    v_mfma_f32_16x16x32_bf16 v[188:191], v[248:251], v[80:83], v[188:191]
    ds_read_b128 v[80:83], v9 offset:6144
    v_mfma_f32_16x16x32_bf16 v[188:191], v[252:255], v[84:87], v[188:191]
    ds_read_b128 v[84:87], v9 offset:7168
    s_waitcnt lgkmcnt(8)
    v_mfma_f32_16x16x32_bf16 v[192:195], v[200:203], v[32:35], 0
    ds_read_b128 v[32:35], v9 offset:8192
    v_mfma_f32_16x16x32_bf16 v[192:195], v[204:207], v[36:39], v[192:195]
    ds_read_b128 v[36:39], v9 offset:9216
    s_mul_i32 s11, s42, 4096
    s_min_u32 s11, s11, 10240
    s_mul_i32 s10, s46, 14336
    s_add_u32 s10, s10, s11
    s_add_u32 m0, s11, 28672
    s_add_u32 s81, s10, 2097152
    buffer_load_dwordx4 v7, s[36:39], s81 offen offset:0 sc1 lds
    s_waitcnt lgkmcnt(8)
    v_mfma_f32_16x16x32_bf16 v[192:195], v[208:211], v[40:43], v[192:195]
    ds_read_b128 v[40:43], v9 offset:10240
    v_mfma_f32_16x16x32_bf16 v[192:195], v[212:215], v[44:47], v[192:195]
    ds_read_b128 v[44:47], v9 offset:11264
    s_waitcnt lgkmcnt(8)
    v_mfma_f32_16x16x32_bf16 v[192:195], v[216:219], v[64:67], v[192:195]
    ds_read_b128 v[64:67], v9 offset:12288
    v_mfma_f32_16x16x32_bf16 v[192:195], v[220:223], v[68:71], v[192:195]
    ds_read_b128 v[68:71], v9 offset:13312
    s_waitcnt lgkmcnt(8)
    v_mfma_f32_16x16x32_bf16 v[192:195], v[224:227], v[72:75], v[192:195]
    ds_read_b128 v[72:75], v9 offset:14336
    v_mfma_f32_16x16x32_bf16 v[192:195], v[228:231], v[76:79], v[192:195]
    buffer_load_dwordx4 v7, s[36:39], s81 offen offset:1024 sc1 lds
    ds_read_b128 v[76:79], v9 offset:15360
    s_waitcnt lgkmcnt(8)
    v_mfma_f32_16x16x32_bf16 v[192:195], v[232:235], v[80:83], v[192:195]
    ds_read_b128 v[80:83], v9 offset:16384
    v_mfma_f32_16x16x32_bf16 v[192:195], v[236:239], v[84:87], v[192:195]
    ds_read_b128 v[84:87], v9 offset:17408
    s_waitcnt lgkmcnt(8)
    v_mfma_f32_16x16x32_bf16 v[192:195], v[240:243], v[32:35], v[192:195]
    ds_read_b128 v[32:35], v9 offset:18432
    v_mfma_f32_16x16x32_bf16 v[192:195], v[244:247], v[36:39], v[192:195]
    ds_read_b128 v[36:39], v9 offset:19456
    s_waitcnt lgkmcnt(8)
    v_mfma_f32_16x16x32_bf16 v[192:195], v[248:251], v[40:43], v[192:195]
    ds_read_b128 v[40:43], v9 offset:20480
    buffer_load_dwordx4 v7, s[36:39], s81 offen offset:2048 sc1 lds
    v_mfma_f32_16x16x32_bf16 v[192:195], v[252:255], v[44:47], v[192:195]
    ds_read_b128 v[44:47], v9 offset:21504
    s_waitcnt lgkmcnt(8)
    v_mfma_f32_16x16x32_bf16 v[196:199], v[200:203], v[64:67], 0
    ds_read_b128 v[64:67], v9 offset:22528
    v_mfma_f32_16x16x32_bf16 v[196:199], v[204:207], v[68:71], v[196:199]
    ds_read_b128 v[68:71], v9 offset:23552
    s_waitcnt lgkmcnt(8)
    v_mfma_f32_16x16x32_bf16 v[196:199], v[208:211], v[72:75], v[196:199]
    ds_read_b128 v[72:75], v9 offset:24576
    v_mfma_f32_16x16x32_bf16 v[196:199], v[212:215], v[76:79], v[196:199]
    ds_read_b128 v[76:79], v9 offset:25600
    s_waitcnt lgkmcnt(8)
    v_mfma_f32_16x16x32_bf16 v[196:199], v[216:219], v[80:83], v[196:199]
    buffer_load_dwordx4 v7, s[36:39], s81 offen offset:3072 sc1 lds
    v_mfma_f32_16x16x32_bf16 v[196:199], v[220:223], v[84:87], v[196:199]
    s_waitcnt lgkmcnt(6)
    v_mfma_f32_16x16x32_bf16 v[196:199], v[224:227], v[32:35], v[196:199]
    v_mfma_f32_16x16x32_bf16 v[196:199], v[228:231], v[36:39], v[196:199]
    s_waitcnt lgkmcnt(4)
    v_mfma_f32_16x16x32_bf16 v[196:199], v[232:235], v[40:43], v[196:199]
    v_mfma_f32_16x16x32_bf16 v[196:199], v[236:239], v[44:47], v[196:199]
    s_waitcnt lgkmcnt(2)
    v_mfma_f32_16x16x32_bf16 v[196:199], v[240:243], v[64:67], v[196:199]
    v_mfma_f32_16x16x32_bf16 v[196:199], v[244:247], v[68:71], v[196:199]
    s_waitcnt lgkmcnt(0)
    v_mfma_f32_16x16x32_bf16 v[196:199], v[248:251], v[72:75], v[196:199]
    v_mfma_f32_16x16x32_bf16 v[196:199], v[252:255], v[76:79], v[196:199]
    s_lshl_b32 s77, s52, 11
    s_add_u32 s77, s77, 1310720
    s_lshl_b32 s71, s41, 8
    s_add_u32 s71, s71, s77
    v_pk_mul_f32 v[100:101], v[172:173], v[172:173]
    v_pk_mul_f32 v[102:103], v[174:175], v[174:175]
    v_pk_mul_f32 v[104:105], v[176:177], v[176:177]
    v_pk_mul_f32 v[106:107], v[178:179], v[178:179]
    v_pk_fma_f32 v[100:101], v[100:101], s[60:61], v[12:13]
    v_pk_fma_f32 v[102:103], v[102:103], s[60:61], v[12:13]
    v_pk_fma_f32 v[104:105], v[104:105], s[60:61], v[12:13]
    v_pk_fma_f32 v[106:107], v[106:107], s[60:61], v[12:13]
    v_pk_mul_f32 v[100:101], v[100:101], v[172:173]
    v_pk_mul_f32 v[102:103], v[102:103], v[174:175]
    v_pk_mul_f32 v[104:105], v[104:105], v[176:177]
    v_pk_mul_f32 v[106:107], v[106:107], v[178:179]
    v_exp_f32 v100, v100
    v_exp_f32 v101, v101
    v_exp_f32 v102, v102
    v_exp_f32 v103, v103
    v_exp_f32 v104, v104
    v_exp_f32 v105, v105
    v_exp_f32 v106, v106
    v_exp_f32 v107, v107
    v_pk_add_f32 v[100:101], v[100:101], 1.0 op_sel_hi:[1,0]
    v_pk_add_f32 v[102:103], v[102:103], 1.0 op_sel_hi:[1,0]
    v_pk_add_f32 v[104:105], v[104:105], 1.0 op_sel_hi:[1,0]
    v_pk_add_f32 v[106:107], v[106:107], 1.0 op_sel_hi:[1,0]
    v_rcp_f32 v100, v100
    v_rcp_f32 v101, v101
    v_rcp_f32 v102, v102
    v_rcp_f32 v103, v103
    v_rcp_f32 v104, v104
    v_rcp_f32 v105, v105
    v_rcp_f32 v106, v106
    v_rcp_f32 v107, v107
    v_pk_mul_f32 v[172:173], v[172:173], v[100:101]
    v_pk_mul_f32 v[174:175], v[174:175], v[102:103]
    v_pk_mul_f32 v[176:177], v[176:177], v[104:105]
    v_pk_mul_f32 v[178:179], v[178:179], v[106:107]
    v_pk_mul_f32 v[100:101], v[180:181], v[180:181]
    v_pk_mul_f32 v[102:103], v[182:183], v[182:183]
    v_pk_mul_f32 v[104:105], v[184:185], v[184:185]
    v_pk_mul_f32 v[106:107], v[186:187], v[186:187]
    v_pk_fma_f32 v[100:101], v[100:101], s[60:61], v[12:13]
    v_pk_fma_f32 v[102:103], v[102:103], s[60:61], v[12:13]
    v_pk_fma_f32 v[104:105], v[104:105], s[60:61], v[12:13]
    v_pk_fma_f32 v[106:107], v[106:107], s[60:61], v[12:13]
    v_pk_mul_f32 v[100:101], v[100:101], v[180:181]
    v_pk_mul_f32 v[102:103], v[102:103], v[182:183]
    v_pk_mul_f32 v[104:105], v[104:105], v[184:185]
    v_pk_mul_f32 v[106:107], v[106:107], v[186:187]
    v_exp_f32 v100, v100
    v_exp_f32 v101, v101
    v_exp_f32 v102, v102
    v_exp_f32 v103, v103
    v_exp_f32 v104, v104
    v_exp_f32 v105, v105
    v_exp_f32 v106, v106
    v_exp_f32 v107, v107
    v_pk_add_f32 v[100:101], v[100:101], 1.0 op_sel_hi:[1,0]
    v_pk_add_f32 v[102:103], v[102:103], 1.0 op_sel_hi:[1,0]
    v_pk_add_f32 v[104:105], v[104:105], 1.0 op_sel_hi:[1,0]
    v_pk_add_f32 v[106:107], v[106:107], 1.0 op_sel_hi:[1,0]
    v_rcp_f32 v100, v100
    v_rcp_f32 v101, v101
    v_rcp_f32 v102, v102
    v_rcp_f32 v103, v103
    v_rcp_f32 v104, v104
    v_rcp_f32 v105, v105
    v_rcp_f32 v106, v106
    v_rcp_f32 v107, v107
    v_pk_mul_f32 v[180:181], v[180:181], v[100:101]
    v_pk_mul_f32 v[182:183], v[182:183], v[102:103]
    v_pk_mul_f32 v[184:185], v[184:185], v[104:105]
    v_pk_mul_f32 v[186:187], v[186:187], v[106:107]
    v_pk_mul_f32 v[100:101], v[188:189], v[188:189]
L_pad_6454:
    s_cbranch_execz L_ret_3
    v_pk_mul_f32 v[102:103], v[190:191], v[190:191]
    v_pk_mul_f32 v[104:105], v[192:193], v[192:193]
    v_pk_mul_f32 v[106:107], v[194:195], v[194:195]
    v_pk_fma_f32 v[100:101], v[100:101], s[60:61], v[12:13]
    v_pk_fma_f32 v[102:103], v[102:103], s[60:61], v[12:13]
    v_pk_fma_f32 v[104:105], v[104:105], s[60:61], v[12:13]
    v_pk_fma_f32 v[106:107], v[106:107], s[60:61], v[12:13]
    v_pk_mul_f32 v[100:101], v[100:101], v[188:189]
    v_pk_mul_f32 v[102:103], v[102:103], v[190:191]
    v_pk_mul_f32 v[104:105], v[104:105], v[192:193]
    v_pk_mul_f32 v[106:107], v[106:107], v[194:195]
    v_exp_f32 v100, v100
    v_exp_f32 v101, v101
    v_exp_f32 v102, v102
    v_exp_f32 v103, v103
    v_exp_f32 v104, v104
    v_exp_f32 v105, v105
    v_exp_f32 v106, v106
    v_exp_f32_e64 v107, v107
    v_pk_add_f32 v[100:101], v[100:101], 1.0 op_sel_hi:[1,0]
    v_pk_add_f32 v[102:103], v[102:103], 1.0 op_sel_hi:[1,0]
    v_pk_add_f32 v[104:105], v[104:105], 1.0 op_sel_hi:[1,0]
    v_pk_add_f32 v[106:107], v[106:107], 1.0 op_sel_hi:[1,0]
    v_rcp_f32 v100, v100
    v_rcp_f32 v101, v101
    v_rcp_f32 v102, v102
    v_rcp_f32 v103, v103
    v_rcp_f32 v104, v104
    v_rcp_f32 v105, v105
    v_rcp_f32 v106, v106
    v_rcp_f32 v107, v107
    v_pk_mul_f32 v[188:189], v[188:189], v[100:101]
    v_pk_mul_f32 v[190:191], v[190:191], v[102:103]
    v_pk_mul_f32 v[192:193], v[192:193], v[104:105]
    v_pk_mul_f32 v[194:195], v[194:195], v[106:107]
    v_pk_mul_f32 v[100:101], v[196:197], v[196:197]
    v_pk_mul_f32 v[102:103], v[198:199], v[198:199]
    v_pk_fma_f32 v[100:101], v[100:101], s[60:61], v[12:13]
    v_pk_fma_f32 v[102:103], v[102:103], s[60:61], v[12:13]
    v_pk_mul_f32 v[100:101], v[100:101], v[196:197]
    v_pk_mul_f32 v[102:103], v[102:103], v[198:199]
    v_exp_f32 v100, v100
    v_exp_f32 v101, v101
    v_exp_f32 v102, v102
    v_exp_f32 v103, v103
    v_pk_add_f32 v[100:101], v[100:101], 1.0 op_sel_hi:[1,0]
    v_pk_add_f32 v[102:103], v[102:103], 1.0 op_sel_hi:[1,0]
    v_rcp_f32 v100, v100
    v_rcp_f32 v101, v101
    v_rcp_f32 v102, v102
    v_rcp_f32 v103, v103
    v_pk_mul_f32 v[196:197], v[196:197], v[100:101]
    v_pk_mul_f32 v[198:199], v[198:199], v[102:103]
    v_pk_add_f32 v[24:25], v[172:173], v[176:177]
    v_pk_mul_f32 v[28:29], v[172:173], v[172:173]
    v_pk_add_f32 v[26:27], v[174:175], v[178:179]
    v_pk_mul_f32 v[30:31], v[174:175], v[174:175]
    v_pk_fma_f32 v[28:29], v[176:177], v[176:177], v[28:29]
    v_pk_fma_f32 v[30:31], v[178:179], v[178:179], v[30:31]
    v_pk_add_f32 v[24:25], v[24:25], v[180:181]
    v_pk_fma_f32 v[28:29], v[180:181], v[180:181], v[28:29]
    v_pk_add_f32 v[26:27], v[26:27], v[182:183]
    v_pk_fma_f32 v[30:31], v[182:183], v[182:183], v[30:31]
    v_pk_add_f32 v[24:25], v[24:25], v[184:185]
    v_pk_fma_f32 v[28:29], v[184:185], v[184:185], v[28:29]
    v_pk_add_f32 v[26:27], v[26:27], v[186:187]
    v_pk_fma_f32 v[30:31], v[186:187], v[186:187], v[30:31]
    v_pk_add_f32 v[24:25], v[24:25], v[188:189]
    v_pk_fma_f32 v[28:29], v[188:189], v[188:189], v[28:29]
    v_pk_add_f32 v[26:27], v[26:27], v[190:191]
    v_pk_fma_f32 v[30:31], v[190:191], v[190:191], v[30:31]
    v_pk_add_f32 v[24:25], v[24:25], v[192:193]
    v_pk_fma_f32 v[28:29], v[192:193], v[192:193], v[28:29]
    v_pk_add_f32 v[26:27], v[26:27], v[194:195]
    v_pk_fma_f32 v[30:31], v[194:195], v[194:195], v[30:31]
    v_pk_add_f32 v[24:25], v[24:25], v[196:197]
    v_pk_fma_f32 v[28:29], v[196:197], v[196:197], v[28:29]
    v_pk_add_f32 v[26:27], v[26:27], v[198:199]
    v_pk_fma_f32 v[30:31], v[198:199], v[198:199], v[30:31]
    v_add_f32_dpp v88, v24, v24 row_ror:8 row_mask:0xf bank_mask:0x3
    v_add_f32_dpp v89, v28, v28 row_ror:8 row_mask:0xf bank_mask:0x3
    v_add_f32_dpp v90, v25, v25 row_ror:8 row_mask:0xf bank_mask:0x3
    v_add_f32_dpp v91, v29, v29 row_ror:8 row_mask:0xf bank_mask:0x3
    v_add_f32_dpp v88, v26, v26 row_ror:8 row_mask:0xf bank_mask:0xc
    v_add_f32_dpp v89, v30, v30 row_ror:8 row_mask:0xf bank_mask:0xc
    v_add_f32_dpp v90, v27, v27 row_ror:8 row_mask:0xf bank_mask:0xc
    v_add_f32_dpp v91, v31, v31 row_ror:8 row_mask:0xf bank_mask:0xc
    v_add_f32_dpp v24, v88, v88 row_half_mirror row_mask:0xf bank_mask:0x5
    v_add_f32_dpp v25, v89, v89 row_half_mirror row_mask:0xf bank_mask:0x5
    s_nop 0
    v_add_f32_dpp v24, v90, v90 row_half_mirror row_mask:0xf bank_mask:0xa
    v_add_f32_dpp v25, v91, v91 row_half_mirror row_mask:0xf bank_mask:0xa
    s_nop 0
    v_add_f32_dpp v24, v24, v24 quad_perm:[1,0,3,2] row_mask:0xf bank_mask:0xf
    v_add_f32_dpp v25, v25, v25 quad_perm:[1,0,3,2] row_mask:0xf bank_mask:0xf
    s_nop 0
    v_add_f32_dpp v24, v24, v24 quad_perm:[2,3,0,1] row_mask:0xf bank_mask:0xf
    v_add_f32_dpp v25, v25, v25 quad_perm:[2,3,0,1] row_mask:0xf bank_mask:0xf
    v_cndmask_b32 v24, v24, v25, s[62:63]
    v_cndmask_b32 v24, v24, v10, s[64:65]
    buffer_store_dword v24, v21, s[36:39], s71 offen sc1
    s_waitcnt vmcnt(1)
    s_barrier
    ds_read_b128 v[32:35], v7 offset:43008
    ds_read_b128 v[36:39], v7 offset:44032
    ds_read_b128 v[40:43], v7 offset:45056
    ds_read_b128 v[44:47], v7 offset:46080
    ds_read_b128 v[64:67], v7 offset:47104
    ds_read_b128 v[68:71], v7 offset:48128
    ds_read_b128 v[72:75], v7 offset:49152
    ds_read_b128 v[76:79], v7 offset:50176
    ds_read_b128 v[80:83], v7 offset:51200
    v_and_b32 v23, 3, v4
    v_lshl_add_u32 v23, v5, 2, v23
    v_lshlrev_b32 v23, 4, v23
    v_lshrrev_b32 v96, 2, v4
    v_lshl_add_u32 v96, v96, 8, v23
    s_mul_i32 s8, s89, 114688
    s_mul_i32 s9, s42, 14336
    s_add_u32 s8, s8, s9
    s_add_u32 m0, s9, 100352
    s_add_u32 s81, s8, 4194304
    buffer_load_dwordx4 v7, s[36:39], s81 offen offset:0 sc1 lds
    ds_read_b128 v[84:87], v7 offset:52224
    s_waitcnt lgkmcnt(9)
    v_mfma_f32_16x16x32_bf16 v[144:147], v[32:35], v[200:203], 0
    ds_read_b128 v[32:35], v7 offset:53248
    s_waitcnt lgkmcnt(9)
    v_mfma_f32_16x16x32_bf16 v[144:147], v[36:39], v[204:207], v[144:147]
    ds_read_b128 v[36:39], v7 offset:54272
    s_waitcnt lgkmcnt(8)
    v_mfma_f32_16x16x32_bf16 v[144:147], v[40:43], v[208:211], v[144:147]
    ds_read_b128 v[40:43], v7 offset:55296
    v_mfma_f32_16x16x32_bf16 v[144:147], v[44:47], v[212:215], v[144:147]
    ds_read_b128 v[44:47], v7 offset:56320
    s_waitcnt lgkmcnt(8)
    v_mfma_f32_16x16x32_bf16 v[144:147], v[64:67], v[216:219], v[144:147]
    ds_read_b128 v[64:67], v7 offset:57344
    buffer_load_dwordx4 v7, s[36:39], s81 offen offset:1024 sc1 lds
    v_mfma_f32_16x16x32_bf16 v[144:147], v[68:71], v[220:223], v[144:147]
    ds_read_b128 v[68:71], v7 offset:58368
    s_waitcnt lgkmcnt(8)
    v_mfma_f32_16x16x32_bf16 v[144:147], v[72:75], v[224:227], v[144:147]
    ds_read_b128 v[72:75], v7 offset:59392
    v_mfma_f32_16x16x32_bf16 v[144:147], v[76:79], v[228:231], v[144:147]
    ds_read_b128 v[76:79], v7 offset:60416
    s_waitcnt lgkmcnt(8)
    v_mfma_f32_16x16x32_bf16 v[144:147], v[80:83], v[232:235], v[144:147]
    ds_read_b128 v[80:83], v7 offset:61440
    v_mfma_f32_16x16x32_bf16 v[144:147], v[84:87], v[236:239], v[144:147]
    ds_read_b128 v[84:87], v7 offset:62464
    s_waitcnt lgkmcnt(8)
    buffer_load_dwordx4 v7, s[36:39], s81 offen offset:2048 sc1 lds
    v_mfma_f32_16x16x32_bf16 v[144:147], v[32:35], v[240:243], v[144:147]
    ds_read_b128 v[32:35], v7 offset:63488
    v_mfma_f32_16x16x32_bf16 v[144:147], v[36:39], v[244:247], v[144:147]
    ds_read_b128 v[36:39], v7 offset:64512
    s_waitcnt lgkmcnt(8)
    v_mfma_f32_16x16x32_bf16 v[144:147], v[40:43], v[248:251], v[144:147]
    ds_read_b128 v[40:43], v8 offset:0
    v_mfma_f32_16x16x32_bf16 v[144:147], v[44:47], v[252:255], v[144:147]
    ds_read_b128 v[44:47], v8 offset:1024
    s_waitcnt lgkmcnt(8)
    v_mfma_f32_16x16x32_bf16 v[148:151], v[64:67], v[200:203], 0
    ds_read_b128 v[64:67], v8 offset:2048
    buffer_load_dwordx4 v7, s[36:39], s81 offen offset:3072 sc1 lds
    v_mfma_f32_16x16x32_bf16 v[148:151], v[68:71], v[204:207], v[148:151]
    ds_read_b128 v[68:71], v8 offset:3072
    s_waitcnt lgkmcnt(8)
    v_mfma_f32_16x16x32_bf16 v[148:151], v[72:75], v[208:211], v[148:151]
    ds_read_b128 v[72:75], v8 offset:4096
    v_mfma_f32_16x16x32_bf16 v[148:151], v[76:79], v[212:215], v[148:151]
    ds_read_b128 v[76:79], v8 offset:5120
    s_waitcnt lgkmcnt(8)
    v_mfma_f32_16x16x32_bf16 v[148:151], v[80:83], v[216:219], v[148:151]
    ds_read_b128 v[80:83], v8 offset:6144
    v_mfma_f32_16x16x32_bf16 v[148:151], v[84:87], v[220:223], v[148:151]
    ds_read_b128 v[84:87], v8 offset:7168
    s_waitcnt lgkmcnt(8)
    s_add_u32 m0, s9, 104448
    s_add_u32 s81, s8, 4198400
    buffer_load_dwordx4 v7, s[36:39], s81 offen offset:0 sc1 lds
    v_mfma_f32_16x16x32_bf16 v[148:151], v[32:35], v[224:227], v[148:151]
    ds_read_b128 v[32:35], v8 offset:8192
    v_mfma_f32_16x16x32_bf16 v[148:151], v[36:39], v[228:231], v[148:151]
    ds_read_b128 v[36:39], v8 offset:9216
    s_waitcnt lgkmcnt(8)
    v_mfma_f32_16x16x32_bf16 v[148:151], v[40:43], v[232:235], v[148:151]
    ds_read_b128 v[40:43], v8 offset:10240
    v_mfma_f32_16x16x32_bf16 v[148:151], v[44:47], v[236:239], v[148:151]
    ds_read_b128 v[44:47], v8 offset:11264
    s_waitcnt lgkmcnt(8)
    v_mfma_f32_16x16x32_bf16 v[148:151], v[64:67], v[240:243], v[148:151]
    ds_read_b128 v[64:67], v8 offset:12288
    buffer_load_dwordx4 v7, s[36:39], s81 offen offset:1024 sc1 lds
    v_mfma_f32_16x16x32_bf16 v[148:151], v[68:71], v[244:247], v[148:151]
    ds_read_b128 v[68:71], v8 offset:13312
    s_waitcnt lgkmcnt(8)
    v_mfma_f32_16x16x32_bf16 v[148:151], v[72:75], v[248:251], v[148:151]
    ds_read_b128 v[72:75], v8 offset:14336
    v_mfma_f32_16x16x32_bf16 v[148:151], v[76:79], v[252:255], v[148:151]
    ds_read_b128 v[76:79], v8 offset:15360
    s_waitcnt lgkmcnt(8)
    v_mfma_f32_16x16x32_bf16 v[152:155], v[80:83], v[200:203], 0
    ds_read_b128 v[80:83], v8 offset:16384
    v_mfma_f32_16x16x32_bf16 v[152:155], v[84:87], v[204:207], v[152:155]
    ds_read_b128 v[84:87], v8 offset:17408
    s_waitcnt lgkmcnt(8)
    buffer_load_dwordx4 v7, s[36:39], s81 offen offset:2048 sc1 lds
    v_mfma_f32_16x16x32_bf16 v[152:155], v[32:35], v[208:211], v[152:155]
    ds_read_b128 v[32:35], v8 offset:18432
    v_mfma_f32_16x16x32_bf16 v[152:155], v[36:39], v[212:215], v[152:155]
    ds_read_b128 v[36:39], v8 offset:19456
    s_waitcnt lgkmcnt(8)
    v_mfma_f32_16x16x32_bf16 v[152:155], v[40:43], v[216:219], v[152:155]
    ds_read_b128 v[40:43], v8 offset:20480
    v_mfma_f32_16x16x32_bf16 v[152:155], v[44:47], v[220:223], v[152:155]
    ds_read_b128 v[44:47], v8 offset:21504
    s_waitcnt lgkmcnt(8)
    v_mfma_f32_16x16x32_bf16 v[152:155], v[64:67], v[224:227], v[152:155]
    ds_read_b128 v[64:67], v8 offset:22528
    v_mfma_f32_16x16x32_bf16 v[152:155], v[68:71], v[228:231], v[152:155]
    buffer_load_dwordx4 v7, s[36:39], s81 offen offset:3072 sc1 lds
    ds_read_b128 v[68:71], v8 offset:23552
    s_waitcnt lgkmcnt(8)
    v_mfma_f32_16x16x32_bf16 v[152:155], v[72:75], v[232:235], v[152:155]
    ds_read_b128 v[72:75], v8 offset:24576
    v_mfma_f32_16x16x32_bf16 v[152:155], v[76:79], v[236:239], v[152:155]
    ds_read_b128 v[76:79], v8 offset:25600
    s_waitcnt lgkmcnt(8)
    v_mfma_f32_16x16x32_bf16 v[152:155], v[80:83], v[240:243], v[152:155]
    ds_read_b128 v[80:83], v8 offset:26624
    v_mfma_f32_16x16x32_bf16 v[152:155], v[84:87], v[244:247], v[152:155]
    ds_read_b128 v[84:87], v8 offset:27648
    s_waitcnt lgkmcnt(8)
    s_add_u32 m0, s9, 108544
    s_add_u32 s81, s8, 4202496
    buffer_load_dwordx4 v7, s[36:39], s81 offen offset:0 sc1 lds
    v_mfma_f32_16x16x32_bf16 v[152:155], v[32:35], v[248:251], v[152:155]
    ds_read_b128 v[32:35], v8 offset:28672
    v_mfma_f32_16x16x32_bf16 v[152:155], v[36:39], v[252:255], v[152:155]
    ds_read_b128 v[36:39], v8 offset:29696
    s_waitcnt lgkmcnt(8)
    v_mfma_f32_16x16x32_bf16 v[156:159], v[40:43], v[200:203], 0
    ds_read_b128 v[40:43], v8 offset:30720
    v_mfma_f32_16x16x32_bf16 v[156:159], v[44:47], v[204:207], v[156:159]
    ds_read_b128 v[44:47], v8 offset:31744
    s_waitcnt lgkmcnt(8)
    v_mfma_f32_16x16x32_bf16 v[156:159], v[64:67], v[208:211], v[156:159]
    ds_read_b128 v[64:67], v8 offset:32768
    v_mfma_f32_16x16x32_bf16 v[156:159], v[68:71], v[212:215], v[156:159]
    buffer_load_dwordx4 v7, s[36:39], s81 offen offset:1024 sc1 lds
    ds_read_b128 v[68:71], v8 offset:33792
    s_waitcnt lgkmcnt(8)
    v_mfma_f32_16x16x32_bf16 v[156:159], v[72:75], v[216:219], v[156:159]
    ds_read_b128 v[72:75], v7 offset:0
    v_mfma_f32_16x16x32_bf16 v[156:159], v[76:79], v[220:223], v[156:159]
    ds_read_b128 v[76:79], v7 offset:1024
    s_waitcnt lgkmcnt(8)
    v_mfma_f32_16x16x32_bf16 v[156:159], v[80:83], v[224:227], v[156:159]
    ds_read_b128 v[80:83], v7 offset:2048
    v_mfma_f32_16x16x32_bf16 v[156:159], v[84:87], v[228:231], v[156:159]
    ds_read_b128 v[84:87], v7 offset:3072
    s_waitcnt lgkmcnt(8)
    buffer_load_dwordx4 v[88:91], v96, s[36:39], s77 offen sc1
    buffer_load_dwordx4 v[92:95], v96, s[36:39], s77 offen offset:1024 sc1
    s_lshl2_add_u32 s88, s41, s42
    s_lshl_b32 s88, s88, 10
    s_add_u32 s88, s88, 753664
    v_lshlrev_b32 v20, 7, v1
    v_mov_b32_e64 v97, s44
    s_bfm_b64 exec, 8, 0
    buffer_load_dword v97, v20, s[36:39], s88 offen sc1
    s_mov_b64 exec, -1
    s_add_u32 m0, s9, 110592
    s_add_u32 s81, s8, 4204544
    buffer_load_dwordx4 v7, s[36:39], s81 offen offset:0 sc1 lds
    v_mfma_f32_16x16x32_bf16 v[156:159], v[32:35], v[232:235], v[156:159]
    ds_read_b128 v[32:35], v7 offset:4096
    v_mfma_f32_16x16x32_bf16 v[156:159], v[36:39], v[236:239], v[156:159]
    ds_read_b128 v[36:39], v7 offset:5120
    s_waitcnt lgkmcnt(8)
    v_mfma_f32_16x16x32_bf16 v[156:159], v[40:43], v[240:243], v[156:159]
    ds_read_b128 v[40:43], v7 offset:6144
    v_mfma_f32_16x16x32_bf16 v[156:159], v[44:47], v[244:247], v[156:159]
    ds_read_b128 v[44:47], v7 offset:7168
    s_waitcnt lgkmcnt(8)
    v_mfma_f32_16x16x32_bf16 v[156:159], v[64:67], v[248:251], v[156:159]
    ds_read_b128 v[64:67], v7 offset:8192
    v_mfma_f32_16x16x32_bf16 v[156:159], v[68:71], v[252:255], v[156:159]
    ds_read_b128 v[68:71], v7 offset:9216
    s_waitcnt lgkmcnt(8)
    v_mfma_f32_16x16x32_bf16 v[160:163], v[72:75], v[200:203], 0
    ds_read_b128 v[72:75], v7 offset:10240
    v_mfma_f32_16x16x32_bf16 v[160:163], v[76:79], v[204:207], v[160:163]
    ds_read_b128 v[76:79], v7 offset:11264
    s_waitcnt lgkmcnt(8)
    v_mfma_f32_16x16x32_bf16 v[160:163], v[80:83], v[208:211], v[160:163]
    ds_read_b128 v[80:83], v7 offset:12288
    v_mfma_f32_16x16x32_bf16 v[160:163], v[84:87], v[212:215], v[160:163]
    ds_read_b128 v[84:87], v7 offset:13312
    s_waitcnt lgkmcnt(8)
    v_mfma_f32_16x16x32_bf16 v[160:163], v[32:35], v[216:219], v[160:163]
    ds_read_b128 v[32:35], v7 offset:14336
    v_mfma_f32_16x16x32_bf16 v[160:163], v[36:39], v[220:223], v[160:163]
    buffer_load_dwordx4 v7, s[36:39], s81 offen offset:1024 sc1 lds
    ds_read_b128 v[36:39], v7 offset:15360
    s_waitcnt lgkmcnt(8)
    v_mfma_f32_16x16x32_bf16 v[160:163], v[40:43], v[224:227], v[160:163]
    ds_read_b128 v[40:43], v7 offset:16384
    v_mfma_f32_16x16x32_bf16 v[160:163], v[44:47], v[228:231], v[160:163]
    ds_read_b128 v[44:47], v7 offset:17408
    s_waitcnt lgkmcnt(8)
    v_mfma_f32_16x16x32_bf16 v[160:163], v[64:67], v[232:235], v[160:163]
    ds_read_b128 v[64:67], v7 offset:18432
    v_mfma_f32_16x16x32_bf16 v[160:163], v[68:71], v[236:239], v[160:163]
    ds_read_b128 v[68:71], v7 offset:19456
    s_waitcnt lgkmcnt(8)
    v_mfma_f32_16x16x32_bf16 v[160:163], v[72:75], v[240:243], v[160:163]
    ds_read_b128 v[72:75], v7 offset:20480
    v_mfma_f32_16x16x32_bf16 v[160:163], v[76:79], v[244:247], v[160:163]
    ds_read_b128 v[76:79], v7 offset:21504
    s_waitcnt lgkmcnt(8)
    v_mfma_f32_16x16x32_bf16 v[160:163], v[80:83], v[248:251], v[160:163]
    ds_read_b128 v[80:83], v7 offset:22528
    v_mfma_f32_16x16x32_bf16 v[160:163], v[84:87], v[252:255], v[160:163]
    ds_read_b128 v[84:87], v7 offset:23552
    s_waitcnt lgkmcnt(8)
    v_mfma_f32_16x16x32_bf16 v[164:167], v[32:35], v[200:203], 0
    ds_read_b128 v[32:35], v7 offset:24576
    v_mfma_f32_16x16x32_bf16 v[164:167], v[36:39], v[204:207], v[164:167]
    ds_read_b128 v[36:39], v7 offset:25600
    s_waitcnt lgkmcnt(8)
    buffer_load_dwordx4 v7, s[36:39], s81 offen offset:2048 sc1 lds
    v_mfma_f32_16x16x32_bf16 v[164:167], v[40:43], v[208:211], v[164:167]
    ds_read_b128 v[40:43], v7 offset:26624
    v_mfma_f32_16x16x32_bf16 v[164:167], v[44:47], v[212:215], v[164:167]
    ds_read_b128 v[44:47], v7 offset:27648
    s_waitcnt lgkmcnt(8)
    v_mfma_f32_16x16x32_bf16 v[164:167], v[64:67], v[216:219], v[164:167]
    ds_read_b128 v[64:67], v7 offset:28672
    v_mfma_f32_16x16x32_bf16 v[164:167], v[68:71], v[220:223], v[164:167]
    ds_read_b128 v[68:71], v7 offset:29696
    s_waitcnt lgkmcnt(8)
    v_mfma_f32_16x16x32_bf16 v[164:167], v[72:75], v[224:227], v[164:167]
    ds_read_b128 v[72:75], v7 offset:30720
    v_mfma_f32_16x16x32_bf16 v[164:167], v[76:79], v[228:231], v[164:167]
    ds_read_b128 v[76:79], v7 offset:31744
    s_waitcnt lgkmcnt(8)
    v_mfma_f32_16x16x32_bf16 v[164:167], v[80:83], v[232:235], v[164:167]
    ds_read_b128 v[80:83], v7 offset:32768
    v_mfma_f32_16x16x32_bf16 v[164:167], v[84:87], v[236:239], v[164:167]
    ds_read_b128 v[84:87], v7 offset:33792
    s_waitcnt lgkmcnt(8)
    v_mfma_f32_16x16x32_bf16 v[164:167], v[32:35], v[240:243], v[164:167]
    ds_read_b128 v[32:35], v7 offset:34816
    v_mfma_f32_16x16x32_bf16 v[164:167], v[36:39], v[244:247], v[164:167]
    ds_read_b128 v[36:39], v7 offset:35840
    s_waitcnt lgkmcnt(8)
    v_mfma_f32_16x16x32_bf16 v[164:167], v[40:43], v[248:251], v[164:167]
    ds_read_b128 v[40:43], v7 offset:36864
    buffer_load_dwordx4 v7, s[36:39], s81 offen offset:3072 sc1 lds
    v_mfma_f32_16x16x32_bf16 v[164:167], v[44:47], v[252:255], v[164:167]
    ds_read_b128 v[44:47], v7 offset:37888
    s_waitcnt lgkmcnt(8)
    v_mfma_f32_16x16x32_bf16 v[168:171], v[64:67], v[200:203], 0
    ds_read_b128 v[64:67], v7 offset:38912
    v_mfma_f32_16x16x32_bf16 v[168:171], v[68:71], v[204:207], v[168:171]
    ds_read_b128 v[68:71], v7 offset:39936
    s_waitcnt lgkmcnt(8)
    v_mfma_f32_16x16x32_bf16 v[168:171], v[72:75], v[208:211], v[168:171]
    ds_read_b128 v[72:75], v7 offset:40960
    v_mfma_f32_16x16x32_bf16 v[168:171], v[76:79], v[212:215], v[168:171]
    ds_read_b128 v[76:79], v7 offset:41984
    s_waitcnt lgkmcnt(8)
    v_mfma_f32_16x16x32_bf16 v[168:171], v[80:83], v[216:219], v[168:171]
    v_mfma_f32_16x16x32_bf16 v[168:171], v[84:87], v[220:223], v[168:171]
    s_waitcnt lgkmcnt(6)
    v_mfma_f32_16x16x32_bf16 v[168:171], v[32:35], v[224:227], v[168:171]
    v_mfma_f32_16x16x32_bf16 v[168:171], v[36:39], v[228:231], v[168:171]
    s_waitcnt lgkmcnt(4)
    v_mfma_f32_16x16x32_bf16 v[168:171], v[40:43], v[232:235], v[168:171]
    v_mfma_f32_16x16x32_bf16 v[168:171], v[44:47], v[236:239], v[168:171]
    s_waitcnt lgkmcnt(2)
    v_mfma_f32_16x16x32_bf16 v[168:171], v[64:67], v[240:243], v[168:171]
    v_mfma_f32_16x16x32_bf16 v[168:171], v[68:71], v[244:247], v[168:171]
    s_waitcnt lgkmcnt(0)
    v_mfma_f32_16x16x32_bf16 v[168:171], v[72:75], v[248:251], v[168:171]
    v_mfma_f32_16x16x32_bf16 v[168:171], v[76:79], v[252:255], v[168:171]
    s_waitcnt vmcnt(6)
    v_cmp_ne_u32_e64 vcc, s44, v90
    s_waitcnt vmcnt(5)
    v_cmp_ne_u32 s[70:71], s44, v94
    s_or_b64 vcc, vcc, s[70:71]
    s_cbranch_scc1 ss_111
sb_112:
    v_pk_add_f32 v[88:89], v[88:89], v[92:93]
    s_nop 1
    v_add_f32_dpp v88, v88, v88 row_ror:4 row_mask:0xf bank_mask:0xf
    v_add_f32_dpp v89, v89, v89 row_ror:4 row_mask:0xf bank_mask:0xf
    s_nop 0
    v_add_f32_dpp v88, v88, v88 row_ror:8 row_mask:0xf bank_mask:0xf
    v_add_f32_dpp v89, v89, v89 row_ror:8 row_mask:0xf bank_mask:0xf
    v_mul_f32 v88, 0x3a924925, v88
    v_mul_f32 v89, 0x3a924925, v89
    v_fma_f32 v89, -v88, v88, v89
    v_max_f32 v89, 0, v89
    v_add_f32 v89, s53, v89
    v_rsq_f32 v90, v89
    s_nop 0
    v_mul_f32_e64 v91, -v88, v90
    v_mov_b32_dpp v24, v90 quad_perm:[0,0,0,0] row_mask:0xf bank_mask:0xf
    v_mov_b32_dpp v25, v90 quad_perm:[1,1,1,1] row_mask:0xf bank_mask:0xf
    v_mov_b32_dpp v26, v90 quad_perm:[2,2,2,2] row_mask:0xf bank_mask:0xf
    v_mov_b32_dpp v27, v90 quad_perm:[3,3,3,3] row_mask:0xf bank_mask:0xf
    v_mov_b32_dpp v28, v91 quad_perm:[0,0,0,0] row_mask:0xf bank_mask:0xf
    v_mov_b32_dpp v29, v91 quad_perm:[1,1,1,1] row_mask:0xf bank_mask:0xf
    v_mov_b32_dpp v30, v91 quad_perm:[2,2,2,2] row_mask:0xf bank_mask:0xf
    v_mov_b32_dpp v31, v91 quad_perm:[3,3,3,3] row_mask:0xf bank_mask:0xf
    v_pk_fma_f32 v[172:173], v[172:173], v[24:25], v[28:29]
    v_pk_fma_f32 v[174:175], v[174:175], v[26:27], v[30:31]
    v_cvt_pk_bf16_f32 v88, v172, v173
    v_cvt_pk_bf16_f32 v89, v174, v175
    v_pk_fma_f32 v[176:177], v[176:177], v[24:25], v[28:29]
    v_pk_fma_f32 v[178:179], v[178:179], v[26:27], v[30:31]
    v_cvt_pk_bf16_f32 v90, v176, v177
    v_cvt_pk_bf16_f32 v91, v178, v179
    s_nop 0
    v_permlane16_swap_b32 v88, v90
    v_permlane16_swap_b32 v89, v91
    v_and_b32 v88, -2, v88
    s_add_u32 s78, s83, 35651584
    buffer_store_dwordx4 v[88:91], v15, s[36:39], s78 offen sc1
    v_pk_fma_f32 v[180:181], v[180:181], v[24:25], v[28:29]
    v_pk_fma_f32 v[182:183], v[182:183], v[26:27], v[30:31]
    v_cvt_pk_bf16_f32 v92, v180, v181
    v_cvt_pk_bf16_f32 v93, v182, v183
    v_pk_fma_f32 v[184:185], v[184:185], v[24:25], v[28:29]
    v_pk_fma_f32 v[186:187], v[186:187], v[26:27], v[30:31]
    v_cvt_pk_bf16_f32 v94, v184, v185
    v_cvt_pk_bf16_f32 v95, v186, v187
    s_nop 0
    v_permlane16_swap_b32 v92, v94
    v_permlane16_swap_b32 v93, v95
    v_and_b32 v92, -2, v92
    s_add_u32 s78, s83, 35782656
    buffer_store_dwordx4 v[92:95], v15, s[36:39], s78 offen sc1
    v_pk_fma_f32 v[188:189], v[188:189], v[24:25], v[28:29]
    v_pk_fma_f32 v[190:191], v[190:191], v[26:27], v[30:31]
    v_cvt_pk_bf16_f32 v88, v188, v189
    v_cvt_pk_bf16_f32 v89, v190, v191
    v_pk_fma_f32 v[192:193], v[192:193], v[24:25], v[28:29]
    v_pk_fma_f32 v[194:195], v[194:195], v[26:27], v[30:31]
    v_cvt_pk_bf16_f32 v90, v192, v193
    v_cvt_pk_bf16_f32 v91, v194, v195
    s_nop 0
    v_permlane16_swap_b32 v88, v90
    v_permlane16_swap_b32 v89, v91
    v_and_b32 v88, -2, v88
    s_add_u32 s78, s83, 35913728
    buffer_store_dwordx4 v[88:91], v15, s[36:39], s78 offen sc1
    v_pk_fma_f32 v[196:197], v[196:197], v[24:25], v[28:29]
    v_pk_fma_f32 v[198:199], v[198:199], v[26:27], v[30:31]
    v_cvt_pk_bf16_f32 v92, v196, v197
    v_cvt_pk_bf16_f32 v93, v198, v199
    s_nop 0
    v_permlane16_swap_b32 v92, v94
    v_permlane16_swap_b32 v93, v95
    v_and_b32 v92, -2, v92
    s_add_u32 s78, s84, 35651584
    s_mov_b32 exec_lo, 0xffff
    s_mov_b32 exec_hi, 0xffff
    buffer_store_dwordx4 v[92:95], v15, s[36:39], s78 offen sc1
    s_mov_b64 exec, -1
    s_barrier
    s_lshl_b32 s70, s42, 11
    s_add_u32 s70, s70, 32768
    v_lshl_add_u32 v23, v4, 4, s70
    v_add_u32_e64 v24, s70, v7
    s_cmp_lt_u32 s89, 3
    s_cbranch_scc1 x1n_114
    s_cmp_lt_u32 s89, 5
    s_cbranch_scc1 x1n_115
    s_cmp_lt_u32 s89, 6
    s_cbranch_scc1 x1n_116
    s_lshl_b64 exec, s[66:67], 16
    ds_write_b128 v23, v[252:255] offset:0
    s_lshl_b64 exec, s[66:67], 0
    ds_write_b128 v23, v[228:231] offset:256
    ds_write_b128 v23, v[232:235] offset:512
    ds_write_b128 v23, v[236:239] offset:768
    ds_write_b128 v23, v[240:243] offset:1024
    ds_write_b128 v23, v[244:247] offset:1280
    ds_write_b128 v23, v[248:251] offset:1536
    ds_write_b128 v23, v[252:255] offset:1792
    s_branch x1d_113
x1n_116:
    s_lshl_b64 exec, s[66:67], 32
    ds_write_b128 v23, v[248:251] offset:0
    ds_write_b128 v23, v[252:255] offset:256
    s_lshl_b64 exec, s[66:67], 16
    ds_write_b128 v23, v[228:231] offset:512
    ds_write_b128 v23, v[232:235] offset:768
    ds_write_b128 v23, v[236:239] offset:1024
    ds_write_b128 v23, v[240:243] offset:1280
    ds_write_b128 v23, v[244:247] offset:1536
    ds_write_b128 v23, v[248:251] offset:1792
    s_branch x1d_113
x1n_115:
    s_cmp_lt_u32 s89, 4
    s_cbranch_scc1 x1n_117
    s_lshl_b64 exec, s[66:67], 48
    ds_write_b128 v23, v[244:247] offset:0
    ds_write_b128 v23, v[248:251] offset:256
    ds_write_b128 v23, v[252:255] offset:512
    s_lshl_b64 exec, s[66:67], 32
    ds_write_b128 v23, v[228:231] offset:768
    ds_write_b128 v23, v[232:235] offset:1024
    ds_write_b128 v23, v[236:239] offset:1280
    ds_write_b128 v23, v[240:243] offset:1536
    ds_write_b128 v23, v[244:247] offset:1792
    s_branch x1d_113
x1n_117:
    s_lshl_b64 exec, s[66:67], 48
    ds_write_b128 v23, v[212:215] offset:0
    ds_write_b128 v23, v[216:219] offset:256
    ds_write_b128 v23, v[220:223] offset:512
    ds_write_b128 v23, v[224:227] offset:768
    s_lshl_b64 exec, s[66:67], 48
    ds_write_b128 v23, v[228:231] offset:1024
    ds_write_b128 v23, v[232:235] offset:1280
    ds_write_b128 v23, v[236:239] offset:1536
    ds_write_b128 v23, v[240:243] offset:1792
    s_branch x1d_113
x1n_114:
    s_cmp_lt_u32 s89, 1
    s_cbranch_scc1 x1n_118
    s_cmp_lt_u32 s89, 2
    s_cbranch_scc1 x1n_119
    s_lshl_b64 exec, s[66:67], 32
    ds_write_b128 v23, v[208:211] offset:0
    ds_write_b128 v23, v[212:215] offset:256
    ds_write_b128 v23, v[216:219] offset:512
    ds_write_b128 v23, v[220:223] offset:768
    ds_write_b128 v23, v[224:227] offset:1024
    s_lshl_b64 exec, s[66:67], 48
    ds_write_b128 v23, v[200:203] offset:1280
    ds_write_b128 v23, v[204:207] offset:1536
    ds_write_b128 v23, v[208:211] offset:1792
    s_branch x1d_113
x1n_119:
    s_lshl_b64 exec, s[66:67], 16
    ds_write_b128 v23, v[204:207] offset:0
    ds_write_b128 v23, v[208:211] offset:256
    ds_write_b128 v23, v[212:215] offset:512
    ds_write_b128 v23, v[216:219] offset:768
    ds_write_b128 v23, v[220:223] offset:1024
    ds_write_b128 v23, v[224:227] offset:1280
    s_lshl_b64 exec, s[66:67], 32
    ds_write_b128 v23, v[200:203] offset:1536
    ds_write_b128 v23, v[204:207] offset:1792
    s_branch x1d_113
x1n_118:
    s_lshl_b64 exec, s[66:67], 0
    ds_write_b128 v23, v[200:203] offset:0
    ds_write_b128 v23, v[204:207] offset:256
    ds_write_b128 v23, v[208:211] offset:512
    ds_write_b128 v23, v[212:215] offset:768
    ds_write_b128 v23, v[216:219] offset:1024
    ds_write_b128 v23, v[220:223] offset:1280
    ds_write_b128 v23, v[224:227] offset:1536
    s_lshl_b64 exec, s[66:67], 16
    ds_write_b128 v23, v[200:203] offset:1792
x1d_113:
    s_mov_b64 exec, -1
    ds_read_b128 v[100:103], v24 offset:0
    ds_read_b128 v[104:107], v24 offset:1024
    s_mul_i32 s8, s89, 114688
    s_mul_i32 s9, s42, 14336
    s_add_u32 s8, s8, s9
    s_nop 0
    s_add_u32 m0, s9, 43008
    s_add_u32 s81, s8, 4251648
    buffer_load_dwordx4 v7, s[36:39], s81 offen offset:0 sc1 lds
    v_pk_mul_f32 v[24:25], v[144:145], v[144:145]
    v_pk_mul_f32 v[26:27], v[146:147], v[146:147]
    v_pk_mul_f32 v[28:29], v[148:149], v[148:149]
    v_pk_mul_f32 v[30:31], v[150:151], v[150:151]
    v_pk_fma_f32 v[24:25], v[24:25], s[60:61], v[12:13]
    v_pk_fma_f32 v[26:27], v[26:27], s[60:61], v[12:13]
    v_pk_fma_f32 v[28:29], v[28:29], s[60:61], v[12:13]
    v_pk_fma_f32 v[30:31], v[30:31], s[60:61], v[12:13]
    v_pk_mul_f32 v[24:25], v[24:25], v[144:145]
    v_pk_mul_f32 v[26:27], v[26:27], v[146:147]
    v_pk_mul_f32 v[28:29], v[28:29], v[148:149]
L_pad_7050:
    s_cbranch_execz L_ret_3
    v_pk_mul_f32 v[30:31], v[30:31], v[150:151]
    v_exp_f32 v24, v24
    buffer_load_dwordx4 v7, s[36:39], s81 offen offset:1024 sc1 lds
    v_exp_f32 v25, v25
    v_exp_f32 v26, v26
    v_exp_f32 v27, v27
    v_exp_f32 v28, v28
    v_exp_f32 v29, v29
    v_exp_f32 v30, v30
    v_exp_f32_e64 v31, v31
    v_pk_add_f32 v[24:25], v[24:25], 1.0 op_sel_hi:[1,0]
    v_pk_add_f32 v[26:27], v[26:27], 1.0 op_sel_hi:[1,0]
    v_pk_add_f32 v[28:29], v[28:29], 1.0 op_sel_hi:[1,0]
    v_pk_add_f32 v[30:31], v[30:31], 1.0 op_sel_hi:[1,0]
    v_rcp_f32 v24, v24
    v_rcp_f32 v25, v25
    buffer_load_dwordx4 v7, s[36:39], s81 offen offset:2048 sc1 lds
    v_rcp_f32 v26, v26
    v_rcp_f32 v27, v27
    v_rcp_f32 v28, v28
    v_rcp_f32 v29, v29
    v_rcp_f32 v30, v30
    v_rcp_f32 v31, v31
    v_pk_mul_f32 v[144:145], v[144:145], v[24:25]
    v_pk_mul_f32 v[146:147], v[146:147], v[26:27]
    v_pk_mul_f32 v[148:149], v[148:149], v[28:29]
    v_pk_mul_f32 v[150:151], v[150:151], v[30:31]
    v_pk_mul_f32 v[24:25], v[152:153], v[152:153]
    v_pk_mul_f32 v[26:27], v[154:155], v[154:155]
    buffer_load_dwordx4 v7, s[36:39], s81 offen offset:3072 sc1 lds
    v_pk_mul_f32 v[28:29], v[156:157], v[156:157]
    v_pk_mul_f32 v[30:31], v[158:159], v[158:159]
    v_pk_fma_f32 v[24:25], v[24:25], s[60:61], v[12:13]
    v_pk_fma_f32 v[26:27], v[26:27], s[60:61], v[12:13]
    v_pk_fma_f32 v[28:29], v[28:29], s[60:61], v[12:13]
    v_pk_fma_f32 v[30:31], v[30:31], s[60:61], v[12:13]
    v_pk_mul_f32 v[24:25], v[24:25], v[152:153]
    v_pk_mul_f32 v[26:27], v[26:27], v[154:155]
    v_pk_mul_f32 v[28:29], v[28:29], v[156:157]
    v_pk_mul_f32 v[30:31], v[30:31], v[158:159]
    v_exp_f32 v24, v24
    v_exp_f32 v25, v25
    v_exp_f32_e64 v26, v26
    s_add_u32 m0, s9, 47104
    s_add_u32 s81, s8, 4255744
    buffer_load_dwordx4 v7, s[36:39], s81 offen offset:0 sc1 lds
    v_exp_f32 v27, v27
    v_exp_f32 v28, v28
    v_exp_f32 v29, v29
    v_exp_f32 v30, v30
    v_exp_f32_e64 v31, v31
    v_pk_add_f32 v[24:25], v[24:25], 1.0 op_sel_hi:[1,0]
    v_pk_add_f32 v[26:27], v[26:27], 1.0 op_sel_hi:[1,0]
    v_pk_add_f32 v[28:29], v[28:29], 1.0 op_sel_hi:[1,0]
    v_pk_add_f32 v[30:31], v[30:31], 1.0 op_sel_hi:[1,0]
    v_rcp_f32 v24, v24
    v_rcp_f32 v25, v25
    v_rcp_f32_e64 v26, v26
    buffer_load_dwordx4 v7, s[36:39], s81 offen offset:1024 sc1 lds
    v_rcp_f32 v27, v27
    v_rcp_f32 v28, v28
    v_rcp_f32 v29, v29
    v_rcp_f32 v30, v30
    v_rcp_f32_e64 v31, v31
    v_pk_mul_f32 v[152:153], v[152:153], v[24:25]
    v_pk_mul_f32 v[154:155], v[154:155], v[26:27]
    v_pk_mul_f32 v[156:157], v[156:157], v[28:29]
    v_pk_mul_f32 v[158:159], v[158:159], v[30:31]
    v_pk_mul_f32 v[24:25], v[160:161], v[160:161]
    v_pk_mul_f32 v[26:27], v[162:163], v[162:163]
    v_pk_mul_f32 v[28:29], v[164:165], v[164:165]
    v_pk_mul_f32 v[30:31], v[166:167], v[166:167]
    buffer_load_dwordx4 v7, s[36:39], s81 offen offset:2048 sc1 lds
    v_pk_fma_f32 v[24:25], v[24:25], s[60:61], v[12:13]
    v_pk_fma_f32 v[26:27], v[26:27], s[60:61], v[12:13]
    v_pk_fma_f32 v[28:29], v[28:29], s[60:61], v[12:13]
    v_pk_fma_f32 v[30:31], v[30:31], s[60:61], v[12:13]
    v_pk_mul_f32 v[24:25], v[24:25], v[160:161]
    v_pk_mul_f32 v[26:27], v[26:27], v[162:163]
    v_pk_mul_f32 v[28:29], v[28:29], v[164:165]
    v_pk_mul_f32 v[30:31], v[30:31], v[166:167]
    v_exp_f32 v24, v24
    v_exp_f32 v25, v25
    v_exp_f32 v26, v26
    v_exp_f32 v27, v27
    v_exp_f32_e64 v28, v28
    buffer_load_dwordx4 v7, s[36:39], s81 offen offset:3072 sc1 lds
    v_exp_f32 v29, v29
    v_exp_f32 v30, v30
    v_exp_f32_e64 v31, v31
    v_pk_add_f32 v[24:25], v[24:25], 1.0 op_sel_hi:[1,0]
    v_pk_add_f32 v[26:27], v[26:27], 1.0 op_sel_hi:[1,0]
    v_pk_add_f32 v[28:29], v[28:29], 1.0 op_sel_hi:[1,0]
    v_pk_add_f32 v[30:31], v[30:31], 1.0 op_sel_hi:[1,0]
    v_rcp_f32 v24, v24
    v_rcp_f32 v25, v25
    v_rcp_f32 v26, v26
    v_rcp_f32 v27, v27
    v_rcp_f32_e64 v28, v28
    s_add_u32 m0, s9, 51200
    s_add_u32 s81, s8, 4259840
    buffer_load_dwordx4 v7, s[36:39], s81 offen offset:0 sc1 lds
    v_rcp_f32 v29, v29
    v_rcp_f32 v30, v30
    v_rcp_f32_e64 v31, v31
    v_pk_mul_f32 v[160:161], v[160:161], v[24:25]
    v_pk_mul_f32 v[162:163], v[162:163], v[26:27]
    v_pk_mul_f32 v[164:165], v[164:165], v[28:29]
    v_pk_mul_f32 v[166:167], v[166:167], v[30:31]
    v_pk_mul_f32 v[24:25], v[168:169], v[168:169]
    v_pk_mul_f32 v[26:27], v[170:171], v[170:171]
    v_pk_fma_f32 v[24:25], v[24:25], s[60:61], v[12:13]
    v_pk_fma_f32 v[26:27], v[26:27], s[60:61], v[12:13]
    v_pk_mul_f32 v[24:25], v[24:25], v[168:169]
    v_pk_mul_f32 v[26:27], v[26:27], v[170:171]
    buffer_load_dwordx4 v7, s[36:39], s81 offen offset:1024 sc1 lds
    v_exp_f32 v24, v24
    v_exp_f32 v25, v25
    v_exp_f32 v26, v26
    v_exp_f32 v27, v27
    v_pk_add_f32 v[24:25], v[24:25], 1.0 op_sel_hi:[1,0]
    v_pk_add_f32 v[26:27], v[26:27], 1.0 op_sel_hi:[1,0]
    v_rcp_f32 v24, v24
    v_rcp_f32 v25, v25
    v_rcp_f32 v26, v26
    v_rcp_f32 v27, v27
    v_pk_mul_f32 v[168:169], v[168:169], v[24:25]
    v_pk_mul_f32 v[170:171], v[170:171], v[26:27]
    s_waitcnt vmcnt(18)
    v_cmp_ne_u32 vcc, s44, v97
    s_cbranch_vccnz ps_120
pb_121:
    s_lshl_b32 s70, s42, 12
    v_add_u32_e64 v26, s70, v7
    v_xor_b32 v23, 4096, v26
    v_xor_b32 v24, 8192, v26
    v_xor_b32 v25, 12288, v26
    s_lshl_b32 s70, s42, 14
    s_add_u32 s70, s70, 35651584
    s_lshl_b32 s73, s45, 16
    s_add_u32 s73, s73, s70
    s_lshl_b32 s74, s46, 16
    s_add_u32 s74, s74, s70
    s_mul_i32 s75, s52, 28672
    s_waitcnt vmcnt(10)
    s_add_u32 s77, s73, 0
    s_nop 0
    buffer_load_dwordx4 v[28:31], v7, s[36:39], s77 offen offset:0 sc1
    buffer_load_dwordx4 v[32:35], v7, s[36:39], s77 offen offset:1024 sc1
    buffer_load_dwordx4 v[36:39], v7, s[36:39], s77 offen offset:2048 sc1
    buffer_load_dwordx4 v[40:43], v7, s[36:39], s77 offen offset:3072 sc1
    s_add_u32 s77, s73, 4096
    buffer_load_dwordx4 v[44:47], v7, s[36:39], s77 offen offset:0 sc1
    buffer_load_dwordx4 v[64:67], v7, s[36:39], s77 offen offset:1024 sc1
    buffer_load_dwordx4 v[68:71], v7, s[36:39], s77 offen offset:2048 sc1
    buffer_load_dwordx4 v[72:75], v7, s[36:39], s77 offen offset:3072 sc1
    s_add_u32 s77, s73, 8192
    buffer_load_dwordx4 v[76:79], v7, s[36:39], s77 offen offset:0 sc1
    buffer_load_dwordx4 v[80:83], v7, s[36:39], s77 offen offset:1024 sc1
    buffer_load_dwordx4 v[84:87], v7, s[36:39], s77 offen offset:2048 sc1
    s_mov_b64 exec, 0
    s_cmp_eq_u32 s42, 0
    s_cbranch_scc1 L_pad_9832
    s_cmp_eq_u32 s42, 1
    s_cbranch_scc1 L_pad_8254
    s_cmp_eq_u32 s42, 2
    s_cbranch_scc1 L_ret_4
    s_branch L_ret_4
L_ret_4:
    s_mov_b64 exec, -1
    s_waitcnt vmcnt(7)
    v_bitop3_b32 v20, v28, v32, v36 bitop3:254
    v_bitop3_b32 v20, v20, v40, -2 bitop3:254
    v_cmp_eq_u32 vcc, -1, v20
    s_cbranch_vccnz cs_122
cb_123:
    v_mfma_f32_16x16x32_bf16 v[224:227], v[28:31], a[0:3], 0
    buffer_load_dwordx4 v[88:91], v7, s[36:39], s77 offen offset:3072 sc1
    v_mfma_f32_16x16x32_bf16 v[224:227], v[32:35], a[16:19], v[224:227]
    s_add_u32 s77, s73, 12288
    v_mfma_f32_16x16x32_bf16 v[228:231], v[32:35], a[20:23], 0
    buffer_load_dwordx4 v[92:95], v7, s[36:39], s77 offen offset:0 sc1
    v_mfma_f32_16x16x32_bf16 v[228:231], v[28:31], a[4:7], v[228:231]
    v_mfma_f32_16x16x32_bf16 v[232:235], v[28:31], a[8:11], 0
    buffer_load_dwordx4 v[96:99], v7, s[36:39], s77 offen offset:1024 sc1
    v_mfma_f32_16x16x32_bf16 v[232:235], v[32:35], a[24:27], v[232:235]
    v_mfma_f32_16x16x32_bf16 v[236:239], v[32:35], a[28:31], 0
    v_mfma_f32_16x16x32_bf16 v[236:239], v[28:31], a[12:15], v[236:239]
    v_mfma_f32_16x16x32_bf16 v[236:239], v[36:39], a[44:47], v[236:239]
    buffer_load_dwordx4 v[108:111], v7, s[36:39], s77 offen offset:2048 sc1
    v_mfma_f32_16x16x32_bf16 v[236:239], v[40:43], a[60:63], v[236:239]
    v_mfma_f32_16x16x32_bf16 v[232:235], v[40:43], a[56:59], v[232:235]
    v_mfma_f32_16x16x32_bf16 v[232:235], v[36:39], a[40:43], v[232:235]
    v_mfma_f32_16x16x32_bf16 v[228:231], v[36:39], a[36:39], v[228:231]
    buffer_load_dwordx4 v[112:115], v7, s[36:39], s77 offen offset:3072 sc1
    v_mfma_f32_16x16x32_bf16 v[228:231], v[40:43], a[52:55], v[228:231]
    s_waitcnt vmcnt(8)
    v_bitop3_b32 v20, v44, v64, v68 bitop3:254
    v_mfma_f32_16x16x32_bf16 v[224:227], v[40:43], a[48:51], v[224:227]
    v_bitop3_b32 v20, v20, v72, -2 bitop3:254
    v_cmp_eq_u32 vcc, -1, v20
    v_mfma_f32_16x16x32_bf16 v[224:227], v[36:39], a[32:35], v[224:227]
    s_cbranch_vccnz cs_124
cb_125:
    s_nop 0
    v_mfma_f32_16x16x32_bf16 v[224:227], v[44:47], a[64:67], v[224:227]
    s_add_u32 s77, s73, 65536
    buffer_load_dwordx4 v[28:31], v7, s[36:39], s77 offen offset:0 sc1
    v_mfma_f32_16x16x32_bf16 v[224:227], v[64:67], a[80:83], v[224:227]
    v_mfma_f32_16x16x32_bf16 v[228:231], v[64:67], a[84:87], v[228:231]
    buffer_load_dwordx4 v[32:35], v7, s[36:39], s77 offen offset:1024 sc1
    v_mfma_f32_16x16x32_bf16 v[228:231], v[44:47], a[68:71], v[228:231]
    v_mfma_f32_16x16x32_bf16 v[232:235], v[44:47], a[72:75], v[232:235]
    buffer_load_dwordx4 v[36:39], v7, s[36:39], s77 offen offset:2048 sc1
    v_mfma_f32_16x16x32_bf16 v[232:235], v[64:67], a[88:91], v[232:235]
    v_mfma_f32_16x16x32_bf16 v[236:239], v[64:67], a[92:95], v[236:239]
    v_mfma_f32_16x16x32_bf16 v[236:239], v[44:47], a[76:79], v[236:239]
    v_mfma_f32_16x16x32_bf16 v[236:239], v[68:71], a[108:111], v[236:239]
    buffer_load_dwordx4 v[40:43], v7, s[36:39], s77 offen offset:3072 sc1
    v_mfma_f32_16x16x32_bf16 v[236:239], v[72:75], a[124:127], v[236:239]
    v_mfma_f32_16x16x32_bf16 v[232:235], v[72:75], a[120:123], v[232:235]
    v_mfma_f32_16x16x32_bf16 v[232:235], v[68:71], a[104:107], v[232:235]
    v_mfma_f32_16x16x32_bf16 v[228:231], v[68:71], a[100:103], v[228:231]
    s_add_u32 s77, s73, 69632
    buffer_load_dwordx4 v[44:47], v7, s[36:39], s77 offen offset:0 sc1
    v_mfma_f32_16x16x32_bf16 v[228:231], v[72:75], a[116:119], v[228:231]
    s_waitcnt vmcnt(9)
    v_bitop3_b32 v20, v76, v80, v84 bitop3:254
    v_mfma_f32_16x16x32_bf16 v[224:227], v[72:75], a[112:115], v[224:227]
    v_bitop3_b32 v20, v20, v88, -2 bitop3:254
    v_cmp_eq_u32 vcc, -1, v20
    v_mfma_f32_16x16x32_bf16 v[224:227], v[68:71], a[96:99], v[224:227]
    s_cbranch_vccnz cs_126
cb_127:
    s_nop 0
    v_mfma_f32_16x16x32_bf16 v[224:227], v[76:79], a[128:131], v[224:227]
    buffer_load_dwordx4 v[64:67], v7, s[36:39], s77 offen offset:1024 sc1
    v_mfma_f32_16x16x32_bf16 v[224:227], v[80:83], a[144:147], v[224:227]
    v_mfma_f32_16x16x32_bf16 v[228:231], v[80:83], a[148:151], v[228:231]
    buffer_load_dwordx4 v[68:71], v7, s[36:39], s77 offen offset:2048 sc1
    v_mfma_f32_16x16x32_bf16 v[228:231], v[76:79], a[132:135], v[228:231]
    v_mfma_f32_16x16x32_bf16 v[232:235], v[76:79], a[136:139], v[232:235]
    buffer_load_dwordx4 v[72:75], v7, s[36:39], s77 offen offset:3072 sc1
    v_mfma_f32_16x16x32_bf16 v[232:235], v[80:83], a[152:155], v[232:235]
    v_mfma_f32_16x16x32_bf16 v[236:239], v[80:83], a[156:159], v[236:239]
    v_mfma_f32_16x16x32_bf16 v[236:239], v[76:79], a[140:143], v[236:239]
    v_mfma_f32_16x16x32_bf16 v[236:239], v[84:87], a[172:175], v[236:239]
    s_add_u32 s77, s73, 73728
    buffer_load_dwordx4 v[76:79], v7, s[36:39], s77 offen offset:0 sc1
    v_mfma_f32_16x16x32_bf16 v[236:239], v[88:91], a[188:191], v[236:239]
    v_mfma_f32_16x16x32_bf16 v[232:235], v[88:91], a[184:187], v[232:235]
    v_mfma_f32_16x16x32_bf16 v[232:235], v[84:87], a[168:171], v[232:235]
    v_mfma_f32_16x16x32_bf16 v[228:231], v[84:87], a[164:167], v[228:231]
    buffer_load_dwordx4 v[80:83], v7, s[36:39], s77 offen offset:1024 sc1
    v_mfma_f32_16x16x32_bf16 v[228:231], v[88:91], a[180:183], v[228:231]
    s_waitcnt vmcnt(10)
    v_bitop3_b32 v20, v92, v96, v108 bitop3:254
    v_mfma_f32_16x16x32_bf16 v[224:227], v[88:91], a[176:179], v[224:227]
    v_bitop3_b32 v20, v20, v112, -2 bitop3:254
    v_cmp_eq_u32 vcc, -1, v20
    v_mfma_f32_16x16x32_bf16 v[224:227], v[84:87], a[160:163], v[224:227]
    s_cbranch_vccnz cs_128
cb_129:
    s_nop 0
    v_mfma_f32_16x16x32_bf16 v[224:227], v[92:95], a[192:195], v[224:227]
    buffer_load_dwordx4 v[84:87], v7, s[36:39], s77 offen offset:2048 sc1
    v_mfma_f32_16x16x32_bf16 v[224:227], v[96:99], a[208:211], v[224:227]
    v_mfma_f32_16x16x32_bf16 v[228:231], v[96:99], a[212:215], v[228:231]
    v_mfma_f32_16x16x32_bf16 v[228:231], v[92:95], a[196:199], v[228:231]
    v_mfma_f32_16x16x32_bf16 v[232:235], v[92:95], a[200:203], v[232:235]
    buffer_load_dwordx4 v[88:91], v7, s[36:39], s77 offen offset:3072 sc1
    v_mfma_f32_16x16x32_bf16 v[232:235], v[96:99], a[216:219], v[232:235]
    v_mfma_f32_16x16x32_bf16 v[236:239], v[96:99], a[220:223], v[236:239]
    v_mfma_f32_16x16x32_bf16 v[236:239], v[92:95], a[204:207], v[236:239]
    v_mfma_f32_16x16x32_bf16 v[236:239], v[108:111], a[236:239], v[236:239]
    s_add_u32 s77, s73, 77824
    buffer_load_dwordx4 v[92:95], v7, s[36:39], s77 offen offset:0 sc1
    v_mfma_f32_16x16x32_bf16 v[236:239], v[112:115], a[252:255], v[236:239]
    v_mfma_f32_16x16x32_bf16 v[232:235], v[112:115], a[248:251], v[232:235]
    v_mfma_f32_16x16x32_bf16 v[232:235], v[108:111], a[232:235], v[232:235]
    v_mfma_f32_16x16x32_bf16 v[228:231], v[108:111], a[228:231], v[228:231]
    buffer_load_dwordx4 v[96:99], v7, s[36:39], s77 offen offset:1024 sc1
    v_mfma_f32_16x16x32_bf16 v[228:231], v[112:115], a[244:247], v[228:231]
    s_waitcnt vmcnt(10)
    v_bitop3_b32 v20, v28, v32, v36 bitop3:254
    v_mfma_f32_16x16x32_bf16 v[224:227], v[112:115], a[240:243], v[224:227]
    v_bitop3_b32 v20, v20, v40, -2 bitop3:254
    v_cmp_eq_u32 vcc, -1, v20
    v_mfma_f32_16x16x32_bf16 v[224:227], v[108:111], a[224:227], v[224:227]
    s_cbranch_vccnz cs_130
cb_131:
    s_nop 0
    v_mfma_f32_16x16x32_bf16 v[240:243], v[28:31], a[0:3], 0
    buffer_load_dwordx4 v[108:111], v7, s[36:39], s77 offen offset:2048 sc1
    v_mfma_f32_16x16x32_bf16 v[240:243], v[32:35], a[16:19], v[240:243]
    v_mfma_f32_16x16x32_bf16 v[244:247], v[32:35], a[20:23], 0
    v_mfma_f32_16x16x32_bf16 v[244:247], v[28:31], a[4:7], v[244:247]
    v_mfma_f32_16x16x32_bf16 v[248:251], v[28:31], a[8:11], 0
    buffer_load_dwordx4 v[112:115], v7, s[36:39], s77 offen offset:3072 sc1
    v_mfma_f32_16x16x32_bf16 v[248:251], v[32:35], a[24:27], v[248:251]
    ds_write_b128 v23, v[228:231] offset:0
    v_mfma_f32_16x16x32_bf16 v[252:255], v[32:35], a[28:31], 0
    v_mfma_f32_16x16x32_bf16 v[252:255], v[28:31], a[12:15], v[252:255]
    ds_write_b128 v24, v[232:235] offset:1024
    v_mfma_f32_16x16x32_bf16 v[252:255], v[36:39], a[44:47], v[252:255]
    s_add_u32 s77, s73, 131072
    buffer_load_dwordx4 v[28:31], v7, s[36:39], s77 offen offset:0 sc1
    v_mfma_f32_16x16x32_bf16 v[252:255], v[40:43], a[60:63], v[252:255]
    ds_write_b128 v25, v[236:239] offset:2048
    v_mfma_f32_16x16x32_bf16 v[248:251], v[40:43], a[56:59], v[248:251]
    v_add_f32 v116, v11, v224
    v_add_f32 v117, v11, v225
    v_mfma_f32_16x16x32_bf16 v[248:251], v[36:39], a[40:43], v[248:251]
    v_add_f32 v118, v11, v226
    v_add_f32 v119, v11, v227
    v_mfma_f32_16x16x32_bf16 v[244:247], v[36:39], a[36:39], v[244:247]
    buffer_load_dwordx4 v[32:35], v7, s[36:39], s77 offen offset:1024 sc1
    v_mfma_f32_16x16x32_bf16 v[244:247], v[40:43], a[52:55], v[244:247]
    s_waitcnt vmcnt(10)
    v_bitop3_b32 v20, v44, v64, v68 bitop3:254
    v_mfma_f32_16x16x32_bf16 v[240:243], v[40:43], a[48:51], v[240:243]
    v_bitop3_b32 v20, v20, v72, -2 bitop3:254
    v_cmp_eq_u32 vcc, -1, v20
    v_mfma_f32_16x16x32_bf16 v[240:243], v[36:39], a[32:35], v[240:243]
    s_cbranch_vccnz cs_132
cb_133:
    v_mfma_f32_16x16x32_bf16 v[240:243], v[44:47], a[64:67], v[240:243]
    buffer_load_dwordx4 v[36:39], v7, s[36:39], s77 offen offset:2048 sc1
    v_mfma_f32_16x16x32_bf16 v[240:243], v[64:67], a[80:83], v[240:243]
    s_waitcnt lgkmcnt(0)
    s_barrier
    s_nop 0
    v_mfma_f32_16x16x32_bf16 v[244:247], v[64:67], a[84:87], v[244:247]
    ds_read_b128 v[120:123], v26 offset:0
    v_mfma_f32_16x16x32_bf16 v[244:247], v[44:47], a[68:71], v[244:247]
    ds_read_b128 v[124:127], v26 offset:1024
    v_mfma_f32_16x16x32_bf16 v[248:251], v[44:47], a[72:75], v[248:251]
    buffer_load_dwordx4 v[40:43], v7, s[36:39], s77 offen offset:3072 sc1
    v_mfma_f32_16x16x32_bf16 v[248:251], v[64:67], a[88:91], v[248:251]
    ds_read_b128 v[128:131], v26 offset:2048
    v_mfma_f32_16x16x32_bf16 v[252:255], v[64:67], a[92:95], v[252:255]
    v_mfma_f32_16x16x32_bf16 v[252:255], v[44:47], a[76:79], v[252:255]
    v_mfma_f32_16x16x32_bf16 v[252:255], v[68:71], a[108:111], v[252:255]
    s_add_u32 s77, s73, 135168
    buffer_load_dwordx4 v[44:47], v7, s[36:39], s77 offen offset:0 sc1
    v_mfma_f32_16x16x32_bf16 v[252:255], v[72:75], a[124:127], v[252:255]
    v_mfma_f32_16x16x32_bf16 v[248:251], v[72:75], a[120:123], v[248:251]
    v_mfma_f32_16x16x32_bf16 v[248:251], v[68:71], a[104:107], v[248:251]
    v_mfma_f32_16x16x32_bf16 v[244:247], v[68:71], a[100:103], v[244:247]
    buffer_load_dwordx4 v[64:67], v7, s[36:39], s77 offen offset:1024 sc1
    v_mfma_f32_16x16x32_bf16 v[244:247], v[72:75], a[116:119], v[244:247]
    s_waitcnt vmcnt(10)
    v_bitop3_b32 v20, v76, v80, v84 bitop3:254
    v_mfma_f32_16x16x32_bf16 v[240:243], v[72:75], a[112:115], v[240:243]
    v_bitop3_b32 v20, v20, v88, -2 bitop3:254
    v_cmp_eq_u32 vcc, -1, v20
    v_mfma_f32_16x16x32_bf16 v[240:243], v[68:71], a[96:99], v[240:243]
    s_cbranch_vccnz cs_134
cb_135:
    v_mfma_f32_16x16x32_bf16 v[240:243], v[76:79], a[128:131], v[240:243]
    buffer_load_dwordx4 v[68:71], v7, s[36:39], s77 offen offset:2048 sc1
    v_mfma_f32_16x16x32_bf16 v[240:243], v[80:83], a[144:147], v[240:243]
    s_waitcnt lgkmcnt(2)
    v_add_f32 v116, v116, v120
    v_add_f32 v117, v117, v121
    v_mfma_f32_16x16x32_bf16 v[244:247], v[80:83], a[148:151], v[244:247]
    v_add_f32 v118, v118, v122
    v_add_f32 v119, v119, v123
    v_mfma_f32_16x16x32_bf16 v[244:247], v[76:79], a[132:135], v[244:247]
    s_waitcnt lgkmcnt(0)
    v_add_f32 v124, v124, v128
    v_add_f32_e64 v125, v125, v129
    v_mfma_f32_16x16x32_bf16 v[248:251], v[76:79], a[136:139], v[248:251]
    buffer_load_dwordx4 v[72:75], v7, s[36:39], s77 offen offset:3072 sc1
    v_mfma_f32_16x16x32_bf16 v[248:251], v[80:83], a[152:155], v[248:251]
    v_add_f32 v126, v126, v130
    v_add_f32 v127, v127, v131
    v_mfma_f32_16x16x32_bf16 v[252:255], v[80:83], a[156:159], v[252:255]
    v_add_f32 v116, v116, v124
    v_add_f32 v117, v117, v125
    v_mfma_f32_16x16x32_bf16 v[252:255], v[76:79], a[140:143], v[252:255]
    v_add_f32 v118, v118, v126
    v_add_f32 v119, v119, v127
    v_mfma_f32_16x16x32_bf16 v[252:255], v[84:87], a[172:175], v[252:255]
    s_add_u32 s77, s73, 139264
    buffer_load_dwordx4 v[76:79], v7, s[36:39], s77 offen offset:0 sc1
    v_mfma_f32_16x16x32_bf16 v[252:255], v[88:91], a[188:191], v[252:255]
    v_mul_f32 v116, v116, v144
    v_mul_f32 v117, v117, v145
    v_mfma_f32_16x16x32_bf16 v[248:251], v[88:91], a[184:187], v[248:251]
    v_mul_f32 v118, v118, v146
    v_mul_f32 v119, v119, v147
    v_mfma_f32_16x16x32_bf16 v[248:251], v[84:87], a[168:171], v[248:251]
    v_cvt_pk_bf16_f32 v132, v116, v117
    v_cvt_pk_bf16_f32 v133, v118, v119
    v_mfma_f32_16x16x32_bf16 v[244:247], v[84:87], a[164:167], v[244:247]
    buffer_load_dwordx4 v[80:83], v7, s[36:39], s77 offen offset:1024 sc1
    v_mfma_f32_16x16x32_bf16 v[244:247], v[88:91], a[180:183], v[244:247]
    s_waitcnt vmcnt(10)
    v_bitop3_b32 v20, v92, v96, v108 bitop3:254
    v_mfma_f32_16x16x32_bf16 v[240:243], v[88:91], a[176:179], v[240:243]
    v_bitop3_b32 v20, v20, v112, -2 bitop3:254
    v_cmp_eq_u32 vcc, -1, v20
    v_mfma_f32_16x16x32_bf16 v[240:243], v[84:87], a[160:163], v[240:243]
    s_cbranch_vccnz cs_136
cb_137:
    s_nop 0
    v_mfma_f32_16x16x32_bf16 v[240:243], v[92:95], a[192:195], v[240:243]
    buffer_load_dwordx4 v[84:87], v7, s[36:39], s77 offen offset:2048 sc1
    v_mfma_f32_16x16x32_bf16 v[240:243], v[96:99], a[208:211], v[240:243]
    v_mfma_f32_16x16x32_bf16 v[244:247], v[96:99], a[212:215], v[244:247]
    v_mfma_f32_16x16x32_bf16 v[244:247], v[92:95], a[196:199], v[244:247]
    v_mfma_f32_16x16x32_bf16 v[248:251], v[92:95], a[200:203], v[248:251]
    buffer_load_dwordx4 v[88:91], v7, s[36:39], s77 offen offset:3072 sc1
    v_mfma_f32_16x16x32_bf16 v[248:251], v[96:99], a[216:219], v[248:251]
    v_mfma_f32_16x16x32_bf16 v[252:255], v[96:99], a[220:223], v[252:255]
    v_mfma_f32_16x16x32_bf16 v[252:255], v[92:95], a[204:207], v[252:255]
    v_mfma_f32_16x16x32_bf16 v[252:255], v[108:111], a[236:239], v[252:255]
    s_add_u32 s77, s73, 143360
    buffer_load_dwordx4 v[92:95], v7, s[36:39], s77 offen offset:0 sc1
    v_mfma_f32_16x16x32_bf16 v[252:255], v[112:115], a[252:255], v[252:255]
    v_mfma_f32_16x16x32_bf16 v[248:251], v[112:115], a[248:251], v[248:251]
    v_mfma_f32_16x16x32_bf16 v[248:251], v[108:111], a[232:235], v[248:251]
    v_mfma_f32_16x16x32_bf16 v[244:247], v[108:111], a[228:231], v[244:247]
    buffer_load_dwordx4 v[96:99], v7, s[36:39], s77 offen offset:1024 sc1
    v_mfma_f32_16x16x32_bf16 v[244:247], v[112:115], a[244:247], v[244:247]
    s_waitcnt vmcnt(10)
    v_bitop3_b32 v20, v28, v32, v36 bitop3:254
    v_mfma_f32_16x16x32_bf16 v[240:243], v[112:115], a[240:243], v[240:243]
    v_bitop3_b32 v20, v20, v40, -2 bitop3:254
    v_cmp_eq_u32 vcc, -1, v20
    v_mfma_f32_16x16x32_bf16 v[240:243], v[108:111], a[224:227], v[240:243]
    s_cbranch_vccnz cs_138
cb_139:
    s_nop 0
    v_mfma_f32_16x16x32_bf16 v[224:227], v[28:31], a[0:3], 0
    buffer_load_dwordx4 v[108:111], v7, s[36:39], s77 offen offset:2048 sc1
    v_mfma_f32_16x16x32_bf16 v[224:227], v[32:35], a[16:19], v[224:227]
    v_mfma_f32_16x16x32_bf16 v[228:231], v[32:35], a[20:23], 0
    v_mfma_f32_16x16x32_bf16 v[228:231], v[28:31], a[4:7], v[228:231]
    v_mfma_f32_16x16x32_bf16 v[232:235], v[28:31], a[8:11], 0
    buffer_load_dwordx4 v[112:115], v7, s[36:39], s77 offen offset:3072 sc1
    v_mfma_f32_16x16x32_bf16 v[232:235], v[32:35], a[24:27], v[232:235]
    ds_write_b128 v23, v[244:247] offset:16384
    v_mfma_f32_16x16x32_bf16 v[236:239], v[32:35], a[28:31], 0
    v_mfma_f32_16x16x32_bf16 v[236:239], v[28:31], a[12:15], v[236:239]
    ds_write_b128 v24, v[248:251] offset:17408
    v_mfma_f32_16x16x32_bf16 v[236:239], v[36:39], a[44:47], v[236:239]
    s_add_u32 s77, s73, 196608
    buffer_load_dwordx4 v[28:31], v7, s[36:39], s77 offen offset:0 sc1
    v_mfma_f32_16x16x32_bf16 v[236:239], v[40:43], a[60:63], v[236:239]
    ds_write_b128 v25, v[252:255] offset:18432
    v_mfma_f32_16x16x32_bf16 v[232:235], v[40:43], a[56:59], v[232:235]
    v_add_f32 v116, v11, v240
    v_add_f32 v117, v11, v241
    v_mfma_f32_16x16x32_bf16 v[232:235], v[36:39], a[40:43], v[232:235]
    v_add_f32 v118, v11, v242
    v_add_f32 v119, v11, v243
    v_mfma_f32_16x16x32_bf16 v[228:231], v[36:39], a[36:39], v[228:231]
    buffer_load_dwordx4 v[32:35], v7, s[36:39], s77 offen offset:1024 sc1
    v_mfma_f32_16x16x32_bf16 v[228:231], v[40:43], a[52:55], v[228:231]
    s_waitcnt vmcnt(10)
    v_bitop3_b32 v20, v44, v64, v68 bitop3:254
    v_mfma_f32_16x16x32_bf16 v[224:227], v[40:43], a[48:51], v[224:227]
    v_bitop3_b32 v20, v20, v72, -2 bitop3:254
    v_cmp_eq_u32 vcc, -1, v20
    v_mfma_f32_16x16x32_bf16 v[224:227], v[36:39], a[32:35], v[224:227]
    s_cbranch_vccnz cs_140
cb_141:
    v_mfma_f32_16x16x32_bf16 v[224:227], v[44:47], a[64:67], v[224:227]
    buffer_load_dwordx4 v[36:39], v7, s[36:39], s77 offen offset:2048 sc1
    v_mfma_f32_16x16x32_bf16 v[224:227], v[64:67], a[80:83], v[224:227]
    s_waitcnt lgkmcnt(0)
    s_barrier
    s_nop 0
    v_mfma_f32_16x16x32_bf16 v[228:231], v[64:67], a[84:87], v[228:231]
    ds_read_b128 v[120:123], v26 offset:16384
    v_mfma_f32_16x16x32_bf16 v[228:231], v[44:47], a[68:71], v[228:231]
    ds_read_b128 v[124:127], v26 offset:17408
    v_mfma_f32_16x16x32_bf16 v[232:235], v[44:47], a[72:75], v[232:235]
    buffer_load_dwordx4 v[40:43], v7, s[36:39], s77 offen offset:3072 sc1
    v_mfma_f32_16x16x32_bf16 v[232:235], v[64:67], a[88:91], v[232:235]
    ds_read_b128 v[128:131], v26 offset:18432
    v_mfma_f32_16x16x32_bf16 v[236:239], v[64:67], a[92:95], v[236:239]
    v_mfma_f32_16x16x32_bf16 v[236:239], v[44:47], a[76:79], v[236:239]
    v_mfma_f32_16x16x32_bf16 v[236:239], v[68:71], a[108:111], v[236:239]
    s_add_u32 s77, s73, 200704
    buffer_load_dwordx4 v[44:47], v7, s[36:39], s77 offen offset:0 sc1
    v_mfma_f32_16x16x32_bf16 v[236:239], v[72:75], a[124:127], v[236:239]
    v_mfma_f32_16x16x32_bf16 v[232:235], v[72:75], a[120:123], v[232:235]
    v_mfma_f32_16x16x32_bf16 v[232:235], v[68:71], a[104:107], v[232:235]
    v_mfma_f32_16x16x32_bf16 v[228:231], v[68:71], a[100:103], v[228:231]
    buffer_load_dwordx4 v[64:67], v7, s[36:39], s77 offen offset:1024 sc1
    v_mfma_f32_16x16x32_bf16 v[228:231], v[72:75], a[116:119], v[228:231]
    s_waitcnt vmcnt(10)
    v_bitop3_b32 v20, v76, v80, v84 bitop3:254
    v_mfma_f32_16x16x32_bf16 v[224:227], v[72:75], a[112:115], v[224:227]
    v_bitop3_b32 v20, v20, v88, -2 bitop3:254
    v_cmp_eq_u32 vcc, -1, v20
    v_mfma_f32_16x16x32_bf16 v[224:227], v[68:71], a[96:99], v[224:227]
    s_cbranch_vccnz cs_142
cb_143:
    v_mfma_f32_16x16x32_bf16 v[224:227], v[76:79], a[128:131], v[224:227]
    buffer_load_dwordx4 v[68:71], v7, s[36:39], s77 offen offset:2048 sc1
    v_mfma_f32_16x16x32_bf16 v[224:227], v[80:83], a[144:147], v[224:227]
    s_waitcnt lgkmcnt(2)
    v_add_f32 v116, v116, v120
    v_add_f32 v117, v117, v121
    v_mfma_f32_16x16x32_bf16 v[228:231], v[80:83], a[148:151], v[228:231]
    v_add_f32 v118, v118, v122
    v_add_f32 v119, v119, v123
    v_mfma_f32_16x16x32_bf16 v[228:231], v[76:79], a[132:135], v[228:231]
    s_waitcnt lgkmcnt(0)
    v_add_f32 v124, v124, v128
    v_add_f32_e64 v125, v125, v129
    v_mfma_f32_16x16x32_bf16 v[232:235], v[76:79], a[136:139], v[232:235]
    buffer_load_dwordx4 v[72:75], v7, s[36:39], s77 offen offset:3072 sc1
    v_mfma_f32_16x16x32_bf16 v[232:235], v[80:83], a[152:155], v[232:235]
    v_add_f32 v126, v126, v130
    v_add_f32 v127, v127, v131
    v_mfma_f32_16x16x32_bf16 v[236:239], v[80:83], a[156:159], v[236:239]
    v_add_f32 v116, v116, v124
    v_add_f32 v117, v117, v125
    v_mfma_f32_16x16x32_bf16 v[236:239], v[76:79], a[140:143], v[236:239]
    v_add_f32 v118, v118, v126
    v_add_f32 v119, v119, v127
    v_mfma_f32_16x16x32_bf16 v[236:239], v[84:87], a[172:175], v[236:239]
    s_add_u32 s77, s73, 204800
    buffer_load_dwordx4 v[76:79], v7, s[36:39], s77 offen offset:0 sc1
    v_mfma_f32_16x16x32_bf16 v[236:239], v[88:91], a[188:191], v[236:239]
    v_mul_f32 v116, v116, v148
    v_mul_f32 v117, v117, v149
    v_mfma_f32_16x16x32_bf16 v[232:235], v[88:91], a[184:187], v[232:235]
    v_mul_f32 v118, v118, v150
    v_mul_f32 v119, v119, v151
    v_mfma_f32_16x16x32_bf16 v[232:235], v[84:87], a[168:171], v[232:235]
    v_cvt_pk_bf16_f32 v134, v116, v117
    v_cvt_pk_bf16_f32 v135, v118, v119
    v_mfma_f32_16x16x32_bf16 v[228:231], v[84:87], a[164:167], v[228:231]
    buffer_load_dwordx4 v[80:83], v7, s[36:39], s77 offen offset:1024 sc1
    v_mfma_f32_16x16x32_bf16 v[228:231], v[88:91], a[180:183], v[228:231]
    s_waitcnt vmcnt(10)
    v_bitop3_b32 v20, v92, v96, v108 bitop3:254
    v_mfma_f32_16x16x32_bf16 v[224:227], v[88:91], a[176:179], v[224:227]
    v_bitop3_b32 v20, v20, v112, -2 bitop3:254
    v_cmp_eq_u32 vcc, -1, v20
    v_mfma_f32_16x16x32_bf16 v[224:227], v[84:87], a[160:163], v[224:227]
    s_cbranch_vccnz cs_144
cb_145:
    v_mfma_f32_16x16x32_bf16 v[224:227], v[92:95], a[192:195], v[224:227]
    buffer_load_dwordx4 v[84:87], v7, s[36:39], s77 offen offset:2048 sc1
    v_mfma_f32_16x16x32_bf16 v[224:227], v[96:99], a[208:211], v[224:227]
    v_or_b32 v132, 1, v132
    s_add_u32 s78, s85, 25165824
    buffer_store_dwordx4 v[132:135], v7, s[36:39], s78 offen sc1
    v_mfma_f32_16x16x32_bf16 v[228:231], v[96:99], a[212:215], v[228:231]
    v_mfma_f32_16x16x32_bf16 v[228:231], v[92:95], a[196:199], v[228:231]
    v_mfma_f32_16x16x32_bf16 v[232:235], v[92:95], a[200:203], v[232:235]
    buffer_load_dwordx4 v[88:91], v7, s[36:39], s77 offen offset:3072 sc1
    v_mfma_f32_16x16x32_bf16 v[232:235], v[96:99], a[216:219], v[232:235]
    v_mfma_f32_16x16x32_bf16 v[236:239], v[96:99], a[220:223], v[236:239]
    v_mfma_f32_16x16x32_bf16 v[236:239], v[92:95], a[204:207], v[236:239]
    v_mfma_f32_16x16x32_bf16 v[236:239], v[108:111], a[236:239], v[236:239]
    s_add_u32 s77, s73, 208896
    buffer_load_dwordx4 v[92:95], v7, s[36:39], s77 offen offset:0 sc1
    v_mfma_f32_16x16x32_bf16 v[236:239], v[112:115], a[252:255], v[236:239]
    v_mfma_f32_16x16x32_bf16 v[232:235], v[112:115], a[248:251], v[232:235]
    v_mfma_f32_16x16x32_bf16 v[232:235], v[108:111], a[232:235], v[232:235]
    v_mfma_f32_16x16x32_bf16 v[228:231], v[108:111], a[228:231], v[228:231]
    buffer_load_dwordx4 v[96:99], v7, s[36:39], s77 offen offset:1024 sc1
    v_mfma_f32_16x16x32_bf16 v[228:231], v[112:115], a[244:247], v[228:231]
    s_waitcnt vmcnt(11)
    v_bitop3_b32 v20, v28, v32, v36 bitop3:254
    v_mfma_f32_16x16x32_bf16 v[224:227], v[112:115], a[240:243], v[224:227]
    v_bitop3_b32 v20, v20, v40, -2 bitop3:254
    v_cmp_eq_u32 vcc, -1, v20
    v_mfma_f32_16x16x32_bf16 v[224:227], v[108:111], a[224:227], v[224:227]
    s_cbranch_vccnz cs_146
cb_147:
    s_nop 0
    v_mfma_f32_16x16x32_bf16 v[240:243], v[28:31], a[0:3], 0
    buffer_load_dwordx4 v[108:111], v7, s[36:39], s77 offen offset:2048 sc1
    v_mfma_f32_16x16x32_bf16 v[240:243], v[32:35], a[16:19], v[240:243]
    v_mfma_f32_16x16x32_bf16 v[244:247], v[32:35], a[20:23], 0
    v_mfma_f32_16x16x32_bf16 v[244:247], v[28:31], a[4:7], v[244:247]
    v_mfma_f32_16x16x32_bf16 v[248:251], v[28:31], a[8:11], 0
    buffer_load_dwordx4 v[112:115], v7, s[36:39], s77 offen offset:3072 sc1
    v_mfma_f32_16x16x32_bf16 v[248:251], v[32:35], a[24:27], v[248:251]
    ds_write_b128 v23, v[228:231] offset:0
    v_mfma_f32_16x16x32_bf16 v[252:255], v[32:35], a[28:31], 0
    v_mfma_f32_16x16x32_bf16 v[252:255], v[28:31], a[12:15], v[252:255]
    ds_write_b128 v24, v[232:235] offset:1024
    v_mfma_f32_16x16x32_bf16 v[252:255], v[36:39], a[44:47], v[252:255]
    s_add_u32 s77, s73, 262144
    buffer_load_dwordx4 v[28:31], v7, s[36:39], s77 offen offset:0 sc1
    v_mfma_f32_16x16x32_bf16 v[252:255], v[40:43], a[60:63], v[252:255]
    ds_write_b128 v25, v[236:239] offset:2048
    v_mfma_f32_16x16x32_bf16 v[248:251], v[40:43], a[56:59], v[248:251]
    v_add_f32 v116, v11, v224
    v_add_f32 v117, v11, v225
    v_mfma_f32_16x16x32_bf16 v[248:251], v[36:39], a[40:43], v[248:251]
    v_add_f32 v118, v11, v226
    v_add_f32 v119, v11, v227
    v_mfma_f32_16x16x32_bf16 v[244:247], v[36:39], a[36:39], v[244:247]
    buffer_load_dwordx4 v[32:35], v7, s[36:39], s77 offen offset:1024 sc1
    v_mfma_f32_16x16x32_bf16 v[244:247], v[40:43], a[52:55], v[244:247]
    s_waitcnt vmcnt(11)
    v_bitop3_b32 v20, v44, v64, v68 bitop3:254
    v_mfma_f32_16x16x32_bf16 v[240:243], v[40:43], a[48:51], v[240:243]
    v_bitop3_b32 v20, v20, v72, -2 bitop3:254
    v_cmp_eq_u32 vcc, -1, v20
L_pad_7653:
    s_cbranch_execz L_ret_3
    v_mfma_f32_16x16x32_bf16 v[240:243], v[36:39], a[32:35], v[240:243]
    s_cbranch_vccnz cs_148
cb_149:
    v_mfma_f32_16x16x32_bf16 v[240:243], v[44:47], a[64:67], v[240:243]
    buffer_load_dwordx4 v[36:39], v7, s[36:39], s77 offen offset:2048 sc1
    v_mfma_f32_16x16x32_bf16 v[240:243], v[64:67], a[80:83], v[240:243]
    s_waitcnt lgkmcnt(0)
    s_barrier
    v_mfma_f32_16x16x32_bf16 v[244:247], v[64:67], a[84:87], v[244:247]
    ds_read_b128 v[120:123], v26 offset:0
    v_mfma_f32_16x16x32_bf16 v[244:247], v[44:47], a[68:71], v[244:247]
    ds_read_b128 v[124:127], v26 offset:1024
    v_mfma_f32_16x16x32_bf16 v[248:251], v[44:47], a[72:75], v[248:251]
    buffer_load_dwordx4 v[40:43], v7, s[36:39], s77 offen offset:3072 sc1
    v_mfma_f32_16x16x32_bf16 v[248:251], v[64:67], a[88:91], v[248:251]
    ds_read_b128 v[128:131], v26 offset:2048
    v_mfma_f32_16x16x32_bf16 v[252:255], v[64:67], a[92:95], v[252:255]
    v_mfma_f32_16x16x32_bf16 v[252:255], v[44:47], a[76:79], v[252:255]
    v_mfma_f32_16x16x32_bf16 v[252:255], v[68:71], a[108:111], v[252:255]
    s_add_u32 s77, s73, 266240
    buffer_load_dwordx4 v[44:47], v7, s[36:39], s77 offen offset:0 sc1
    v_mfma_f32_16x16x32_bf16 v[252:255], v[72:75], a[124:127], v[252:255]
    v_mfma_f32_16x16x32_bf16 v[248:251], v[72:75], a[120:123], v[248:251]
    v_mfma_f32_16x16x32_bf16 v[248:251], v[68:71], a[104:107], v[248:251]
    v_mfma_f32_16x16x32_bf16 v[244:247], v[68:71], a[100:103], v[244:247]
    buffer_load_dwordx4 v[64:67], v7, s[36:39], s77 offen offset:1024 sc1
    v_mfma_f32_16x16x32_bf16 v[244:247], v[72:75], a[116:119], v[244:247]
    s_waitcnt vmcnt(10)
    v_bitop3_b32 v20, v76, v80, v84 bitop3:254
    v_mfma_f32_16x16x32_bf16 v[240:243], v[72:75], a[112:115], v[240:243]
    v_bitop3_b32 v20, v20, v88, -2 bitop3:254
    v_cmp_eq_u32 vcc, -1, v20
    v_mfma_f32_16x16x32_bf16 v[240:243], v[68:71], a[96:99], v[240:243]
    s_cbranch_vccnz cs_150
cb_151:
    v_mfma_f32_16x16x32_bf16 v[240:243], v[76:79], a[128:131], v[240:243]
    buffer_load_dwordx4 v[68:71], v7, s[36:39], s77 offen offset:2048 sc1
    v_mfma_f32_16x16x32_bf16 v[240:243], v[80:83], a[144:147], v[240:243]
    s_waitcnt lgkmcnt(2)
    v_add_f32 v116, v116, v120
    v_add_f32 v117, v117, v121
    v_mfma_f32_16x16x32_bf16 v[244:247], v[80:83], a[148:151], v[244:247]
    v_add_f32 v118, v118, v122
    v_add_f32 v119, v119, v123
    v_mfma_f32_16x16x32_bf16 v[244:247], v[76:79], a[132:135], v[244:247]
    s_waitcnt lgkmcnt(0)
    v_add_f32 v124, v124, v128
    v_add_f32_e64 v125, v125, v129
    v_mfma_f32_16x16x32_bf16 v[248:251], v[76:79], a[136:139], v[248:251]
    buffer_load_dwordx4 v[72:75], v7, s[36:39], s77 offen offset:3072 sc1
    v_mfma_f32_16x16x32_bf16 v[248:251], v[80:83], a[152:155], v[248:251]
    v_add_f32 v126, v126, v130
    v_add_f32 v127, v127, v131
    v_mfma_f32_16x16x32_bf16 v[252:255], v[80:83], a[156:159], v[252:255]
    v_add_f32 v116, v116, v124
    v_add_f32 v117, v117, v125
    v_mfma_f32_16x16x32_bf16 v[252:255], v[76:79], a[140:143], v[252:255]
    v_add_f32 v118, v118, v126
    v_add_f32 v119, v119, v127
    v_mfma_f32_16x16x32_bf16 v[252:255], v[84:87], a[172:175], v[252:255]
    s_add_u32 s77, s73, 270336
    buffer_load_dwordx4 v[76:79], v7, s[36:39], s77 offen offset:0 sc1
    v_mfma_f32_16x16x32_bf16 v[252:255], v[88:91], a[188:191], v[252:255]
    v_mul_f32 v116, v116, v152
    v_mul_f32 v117, v117, v153
    v_mfma_f32_16x16x32_bf16 v[248:251], v[88:91], a[184:187], v[248:251]
    v_mul_f32 v118, v118, v154
    v_mul_f32 v119, v119, v155
    v_mfma_f32_16x16x32_bf16 v[248:251], v[84:87], a[168:171], v[248:251]
    v_cvt_pk_bf16_f32 v136, v116, v117
    v_cvt_pk_bf16_f32 v137, v118, v119
    v_mfma_f32_16x16x32_bf16 v[244:247], v[84:87], a[164:167], v[244:247]
    buffer_load_dwordx4 v[80:83], v7, s[36:39], s77 offen offset:1024 sc1
    v_mfma_f32_16x16x32_bf16 v[244:247], v[88:91], a[180:183], v[244:247]
    s_waitcnt vmcnt(10)
    v_bitop3_b32 v20, v92, v96, v108 bitop3:254
    v_mfma_f32_16x16x32_bf16 v[240:243], v[88:91], a[176:179], v[240:243]
    v_bitop3_b32 v20, v20, v112, -2 bitop3:254
    v_cmp_eq_u32 vcc, -1, v20
    v_mfma_f32_16x16x32_bf16 v[240:243], v[84:87], a[160:163], v[240:243]
    s_cbranch_vccnz cs_152
cb_153:
    s_nop 0
    v_mfma_f32_16x16x32_bf16 v[240:243], v[92:95], a[192:195], v[240:243]
    buffer_load_dwordx4 v[84:87], v7, s[36:39], s77 offen offset:2048 sc1
    v_mfma_f32_16x16x32_bf16 v[240:243], v[96:99], a[208:211], v[240:243]
    v_mfma_f32_16x16x32_bf16 v[244:247], v[96:99], a[212:215], v[244:247]
    v_mfma_f32_16x16x32_bf16 v[244:247], v[92:95], a[196:199], v[244:247]
    v_mfma_f32_16x16x32_bf16 v[248:251], v[92:95], a[200:203], v[248:251]
    buffer_load_dwordx4 v[88:91], v7, s[36:39], s77 offen offset:3072 sc1
    v_mfma_f32_16x16x32_bf16 v[248:251], v[96:99], a[216:219], v[248:251]
    v_mfma_f32_16x16x32_bf16 v[252:255], v[96:99], a[220:223], v[252:255]
    v_mfma_f32_16x16x32_bf16 v[252:255], v[92:95], a[204:207], v[252:255]
    v_mfma_f32_16x16x32_bf16 v[252:255], v[108:111], a[236:239], v[252:255]
    s_add_u32 s77, s73, 274432
    buffer_load_dwordx4 v[92:95], v7, s[36:39], s77 offen offset:0 sc1
    v_mfma_f32_16x16x32_bf16 v[252:255], v[112:115], a[252:255], v[252:255]
    v_mfma_f32_16x16x32_bf16 v[248:251], v[112:115], a[248:251], v[248:251]
    v_mfma_f32_16x16x32_bf16 v[248:251], v[108:111], a[232:235], v[248:251]
    v_mfma_f32_16x16x32_bf16 v[244:247], v[108:111], a[228:231], v[244:247]
    buffer_load_dwordx4 v[96:99], v7, s[36:39], s77 offen offset:1024 sc1
    v_mfma_f32_16x16x32_bf16 v[244:247], v[112:115], a[244:247], v[244:247]
    s_waitcnt vmcnt(10)
    v_bitop3_b32 v20, v28, v32, v36 bitop3:254
    v_mfma_f32_16x16x32_bf16 v[240:243], v[112:115], a[240:243], v[240:243]
    v_bitop3_b32 v20, v20, v40, -2 bitop3:254
    v_cmp_eq_u32 vcc, -1, v20
    v_mfma_f32_16x16x32_bf16 v[240:243], v[108:111], a[224:227], v[240:243]
    s_cbranch_vccnz cs_154
cb_155:
    s_nop 0
    v_mfma_f32_16x16x32_bf16 v[224:227], v[28:31], a[0:3], 0
    buffer_load_dwordx4 v[108:111], v7, s[36:39], s77 offen offset:2048 sc1
    v_mfma_f32_16x16x32_bf16 v[224:227], v[32:35], a[16:19], v[224:227]
    v_mfma_f32_16x16x32_bf16 v[228:231], v[32:35], a[20:23], 0
    v_mfma_f32_16x16x32_bf16 v[228:231], v[28:31], a[4:7], v[228:231]
    v_mfma_f32_16x16x32_bf16 v[232:235], v[28:31], a[8:11], 0
    buffer_load_dwordx4 v[112:115], v7, s[36:39], s77 offen offset:3072 sc1
    v_mfma_f32_16x16x32_bf16 v[232:235], v[32:35], a[24:27], v[232:235]
    ds_write_b128 v23, v[244:247] offset:16384
    v_mfma_f32_16x16x32_bf16 v[236:239], v[32:35], a[28:31], 0
    v_mfma_f32_16x16x32_bf16 v[236:239], v[28:31], a[12:15], v[236:239]
    ds_write_b128 v24, v[248:251] offset:17408
    v_mfma_f32_16x16x32_bf16 v[236:239], v[36:39], a[44:47], v[236:239]
    s_add_u32 s77, s73, 327680
    buffer_load_dwordx4 v[28:31], v7, s[36:39], s77 offen offset:0 sc1
    v_mfma_f32_16x16x32_bf16 v[236:239], v[40:43], a[60:63], v[236:239]
    ds_write_b128 v25, v[252:255] offset:18432
    v_mfma_f32_16x16x32_bf16 v[232:235], v[40:43], a[56:59], v[232:235]
    v_add_f32 v116, v11, v240
    v_add_f32 v117, v11, v241
    v_mfma_f32_16x16x32_bf16 v[232:235], v[36:39], a[40:43], v[232:235]
    v_add_f32 v118, v11, v242
    v_add_f32 v119, v11, v243
    v_mfma_f32_16x16x32_bf16 v[228:231], v[36:39], a[36:39], v[228:231]
    buffer_load_dwordx4 v[32:35], v7, s[36:39], s77 offen offset:1024 sc1
    v_mfma_f32_16x16x32_bf16 v[228:231], v[40:43], a[52:55], v[228:231]
    s_waitcnt vmcnt(10)
    v_bitop3_b32 v20, v44, v64, v68 bitop3:254
    v_mfma_f32_16x16x32_bf16 v[224:227], v[40:43], a[48:51], v[224:227]
    v_bitop3_b32 v20, v20, v72, -2 bitop3:254
    v_cmp_eq_u32 vcc, -1, v20
    v_mfma_f32_16x16x32_bf16 v[224:227], v[36:39], a[32:35], v[224:227]
    s_cbranch_vccnz cs_156
cb_157:
    v_mfma_f32_16x16x32_bf16 v[224:227], v[44:47], a[64:67], v[224:227]
    buffer_load_dwordx4 v[36:39], v7, s[36:39], s77 offen offset:2048 sc1
    v_mfma_f32_16x16x32_bf16 v[224:227], v[64:67], a[80:83], v[224:227]
    s_waitcnt lgkmcnt(0)
    s_barrier
    s_nop 0
    v_mfma_f32_16x16x32_bf16 v[228:231], v[64:67], a[84:87], v[228:231]
    ds_read_b128 v[120:123], v26 offset:16384
    v_mfma_f32_16x16x32_bf16 v[228:231], v[44:47], a[68:71], v[228:231]
    ds_read_b128 v[124:127], v26 offset:17408
    v_mfma_f32_16x16x32_bf16 v[232:235], v[44:47], a[72:75], v[232:235]
    buffer_load_dwordx4 v[40:43], v7, s[36:39], s77 offen offset:3072 sc1
    v_mfma_f32_16x16x32_bf16 v[232:235], v[64:67], a[88:91], v[232:235]
    ds_read_b128 v[128:131], v26 offset:18432
    v_mfma_f32_16x16x32_bf16 v[236:239], v[64:67], a[92:95], v[236:239]
    v_mfma_f32_16x16x32_bf16 v[236:239], v[44:47], a[76:79], v[236:239]
    v_mfma_f32_16x16x32_bf16 v[236:239], v[68:71], a[108:111], v[236:239]
    s_add_u32 s77, s73, 331776
    buffer_load_dwordx4 v[44:47], v7, s[36:39], s77 offen offset:0 sc1
    v_mfma_f32_16x16x32_bf16 v[236:239], v[72:75], a[124:127], v[236:239]
    v_mfma_f32_16x16x32_bf16 v[232:235], v[72:75], a[120:123], v[232:235]
    v_mfma_f32_16x16x32_bf16 v[232:235], v[68:71], a[104:107], v[232:235]
    v_mfma_f32_16x16x32_bf16 v[228:231], v[68:71], a[100:103], v[228:231]
    buffer_load_dwordx4 v[64:67], v7, s[36:39], s77 offen offset:1024 sc1
    v_mfma_f32_16x16x32_bf16 v[228:231], v[72:75], a[116:119], v[228:231]
    s_waitcnt vmcnt(10)
    v_bitop3_b32 v20, v76, v80, v84 bitop3:254
    v_mfma_f32_16x16x32_bf16 v[224:227], v[72:75], a[112:115], v[224:227]
    v_bitop3_b32 v20, v20, v88, -2 bitop3:254
    v_cmp_eq_u32 vcc, -1, v20
    v_mfma_f32_16x16x32_bf16 v[224:227], v[68:71], a[96:99], v[224:227]
    s_cbranch_vccnz cs_158
cb_159:
    v_mfma_f32_16x16x32_bf16 v[224:227], v[76:79], a[128:131], v[224:227]
    buffer_load_dwordx4 v[68:71], v7, s[36:39], s77 offen offset:2048 sc1
    v_mfma_f32_16x16x32_bf16 v[224:227], v[80:83], a[144:147], v[224:227]
    s_waitcnt lgkmcnt(2)
    v_add_f32 v116, v116, v120
    v_add_f32 v117, v117, v121
    v_mfma_f32_16x16x32_bf16 v[228:231], v[80:83], a[148:151], v[228:231]
    v_add_f32 v118, v118, v122
    v_add_f32 v119, v119, v123
    v_mfma_f32_16x16x32_bf16 v[228:231], v[76:79], a[132:135], v[228:231]
    s_waitcnt lgkmcnt(0)
    v_add_f32 v124, v124, v128
    v_add_f32_e64 v125, v125, v129
    v_mfma_f32_16x16x32_bf16 v[232:235], v[76:79], a[136:139], v[232:235]
    buffer_load_dwordx4 v[72:75], v7, s[36:39], s77 offen offset:3072 sc1
    v_mfma_f32_16x16x32_bf16 v[232:235], v[80:83], a[152:155], v[232:235]
    v_add_f32 v126, v126, v130
    v_add_f32 v127, v127, v131
    v_mfma_f32_16x16x32_bf16 v[236:239], v[80:83], a[156:159], v[236:239]
    v_add_f32 v116, v116, v124
    v_add_f32 v117, v117, v125
    v_mfma_f32_16x16x32_bf16 v[236:239], v[76:79], a[140:143], v[236:239]
    v_add_f32 v118, v118, v126
    v_add_f32 v119, v119, v127
    v_mfma_f32_16x16x32_bf16 v[236:239], v[84:87], a[172:175], v[236:239]
    s_add_u32 s77, s73, 335872
    buffer_load_dwordx4 v[76:79], v7, s[36:39], s77 offen offset:0 sc1
    v_mfma_f32_16x16x32_bf16 v[236:239], v[88:91], a[188:191], v[236:239]
    v_mul_f32 v116, v116, v156
    v_mul_f32 v117, v117, v157
    v_mfma_f32_16x16x32_bf16 v[232:235], v[88:91], a[184:187], v[232:235]
    v_mul_f32 v118, v118, v158
    v_mul_f32 v119, v119, v159
    v_mfma_f32_16x16x32_bf16 v[232:235], v[84:87], a[168:171], v[232:235]
    v_cvt_pk_bf16_f32 v138, v116, v117
    v_cvt_pk_bf16_f32 v139, v118, v119
    v_mfma_f32_16x16x32_bf16 v[228:231], v[84:87], a[164:167], v[228:231]
    buffer_load_dwordx4 v[80:83], v7, s[36:39], s77 offen offset:1024 sc1
    v_mfma_f32_16x16x32_bf16 v[228:231], v[88:91], a[180:183], v[228:231]
    s_waitcnt vmcnt(10)
    v_bitop3_b32 v20, v92, v96, v108 bitop3:254
    v_mfma_f32_16x16x32_bf16 v[224:227], v[88:91], a[176:179], v[224:227]
    v_bitop3_b32 v20, v20, v112, -2 bitop3:254
    v_cmp_eq_u32 vcc, -1, v20
    v_mfma_f32_16x16x32_bf16 v[224:227], v[84:87], a[160:163], v[224:227]
    s_cbranch_vccnz cs_160
cb_161:
    v_mfma_f32_16x16x32_bf16 v[224:227], v[92:95], a[192:195], v[224:227]
    buffer_load_dwordx4 v[84:87], v7, s[36:39], s77 offen offset:2048 sc1
    v_mfma_f32_16x16x32_bf16 v[224:227], v[96:99], a[208:211], v[224:227]
    v_or_b32 v136, 1, v136
    s_add_u32 s78, s85, 25174016
    buffer_store_dwordx4 v[136:139], v7, s[36:39], s78 offen sc1
    v_mfma_f32_16x16x32_bf16 v[228:231], v[96:99], a[212:215], v[228:231]
    v_mfma_f32_16x16x32_bf16 v[228:231], v[92:95], a[196:199], v[228:231]
    v_mfma_f32_16x16x32_bf16 v[232:235], v[92:95], a[200:203], v[232:235]
    buffer_load_dwordx4 v[88:91], v7, s[36:39], s77 offen offset:3072 sc1
    v_mfma_f32_16x16x32_bf16 v[232:235], v[96:99], a[216:219], v[232:235]
    v_mfma_f32_16x16x32_bf16 v[236:239], v[96:99], a[220:223], v[236:239]
    v_mfma_f32_16x16x32_bf16 v[236:239], v[92:95], a[204:207], v[236:239]
    v_mfma_f32_16x16x32_bf16 v[236:239], v[108:111], a[236:239], v[236:239]
    s_add_u32 s77, s73, 339968
    buffer_load_dwordx4 v[92:95], v7, s[36:39], s77 offen offset:0 sc1
    v_mfma_f32_16x16x32_bf16 v[236:239], v[112:115], a[252:255], v[236:239]
    v_mfma_f32_16x16x32_bf16 v[232:235], v[112:115], a[248:251], v[232:235]
    v_mfma_f32_16x16x32_bf16 v[232:235], v[108:111], a[232:235], v[232:235]
    v_mfma_f32_16x16x32_bf16 v[228:231], v[108:111], a[228:231], v[228:231]
    buffer_load_dwordx4 v[96:99], v7, s[36:39], s77 offen offset:1024 sc1
    v_mfma_f32_16x16x32_bf16 v[228:231], v[112:115], a[244:247], v[228:231]
    s_waitcnt vmcnt(11)
    v_bitop3_b32 v20, v28, v32, v36 bitop3:254
    v_mfma_f32_16x16x32_bf16 v[224:227], v[112:115], a[240:243], v[224:227]
    v_bitop3_b32 v20, v20, v40, -2 bitop3:254
    v_cmp_eq_u32 vcc, -1, v20
    v_mfma_f32_16x16x32_bf16 v[224:227], v[108:111], a[224:227], v[224:227]
    s_cbranch_vccnz cs_162
cb_163:
    s_nop 0
    v_mfma_f32_16x16x32_bf16 v[240:243], v[28:31], a[0:3], 0
    buffer_load_dwordx4 v[108:111], v7, s[36:39], s77 offen offset:2048 sc1
    v_mfma_f32_16x16x32_bf16 v[240:243], v[32:35], a[16:19], v[240:243]
    v_mfma_f32_16x16x32_bf16 v[244:247], v[32:35], a[20:23], 0
    v_mfma_f32_16x16x32_bf16 v[244:247], v[28:31], a[4:7], v[244:247]
    v_mfma_f32_16x16x32_bf16 v[248:251], v[28:31], a[8:11], 0
    buffer_load_dwordx4 v[112:115], v7, s[36:39], s77 offen offset:3072 sc1
    v_mfma_f32_16x16x32_bf16 v[248:251], v[32:35], a[24:27], v[248:251]
    ds_write_b128 v23, v[228:231] offset:0
    v_mfma_f32_16x16x32_bf16 v[252:255], v[32:35], a[28:31], 0
    v_mfma_f32_16x16x32_bf16 v[252:255], v[28:31], a[12:15], v[252:255]
    ds_write_b128 v24, v[232:235] offset:1024
    v_mfma_f32_16x16x32_bf16 v[252:255], v[36:39], a[44:47], v[252:255]
    s_add_u32 s77, s74, 0
    buffer_load_dwordx4 v[28:31], v7, s[36:39], s77 offen offset:0 sc1
    v_mfma_f32_16x16x32_bf16 v[252:255], v[40:43], a[60:63], v[252:255]
    ds_write_b128 v25, v[236:239] offset:2048
    v_mfma_f32_16x16x32_bf16 v[248:251], v[40:43], a[56:59], v[248:251]
    v_add_f32 v116, v11, v224
    v_add_f32_e64 v117, v11, v225
    v_mfma_f32_16x16x32_bf16 v[248:251], v[36:39], a[40:43], v[248:251]
    v_add_f32 v118, v11, v226
    v_add_f32 v119, v11, v227
    v_mfma_f32_16x16x32_bf16 v[244:247], v[36:39], a[36:39], v[244:247]
    buffer_load_dwordx4 v[32:35], v7, s[36:39], s77 offen offset:1024 sc1
    v_mfma_f32_16x16x32_bf16 v[244:247], v[40:43], a[52:55], v[244:247]
    s_waitcnt vmcnt(11)
    v_bitop3_b32 v20, v44, v64, v68 bitop3:254
    v_mfma_f32_16x16x32_bf16 v[240:243], v[40:43], a[48:51], v[240:243]
    v_bitop3_b32 v20, v20, v72, -2 bitop3:254
    v_cmp_eq_u32 vcc, -1, v20
    v_mfma_f32_16x16x32_bf16 v[240:243], v[36:39], a[32:35], v[240:243]
    s_cbranch_vccnz cs_164
cb_165:
    v_mfma_f32_16x16x32_bf16 v[240:243], v[44:47], a[64:67], v[240:243]
    buffer_load_dwordx4 v[36:39], v7, s[36:39], s77 offen offset:2048 sc1
    v_mfma_f32_16x16x32_bf16 v[240:243], v[64:67], a[80:83], v[240:243]
    s_waitcnt lgkmcnt(0)
    s_barrier
    s_nop 0
    v_mfma_f32_16x16x32_bf16 v[244:247], v[64:67], a[84:87], v[244:247]
    ds_read_b128 v[120:123], v26 offset:0
    v_mfma_f32_16x16x32_bf16 v[244:247], v[44:47], a[68:71], v[244:247]
    ds_read_b128 v[124:127], v26 offset:1024
    v_mfma_f32_16x16x32_bf16 v[248:251], v[44:47], a[72:75], v[248:251]
    buffer_load_dwordx4 v[40:43], v7, s[36:39], s77 offen offset:3072 sc1
    v_mfma_f32_16x16x32_bf16 v[248:251], v[64:67], a[88:91], v[248:251]
    ds_read_b128 v[128:131], v26 offset:2048
    v_mfma_f32_16x16x32_bf16 v[252:255], v[64:67], a[92:95], v[252:255]
    v_mfma_f32_16x16x32_bf16 v[252:255], v[44:47], a[76:79], v[252:255]
    v_mfma_f32_16x16x32_bf16 v[252:255], v[68:71], a[108:111], v[252:255]
    s_add_u32 s77, s74, 4096
    buffer_load_dwordx4 v[44:47], v7, s[36:39], s77 offen offset:0 sc1
    v_mfma_f32_16x16x32_bf16 v[252:255], v[72:75], a[124:127], v[252:255]
    v_mfma_f32_16x16x32_bf16 v[248:251], v[72:75], a[120:123], v[248:251]
    v_mfma_f32_16x16x32_bf16 v[248:251], v[68:71], a[104:107], v[248:251]
    v_mfma_f32_16x16x32_bf16 v[244:247], v[68:71], a[100:103], v[244:247]
    buffer_load_dwordx4 v[64:67], v7, s[36:39], s77 offen offset:1024 sc1
    v_mfma_f32_16x16x32_bf16 v[244:247], v[72:75], a[116:119], v[244:247]
    s_waitcnt vmcnt(10)
    v_bitop3_b32 v20, v76, v80, v84 bitop3:254
    v_mfma_f32_16x16x32_bf16 v[240:243], v[72:75], a[112:115], v[240:243]
    v_bitop3_b32 v20, v20, v88, -2 bitop3:254
    v_cmp_eq_u32 vcc, -1, v20
    v_mfma_f32_16x16x32_bf16 v[240:243], v[68:71], a[96:99], v[240:243]
    s_cbranch_vccnz cs_166
cb_167:
    v_mfma_f32_16x16x32_bf16 v[240:243], v[76:79], a[128:131], v[240:243]
    buffer_load_dwordx4 v[68:71], v7, s[36:39], s77 offen offset:2048 sc1
    v_mfma_f32_16x16x32_bf16 v[240:243], v[80:83], a[144:147], v[240:243]
    s_waitcnt lgkmcnt(2)
    v_add_f32 v116, v116, v120
    v_add_f32 v117, v117, v121
    v_mfma_f32_16x16x32_bf16 v[244:247], v[80:83], a[148:151], v[244:247]
    v_add_f32 v118, v118, v122
    v_add_f32 v119, v119, v123
    v_mfma_f32_16x16x32_bf16 v[244:247], v[76:79], a[132:135], v[244:247]
    s_waitcnt lgkmcnt(0)
    v_add_f32 v124, v124, v128
    v_add_f32_e64 v125, v125, v129
    v_mfma_f32_16x16x32_bf16 v[248:251], v[76:79], a[136:139], v[248:251]
    buffer_load_dwordx4 v[72:75], v7, s[36:39], s77 offen offset:3072 sc1
    v_mfma_f32_16x16x32_bf16 v[248:251], v[80:83], a[152:155], v[248:251]
    v_add_f32 v126, v126, v130
    v_add_f32 v127, v127, v131
    v_mfma_f32_16x16x32_bf16 v[252:255], v[80:83], a[156:159], v[252:255]
    v_add_f32 v116, v116, v124
    v_add_f32 v117, v117, v125
    v_mfma_f32_16x16x32_bf16 v[252:255], v[76:79], a[140:143], v[252:255]
    v_add_f32 v118, v118, v126
    v_add_f32 v119, v119, v127
    v_mfma_f32_16x16x32_bf16 v[252:255], v[84:87], a[172:175], v[252:255]
    s_add_u32 s77, s74, 8192
    buffer_load_dwordx4 v[76:79], v7, s[36:39], s77 offen offset:0 sc1
    v_mfma_f32_16x16x32_bf16 v[252:255], v[88:91], a[188:191], v[252:255]
    v_mul_f32 v116, v116, v160
    v_mul_f32 v117, v117, v161
    v_mfma_f32_16x16x32_bf16 v[248:251], v[88:91], a[184:187], v[248:251]
    v_mul_f32 v118, v118, v162
    v_mul_f32 v119, v119, v163
    v_mfma_f32_16x16x32_bf16 v[248:251], v[84:87], a[168:171], v[248:251]
    v_cvt_pk_bf16_f32 v132, v116, v117
    v_cvt_pk_bf16_f32 v133, v118, v119
    v_mfma_f32_16x16x32_bf16 v[244:247], v[84:87], a[164:167], v[244:247]
    buffer_load_dwordx4 v[80:83], v7, s[36:39], s77 offen offset:1024 sc1
    v_mfma_f32_16x16x32_bf16 v[244:247], v[88:91], a[180:183], v[244:247]
    s_waitcnt vmcnt(10)
    v_bitop3_b32 v20, v92, v96, v108 bitop3:254
    v_mfma_f32_16x16x32_bf16 v[240:243], v[88:91], a[176:179], v[240:243]
    v_bitop3_b32 v20, v20, v112, -2 bitop3:254
    v_cmp_eq_u32 vcc, -1, v20
    v_mfma_f32_16x16x32_bf16 v[240:243], v[84:87], a[160:163], v[240:243]
    s_cbranch_vccnz cs_168
cb_169:
    s_nop 0
    v_mfma_f32_16x16x32_bf16 v[240:243], v[92:95], a[192:195], v[240:243]
    buffer_load_dwordx4 v[84:87], v7, s[36:39], s77 offen offset:2048 sc1
    v_mfma_f32_16x16x32_bf16 v[240:243], v[96:99], a[208:211], v[240:243]
    v_mfma_f32_16x16x32_bf16 v[244:247], v[96:99], a[212:215], v[244:247]
    v_mfma_f32_16x16x32_bf16 v[244:247], v[92:95], a[196:199], v[244:247]
    v_mfma_f32_16x16x32_bf16 v[248:251], v[92:95], a[200:203], v[248:251]
    buffer_load_dwordx4 v[88:91], v7, s[36:39], s77 offen offset:3072 sc1
    v_mfma_f32_16x16x32_bf16 v[248:251], v[96:99], a[216:219], v[248:251]
    v_mfma_f32_16x16x32_bf16 v[252:255], v[96:99], a[220:223], v[252:255]
    v_mfma_f32_16x16x32_bf16 v[252:255], v[92:95], a[204:207], v[252:255]
    v_mfma_f32_16x16x32_bf16 v[252:255], v[108:111], a[236:239], v[252:255]
    s_add_u32 s77, s74, 12288
    buffer_load_dwordx4 v[92:95], v7, s[36:39], s77 offen offset:0 sc1
    v_mfma_f32_16x16x32_bf16 v[252:255], v[112:115], a[252:255], v[252:255]
    v_mfma_f32_16x16x32_bf16 v[248:251], v[112:115], a[248:251], v[248:251]
    v_mfma_f32_16x16x32_bf16 v[248:251], v[108:111], a[232:235], v[248:251]
    v_mfma_f32_16x16x32_bf16 v[244:247], v[108:111], a[228:231], v[244:247]
    buffer_load_dwordx4 v[96:99], v7, s[36:39], s77 offen offset:1024 sc1
    v_mfma_f32_16x16x32_bf16 v[244:247], v[112:115], a[244:247], v[244:247]
    s_waitcnt vmcnt(10)
    v_bitop3_b32 v20, v28, v32, v36 bitop3:254
    v_mfma_f32_16x16x32_bf16 v[240:243], v[112:115], a[240:243], v[240:243]
    v_bitop3_b32 v20, v20, v40, -2 bitop3:254
    v_cmp_eq_u32 vcc, -1, v20
    v_mfma_f32_16x16x32_bf16 v[240:243], v[108:111], a[224:227], v[240:243]
    s_cbranch_vccnz cs_170
cb_171:
    s_nop 0
    v_mfma_f32_16x16x32_bf16 v[224:227], v[28:31], a[0:3], 0
    buffer_load_dwordx4 v[108:111], v7, s[36:39], s77 offen offset:2048 sc1
    v_mfma_f32_16x16x32_bf16 v[224:227], v[32:35], a[16:19], v[224:227]
    v_mfma_f32_16x16x32_bf16 v[228:231], v[32:35], a[20:23], 0
    v_mfma_f32_16x16x32_bf16 v[228:231], v[28:31], a[4:7], v[228:231]
    v_mfma_f32_16x16x32_bf16 v[232:235], v[28:31], a[8:11], 0
    buffer_load_dwordx4 v[112:115], v7, s[36:39], s77 offen offset:3072 sc1
    v_mfma_f32_16x16x32_bf16 v[232:235], v[32:35], a[24:27], v[232:235]
    ds_write_b128 v23, v[244:247] offset:16384
    v_mfma_f32_16x16x32_bf16 v[236:239], v[32:35], a[28:31], 0
    v_mfma_f32_16x16x32_bf16 v[236:239], v[28:31], a[12:15], v[236:239]
    ds_write_b128 v24, v[248:251] offset:17408
    v_mfma_f32_16x16x32_bf16 v[236:239], v[36:39], a[44:47], v[236:239]
    s_add_u32 s77, s75, 25165824
    buffer_load_dwordx4 v[28:31], v7, s[36:39], s77 offen offset:0 sc1
    v_mfma_f32_16x16x32_bf16 v[236:239], v[40:43], a[60:63], v[236:239]
    ds_write_b128 v25, v[252:255] offset:18432
    v_mfma_f32_16x16x32_bf16 v[232:235], v[40:43], a[56:59], v[232:235]
    v_add_f32 v116, v11, v240
    v_add_f32 v117, v11, v241
    v_mfma_f32_16x16x32_bf16 v[232:235], v[36:39], a[40:43], v[232:235]
    v_add_f32 v118, v11, v242
    v_add_f32 v119, v11, v243
    v_mfma_f32_16x16x32_bf16 v[228:231], v[36:39], a[36:39], v[228:231]
    buffer_load_dwordx4 v[32:35], v7, s[36:39], s77 offen offset:1024 sc1
    v_mfma_f32_16x16x32_bf16 v[228:231], v[40:43], a[52:55], v[228:231]
    s_waitcnt vmcnt(10)
    v_bitop3_b32 v20, v44, v64, v68 bitop3:254
    v_mfma_f32_16x16x32_bf16 v[224:227], v[40:43], a[48:51], v[224:227]
    v_bitop3_b32 v20, v20, v72, -2 bitop3:254
    v_cmp_eq_u32 vcc, -1, v20
    v_mfma_f32_16x16x32_bf16 v[224:227], v[36:39], a[32:35], v[224:227]
    s_cbranch_vccnz cs_172
cb_173:
    v_mfma_f32_16x16x32_bf16 v[224:227], v[44:47], a[64:67], v[224:227]
    buffer_load_dwordx4 v[36:39], v7, s[36:39], s77 offen offset:2048 sc1
    v_mfma_f32_16x16x32_bf16 v[224:227], v[64:67], a[80:83], v[224:227]
    s_waitcnt lgkmcnt(0)
    s_barrier
    v_mfma_f32_16x16x32_bf16 v[228:231], v[64:67], a[84:87], v[228:231]
    ds_read_b128 v[120:123], v26 offset:16384
    v_mfma_f32_16x16x32_bf16 v[228:231], v[44:47], a[68:71], v[228:231]
    ds_read_b128 v[124:127], v26 offset:17408
    v_mfma_f32_16x16x32_bf16 v[232:235], v[44:47], a[72:75], v[232:235]
    buffer_load_dwordx4 v[40:43], v7, s[36:39], s77 offen offset:3072 sc1
    v_mfma_f32_16x16x32_bf16 v[232:235], v[64:67], a[88:91], v[232:235]
    ds_read_b128 v[128:131], v26 offset:18432
    v_mfma_f32_16x16x32_bf16 v[236:239], v[64:67], a[92:95], v[236:239]
    s_waitcnt lgkmcnt(2)
    v_add_f32 v116, v116, v120
    v_add_f32 v117, v117, v121
    v_mfma_f32_16x16x32_bf16 v[236:239], v[44:47], a[76:79], v[236:239]
    v_add_f32 v118, v118, v122
    v_add_f32 v119, v119, v123
    v_mfma_f32_16x16x32_bf16 v[236:239], v[68:71], a[108:111], v[236:239]
    s_add_u32 s77, s75, 25169920
    buffer_load_dwordx4 v[44:47], v7, s[36:39], s77 offen offset:0 sc1
    v_mfma_f32_16x16x32_bf16 v[236:239], v[72:75], a[124:127], v[236:239]
    s_waitcnt lgkmcnt(0)
    v_add_f32 v124, v124, v128
    v_add_f32_e64 v125, v125, v129
    v_mfma_f32_16x16x32_bf16 v[232:235], v[72:75], a[120:123], v[232:235]
    v_add_f32 v126, v126, v130
    v_add_f32 v127, v127, v131
    v_mfma_f32_16x16x32_bf16 v[232:235], v[68:71], a[104:107], v[232:235]
    v_add_f32 v116, v116, v124
    v_add_f32 v117, v117, v125
    v_mfma_f32_16x16x32_bf16 v[228:231], v[68:71], a[100:103], v[228:231]
    buffer_load_dwordx4 v[64:67], v7, s[36:39], s77 offen offset:1024 sc1
    v_mfma_f32_16x16x32_bf16 v[228:231], v[72:75], a[116:119], v[228:231]
    s_waitcnt vmcnt(10)
    v_bitop3_b32 v20, v76, v80, v84 bitop3:254
    v_mfma_f32_16x16x32_bf16 v[224:227], v[72:75], a[112:115], v[224:227]
    v_bitop3_b32 v20, v20, v88, -2 bitop3:254
    v_cmp_eq_u32 vcc, -1, v20
    v_mfma_f32_16x16x32_bf16 v[224:227], v[68:71], a[96:99], v[224:227]
    s_cbranch_vccnz cs_174
cb_175:
    v_mfma_f32_16x16x32_bf16 v[224:227], v[76:79], a[128:131], v[224:227]
    buffer_load_dwordx4 v[68:71], v7, s[36:39], s77 offen offset:2048 sc1
    v_mfma_f32_16x16x32_bf16 v[224:227], v[80:83], a[144:147], v[224:227]
    v_add_f32 v118, v118, v126
    v_add_f32_e64 v119, v119, v127
    v_mfma_f32_16x16x32_bf16 v[228:231], v[80:83], a[148:151], v[228:231]
    v_mul_f32 v116, v116, v164
    v_mul_f32 v117, v117, v165
    v_mfma_f32_16x16x32_bf16 v[228:231], v[76:79], a[132:135], v[228:231]
    v_mul_f32 v118, v118, v166
    v_mul_f32 v119, v119, v167
    v_mfma_f32_16x16x32_bf16 v[232:235], v[76:79], a[136:139], v[232:235]
    buffer_load_dwordx4 v[72:75], v7, s[36:39], s77 offen offset:3072 sc1
    v_mfma_f32_16x16x32_bf16 v[232:235], v[80:83], a[152:155], v[232:235]
    v_cvt_pk_bf16_f32 v134, v116, v117
    v_cvt_pk_bf16_f32 v135, v118, v119
    v_mfma_f32_16x16x32_bf16 v[236:239], v[80:83], a[156:159], v[236:239]
    v_or_b32_e64 v132, 1, v132
    s_add_u32 s78, s85, 25182208
    buffer_store_dwordx4 v[132:135], v7, s[36:39], s78 offen sc1
    v_mfma_f32_16x16x32_bf16 v[236:239], v[76:79], a[140:143], v[236:239]
    v_lshlrev_b32_e64 v240, 16, v100
    v_and_b32 v241, 0xffff0000, v100
    v_mfma_f32_16x16x32_bf16 v[236:239], v[84:87], a[172:175], v[236:239]
    s_add_u32 s77, s75, 25174016
    buffer_load_dwordx4 v[76:79], v7, s[36:39], s77 offen offset:0 sc1
    v_mfma_f32_16x16x32_bf16 v[236:239], v[88:91], a[188:191], v[236:239]
    v_lshlrev_b32_e64 v242, 16, v101
    v_and_b32 v243, 0xffff0000, v101
    v_mfma_f32_16x16x32_bf16 v[232:235], v[88:91], a[184:187], v[232:235]
    v_lshlrev_b32_e64 v244, 16, v102
    v_and_b32 v245, 0xffff0000, v102
    v_mfma_f32_16x16x32_bf16 v[232:235], v[84:87], a[168:171], v[232:235]
    v_lshlrev_b32_e64 v246, 16, v103
    v_and_b32 v247, 0xffff0000, v103
    v_mfma_f32_16x16x32_bf16 v[228:231], v[84:87], a[164:167], v[228:231]
    s_add_u32 m0, s9, 53248
    s_add_u32 s81, s8, 4261888
    buffer_load_dwordx4 v7, s[36:39], s81 offen offset:0 sc1 lds
    v_mfma_f32_16x16x32_bf16 v[228:231], v[88:91], a[180:183], v[228:231]
    s_waitcnt vmcnt(11)
    v_bitop3_b32 v20, v92, v96, v108 bitop3:254
    v_mfma_f32_16x16x32_bf16 v[224:227], v[88:91], a[176:179], v[224:227]
    v_bitop3_b32 v20, v20, v112, -2 bitop3:254
    v_cmp_eq_u32 vcc, -1, v20
    v_mfma_f32_16x16x32_bf16 v[224:227], v[84:87], a[160:163], v[224:227]
    s_cbranch_vccnz cs_176
cb_177:
    v_mfma_f32_16x16x32_bf16 v[224:227], v[92:95], a[192:195], v[224:227]
    buffer_load_dwordx4 v[80:83], v7, s[36:39], s77 offen offset:1024 sc1
    v_mfma_f32_16x16x32_bf16 v[224:227], v[96:99], a[208:211], v[224:227]
    v_lshlrev_b32 v248, 16, v104
    v_and_b32 v249, 0xffff0000, v104
    v_mfma_f32_16x16x32_bf16 v[228:231], v[96:99], a[212:215], v[228:231]
    v_lshlrev_b32_e64 v250, 16, v105
    v_and_b32 v251, 0xffff0000, v105
    v_mfma_f32_16x16x32_bf16 v[228:231], v[92:95], a[196:199], v[228:231]
    v_lshlrev_b32_e64 v252, 16, v106
    v_and_b32 v253, 0xffff0000, v106
    v_mfma_f32_16x16x32_bf16 v[232:235], v[92:95], a[200:203], v[232:235]
    buffer_load_dwordx4 v7, s[36:39], s81 offen offset:1024 sc1 lds
    v_mfma_f32_16x16x32_bf16 v[232:235], v[96:99], a[216:219], v[232:235]
    v_lshlrev_b32_e64 v254, 16, v107
    v_and_b32 v255, 0xffff0000, v107
    v_mfma_f32_16x16x32_bf16 v[236:239], v[96:99], a[220:223], v[236:239]
    v_fma_f32 v240, v240, v2, v3
    v_fma_f32 v241, v241, v2, v3
    v_mfma_f32_16x16x32_bf16 v[236:239], v[92:95], a[204:207], v[236:239]
    v_fma_f32 v242, v242, v2, v3
    v_fma_f32 v243, v243, v2, v3
    v_mfma_f32_16x16x32_bf16 v[236:239], v[108:111], a[236:239], v[236:239]
    buffer_load_dwordx4 v[84:87], v7, s[36:39], s77 offen offset:2048 sc1
    v_mfma_f32_16x16x32_bf16 v[236:239], v[112:115], a[252:255], v[236:239]
    v_fma_f32 v244, v244, v2, v3
    v_fma_f32 v245, v245, v2, v3
    v_mfma_f32_16x16x32_bf16 v[232:235], v[112:115], a[248:251], v[232:235]
    v_fma_f32 v246, v246, v2, v3
    v_fma_f32 v247, v247, v2, v3
    v_mfma_f32_16x16x32_bf16 v[232:235], v[108:111], a[232:235], v[232:235]
    v_fma_f32 v248, v248, v2, v3
    v_fma_f32 v249, v249, v2, v3
    v_mfma_f32_16x16x32_bf16 v[228:231], v[108:111], a[228:231], v[228:231]
    buffer_load_dwordx4 v7, s[36:39], s81 offen offset:2048 sc1 lds
    v_mfma_f32_16x16x32_bf16 v[228:231], v[112:115], a[244:247], v[228:231]
    v_fma_f32 v250, v250, v2, v3
    v_fma_f32 v251, v251, v2, v3
    v_mfma_f32_16x16x32_bf16 v[224:227], v[112:115], a[240:243], v[224:227]
    v_fma_f32 v252, v252, v2, v3
    v_fma_f32 v253, v253, v2, v3
    v_mfma_f32_16x16x32_bf16 v[224:227], v[108:111], a[224:227], v[224:227]
    v_fma_f32 v254, v254, v2, v3
    v_fma_f32 v255, v255, v2, v3
    ds_write_b128 v23, v[228:231] offset:0
    ds_write_b128 v24, v[232:235] offset:1024
    ds_write_b128 v25, v[236:239] offset:2048
    s_nop 2
    v_add_f32 v116, v11, v224
    v_add_f32 v117, v11, v225
    v_add_f32 v118, v11, v226
    v_add_f32_e64 v119, v11, v227
    buffer_load_dwordx4 v[88:91], v7, s[36:39], s77 offen offset:3072 sc1
    buffer_load_dwordx4 v7, s[36:39], s81 offen offset:3072 sc1 lds
    s_waitcnt lgkmcnt(0)
    s_barrier
    ds_read_b128 v[120:123], v26 offset:0
    ds_read_b128 v[124:127], v26 offset:1024
    ds_read_b128 v[128:131], v26 offset:2048
    ds_read_b128 v[144:147], v8 offset:34816
    ds_read_b128 v[148:151], v8 offset:38912
    ds_read_b128 v[152:155], v8 offset:39936
    ds_read_b128 v[156:159], v8 offset:35840
    ds_read_b128 v[160:163], v8 offset:36864
    ds_read_b128 v[164:167], v8 offset:40960
    ds_read_b128 v[172:175], v8 offset:41984
    ds_read_b128 v[176:179], v8 offset:37888
    ds_read_b128 v[180:183], v8 offset:46080
    s_waitcnt lgkmcnt(11)
    v_pk_add_f32 v[116:117], v[116:117], v[120:121]
    v_pk_add_f32 v[118:119], v[118:119], v[122:123]
    s_waitcnt lgkmcnt(9)
    v_pk_add_f32 v[124:125], v[124:125], v[128:129]
    v_pk_add_f32 v[126:127], v[126:127], v[130:131]
    v_pk_add_f32 v[116:117], v[116:117], v[124:125]
L_pad_8254:
    s_cbranch_execz L_ret_4
    v_pk_add_f32 v[118:119], v[118:119], v[126:127]
    v_pk_mul_f32 v[116:117], v[116:117], v[168:169]
    v_pk_mul_f32 v[118:119], v[118:119], v[170:171]
    v_cvt_pk_bf16_f32 v136, v116, v117
    v_cvt_pk_bf16_f32 v137, v118, v119
    v_or_b32 v136, 1, v136
    s_add_u32 s78, s86, 25165824
    buffer_store_dwordx2 v[136:137], v22, s[36:39], s78 offen sc1
    s_cmp_eq_u32 s41, 7
    s_cbranch_scc1 L_fin
    ds_read_b128 v[184:187], v8 offset:50176
    s_add_u32 s77, s75, 25178112
    buffer_load_dwordx4 v[92:95], v7, s[36:39], s77 offen offset:0 sc1
    s_waitcnt vmcnt(15)
    v_bitop3_b32 v20, v28, v32, v36 bitop3:128
    v_bitop3_b32 v20, v20, v40, 1 bitop3:128
    v_cmp_eq_u32 vcc, 0, v20
    s_cbranch_vccnz cs_178
cb_179:
    s_waitcnt lgkmcnt(9)
    v_mfma_f32_16x16x32_bf16 v[240:243], v[144:147], v[28:31], v[240:243]
    ds_read_b128 v[144:147], v8 offset:49152
    s_waitcnt lgkmcnt(9)
    v_mfma_f32_16x16x32_bf16 v[240:243], v[148:151], v[32:35], v[240:243]
    ds_read_b128 v[148:151], v8 offset:45056
    s_waitcnt lgkmcnt(8)
    v_mfma_f32_16x16x32_bf16 v[244:247], v[152:155], v[32:35], v[244:247]
    ds_read_b128 v[152:155], v8 offset:44032
    v_mfma_f32_16x16x32_bf16 v[244:247], v[156:159], v[28:31], v[244:247]
    ds_read_b128 v[156:159], v8 offset:48128
    s_waitcnt lgkmcnt(8)
    buffer_load_dwordx4 v[96:99], v7, s[36:39], s77 offen offset:1024 sc1
    v_mfma_f32_16x16x32_bf16 v[248:251], v[160:163], v[28:31], v[248:251]
    ds_read_b128 v[160:163], v8 offset:47104
    v_mfma_f32_16x16x32_bf16 v[248:251], v[164:167], v[32:35], v[248:251]
    ds_read_b128 v[164:167], v8 offset:43008
    s_waitcnt lgkmcnt(8)
    v_mfma_f32_16x16x32_bf16 v[252:255], v[172:175], v[32:35], v[252:255]
    ds_read_b128 v[172:175], v8 offset:51200
    v_mfma_f32_16x16x32_bf16 v[252:255], v[176:179], v[28:31], v[252:255]
    ds_read_b128 v[176:179], v8 offset:55296
    s_waitcnt lgkmcnt(8)
    buffer_load_dwordx4 v[108:111], v7, s[36:39], s77 offen offset:2048 sc1
    v_mfma_f32_16x16x32_bf16 v[252:255], v[180:183], v[36:39], v[252:255]
    ds_read_b128 v[180:183], v8 offset:56320
    v_mfma_f32_16x16x32_bf16 v[252:255], v[184:187], v[40:43], v[252:255]
    ds_read_b128 v[184:187], v8 offset:52224
    s_waitcnt lgkmcnt(8)
    v_mfma_f32_16x16x32_bf16 v[248:251], v[144:147], v[40:43], v[248:251]
    ds_read_b128 v[144:147], v8 offset:53248
    v_mfma_f32_16x16x32_bf16 v[248:251], v[148:151], v[36:39], v[248:251]
    ds_read_b128 v[148:151], v8 offset:57344
    s_waitcnt lgkmcnt(8)
    buffer_load_dwordx4 v[112:115], v7, s[36:39], s77 offen offset:3072 sc1
    v_mfma_f32_16x16x32_bf16 v[244:247], v[152:155], v[36:39], v[244:247]
    ds_read_b128 v[152:155], v8 offset:58368
    v_mfma_f32_16x16x32_bf16 v[244:247], v[156:159], v[40:43], v[244:247]
    ds_read_b128 v[156:159], v8 offset:54272
    s_waitcnt lgkmcnt(8)
    v_mfma_f32_16x16x32_bf16 v[240:243], v[160:163], v[40:43], v[240:243]
    ds_read_b128 v[160:163], v8 offset:62464
    v_mfma_f32_16x16x32_bf16 v[240:243], v[164:167], v[36:39], v[240:243]
    ds_read_b128 v[164:167], v9 offset:1024
    s_waitcnt lgkmcnt(8)
    s_add_u32 s77, s75, 25182208
    buffer_load_dwordx4 v[28:31], v7, s[36:39], s77 offen offset:0 sc1
    s_waitcnt vmcnt(15)
    v_bitop3_b32 v20, v44, v64, v68 bitop3:128
    v_bitop3_b32 v20, v20, v72, 1 bitop3:128
    v_cmp_eq_u32 vcc, 0, v20
    s_cbranch_vccnz cs_180
cb_181:
    v_mfma_f32_16x16x32_bf16 v[240:243], v[172:175], v[44:47], v[240:243]
    ds_read_b128 v[172:175], v9 offset:0
    v_mfma_f32_16x16x32_bf16 v[240:243], v[176:179], v[64:67], v[240:243]
    ds_read_b128 v[176:179], v8 offset:61440
    s_waitcnt lgkmcnt(8)
    v_mfma_f32_16x16x32_bf16 v[244:247], v[180:183], v[64:67], v[244:247]
    ds_read_b128 v[180:183], v8 offset:60416
    v_mfma_f32_16x16x32_bf16 v[244:247], v[184:187], v[44:47], v[244:247]
    ds_read_b128 v[184:187], v8 offset:64512
    s_waitcnt lgkmcnt(8)
    buffer_load_dwordx4 v[32:35], v7, s[36:39], s77 offen offset:1024 sc1
    v_mfma_f32_16x16x32_bf16 v[248:251], v[144:147], v[44:47], v[248:251]
    ds_read_b128 v[144:147], v8 offset:63488
    v_mfma_f32_16x16x32_bf16 v[248:251], v[148:151], v[64:67], v[248:251]
    ds_read_b128 v[148:151], v8 offset:59392
    s_waitcnt lgkmcnt(8)
    v_mfma_f32_16x16x32_bf16 v[252:255], v[152:155], v[64:67], v[252:255]
    ds_read_b128 v[152:155], v9 offset:2048
    v_mfma_f32_16x16x32_bf16 v[252:255], v[156:159], v[44:47], v[252:255]
    ds_read_b128 v[156:159], v9 offset:6144
    s_waitcnt lgkmcnt(8)
    buffer_load_dwordx4 v[36:39], v7, s[36:39], s77 offen offset:2048 sc1
    v_mfma_f32_16x16x32_bf16 v[252:255], v[160:163], v[68:71], v[252:255]
    ds_read_b128 v[160:163], v9 offset:7168
    v_mfma_f32_16x16x32_bf16 v[252:255], v[164:167], v[72:75], v[252:255]
    ds_read_b128 v[164:167], v9 offset:3072
    s_waitcnt lgkmcnt(8)
    v_mfma_f32_16x16x32_bf16 v[248:251], v[172:175], v[72:75], v[248:251]
    ds_read_b128 v[172:175], v9 offset:4096
    v_mfma_f32_16x16x32_bf16 v[248:251], v[176:179], v[68:71], v[248:251]
    ds_read_b128 v[176:179], v9 offset:8192
    s_waitcnt lgkmcnt(8)
    buffer_load_dwordx4 v[40:43], v7, s[36:39], s77 offen offset:3072 sc1
    v_mfma_f32_16x16x32_bf16 v[244:247], v[180:183], v[68:71], v[244:247]
    ds_read_b128 v[180:183], v9 offset:9216
    v_mfma_f32_16x16x32_bf16 v[244:247], v[184:187], v[72:75], v[244:247]
    ds_read_b128 v[184:187], v9 offset:5120
    s_waitcnt lgkmcnt(8)
    v_mfma_f32_16x16x32_bf16 v[240:243], v[144:147], v[72:75], v[240:243]
    ds_read_b128 v[144:147], v9 offset:13312
    v_mfma_f32_16x16x32_bf16 v[240:243], v[148:151], v[68:71], v[240:243]
    ds_read_b128 v[148:151], v9 offset:17408
    s_waitcnt lgkmcnt(8)
    s_add_u32 s77, s75, 25186304
    buffer_load_dwordx4 v[44:47], v7, s[36:39], s77 offen offset:0 sc1
    s_waitcnt vmcnt(11)
    v_bitop3_b32 v20, v76, v80, v84 bitop3:128
    v_bitop3_b32 v20, v20, v88, 1 bitop3:128
    v_cmp_eq_u32_e64 vcc, 0, v20
    s_cbranch_vccnz cs_182
cb_183:
    v_mfma_f32_16x16x32_bf16 v[240:243], v[152:155], v[76:79], v[240:243]
    ds_read_b128 v[152:155], v9 offset:16384
    v_mfma_f32_16x16x32_bf16 v[240:243], v[156:159], v[80:83], v[240:243]
    ds_read_b128 v[156:159], v9 offset:12288
    s_waitcnt lgkmcnt(8)
    v_mfma_f32_16x16x32_bf16 v[244:247], v[160:163], v[80:83], v[244:247]
    ds_read_b128 v[160:163], v9 offset:11264
    v_mfma_f32_16x16x32_bf16 v[244:247], v[164:167], v[76:79], v[244:247]
    ds_read_b128 v[164:167], v9 offset:15360
    s_waitcnt lgkmcnt(8)
    buffer_load_dwordx4 v[64:67], v7, s[36:39], s77 offen offset:1024 sc1
    v_mfma_f32_16x16x32_bf16 v[248:251], v[172:175], v[76:79], v[248:251]
    ds_read_b128 v[172:175], v9 offset:14336
    v_mfma_f32_16x16x32_bf16 v[248:251], v[176:179], v[80:83], v[248:251]
    ds_read_b128 v[176:179], v9 offset:10240
    s_waitcnt lgkmcnt(8)
    v_mfma_f32_16x16x32_bf16 v[252:255], v[180:183], v[80:83], v[252:255]
    ds_read_b128 v[180:183], v9 offset:18432
    v_mfma_f32_16x16x32_bf16 v[252:255], v[184:187], v[76:79], v[252:255]
    ds_read_b128 v[184:187], v9 offset:22528
    s_waitcnt lgkmcnt(8)
    buffer_load_dwordx4 v[68:71], v7, s[36:39], s77 offen offset:2048 sc1
    v_mfma_f32_16x16x32_bf16 v[252:255], v[144:147], v[84:87], v[252:255]
    ds_read_b128 v[144:147], v9 offset:23552
    v_mfma_f32_16x16x32_bf16 v[252:255], v[148:151], v[88:91], v[252:255]
    ds_read_b128 v[148:151], v9 offset:19456
    s_waitcnt lgkmcnt(8)
    v_mfma_f32_16x16x32_bf16 v[248:251], v[152:155], v[88:91], v[248:251]
    ds_read_b128 v[152:155], v9 offset:20480
    v_mfma_f32_16x16x32_bf16 v[248:251], v[156:159], v[84:87], v[248:251]
    ds_read_b128 v[156:159], v9 offset:24576
    s_waitcnt lgkmcnt(8)
    buffer_load_dwordx4 v[72:75], v7, s[36:39], s77 offen offset:3072 sc1
    v_mfma_f32_16x16x32_bf16 v[244:247], v[160:163], v[84:87], v[244:247]
    ds_read_b128 v[160:163], v9 offset:25600
    v_mfma_f32_16x16x32_bf16 v[244:247], v[164:167], v[88:91], v[244:247]
    ds_read_b128 v[164:167], v9 offset:21504
    s_waitcnt lgkmcnt(8)
    v_mfma_f32_16x16x32_bf16 v[240:243], v[172:175], v[88:91], v[240:243]
    s_waitcnt vmcnt(13)
    s_barrier
    ds_read_b128 v[172:175], v7 offset:46080
    v_mfma_f32_16x16x32_bf16 v[240:243], v[176:179], v[84:87], v[240:243]
    ds_read_b128 v[176:179], v7 offset:50176
    s_waitcnt lgkmcnt(8)
    s_waitcnt vmcnt(12)
    s_add_u32 s77, s75, 25190400
    buffer_load_dwordx2 v[76:77], v22, s[36:39], s77 offen offset:0 sc1
    buffer_load_dwordx2 v[78:79], v22, s[36:39], s77 offen offset:512 sc1
    s_waitcnt vmcnt(10)
    v_bitop3_b32 v20, v92, v96, v108 bitop3:128
    v_bitop3_b32 v20, v20, v112, 1 bitop3:128
    v_cmp_eq_u32 vcc, 0, v20
    s_cbranch_vccnz cs_184
cb_185:
    v_mfma_f32_16x16x32_bf16 v[240:243], v[180:183], v[92:95], v[240:243]
    ds_read_b128 v[180:183], v7 offset:49152
    v_mfma_f32_16x16x32_bf16 v[240:243], v[184:187], v[96:99], v[240:243]
    ds_read_b128 v[184:187], v7 offset:45056
    s_waitcnt lgkmcnt(8)
    v_mfma_f32_16x16x32_bf16 v[244:247], v[144:147], v[96:99], v[244:247]
    ds_read_b128 v[144:147], v7 offset:44032
    v_mfma_f32_16x16x32_bf16 v[244:247], v[148:151], v[92:95], v[244:247]
    ds_read_b128 v[148:151], v7 offset:48128
    s_waitcnt lgkmcnt(8)
    buffer_load_dwordx2 v[80:81], v22, s[36:39], s77 offen offset:1024 sc1
    buffer_load_dwordx2 v[82:83], v22, s[36:39], s77 offen offset:1536 sc1
    v_mfma_f32_16x16x32_bf16 v[248:251], v[152:155], v[92:95], v[248:251]
    ds_read_b128 v[152:155], v7 offset:47104
    v_mfma_f32_16x16x32_bf16 v[248:251], v[156:159], v[96:99], v[248:251]
    ds_read_b128 v[156:159], v7 offset:43008
    s_waitcnt lgkmcnt(8)
    v_mfma_f32_16x16x32_bf16 v[252:255], v[160:163], v[96:99], v[252:255]
    ds_read_b128 v[160:163], v7 offset:51200
    v_mfma_f32_16x16x32_bf16 v[252:255], v[164:167], v[92:95], v[252:255]
    ds_read_b128 v[164:167], v7 offset:55296
    s_waitcnt lgkmcnt(8)
    buffer_load_dwordx2 v[84:85], v22, s[36:39], s77 offen offset:2048 sc1
    buffer_load_dwordx2 v[86:87], v22, s[36:39], s77 offen offset:2560 sc1
    v_mfma_f32_16x16x32_bf16 v[252:255], v[172:175], v[108:111], v[252:255]
    ds_read_b128 v[172:175], v7 offset:56320
    v_mfma_f32_16x16x32_bf16 v[252:255], v[176:179], v[112:115], v[252:255]
    ds_read_b128 v[176:179], v7 offset:52224
    s_waitcnt lgkmcnt(8)
    v_mfma_f32_16x16x32_bf16 v[248:251], v[180:183], v[112:115], v[248:251]
    ds_read_b128 v[180:183], v7 offset:53248
    v_mfma_f32_16x16x32_bf16 v[248:251], v[184:187], v[108:111], v[248:251]
    ds_read_b128 v[184:187], v7 offset:57344
    s_waitcnt lgkmcnt(8)
    buffer_load_dwordx2 v[88:89], v22, s[36:39], s77 offen offset:3072 sc1
    buffer_load_dwordx2 v[90:91], v22, s[36:39], s77 offen offset:3584 sc1
    v_mfma_f32_16x16x32_bf16 v[244:247], v[144:147], v[108:111], v[244:247]
    ds_read_b128 v[144:147], v7 offset:58368
    v_mfma_f32_16x16x32_bf16 v[244:247], v[148:151], v[112:115], v[244:247]
    ds_read_b128 v[148:151], v7 offset:54272
    s_waitcnt lgkmcnt(8)
    v_mfma_f32_16x16x32_bf16 v[240:243], v[152:155], v[112:115], v[240:243]
    ds_read_b128 v[152:155], v7 offset:62464
    v_mfma_f32_16x16x32_bf16 v[240:243], v[156:159], v[108:111], v[240:243]
    ds_read_b128 v[156:159], v8 offset:1024
    s_waitcnt lgkmcnt(8)
    s_waitcnt vmcnt(12)
    v_bitop3_b32 v20, v28, v32, v36 bitop3:128
    v_bitop3_b32 v20, v20, v40, 1 bitop3:128
    v_cmp_eq_u32_e64 vcc, 0, v20
    s_cbranch_vccnz cs_186
cb_187:
    v_mfma_f32_16x16x32_bf16 v[240:243], v[160:163], v[28:31], v[240:243]
    ds_read_b128 v[160:163], v8 offset:0
    v_mfma_f32_16x16x32_bf16 v[240:243], v[164:167], v[32:35], v[240:243]
    ds_read_b128 v[164:167], v7 offset:61440
    s_waitcnt lgkmcnt(8)
    v_mfma_f32_16x16x32_bf16 v[244:247], v[172:175], v[32:35], v[244:247]
    ds_read_b128 v[172:175], v7 offset:60416
    v_mfma_f32_16x16x32_bf16 v[244:247], v[176:179], v[28:31], v[244:247]
    ds_read_b128 v[176:179], v7 offset:64512
    s_waitcnt lgkmcnt(8)
    v_mfma_f32_16x16x32_bf16 v[248:251], v[180:183], v[28:31], v[248:251]
    ds_read_b128 v[180:183], v7 offset:63488
    v_mfma_f32_16x16x32_bf16 v[248:251], v[184:187], v[32:35], v[248:251]
    ds_read_b128 v[184:187], v7 offset:59392
    s_waitcnt lgkmcnt(8)
    v_mfma_f32_16x16x32_bf16 v[252:255], v[144:147], v[32:35], v[252:255]
    ds_read_b128 v[144:147], v8 offset:2048
    v_mfma_f32_16x16x32_bf16 v[252:255], v[148:151], v[28:31], v[252:255]
    ds_read_b128 v[148:151], v8 offset:6144
    s_waitcnt lgkmcnt(8)
    v_mfma_f32_16x16x32_bf16 v[252:255], v[152:155], v[36:39], v[252:255]
    ds_read_b128 v[152:155], v8 offset:7168
    v_mfma_f32_16x16x32_bf16 v[252:255], v[156:159], v[40:43], v[252:255]
    ds_read_b128 v[156:159], v8 offset:3072
    s_waitcnt lgkmcnt(8)
    v_mfma_f32_16x16x32_bf16 v[248:251], v[160:163], v[40:43], v[248:251]
    ds_read_b128 v[160:163], v8 offset:4096
    v_mfma_f32_16x16x32_bf16 v[248:251], v[164:167], v[36:39], v[248:251]
    ds_read_b128 v[164:167], v8 offset:8192
    s_waitcnt lgkmcnt(8)
    v_mfma_f32_16x16x32_bf16 v[244:247], v[172:175], v[36:39], v[244:247]
    ds_read_b128 v[172:175], v8 offset:9216
    v_mfma_f32_16x16x32_bf16 v[244:247], v[176:179], v[40:43], v[244:247]
    ds_read_b128 v[176:179], v8 offset:5120
    s_waitcnt lgkmcnt(8)
    v_mfma_f32_16x16x32_bf16 v[240:243], v[180:183], v[40:43], v[240:243]
    ds_read_b128 v[180:183], v8 offset:13312
    v_mfma_f32_16x16x32_bf16 v[240:243], v[184:187], v[36:39], v[240:243]
    ds_read_b128 v[184:187], v8 offset:17408
    s_waitcnt lgkmcnt(8)
    s_waitcnt vmcnt(8)
    v_bitop3_b32 v20, v44, v64, v68 bitop3:128
    v_bitop3_b32 v20, v20, v72, 1 bitop3:128
    v_cmp_eq_u32_e64 vcc, 0, v20
    s_cbranch_vccnz cs_188
cb_189:
    v_mfma_f32_16x16x32_bf16 v[240:243], v[144:147], v[44:47], v[240:243]
    ds_read_b128 v[144:147], v8 offset:16384
    v_mfma_f32_16x16x32_bf16 v[240:243], v[148:151], v[64:67], v[240:243]
    ds_read_b128 v[148:151], v8 offset:12288
    s_waitcnt lgkmcnt(8)
    v_mfma_f32_16x16x32_bf16 v[244:247], v[152:155], v[64:67], v[244:247]
    ds_read_b128 v[152:155], v8 offset:11264
    v_mfma_f32_16x16x32_bf16 v[244:247], v[156:159], v[44:47], v[244:247]
    ds_read_b128 v[156:159], v8 offset:15360
    s_waitcnt lgkmcnt(8)
    v_mfma_f32_16x16x32_bf16 v[248:251], v[160:163], v[44:47], v[248:251]
    ds_read_b128 v[160:163], v8 offset:14336
    v_mfma_f32_16x16x32_bf16 v[248:251], v[164:167], v[64:67], v[248:251]
    ds_read_b128 v[164:167], v8 offset:10240
    s_waitcnt lgkmcnt(8)
    v_mfma_f32_16x16x32_bf16 v[252:255], v[172:175], v[64:67], v[252:255]
    ds_read_b128 v[172:175], v8 offset:18432
    v_mfma_f32_16x16x32_bf16 v[252:255], v[176:179], v[44:47], v[252:255]
    ds_read_b128 v[176:179], v8 offset:22528
    s_waitcnt lgkmcnt(8)
    v_mfma_f32_16x16x32_bf16 v[252:255], v[180:183], v[68:71], v[252:255]
    ds_read_b128 v[180:183], v8 offset:23552
    v_mfma_f32_16x16x32_bf16 v[252:255], v[184:187], v[72:75], v[252:255]
    ds_read_b128 v[184:187], v8 offset:19456
    s_waitcnt lgkmcnt(8)
    v_mfma_f32_16x16x32_bf16 v[248:251], v[144:147], v[72:75], v[248:251]
    ds_read_b128 v[144:147], v8 offset:20480
    v_mfma_f32_16x16x32_bf16 v[248:251], v[148:151], v[68:71], v[248:251]
    ds_read_b128 v[148:151], v8 offset:24576
    s_waitcnt lgkmcnt(8)
    v_mfma_f32_16x16x32_bf16 v[244:247], v[152:155], v[68:71], v[244:247]
    ds_read_b128 v[152:155], v8 offset:25600
    v_mfma_f32_16x16x32_bf16 v[244:247], v[156:159], v[72:75], v[244:247]
    ds_read_b128 v[156:159], v8 offset:21504
    s_waitcnt lgkmcnt(8)
    v_mfma_f32_16x16x32_bf16 v[240:243], v[160:163], v[72:75], v[240:243]
    ds_read_b128 v[160:163], v8 offset:29696
    v_mfma_f32_16x16x32_bf16 v[240:243], v[164:167], v[68:71], v[240:243]
    ds_read_b128 v[164:167], v8 offset:33792
    s_waitcnt lgkmcnt(8)
    s_waitcnt vmcnt(0)
    v_bitop3_b32 v20, v76, v80, v84 bitop3:128
    v_bitop3_b32 v20, v20, v88, v78 bitop3:128
    v_bitop3_b32 v20, v20, v82, v86 bitop3:128
    v_bitop3_b32 v20, v20, v90, 1 bitop3:128
    v_cmp_eq_u32_e64 vcc, 0, v20
    s_cbranch_vccnz cs_190
cb_191:
    v_mfma_f32_16x16x32_bf16 v[240:243], v[172:175], v[76:79], v[240:243]
    ds_read_b128 v[172:175], v8 offset:32768
    v_mfma_f32_16x16x32_bf16 v[240:243], v[176:179], v[80:83], v[240:243]
    ds_read_b128 v[176:179], v8 offset:28672
    s_waitcnt lgkmcnt(8)
    v_mfma_f32_16x16x32_bf16 v[244:247], v[180:183], v[80:83], v[244:247]
    ds_read_b128 v[180:183], v8 offset:27648
    v_mfma_f32_16x16x32_bf16 v[244:247], v[184:187], v[76:79], v[244:247]
    ds_read_b128 v[184:187], v8 offset:31744
    s_waitcnt lgkmcnt(8)
    v_mfma_f32_16x16x32_bf16 v[248:251], v[144:147], v[76:79], v[248:251]
    ds_read_b128 v[144:147], v8 offset:30720
    v_mfma_f32_16x16x32_bf16 v[248:251], v[148:151], v[80:83], v[248:251]
    ds_read_b128 v[148:151], v8 offset:26624
    s_waitcnt lgkmcnt(8)
    v_mfma_f32_16x16x32_bf16 v[252:255], v[152:155], v[80:83], v[252:255]
    v_mfma_f32_16x16x32_bf16 v[252:255], v[156:159], v[76:79], v[252:255]
    s_waitcnt lgkmcnt(6)
    v_mfma_f32_16x16x32_bf16 v[252:255], v[160:163], v[84:87], v[252:255]
    v_mfma_f32_16x16x32_bf16 v[252:255], v[164:167], v[88:91], v[252:255]
    s_waitcnt lgkmcnt(4)
    v_mfma_f32_16x16x32_bf16 v[248:251], v[172:175], v[88:91], v[248:251]
    v_mfma_f32_16x16x32_bf16 v[248:251], v[176:179], v[84:87], v[248:251]
    s_waitcnt lgkmcnt(2)
    v_mfma_f32_16x16x32_bf16 v[244:247], v[180:183], v[84:87], v[244:247]
    v_mfma_f32_16x16x32_bf16 v[244:247], v[184:187], v[88:91], v[244:247]
    s_waitcnt lgkmcnt(0)
    v_mfma_f32_16x16x32_bf16 v[240:243], v[144:147], v[88:91], v[240:243]
    v_mfma_f32_16x16x32_bf16 v[240:243], v[148:151], v[84:87], v[240:243]
    s_lshl_b32 s70, s42, 11
    v_lshrrev_b32 v24, 3, v1
    v_and_b32 v2, 7, v1
    v_xor_b32_e64 v2, v2, v24
    v_mul_u32_u24 v24, 0xe000, v24
    v_lshl_add_u32 v24, v2, 4, v24
    v_add_u32_e64 v23, s70, v7
    v_lshl_add_u32 v2, v4, 7, s70
    v_lshl_add_u32 v2, v6, 4, v2
    v_xor_b32_e64 v3, 64, v2
    s_lshl_b32 s70, s50, 10
    s_add_u32 s70, s70, s43
    s_mul_i32 s70, s70, 896
    s_lshl_b32 s71, s41, 7
    s_add_u32 s70, s70, s71
    s_add_u32 s71, s70, 458752
    v_cvt_pk_bf16_f32 v100, v240, v241
    v_cvt_pk_bf16_f32 v101, v242, v243
    v_cvt_pk_bf16_f32 v102, v244, v245
    v_cvt_pk_bf16_f32 v103, v246, v247
    ds_write_b128 v2, v[100:103]
    v_cvt_pk_bf16_f32 v104, v248, v249
    v_cvt_pk_bf16_f32 v105, v250, v251
    v_cvt_pk_bf16_f32 v106, v252, v253
    v_cvt_pk_bf16_f32 v107, v254, v255
    ds_write_b128 v3, v[104:107]
    ds_read_b128 v[240:243], v23 offset:0
    ds_read_b128 v[244:247], v23 offset:1024
    s_waitcnt lgkmcnt(1)
    buffer_store_dwordx4 v[240:243], v24, s[32:35], s70 offen nt
    s_waitcnt lgkmcnt(0)
    buffer_store_dwordx4 v[244:247], v24, s[32:35], s71 offen nt
L_fin:
    s_endpgm
L_hrest:
    s_mov_b64 exec, 0
    s_cmp_eq_u32 s42, 0
    s_cbranch_scc1 L_pad_8645
    s_cmp_eq_u32 s42, 1
    s_cbranch_scc1 L_pad_8864
    s_cmp_eq_u32 s42, 2
    s_cbranch_scc1 L_ret_5
    s_branch L_ret_5
L_ret_5:
    s_mov_b64 exec, -1
L_pad_8645:
    s_cbranch_execz L_ret_5
    v_mov_b32 v16, -1
    v_mov_b32 v17, -1
    v_mov_b32 v18, -1
    v_mov_b32 v19, -1
    v_lshrrev_b32 v14, 3, v1
    v_and_b32 v20, 7, v1
    v_xor_b32 v6, v20, v5
    v_xor_b32_e64 v20, v20, v14
    v_mul_u32_u24 v14, 28672, v14
    v_lshl_add_u32 v14, v20, 4, v14
    s_mul_i32 s82, s42, 458752
    s_lshl_b32 s71, s89, 12
    s_add_u32 s82, s82, s71
    s_lshl_b32 s71, s40, 7
    s_add_u32 s82, s82, s71
    v_add_u32 v8, 0x10000, v7
    v_add_u32 v9, 0x20000, v7
    v_lshlrev_b32_e64 v21, 2, v1
    s_mov_b32 s53, 0x3727c5ac
    s_mov_b32 s54, 0x3f803f80
    s_mov_b32 s55, 0x05040100
    s_mov_b32 s56, 0x07060302
    s_mov_b32 s47, 200000
    s_lshl2_add_u32 s52, s40, s42
    s_mul_i32 s71, s42, 14848
    v_mul_u32_u24 v64, 928, v4
    v_mul_u32_u24 v20, 112, v5
    v_add_u32 v64, s71, v64
    v_add_u32 v23, v64, v20
    v_sub_u32 v64, v64, v20
    v_add_u32 v64, 784, v64
    s_lshl_b32 s70, s50, 4
    v_add_u32 v24, s70, v4
    v_lshrrev_b32 v25, 1, v5
    v_lshlrev_b32 v25, 2, v25
    v_and_or_b32 v25, v5, 1, v25
    v_cvt_f32_u32 v25, v25
    s_cmp_eq_u32 s43, 0
    s_cselect_b32 s70, 32, 31
    v_add_f32 v25, v25, v25
    v_cvt_f32_u32 v27, v24
    v_and_b32 v28, 1, v24
    v_mul_f32 v27, 0x3d000000, v27
    v_lshl_or_b32 v28, v28, 16, v28
    v_mul_f32 v32, v25, v27
    v_lshlrev_b32 v28, 15, v28
    v_add_f32_e64 v33, v32, v27
    v_fma_f32 v34, 4.0, v27, v32
    v_add_f32 v35, v34, v27
    v_cos_f32 v36, v32
    v_cos_f32 v37, v33
    v_cos_f32 v38, v34
    v_cos_f32 v39, v35
    v_sin_f32 v32, v32
    v_sin_f32 v33, v33
    v_sin_f32 v34, v34
    v_sin_f32_e64 v35, v35
    v_cvt_pk_bf16_f32 v48, v36, v32
    v_cvt_pk_bf16_f32 v49, v37, v33
    v_cvt_pk_bf16_f32 v50, v38, v34
    v_cvt_pk_bf16_f32 v51, v39, v35
    v_xor_b32 v52, v28, v48
    v_xor_b32 v53, v28, v49
    v_xor_b32 v54, v28, v50
    v_xor_b32 v55, v28, v51
    v_sub_u32 v24, s70, v24
    v_cvt_f32_u32 v27, v24
    v_and_b32_e64 v28, 1, v24
    v_mul_f32 v27, 0x3d000000, v27
    v_lshl_or_b32 v28, v28, 16, v28
    v_mul_f32 v32, v25, v27
    v_lshlrev_b32 v28, 15, v28
    v_add_f32_e64 v33, v32, v27
    v_fma_f32 v34, 4.0, v27, v32
    v_add_f32 v35, v34, v27
    v_cos_f32 v36, v32
    v_cos_f32 v37, v33
    v_cos_f32 v38, v34
    v_cos_f32 v39, v35
    v_sin_f32 v32, v32
    v_sin_f32 v33, v33
    v_sin_f32 v34, v34
    v_sin_f32_e64 v35, v35
    v_cvt_pk_bf16_f32 v56, v36, v32
    v_cvt_pk_bf16_f32 v57, v37, v33
    v_cvt_pk_bf16_f32 v58, v38, v34
    v_cvt_pk_bf16_f32 v59, v39, v35
    v_xor_b32 v60, v28, v56
    v_xor_b32 v61, v28, v57
    v_xor_b32 v62, v28, v58
    v_xor_b32 v63, v28, v59
    v_mov_b32 v12, 0xc0135761
    v_mov_b32 v13, 0xc0135761
    s_mov_b32 s60, 0xbdd2d3e8
    s_mov_b32 s61, 0xbdd2d3e8
    s_mov_b32 s62, 0xaaaaaaaa
    s_mov_b32 s63, 0xaaaaaaaa
    s_mov_b32 s64, 0xcccccccc
    s_mov_b32 s65, 0xcccccccc
    s_mov_b64 s[66:67], 0xffff
    s_mul_i32 s46, s41, 7
    s_and_b32 s70, s41, 1
    s_add_u32 s45, s46, s70
    s_cmp_eq_u32 s70, 0
    s_cselect_b32 s70, 6, 0
    s_add_u32 s46, s46, s70
    v_lshrrev_b32 v15, 1, v5
    v_lshlrev_b32 v15, 8, v15
    v_lshl_add_u32 v15, v4, 4, v15
    v_and_b32_e64 v24, 1, v5
    v_lshl_add_u32 v15, v24, 16, v15
    s_lshl_b32 s70, s52, 9
    s_mul_i32 s71, s52, 28672
    s_lshl_b32 s83, s45, 16
    s_add_u32 s83, s83, s70
    s_lshl_b32 s84, s46, 16
    s_add_u32 s84, s84, s70
    s_lshl_b32 s70, s41, 9
    s_add_u32 s86, s71, s70
    s_add_u32 s85, s86, s70
    s_add_u32 s86, s86, 24576
    v_lshlrev_b32_e64 v22, 3, v1
    s_mul_i32 s87, s52, 14336
    s_lshl_b32 s70, s89, 11
    s_add_u32 s87, s87, s70
    s_cmp_eq_u32 s41, 7
    s_cselect_b32 s92, 14680064, 0
    s_add_u32 s82, s82, s92
    s_add_u32 s92, s92, s87
    s_bitcmp1_b32 s41, 1
    s_cselect_b32 s74, s49, s48
    s_and_b32 s75, s41, 1
    s_lshl1_add_u32 s75, s75, s51
    s_lshl_b32 s75, s75, 9
    s_add_u32 s74, s74, s75
    s_lshr_b32 s75, s41, 2
    s_lshl1_add_u32 s75, s75, s50
    s_lshl2_add_u32 s74, s74, s75
    s_lshl_b32 s74, s74, 10
    s_lshl_b32 s75, s42, 13
    s_add_u32 m0, s75, 67584
    v_xor_b32_e64 v66, 0, v7
    buffer_load_dwordx4 v66, s[20:23], s74 offen  lds
    s_add_u32 m0, s75, 68608
    s_add_u32 s74, s74, 0x40000
    v_xor_b32_e64 v66, 16, v7
    buffer_load_dwordx4 v66, s[20:23], s74 offen  lds
    s_add_u32 m0, s75, 69632
    s_add_u32 s74, s74, 0x40000
    v_xor_b32_e64 v66, 32, v7
    buffer_load_dwordx4 v66, s[20:23], s74 offen  lds
    s_add_u32 m0, s75, 70656
    s_add_u32 s74, s74, 0x40000
    v_xor_b32_e64 v66, 48, v7
    buffer_load_dwordx4 v66, s[20:23], s74 offen  lds
    s_add_u32 m0, s75, 71680
    s_add_u32 s74, s74, 0x40000
    v_xor_b32_e64 v66, 64, v7
    buffer_load_dwordx4 v66, s[20:23], s74 offen  lds
    s_add_u32 m0, s75, 72704
    s_add_u32 s74, s74, 0x40000
    v_xor_b32 v66, 80, v7
    buffer_load_dwordx4 v66, s[20:23], s74 offen  lds
    s_add_u32 m0, s75, 73728
    s_add_u32 s74, s74, 0x40000
    v_xor_b32 v66, 96, v7
    buffer_load_dwordx4 v66, s[20:23], s74 offen  lds
    s_add_u32 m0, s75, 74752
    s_add_u32 s74, s74, 0x40000
    v_xor_b32 v66, 112, v7
    buffer_load_dwordx4 v66, s[20:23], s74 offen  lds
    s_waitcnt vmcnt(9)
    v_readfirstlane_b32 s44, v10
    s_waitcnt vmcnt(8)
    v_lshlrev_b32 v11, 16, v11
    s_mul_i32 s44, s44, 1664525
    s_add_u32 s44, s44, 1013904223
    v_mov_b32_e64 v10, s44
    v_perm_b32 v68, v228, v224, s55
    v_perm_b32 v69, v236, v232, s55
    v_perm_b32 v70, v244, v240, s55
    v_perm_b32 v71, v252, v248, s55
    buffer_store_dwordx4 v[68:71], v7, s[36:39], s76 offen sc1
    s_add_u32 s76, s76, 14336
    v_perm_b32 v72, v228, v224, s56
    v_perm_b32 v73, v236, v232, s56
    v_perm_b32 v74, v244, v240, s56
    v_perm_b32 v75, v252, v248, s56
    buffer_store_dwordx4 v[72:75], v7, s[36:39], s76 offen sc1
    s_add_u32 s76, s76, 14336
    v_perm_b32 v68, v229, v225, s55
    v_perm_b32 v69, v237, v233, s55
    v_perm_b32 v70, v245, v241, s55
    v_perm_b32 v71, v253, v249, s55
    buffer_store_dwordx4 v[68:71], v7, s[36:39], s76 offen sc1
    s_add_u32 s76, s76, 14336
    v_perm_b32 v72, v229, v225, s56
    v_perm_b32 v73, v237, v233, s56
    v_perm_b32 v74, v245, v241, s56
    v_perm_b32 v75, v253, v249, s56
    buffer_store_dwordx4 v[72:75], v7, s[36:39], s76 offen sc1
    s_add_u32 s76, s76, 14336
    v_perm_b32 v68, v230, v226, s55
    v_perm_b32 v69, v238, v234, s55
    v_perm_b32 v70, v246, v242, s55
    v_perm_b32 v71, v254, v250, s55
    buffer_store_dwordx4 v[68:71], v7, s[36:39], s76 offen sc1
    s_add_u32 s76, s76, 14336
    v_perm_b32 v72, v230, v226, s56
    v_perm_b32 v73, v238, v234, s56
    v_perm_b32 v74, v246, v242, s56
    v_perm_b32 v75, v254, v250, s56
    buffer_store_dwordx4 v[72:75], v7, s[36:39], s76 offen sc1
    s_add_u32 s76, s76, 14336
    v_perm_b32 v68, v231, v227, s55
    v_perm_b32 v69, v239, v235, s55
    v_perm_b32 v70, v247, v243, s55
    v_perm_b32 v71, v255, v251, s55
L_pad_8864:
    s_cbranch_execz L_ret_5
    buffer_store_dwordx4 v[68:71], v7, s[36:39], s76 offen sc1
    s_add_u32 s76, s76, 14336
    v_perm_b32 v72, v231, v227, s56
    v_perm_b32 v73, v239, v235, s56
    v_perm_b32 v74, v247, v243, s56
    v_perm_b32 v75, v255, v251, s56
    buffer_store_dwordx4 v[72:75], v7, s[36:39], s76 offen sc1
    s_add_u32 s76, s76, 14336
    s_cmp_ge_u32 s79, 68
    s_cbranch_scc1 h2_193
    v_perm_b32 v68, v196, v192, s55
    v_perm_b32 v69, v204, v200, s55
    v_perm_b32 v70, v212, v208, s55
    v_perm_b32 v71, v220, v216, s55
    buffer_store_dwordx4 v[68:71], v7, s[36:39], s77 offen sc1
    s_add_u32 s77, s77, 14336
    v_perm_b32 v72, v196, v192, s56
    v_perm_b32 v73, v204, v200, s56
    v_perm_b32 v74, v212, v208, s56
    v_perm_b32 v75, v220, v216, s56
    buffer_store_dwordx4 v[72:75], v7, s[36:39], s77 offen sc1
    s_add_u32 s77, s77, 14336
    v_perm_b32 v68, v197, v193, s55
    v_perm_b32 v69, v205, v201, s55
    v_perm_b32 v70, v213, v209, s55
    v_perm_b32 v71, v221, v217, s55
    buffer_store_dwordx4 v[68:71], v7, s[36:39], s77 offen sc1
    s_add_u32 s77, s77, 14336
    v_perm_b32 v72, v197, v193, s56
    v_perm_b32 v73, v205, v201, s56
    v_perm_b32 v74, v213, v209, s56
    v_perm_b32 v75, v221, v217, s56
    buffer_store_dwordx4 v[72:75], v7, s[36:39], s77 offen sc1
    s_add_u32 s77, s77, 14336
    v_perm_b32 v68, v198, v194, s55
    v_perm_b32 v69, v206, v202, s55
    v_perm_b32 v70, v214, v210, s55
    v_perm_b32 v71, v222, v218, s55
    buffer_store_dwordx4 v[68:71], v7, s[36:39], s77 offen sc1
    s_add_u32 s77, s77, 14336
    v_perm_b32 v72, v198, v194, s56
    v_perm_b32 v73, v206, v202, s56
    v_perm_b32 v74, v214, v210, s56
    v_perm_b32 v75, v222, v218, s56
    buffer_store_dwordx4 v[72:75], v7, s[36:39], s77 offen sc1
    s_add_u32 s77, s77, 14336
    v_perm_b32 v68, v199, v195, s55
    v_perm_b32 v69, v207, v203, s55
    v_perm_b32 v70, v215, v211, s55
    v_perm_b32 v71, v223, v219, s55
    buffer_store_dwordx4 v[68:71], v7, s[36:39], s77 offen sc1
    s_add_u32 s77, s77, 14336
    v_perm_b32 v72, v199, v195, s56
    v_perm_b32 v73, v207, v203, s56
    v_perm_b32 v74, v215, v211, s56
    v_perm_b32 v75, v223, v219, s56
    buffer_store_dwordx4 v[72:75], v7, s[36:39], s77 offen sc1
    s_add_u32 s77, s77, 14336
h2_193:
    s_lshl_b32 s75, s40, 7
    s_add_u32 s75, s75, 655360
    s_waitcnt vmcnt(0)
    s_barrier
    s_cmp_lg_u32 s42, 0
    s_cbranch_scc1 nf_194
    s_bfm_b64 exec, 32, 0
    buffer_store_dword v10, v21, s[36:39], s75 offen sc1
    s_mov_b64 exec, -1
nf_194:
    s_lshl_b32 s72, s50, 10
    s_add_u32 s72, s72, s43
    s_mul_i32 s73, s42, 14848
    s_mul_i32 s72, s72, 896
    s_add_u32 m0, s73, 0
    s_add_u32 s81, s72, 0
    s_bfm_b64 exec, 56, 0
    buffer_load_dwordx4 v7, s[4:7], s81 offen lds
    s_add_u32 m0, m0, 928
    s_add_u32 s81, s81, 57344
    buffer_load_dwordx4 v7, s[4:7], s81 offen lds
    s_mov_b64 exec, -1
    s_add_u32 m0, s73, 1856
    s_add_u32 s81, s72, 114688
    s_bfm_b64 exec, 56, 0
    buffer_load_dwordx4 v7, s[4:7], s81 offen lds
    s_add_u32 m0, m0, 928
    s_add_u32 s81, s81, 57344
    buffer_load_dwordx4 v7, s[4:7], s81 offen lds
    s_mov_b64 exec, -1
    s_add_u32 m0, s73, 3712
    s_add_u32 s81, s72, 229376
    s_bfm_b64 exec, 56, 0
    buffer_load_dwordx4 v7, s[4:7], s81 offen lds
    s_add_u32 m0, m0, 928
    s_add_u32 s81, s81, 57344
    buffer_load_dwordx4 v7, s[4:7], s81 offen lds
    s_mov_b64 exec, -1
    s_add_u32 m0, s73, 5568
    s_add_u32 s81, s72, 344064
    s_bfm_b64 exec, 56, 0
    buffer_load_dwordx4 v7, s[4:7], s81 offen lds
    s_add_u32 m0, m0, 928
    s_add_u32 s81, s81, 57344
    buffer_load_dwordx4 v7, s[4:7], s81 offen lds
    s_mov_b64 exec, -1
    s_add_u32 m0, s73, 7424
    s_add_u32 s81, s72, 458752
    s_bfm_b64 exec, 56, 0
    buffer_load_dwordx4 v7, s[4:7], s81 offen lds
    s_add_u32 m0, m0, 928
    s_add_u32 s81, s81, 57344
    buffer_load_dwordx4 v7, s[4:7], s81 offen lds
    s_mov_b64 exec, -1
    s_add_u32 m0, s73, 9280
    s_add_u32 s81, s72, 573440
    s_bfm_b64 exec, 56, 0
    buffer_load_dwordx4 v7, s[4:7], s81 offen lds
    s_add_u32 m0, m0, 928
    s_add_u32 s81, s81, 57344
    buffer_load_dwordx4 v7, s[4:7], s81 offen lds
    s_mov_b64 exec, -1
    s_add_u32 m0, s73, 11136
    s_add_u32 s81, s72, 688128
    s_bfm_b64 exec, 56, 0
    buffer_load_dwordx4 v7, s[4:7], s81 offen lds
    s_add_u32 m0, m0, 928
    s_add_u32 s81, s81, 57344
    buffer_load_dwordx4 v7, s[4:7], s81 offen lds
    s_mov_b64 exec, -1
    s_add_u32 m0, s73, 12992
    s_add_u32 s81, s72, 802816
    s_bfm_b64 exec, 56, 0
    buffer_load_dwordx4 v7, s[4:7], s81 offen lds
    s_add_u32 m0, m0, 928
    s_add_u32 s81, s81, 57344
    buffer_load_dwordx4 v7, s[4:7], s81 offen lds
    s_mov_b64 exec, -1
    s_waitcnt vmcnt(0) lgkmcnt(0)
    s_branch L_join0
L_hot_end:
ps_2:
L_pad_9006:
    s_cbranch_execz L_ret_1
    s_mul_i32 s88, s42, 7168
    s_add_u32 s88, s88, 65536
    v_lshlrev_b32 v20, 7, v1
    s_bfm_b64 exec, 56, 0
    buffer_load_dword v65, v20, s[36:39], s88 offen sc1
    s_mov_b64 exec, -1
    s_waitcnt vmcnt(0)
    v_cmp_ne_u32_e64 vcc, s44, v65
    s_cbranch_vccz pb_3
    s_sub_u32 s47, s47, 1
    s_cbranch_scc0 ps_2
    s_mov_b32 s47, 0
    s_branch pb_3
ps_4:
    s_lshl_b32 s88, s42, 10
    s_add_u32 s88, s88, 655360
    v_lshlrev_b32 v20, 7, v1
    s_bfm_b64 exec, 8, 0
    buffer_load_dword v65, v20, s[36:39], s88 offen sc1
    s_mov_b64 exec, -1
    s_waitcnt vmcnt(0)
    v_cmp_ne_u32_e64 vcc, s44, v65
    s_cbranch_vccz pb_5
    s_sub_u32 s47, s47, 1
    s_cbranch_scc0 ps_4
    s_mov_b32 s47, 0
    s_branch pb_5
cs_6:
    s_add_u32 m0, s72, 0
    s_add_u32 s88, s73, 14680064
    buffer_load_dwordx4 v7, s[36:39], s88 offen sc1 lds
    s_add_u32 m0, s72, 28672
    s_add_u32 s88, s74, 14680064
    buffer_load_dwordx4 v7, s[36:39], s88 offen sc1 lds
    s_add_u32 m0, s72, 4096
    s_add_u32 s88, s73, 14684160
    buffer_load_dwordx4 v7, s[36:39], s88 offen sc1 lds
    s_add_u32 m0, s72, 32768
    s_add_u32 s88, s74, 14684160
    buffer_load_dwordx4 v7, s[36:39], s88 offen sc1 lds
    s_add_u32 m0, s72, 8192
    s_add_u32 s88, s73, 14688256
    buffer_load_dwordx4 v7, s[36:39], s88 offen sc1 lds
    s_add_u32 m0, s72, 36864
    s_add_u32 s88, s74, 14688256
    buffer_load_dwordx4 v7, s[36:39], s88 offen sc1 lds
    s_add_u32 m0, s72, 12288
    s_add_u32 s88, s73, 14692352
    buffer_load_dwordx4 v7, s[36:39], s88 offen sc1 lds
    s_add_u32 m0, s72, 40960
    s_add_u32 s88, s74, 14692352
    buffer_load_dwordx4 v7, s[36:39], s88 offen sc1 lds
    s_add_u32 m0, s72, 16384
    s_add_u32 s88, s73, 14696448
    buffer_load_dwordx4 v7, s[36:39], s88 offen sc1 lds
    s_add_u32 m0, s72, 45056
    s_add_u32 s88, s74, 14696448
    buffer_load_dwordx4 v7, s[36:39], s88 offen sc1 lds
    s_add_u32 m0, s72, 20480
    s_add_u32 s88, s73, 14700544
    buffer_load_dwordx4 v7, s[36:39], s88 offen sc1 lds
    s_add_u32 m0, s72, 49152
    s_add_u32 s88, s74, 14700544
    buffer_load_dwordx4 v7, s[36:39], s88 offen sc1 lds
    s_add_u32 m0, s72, 24576
    s_add_u32 s88, s73, 14704640
    buffer_load_dwordx4 v7, s[36:39], s88 offen sc1 lds
    s_add_u32 m0, s72, 53248
    s_add_u32 s88, s74, 14704640
    buffer_load_dwordx4 v7, s[36:39], s88 offen sc1 lds
    s_waitcnt vmcnt(12)
    ds_read_b32 v120, v66 offset:0
    ds_read_b32 v121, v66 offset:28672
    s_waitcnt vmcnt(10)
    ds_read_b32 v122, v66 offset:4096
    ds_read_b32 v123, v66 offset:32768
    s_waitcnt vmcnt(8)
    ds_read_b32 v124, v66 offset:8192
    ds_read_b32 v125, v66 offset:36864
    s_waitcnt vmcnt(6)
    ds_read_b32 v126, v66 offset:12288
    ds_read_b32 v127, v66 offset:40960
    s_waitcnt vmcnt(4)
    ds_read_b32 v128, v66 offset:16384
    ds_read_b32 v129, v66 offset:45056
    s_waitcnt vmcnt(2)
    ds_read_b32 v130, v66 offset:20480
    ds_read_b32 v131, v66 offset:49152
    s_waitcnt vmcnt(0)
    ds_read_b32 v132, v66 offset:24576
    ds_read_b32 v133, v66 offset:53248
    s_waitcnt vmcnt(0) lgkmcnt(0)
    v_bitop3_b32 v20, v120, v121, v122 bitop3:254
    v_bitop3_b32 v20, v20, v123, v124 bitop3:254
    v_bitop3_b32 v20, v20, v125, v126 bitop3:254
    v_bitop3_b32 v20, v20, v127, v128 bitop3:254
    v_bitop3_b32 v20, v20, v129, v130 bitop3:254
    v_bitop3_b32 v20, v20, v131, v132 bitop3:254
    v_bitop3_b32 v20, v20, v133, -2 bitop3:254
    v_cmp_eq_u32_e64 vcc, -1, v20
    s_cbranch_vccz cb_7
    s_sub_u32 s47, s47, 1
    s_cbranch_scc0 cs_6
    s_mov_b32 s47, 0
    s_branch cb_7
ps_10:
    s_lshl_b32 s88, s40, 7
    s_add_u32 s88, s88, 688128
    v_lshlrev_b32 v20, 12, v1
    s_bfm_b64 exec, 8, 0
    buffer_load_dword v23, v20, s[36:39], s88 offen sc1
    s_mov_b64 exec, -1
    s_waitcnt vmcnt(0)
    v_cmp_ne_u32 vcc, s44, v23
    s_cbranch_vccz pb_11
    s_sub_u32 s47, s47, 1
    s_cbranch_scc0 ps_10
    s_mov_b32 s47, 0
    s_branch pb_11
ss_13:
    buffer_load_dwordx4 v[72:75], v233, s[36:39], s77 offen sc1
    buffer_load_dwordx4 v[76:79], v233, s[36:39], s77 offen offset:1024 sc1
    s_waitcnt vmcnt(0)
    v_cmp_ne_u32 vcc, s44, v74
    v_cmp_ne_u32 s[70:71], s44, v78
    s_or_b64 vcc, vcc, s[70:71]
    s_cbranch_scc0 sb_14
    s_sub_u32 s47, s47, 1
    s_cbranch_scc0 ss_13
    s_mov_b32 s47, 0
    s_branch sb_14
ps_22:
    s_lshl2_add_u32 s88, s41, s42
    s_lshl_b32 s88, s88, 10
    s_add_u32 s88, s88, 720896
    v_lshlrev_b32 v20, 7, v1
    s_bfm_b64 exec, 8, 0
    buffer_load_dword v23, v20, s[36:39], s88 offen sc1
    s_mov_b64 exec, -1
    s_waitcnt vmcnt(0)
    v_cmp_ne_u32_e64 vcc, s44, v23
    s_cbranch_vccz pb_23
    s_sub_u32 s47, s47, 1
    s_cbranch_scc0 ps_22
    s_mov_b32 s47, 0
    s_branch pb_23
cs_24:
    s_add_u32 s88, s73, 0
    buffer_load_dwordx4 v[68:71], v7, s[36:39], s88 offen offset:0 sc1
    buffer_load_dwordx4 v[72:75], v7, s[36:39], s88 offen offset:1024 sc1
    buffer_load_dwordx4 v[76:79], v7, s[36:39], s88 offen offset:2048 sc1
    buffer_load_dwordx4 v[80:83], v7, s[36:39], s88 offen offset:3072 sc1
    s_add_u32 s88, s73, 4096
    buffer_load_dwordx4 v[84:87], v7, s[36:39], s88 offen offset:0 sc1
    buffer_load_dwordx4 v[88:91], v7, s[36:39], s88 offen offset:1024 sc1
    buffer_load_dwordx4 v[92:95], v7, s[36:39], s88 offen offset:2048 sc1
    buffer_load_dwordx4 v[96:99], v7, s[36:39], s88 offen offset:3072 sc1
    s_add_u32 s88, s73, 8192
    buffer_load_dwordx4 v[100:103], v7, s[36:39], s88 offen offset:0 sc1
    buffer_load_dwordx4 v[104:107], v7, s[36:39], s88 offen offset:1024 sc1
    buffer_load_dwordx4 v[108:111], v7, s[36:39], s88 offen offset:2048 sc1
    s_waitcnt vmcnt(0) lgkmcnt(0)
    v_bitop3_b32 v20, v68, v72, v76 bitop3:254
    v_bitop3_b32 v20, v20, v80, -2 bitop3:254
    v_cmp_eq_u32_e64 vcc, -1, v20
    s_cbranch_vccz cb_25
    s_sub_u32 s47, s47, 1
    s_cbranch_scc0 cs_24
    s_mov_b32 s47, 0
    s_branch cb_25
cs_26:
    s_add_u32 s88, s73, 4096
    buffer_load_dwordx4 v[84:87], v7, s[36:39], s88 offen offset:0 sc1
    buffer_load_dwordx4 v[88:91], v7, s[36:39], s88 offen offset:1024 sc1
    buffer_load_dwordx4 v[92:95], v7, s[36:39], s88 offen offset:2048 sc1
    buffer_load_dwordx4 v[96:99], v7, s[36:39], s88 offen offset:3072 sc1
    s_add_u32 s88, s73, 8192
    buffer_load_dwordx4 v[100:103], v7, s[36:39], s88 offen offset:0 sc1
    buffer_load_dwordx4 v[104:107], v7, s[36:39], s88 offen offset:1024 sc1
    buffer_load_dwordx4 v[108:111], v7, s[36:39], s88 offen offset:2048 sc1
    buffer_load_dwordx4 v[112:115], v7, s[36:39], s88 offen offset:3072 sc1
    s_add_u32 s88, s73, 12288
    buffer_load_dwordx4 v[116:119], v7, s[36:39], s88 offen offset:0 sc1
    buffer_load_dwordx4 v[120:123], v7, s[36:39], s88 offen offset:1024 sc1
    buffer_load_dwordx4 v[124:127], v7, s[36:39], s88 offen offset:2048 sc1
    buffer_load_dwordx4 v[128:131], v7, s[36:39], s88 offen offset:3072 sc1
    s_waitcnt vmcnt(0) lgkmcnt(0)
    v_bitop3_b32 v20, v84, v88, v92 bitop3:254
    v_bitop3_b32 v20, v20, v96, -2 bitop3:254
    v_cmp_eq_u32_e64 vcc, -1, v20
    s_cbranch_vccz cb_27
    s_sub_u32 s47, s47, 1
    s_cbranch_scc0 cs_26
    s_mov_b32 s47, 0
    s_branch cb_27
cs_28:
    s_add_u32 s88, s73, 8192
    buffer_load_dwordx4 v[100:103], v7, s[36:39], s88 offen offset:0 sc1
    buffer_load_dwordx4 v[104:107], v7, s[36:39], s88 offen offset:1024 sc1
    buffer_load_dwordx4 v[108:111], v7, s[36:39], s88 offen offset:2048 sc1
    buffer_load_dwordx4 v[112:115], v7, s[36:39], s88 offen offset:3072 sc1
    s_add_u32 s88, s73, 12288
    buffer_load_dwordx4 v[116:119], v7, s[36:39], s88 offen offset:0 sc1
    buffer_load_dwordx4 v[120:123], v7, s[36:39], s88 offen offset:1024 sc1
    buffer_load_dwordx4 v[124:127], v7, s[36:39], s88 offen offset:2048 sc1
    buffer_load_dwordx4 v[128:131], v7, s[36:39], s88 offen offset:3072 sc1
    s_add_u32 s88, s73, 65536
    buffer_load_dwordx4 v[68:71], v7, s[36:39], s88 offen offset:0 sc1
    buffer_load_dwordx4 v[72:75], v7, s[36:39], s88 offen offset:1024 sc1
    buffer_load_dwordx4 v[76:79], v7, s[36:39], s88 offen offset:2048 sc1
    buffer_load_dwordx4 v[80:83], v7, s[36:39], s88 offen offset:3072 sc1
    s_add_u32 s88, s73, 69632
    buffer_load_dwordx4 v[84:87], v7, s[36:39], s88 offen offset:0 sc1
    s_waitcnt vmcnt(0) lgkmcnt(0)
    v_bitop3_b32 v20, v100, v104, v108 bitop3:254
    v_bitop3_b32 v20, v20, v112, -2 bitop3:254
    v_cmp_eq_u32_e64 vcc, -1, v20
    s_cbranch_vccz cb_29
    s_sub_u32 s47, s47, 1
    s_cbranch_scc0 cs_28
    s_mov_b32 s47, 0
    s_branch cb_29
cs_30:
    s_add_u32 s88, s73, 12288
    buffer_load_dwordx4 v[116:119], v7, s[36:39], s88 offen offset:0 sc1
    buffer_load_dwordx4 v[120:123], v7, s[36:39], s88 offen offset:1024 sc1
    buffer_load_dwordx4 v[124:127], v7, s[36:39], s88 offen offset:2048 sc1
    buffer_load_dwordx4 v[128:131], v7, s[36:39], s88 offen offset:3072 sc1
    s_add_u32 s88, s73, 65536
    buffer_load_dwordx4 v[68:71], v7, s[36:39], s88 offen offset:0 sc1
    buffer_load_dwordx4 v[72:75], v7, s[36:39], s88 offen offset:1024 sc1
    buffer_load_dwordx4 v[76:79], v7, s[36:39], s88 offen offset:2048 sc1
    buffer_load_dwordx4 v[80:83], v7, s[36:39], s88 offen offset:3072 sc1
    s_add_u32 s88, s73, 69632
    buffer_load_dwordx4 v[84:87], v7, s[36:39], s88 offen offset:0 sc1
    buffer_load_dwordx4 v[88:91], v7, s[36:39], s88 offen offset:1024 sc1
    buffer_load_dwordx4 v[92:95], v7, s[36:39], s88 offen offset:2048 sc1
    buffer_load_dwordx4 v[96:99], v7, s[36:39], s88 offen offset:3072 sc1
    s_add_u32 s88, s73, 73728
    buffer_load_dwordx4 v[100:103], v7, s[36:39], s88 offen offset:0 sc1
    buffer_load_dwordx4 v[104:107], v7, s[36:39], s88 offen offset:1024 sc1
    s_waitcnt vmcnt(0) lgkmcnt(0)
    v_bitop3_b32 v20, v116, v120, v124 bitop3:254
    v_bitop3_b32 v20, v20, v128, -2 bitop3:254
    v_cmp_eq_u32 vcc, -1, v20
    s_cbranch_vccz cb_31
    s_sub_u32 s47, s47, 1
    s_cbranch_scc0 cs_30
    s_mov_b32 s47, 0
    s_branch cb_31
L_helper2:
L_pad_9258:
    s_cbranch_execz L_ret_2
    s_waitcnt vmcnt(0) lgkmcnt(0)
    s_barrier
    v_mul_u32_u24 v2, 1792, v5
    v_sub_u32 v3, 12544, v2
    v_lshl_add_u32 v2, v4, 4, v2
    v_lshl_add_u32 v3, v4, 4, v3
    s_mul_i32 s9, s42, 11264
    s_min_u32 s9, s9, 31744
    s_mul_i32 s8, s45, 14336
    s_add_u32 s8, s8, s9
    s_add_u32 m0, s9, 0
    s_add_u32 s81, s8, 2899968
    buffer_load_dwordx4 v7, s[36:39], s81 offen offset:0 sc1 lds
    buffer_load_dwordx4 v7, s[36:39], s81 offen offset:1024 sc1 lds
    buffer_load_dwordx4 v7, s[36:39], s81 offen offset:2048 sc1 lds
    buffer_load_dwordx4 v7, s[36:39], s81 offen offset:3072 sc1 lds
    s_add_u32 m0, s9, 4096
    s_add_u32 s81, s8, 2904064
    buffer_load_dwordx4 v7, s[36:39], s81 offen offset:0 sc1 lds
    buffer_load_dwordx4 v7, s[36:39], s81 offen offset:1024 sc1 lds
    buffer_load_dwordx4 v7, s[36:39], s81 offen offset:2048 sc1 lds
    buffer_load_dwordx4 v7, s[36:39], s81 offen offset:3072 sc1 lds
    s_add_u32 m0, s9, 8192
    s_add_u32 s81, s8, 2908160
    buffer_load_dwordx4 v7, s[36:39], s81 offen offset:0 sc1 lds
    buffer_load_dwordx4 v7, s[36:39], s81 offen offset:1024 sc1 lds
    s_add_u32 m0, s9, 10240
    s_add_u32 s81, s8, 2910208
    buffer_load_dwordx4 v7, s[36:39], s81 offen offset:0 sc1 lds
    s_mul_i32 s11, s42, 11264
    s_min_u32 s11, s11, 31744
    s_mul_i32 s10, s45, 14336
    s_add_u32 s10, s10, s11
    s_add_u32 m0, s11, 100352
    s_add_u32 s81, s10, 2942976
    buffer_load_dwordx4 v7, s[36:39], s81 offen offset:0 sc1 lds
    s_waitcnt vmcnt(0)
    s_lshl_b32 s88, s40, 7
    s_add_u32 s88, s88, 671744
    v_lshlrev_b32 v20, 7, v1
    v_mov_b32 v23, s44
    s_bfm_b64 exec, 1, 0
    buffer_load_dword v23, v20, s[36:39], s88 offen sc1
    s_mov_b64 exec, -1
    s_waitcnt vmcnt(0)
    v_cmp_ne_u32_e64 vcc, s44, v23
    s_cbranch_vccnz ps_104
pb_105:
    s_branch L_join1
cs_80:
    s_cmp_eq_u32 s41, 7
    s_cbranch_scc1 cb_81
    s_add_u32 s88, s75, 25165824
    buffer_load_dwordx4 v[68:71], v7, s[36:39], s88 offen offset:0 sc1
    buffer_load_dwordx4 v[72:75], v7, s[36:39], s88 offen offset:1024 sc1
    buffer_load_dwordx4 v[76:79], v7, s[36:39], s88 offen offset:2048 sc1
    buffer_load_dwordx4 v[80:83], v7, s[36:39], s88 offen offset:3072 sc1
    s_add_u32 s88, s75, 25169920
    buffer_load_dwordx4 v[84:87], v7, s[36:39], s88 offen offset:0 sc1
    buffer_load_dwordx4 v[88:91], v7, s[36:39], s88 offen offset:1024 sc1
    buffer_load_dwordx4 v[92:95], v7, s[36:39], s88 offen offset:2048 sc1
    buffer_load_dwordx4 v[96:99], v7, s[36:39], s88 offen offset:3072 sc1
    s_add_u32 s88, s75, 25174016
    buffer_load_dwordx4 v[100:103], v7, s[36:39], s88 offen offset:0 sc1
    buffer_load_dwordx4 v[104:107], v7, s[36:39], s88 offen offset:1024 sc1
    buffer_load_dwordx4 v[108:111], v7, s[36:39], s88 offen offset:2048 sc1
    buffer_load_dwordx4 v[112:115], v7, s[36:39], s88 offen offset:3072 sc1
    s_add_u32 s88, s75, 25178112
    buffer_load_dwordx4 v[116:119], v7, s[36:39], s88 offen offset:0 sc1
    s_waitcnt vmcnt(0) lgkmcnt(0)
    v_bitop3_b32 v20, v68, v72, v76 bitop3:254
    v_bitop3_b32 v20, v20, v80, -2 bitop3:254
    v_cmp_eq_u32_e64 vcc, -1, v20
    s_cbranch_vccz cb_81
    s_sub_u32 s47, s47, 1
    s_cbranch_scc0 cs_80
    s_mov_b32 s47, 0
    s_branch cb_81
cs_82:
    s_cmp_eq_u32 s41, 7
    s_cbranch_scc1 cb_83
    s_add_u32 s88, s75, 25169920
    buffer_load_dwordx4 v[84:87], v7, s[36:39], s88 offen offset:0 sc1
    buffer_load_dwordx4 v[88:91], v7, s[36:39], s88 offen offset:1024 sc1
    buffer_load_dwordx4 v[92:95], v7, s[36:39], s88 offen offset:2048 sc1
    buffer_load_dwordx4 v[96:99], v7, s[36:39], s88 offen offset:3072 sc1
    s_add_u32 s88, s75, 25174016
    buffer_load_dwordx4 v[100:103], v7, s[36:39], s88 offen offset:0 sc1
    buffer_load_dwordx4 v[104:107], v7, s[36:39], s88 offen offset:1024 sc1
    buffer_load_dwordx4 v[108:111], v7, s[36:39], s88 offen offset:2048 sc1
    buffer_load_dwordx4 v[112:115], v7, s[36:39], s88 offen offset:3072 sc1
    s_add_u32 s88, s75, 25178112
    buffer_load_dwordx4 v[116:119], v7, s[36:39], s88 offen offset:0 sc1
    buffer_load_dwordx4 v[120:123], v7, s[36:39], s88 offen offset:1024 sc1
    buffer_load_dwordx4 v[124:127], v7, s[36:39], s88 offen offset:2048 sc1
    s_waitcnt vmcnt(0) lgkmcnt(0)
    v_bitop3_b32 v20, v84, v88, v92 bitop3:254
    v_bitop3_b32 v20, v20, v96, -2 bitop3:254
    v_cmp_eq_u32_e64 vcc, -1, v20
    s_cbranch_vccz cb_83
    s_sub_u32 s47, s47, 1
    s_cbranch_scc0 cs_82
    s_mov_b32 s47, 0
    s_branch cb_83
cs_84:
    s_cmp_eq_u32 s41, 7
    s_cbranch_scc1 cb_85
    s_add_u32 s88, s75, 25174016
    buffer_load_dwordx4 v[100:103], v7, s[36:39], s88 offen offset:0 sc1
    buffer_load_dwordx4 v[104:107], v7, s[36:39], s88 offen offset:1024 sc1
    buffer_load_dwordx4 v[108:111], v7, s[36:39], s88 offen offset:2048 sc1
    buffer_load_dwordx4 v[112:115], v7, s[36:39], s88 offen offset:3072 sc1
    s_add_u32 s88, s75, 25178112
    buffer_load_dwordx4 v[116:119], v7, s[36:39], s88 offen offset:0 sc1
    buffer_load_dwordx4 v[120:123], v7, s[36:39], s88 offen offset:1024 sc1
    buffer_load_dwordx4 v[124:127], v7, s[36:39], s88 offen offset:2048 sc1
    buffer_load_dwordx4 v[128:131], v7, s[36:39], s88 offen offset:3072 sc1
    s_add_u32 s88, s75, 25182208
    buffer_load_dwordx4 v[68:71], v7, s[36:39], s88 offen offset:0 sc1
    buffer_load_dwordx4 v[72:75], v7, s[36:39], s88 offen offset:1024 sc1
    buffer_load_dwordx4 v[76:79], v7, s[36:39], s88 offen offset:2048 sc1
    s_waitcnt vmcnt(0) lgkmcnt(0)
    v_bitop3_b32 v20, v100, v104, v108 bitop3:254
    v_bitop3_b32 v20, v20, v112, -2 bitop3:254
    v_cmp_eq_u32_e64 vcc, -1, v20
    s_cbranch_vccz cb_85
    s_sub_u32 s47, s47, 1
    s_cbranch_scc0 cs_84
    s_mov_b32 s47, 0
    s_branch cb_85
cs_86:
    s_cmp_eq_u32 s41, 7
    s_cbranch_scc1 cb_87
    s_add_u32 s88, s75, 25178112
    buffer_load_dwordx4 v[116:119], v7, s[36:39], s88 offen offset:0 sc1
    buffer_load_dwordx4 v[120:123], v7, s[36:39], s88 offen offset:1024 sc1
    buffer_load_dwordx4 v[124:127], v7, s[36:39], s88 offen offset:2048 sc1
    buffer_load_dwordx4 v[128:131], v7, s[36:39], s88 offen offset:3072 sc1
    s_add_u32 s88, s75, 25182208
    buffer_load_dwordx4 v[68:71], v7, s[36:39], s88 offen offset:0 sc1
    buffer_load_dwordx4 v[72:75], v7, s[36:39], s88 offen offset:1024 sc1
    buffer_load_dwordx4 v[76:79], v7, s[36:39], s88 offen offset:2048 sc1
    buffer_load_dwordx4 v[80:83], v7, s[36:39], s88 offen offset:3072 sc1
    s_add_u32 s88, s75, 25186304
    buffer_load_dwordx4 v[84:87], v7, s[36:39], s88 offen offset:0 sc1
    buffer_load_dwordx4 v[88:91], v7, s[36:39], s88 offen offset:1024 sc1
    buffer_load_dwordx4 v[92:95], v7, s[36:39], s88 offen offset:2048 sc1
    s_waitcnt vmcnt(0) lgkmcnt(0)
    v_bitop3_b32 v20, v116, v120, v124 bitop3:254
    v_bitop3_b32 v20, v20, v128, -2 bitop3:254
    v_cmp_eq_u32_e64 vcc, -1, v20
    s_cbranch_vccz cb_87
    s_sub_u32 s47, s47, 1
    s_cbranch_scc0 cs_86
    s_mov_b32 s47, 0
    s_branch cb_87
cs_88:
    s_cmp_eq_u32 s41, 7
    s_cbranch_scc1 cb_89
    s_add_u32 s88, s75, 25182208
    buffer_load_dwordx4 v[68:71], v7, s[36:39], s88 offen offset:0 sc1
    buffer_load_dwordx4 v[72:75], v7, s[36:39], s88 offen offset:1024 sc1
    buffer_load_dwordx4 v[76:79], v7, s[36:39], s88 offen offset:2048 sc1
    buffer_load_dwordx4 v[80:83], v7, s[36:39], s88 offen offset:3072 sc1
    s_add_u32 s88, s75, 25186304
    buffer_load_dwordx4 v[84:87], v7, s[36:39], s88 offen offset:0 sc1
    buffer_load_dwordx4 v[88:91], v7, s[36:39], s88 offen offset:1024 sc1
    buffer_load_dwordx4 v[92:95], v7, s[36:39], s88 offen offset:2048 sc1
    buffer_load_dwordx4 v[96:99], v7, s[36:39], s88 offen offset:3072 sc1
    s_add_u32 s88, s75, 25190400
    buffer_load_dwordx2 v[100:101], v22, s[36:39], s88 offen offset:0 sc1
    buffer_load_dwordx2 v[102:103], v22, s[36:39], s88 offen offset:512 sc1
    buffer_load_dwordx2 v[104:105], v22, s[36:39], s88 offen offset:1024 sc1
    buffer_load_dwordx2 v[106:107], v22, s[36:39], s88 offen offset:1536 sc1
    buffer_load_dwordx2 v[108:109], v22, s[36:39], s88 offen offset:2048 sc1
    buffer_load_dwordx2 v[110:111], v22, s[36:39], s88 offen offset:2560 sc1
    s_waitcnt vmcnt(10) lgkmcnt(0)
    v_bitop3_b32 v20, v68, v72, v76 bitop3:254
    v_bitop3_b32 v20, v20, v80, -2 bitop3:254
    v_cmp_eq_u32_e64 vcc, -1, v20
    s_cbranch_vccz cb_89
    s_sub_u32 s47, s47, 1
    s_cbranch_scc0 cs_88
    s_mov_b32 s47, 0
    s_branch cb_89
cs_90:
    s_cmp_eq_u32 s41, 7
    s_cbranch_scc1 cb_91
    s_add_u32 s88, s75, 25186304
    buffer_load_dwordx4 v[84:87], v7, s[36:39], s88 offen offset:0 sc1
    buffer_load_dwordx4 v[88:91], v7, s[36:39], s88 offen offset:1024 sc1
    buffer_load_dwordx4 v[92:95], v7, s[36:39], s88 offen offset:2048 sc1
    buffer_load_dwordx4 v[96:99], v7, s[36:39], s88 offen offset:3072 sc1
    s_add_u32 s88, s75, 25190400
    buffer_load_dwordx2 v[100:101], v22, s[36:39], s88 offen offset:0 sc1
    buffer_load_dwordx2 v[102:103], v22, s[36:39], s88 offen offset:512 sc1
    buffer_load_dwordx2 v[104:105], v22, s[36:39], s88 offen offset:1024 sc1
    buffer_load_dwordx2 v[106:107], v22, s[36:39], s88 offen offset:1536 sc1
    buffer_load_dwordx2 v[108:109], v22, s[36:39], s88 offen offset:2048 sc1
    buffer_load_dwordx2 v[110:111], v22, s[36:39], s88 offen offset:2560 sc1
    buffer_load_dwordx2 v[112:113], v22, s[36:39], s88 offen offset:3072 sc1
    buffer_load_dwordx2 v[114:115], v22, s[36:39], s88 offen offset:3584 sc1
    s_waitcnt vmcnt(8) lgkmcnt(0)
    v_bitop3_b32 v20, v84, v88, v92 bitop3:254
    v_bitop3_b32 v20, v20, v96, -2 bitop3:254
    v_cmp_eq_u32_e64 vcc, -1, v20
    s_cbranch_vccz cb_91
    s_sub_u32 s47, s47, 1
    s_cbranch_scc0 cs_90
    s_mov_b32 s47, 0
    s_branch cb_91
cs_92:
    s_cmp_eq_u32 s41, 7
    s_cbranch_scc1 cb_93
    s_add_u32 s88, s75, 25190400
    buffer_load_dwordx2 v[100:101], v22, s[36:39], s88 offen offset:0 sc1
    buffer_load_dwordx2 v[102:103], v22, s[36:39], s88 offen offset:512 sc1
    buffer_load_dwordx2 v[104:105], v22, s[36:39], s88 offen offset:1024 sc1
    buffer_load_dwordx2 v[106:107], v22, s[36:39], s88 offen offset:1536 sc1
    buffer_load_dwordx2 v[108:109], v22, s[36:39], s88 offen offset:2048 sc1
    buffer_load_dwordx2 v[110:111], v22, s[36:39], s88 offen offset:2560 sc1
    buffer_load_dwordx2 v[112:113], v22, s[36:39], s88 offen offset:3072 sc1
    buffer_load_dwordx2 v[114:115], v22, s[36:39], s88 offen offset:3584 sc1
    s_waitcnt vmcnt(0) lgkmcnt(0)
    v_bitop3_b32 v20, v100, v104, v108 bitop3:254
    v_bitop3_b32 v20, v20, v112, v102 bitop3:254
    v_bitop3_b32 v20, v20, v106, v110 bitop3:254
    v_bitop3_b32 v20, v20, v114, -2 bitop3:254
    v_cmp_eq_u32_e64 vcc, -1, v20
    s_cbranch_vccz cb_93
    s_sub_u32 s47, s47, 1
    s_cbranch_scc0 cs_92
    s_mov_b32 s47, 0
    s_branch cb_93
cs_94:
    s_mul_i32 s88, s74, 14336
L_pad_9495:
    s_cbranch_execz L_ret_2
    s_nop 0
    s_add_u32 s88, s88, 16777216
    buffer_load_dwordx4 v[200:203], v2, s[36:39], s88 offen offset:0 sc1
    buffer_load_dwordx4 v[204:207], v2, s[36:39], s88 offen offset:256 sc1
    buffer_load_dwordx4 v[208:211], v2, s[36:39], s88 offen offset:512 sc1
    buffer_load_dwordx4 v[212:215], v2, s[36:39], s88 offen offset:768 sc1
    buffer_load_dwordx4 v[216:219], v2, s[36:39], s88 offen offset:1024 sc1
    buffer_load_dwordx4 v[220:223], v2, s[36:39], s88 offen offset:1280 sc1
    buffer_load_dwordx4 v[224:227], v2, s[36:39], s88 offen offset:1536 sc1
    buffer_load_dwordx4 v[228:231], v3, s[36:39], s88 offen offset:0 sc1
    buffer_load_dwordx4 v[232:235], v3, s[36:39], s88 offen offset:256 sc1
    buffer_load_dwordx4 v[236:239], v3, s[36:39], s88 offen offset:512 sc1
    buffer_load_dwordx4 v[240:243], v3, s[36:39], s88 offen offset:768 sc1
    buffer_load_dwordx4 v[244:247], v3, s[36:39], s88 offen offset:1024 sc1
    buffer_load_dwordx4 v[248:251], v3, s[36:39], s88 offen offset:1280 sc1
    buffer_load_dwordx4 v[252:255], v3, s[36:39], s88 offen offset:1536 sc1
    s_waitcnt vmcnt(0) lgkmcnt(0)
    v_bitop3_b32 v20, v200, v204, v208 bitop3:254
    v_bitop3_b32 v20, v20, v212, -2 bitop3:254
    v_cmp_eq_u32_e64 vcc, -1, v20
    s_cbranch_vccz cb_95
    s_sub_u32 s47, s47, 1
    s_cbranch_scc0 cs_94
    s_mov_b32 s47, 0
    s_branch cb_95
cs_96:
    s_mul_i32 s88, s74, 14336
    s_add_u32 s88, s88, 16777216
    buffer_load_dwordx4 v[216:219], v2, s[36:39], s88 offen offset:1024 sc1
    buffer_load_dwordx4 v[220:223], v2, s[36:39], s88 offen offset:1280 sc1
    buffer_load_dwordx4 v[224:227], v2, s[36:39], s88 offen offset:1536 sc1
    buffer_load_dwordx4 v[228:231], v3, s[36:39], s88 offen offset:0 sc1
    buffer_load_dwordx4 v[232:235], v3, s[36:39], s88 offen offset:256 sc1
    buffer_load_dwordx4 v[236:239], v3, s[36:39], s88 offen offset:512 sc1
    buffer_load_dwordx4 v[240:243], v3, s[36:39], s88 offen offset:768 sc1
    buffer_load_dwordx4 v[244:247], v3, s[36:39], s88 offen offset:1024 sc1
    buffer_load_dwordx4 v[248:251], v3, s[36:39], s88 offen offset:1280 sc1
    buffer_load_dwordx4 v[252:255], v3, s[36:39], s88 offen offset:1536 sc1
    s_waitcnt vmcnt(0) lgkmcnt(0)
    v_bitop3_b32 v20, v216, v220, v224 bitop3:254
    v_bitop3_b32 v20, v20, v228, -2 bitop3:254
    v_cmp_eq_u32_e64 vcc, -1, v20
    s_cbranch_vccz cb_97
    s_sub_u32 s47, s47, 1
    s_cbranch_scc0 cs_96
    s_mov_b32 s47, 0
    s_branch cb_97
cs_99:
    s_mul_i32 s88, s74, 14336
    s_add_u32 s88, s88, 16777216
    buffer_load_dwordx4 v[232:235], v3, s[36:39], s88 offen offset:256 sc1
    buffer_load_dwordx4 v[236:239], v3, s[36:39], s88 offen offset:512 sc1
    buffer_load_dwordx4 v[240:243], v3, s[36:39], s88 offen offset:768 sc1
    buffer_load_dwordx4 v[244:247], v3, s[36:39], s88 offen offset:1024 sc1
    buffer_load_dwordx4 v[248:251], v3, s[36:39], s88 offen offset:1280 sc1
    buffer_load_dwordx4 v[252:255], v3, s[36:39], s88 offen offset:1536 sc1
    s_waitcnt vmcnt(0) lgkmcnt(0)
    v_bitop3_b32 v20, v232, v236, v240 bitop3:254
    v_bitop3_b32 v20, v20, v244, v248 bitop3:254
    v_bitop3_b32 v20, v20, v252, -2 bitop3:254
    v_cmp_eq_u32_e64 vcc, -1, v20
    s_cbranch_vccz cb_100
    s_sub_u32 s47, s47, 1
    s_cbranch_scc0 cs_99
    s_mov_b32 s47, 0
    s_branch cb_100
ss_101:
    buffer_load_dwordx4 v[64:67], v23, s[36:39], s77 offen sc1
    s_mov_b32 exec_lo, 0x0fff0fff
    s_mov_b32 exec_hi, 0x0fff0fff
    buffer_load_dwordx4 v[68:71], v23, s[36:39], s77 offen offset:1024 sc1
    s_mov_b64 exec, -1
    s_waitcnt vmcnt(0)
    v_cmp_ne_u32_e64 vcc, s44, v66
    v_cmp_ne_u32 s[70:71], s44, v70
    s_or_b64 vcc, vcc, s[70:71]
    s_cbranch_scc0 sb_102
    s_sub_u32 s47, s47, 1
    s_cbranch_scc0 ss_101
    s_mov_b32 s47, 0
    s_branch sb_102
ps_104:
    s_lshl_b32 s88, s40, 7
    s_add_u32 s88, s88, 671744
    v_lshlrev_b32_e64 v20, 7, v1
    s_bfm_b64 exec, 1, 0
    buffer_load_dword v23, v20, s[36:39], s88 offen sc1
    s_mov_b64 exec, -1
    s_waitcnt vmcnt(0)
    v_cmp_ne_u32 vcc, s44, v23
    s_cbranch_vccz pb_105
    s_sub_u32 s47, s47, 1
    s_cbranch_scc0 ps_104
    s_mov_b32 s47, 0
    s_branch pb_105
cs_106:
    s_mul_i32 s88, s52, 14336
    s_add_u32 s88, s88, 16777216
    buffer_load_dwordx4 v[200:203], v2, s[36:39], s88 offen offset:0 sc1
    buffer_load_dwordx4 v[204:207], v2, s[36:39], s88 offen offset:256 sc1
    buffer_load_dwordx4 v[208:211], v2, s[36:39], s88 offen offset:512 sc1
    buffer_load_dwordx4 v[212:215], v2, s[36:39], s88 offen offset:768 sc1
    buffer_load_dwordx4 v[216:219], v2, s[36:39], s88 offen offset:1024 sc1
    buffer_load_dwordx4 v[220:223], v2, s[36:39], s88 offen offset:1280 sc1
    buffer_load_dwordx4 v[224:227], v2, s[36:39], s88 offen offset:1536 sc1
    buffer_load_dwordx4 v[228:231], v3, s[36:39], s88 offen offset:0 sc1
    buffer_load_dwordx4 v[232:235], v3, s[36:39], s88 offen offset:256 sc1
    buffer_load_dwordx4 v[236:239], v3, s[36:39], s88 offen offset:512 sc1
    buffer_load_dwordx4 v[240:243], v3, s[36:39], s88 offen offset:768 sc1
    buffer_load_dwordx4 v[244:247], v3, s[36:39], s88 offen offset:1024 sc1
    buffer_load_dwordx4 v[248:251], v3, s[36:39], s88 offen offset:1280 sc1
    buffer_load_dwordx4 v[252:255], v3, s[36:39], s88 offen offset:1536 sc1
    s_waitcnt vmcnt(0) lgkmcnt(0)
    v_bitop3_b32 v20, v200, v204, v208 bitop3:254
    v_bitop3_b32 v20, v20, v212, v216 bitop3:254
    v_bitop3_b32 v20, v20, v220, v224 bitop3:254
    v_bitop3_b32 v20, v20, v228, v232 bitop3:254
    v_bitop3_b32 v20, v20, v236, v240 bitop3:254
    v_bitop3_b32 v20, v20, v244, v248 bitop3:254
    v_bitop3_b32 v20, v20, v252, -2 bitop3:254
    v_cmp_eq_u32 vcc, -1, v20
    s_cbranch_vccz cb_107
    s_sub_u32 s47, s47, 1
    s_cbranch_scc0 cs_106
    s_mov_b32 s47, 0
    s_branch cb_107
cs_108:
    s_add_u32 m0, s72, 0
    s_add_u32 s88, s73, 14680064
    buffer_load_dwordx4 v7, s[36:39], s88 offen sc1 lds
    s_add_u32 m0, s72, 28672
    s_add_u32 s88, s74, 14680064
    buffer_load_dwordx4 v7, s[36:39], s88 offen sc1 lds
    s_add_u32 m0, s72, 4096
    s_add_u32 s88, s73, 14684160
    buffer_load_dwordx4 v7, s[36:39], s88 offen sc1 lds
    s_add_u32 m0, s72, 32768
    s_add_u32 s88, s74, 14684160
    buffer_load_dwordx4 v7, s[36:39], s88 offen sc1 lds
    s_add_u32 m0, s72, 8192
    s_add_u32 s88, s73, 14688256
    buffer_load_dwordx4 v7, s[36:39], s88 offen sc1 lds
    s_add_u32 m0, s72, 36864
    s_add_u32 s88, s74, 14688256
    buffer_load_dwordx4 v7, s[36:39], s88 offen sc1 lds
    s_add_u32 m0, s72, 12288
    s_add_u32 s88, s73, 14692352
    buffer_load_dwordx4 v7, s[36:39], s88 offen sc1 lds
    s_add_u32 m0, s72, 40960
    s_add_u32 s88, s74, 14692352
    buffer_load_dwordx4 v7, s[36:39], s88 offen sc1 lds
    s_add_u32 m0, s72, 16384
    s_add_u32 s88, s73, 14696448
    buffer_load_dwordx4 v7, s[36:39], s88 offen sc1 lds
    s_add_u32 m0, s72, 45056
    s_add_u32 s88, s74, 14696448
    buffer_load_dwordx4 v7, s[36:39], s88 offen sc1 lds
    s_add_u32 m0, s72, 20480
    s_add_u32 s88, s73, 14700544
    buffer_load_dwordx4 v7, s[36:39], s88 offen sc1 lds
    s_add_u32 m0, s72, 49152
    s_add_u32 s88, s74, 14700544
    buffer_load_dwordx4 v7, s[36:39], s88 offen sc1 lds
    s_add_u32 m0, s72, 24576
    s_add_u32 s88, s73, 14704640
    buffer_load_dwordx4 v7, s[36:39], s88 offen sc1 lds
    s_add_u32 m0, s72, 53248
    s_add_u32 s88, s74, 14704640
    buffer_load_dwordx4 v7, s[36:39], s88 offen sc1 lds
    s_waitcnt vmcnt(12)
    ds_read_b32 v232, v25 offset:0
    ds_read_b32 v233, v25 offset:28672
    s_waitcnt vmcnt(10)
    ds_read_b32 v234, v25 offset:4096
    ds_read_b32 v235, v25 offset:32768
    s_waitcnt vmcnt(8)
    ds_read_b32 v236, v25 offset:8192
    ds_read_b32 v237, v25 offset:36864
    s_waitcnt vmcnt(6)
    ds_read_b32 v238, v25 offset:12288
    ds_read_b32 v239, v25 offset:40960
    s_waitcnt vmcnt(4)
    ds_read_b32 v240, v25 offset:16384
    ds_read_b32 v241, v25 offset:45056
    s_waitcnt vmcnt(2)
    ds_read_b32 v242, v25 offset:20480
    ds_read_b32 v243, v25 offset:49152
    s_waitcnt vmcnt(0)
    ds_read_b32 v244, v25 offset:24576
    ds_read_b32 v245, v25 offset:53248
    s_waitcnt vmcnt(0) lgkmcnt(0)
    v_bitop3_b32 v20, v232, v233, v234 bitop3:128
    v_bitop3_b32 v20, v20, v235, v236 bitop3:128
    v_bitop3_b32 v20, v20, v237, v238 bitop3:128
    v_bitop3_b32 v20, v20, v239, v240 bitop3:128
    v_bitop3_b32 v20, v20, v241, v242 bitop3:128
    v_bitop3_b32 v20, v20, v243, v244 bitop3:128
    v_bitop3_b32 v20, v20, v245, 1 bitop3:128
    v_cmp_eq_u32 vcc, 0, v20
    s_cbranch_vccz cb_109
    s_sub_u32 s47, s47, 1
    s_cbranch_scc0 cs_108
    s_mov_b32 s47, 0
    s_branch cb_109
ss_111:
    buffer_load_dwordx4 v[88:91], v96, s[36:39], s77 offen sc1
    buffer_load_dwordx4 v[92:95], v96, s[36:39], s77 offen offset:1024 sc1
    s_waitcnt vmcnt(0)
    v_cmp_ne_u32 vcc, s44, v90
    v_cmp_ne_u32 s[70:71], s44, v94
    s_or_b64 vcc, vcc, s[70:71]
    s_cbranch_scc0 sb_112
    s_sub_u32 s47, s47, 1
    s_cbranch_scc0 ss_111
    s_mov_b32 s47, 0
    s_branch sb_112
ps_120:
    s_lshl2_add_u32 s88, s41, s42
    s_lshl_b32 s88, s88, 10
    s_add_u32 s88, s88, 753664
    v_lshlrev_b32 v20, 7, v1
    s_bfm_b64 exec, 8, 0
    buffer_load_dword v97, v20, s[36:39], s88 offen sc1
    s_mov_b64 exec, -1
    s_waitcnt vmcnt(0)
    v_cmp_ne_u32_e64 vcc, s44, v97
    s_cbranch_vccz pb_121
    s_sub_u32 s47, s47, 1
    s_cbranch_scc0 ps_120
    s_mov_b32 s47, 0
    s_branch pb_121
cs_122:
    s_add_u32 s88, s73, 0
    buffer_load_dwordx4 v[28:31], v7, s[36:39], s88 offen offset:0 sc1
    buffer_load_dwordx4 v[32:35], v7, s[36:39], s88 offen offset:1024 sc1
    buffer_load_dwordx4 v[36:39], v7, s[36:39], s88 offen offset:2048 sc1
    buffer_load_dwordx4 v[40:43], v7, s[36:39], s88 offen offset:3072 sc1
    s_add_u32 s88, s73, 4096
    buffer_load_dwordx4 v[44:47], v7, s[36:39], s88 offen offset:0 sc1
    buffer_load_dwordx4 v[64:67], v7, s[36:39], s88 offen offset:1024 sc1
    buffer_load_dwordx4 v[68:71], v7, s[36:39], s88 offen offset:2048 sc1
    buffer_load_dwordx4 v[72:75], v7, s[36:39], s88 offen offset:3072 sc1
    s_add_u32 s88, s73, 8192
    buffer_load_dwordx4 v[76:79], v7, s[36:39], s88 offen offset:0 sc1
    buffer_load_dwordx4 v[80:83], v7, s[36:39], s88 offen offset:1024 sc1
    buffer_load_dwordx4 v[84:87], v7, s[36:39], s88 offen offset:2048 sc1
    s_waitcnt vmcnt(0) lgkmcnt(0)
    v_bitop3_b32 v20, v28, v32, v36 bitop3:254
    v_bitop3_b32 v20, v20, v40, -2 bitop3:254
    v_cmp_eq_u32_e64 vcc, -1, v20
    s_cbranch_vccz cb_123
    s_sub_u32 s47, s47, 1
    s_cbranch_scc0 cs_122
    s_mov_b32 s47, 0
    s_branch cb_123
cs_124:
    s_add_u32 s88, s73, 4096
    buffer_load_dwordx4 v[44:47], v7, s[36:39], s88 offen offset:0 sc1
    buffer_load_dwordx4 v[64:67], v7, s[36:39], s88 offen offset:1024 sc1
    buffer_load_dwordx4 v[68:71], v7, s[36:39], s88 offen offset:2048 sc1
    buffer_load_dwordx4 v[72:75], v7, s[36:39], s88 offen offset:3072 sc1
    s_add_u32 s88, s73, 8192
    buffer_load_dwordx4 v[76:79], v7, s[36:39], s88 offen offset:0 sc1
    buffer_load_dwordx4 v[80:83], v7, s[36:39], s88 offen offset:1024 sc1
    buffer_load_dwordx4 v[84:87], v7, s[36:39], s88 offen offset:2048 sc1
    buffer_load_dwordx4 v[88:91], v7, s[36:39], s88 offen offset:3072 sc1
    s_add_u32 s88, s73, 12288
    buffer_load_dwordx4 v[92:95], v7, s[36:39], s88 offen offset:0 sc1
    buffer_load_dwordx4 v[96:99], v7, s[36:39], s88 offen offset:1024 sc1
    buffer_load_dwordx4 v[108:111], v7, s[36:39], s88 offen offset:2048 sc1
    buffer_load_dwordx4 v[112:115], v7, s[36:39], s88 offen offset:3072 sc1
    s_waitcnt vmcnt(0) lgkmcnt(0)
    v_bitop3_b32 v20, v44, v64, v68 bitop3:254
    v_bitop3_b32 v20, v20, v72, -2 bitop3:254
    v_cmp_eq_u32_e64 vcc, -1, v20
    s_cbranch_vccz cb_125
    s_sub_u32 s47, s47, 1
    s_cbranch_scc0 cs_124
    s_mov_b32 s47, 0
    s_branch cb_125
cs_126:
    s_add_u32 s88, s73, 8192
    buffer_load_dwordx4 v[76:79], v7, s[36:39], s88 offen offset:0 sc1
    buffer_load_dwordx4 v[80:83], v7, s[36:39], s88 offen offset:1024 sc1
    buffer_load_dwordx4 v[84:87], v7, s[36:39], s88 offen offset:2048 sc1
    buffer_load_dwordx4 v[88:91], v7, s[36:39], s88 offen offset:3072 sc1
    s_add_u32 s88, s73, 12288
    buffer_load_dwordx4 v[92:95], v7, s[36:39], s88 offen offset:0 sc1
    buffer_load_dwordx4 v[96:99], v7, s[36:39], s88 offen offset:1024 sc1
    buffer_load_dwordx4 v[108:111], v7, s[36:39], s88 offen offset:2048 sc1
    buffer_load_dwordx4 v[112:115], v7, s[36:39], s88 offen offset:3072 sc1
    s_add_u32 s88, s73, 65536
    buffer_load_dwordx4 v[28:31], v7, s[36:39], s88 offen offset:0 sc1
    buffer_load_dwordx4 v[32:35], v7, s[36:39], s88 offen offset:1024 sc1
    buffer_load_dwordx4 v[36:39], v7, s[36:39], s88 offen offset:2048 sc1
    buffer_load_dwordx4 v[40:43], v7, s[36:39], s88 offen offset:3072 sc1
    s_add_u32 s88, s73, 69632
    buffer_load_dwordx4 v[44:47], v7, s[36:39], s88 offen offset:0 sc1
    s_waitcnt vmcnt(0) lgkmcnt(0)
    v_bitop3_b32 v20, v76, v80, v84 bitop3:254
    v_bitop3_b32 v20, v20, v88, -2 bitop3:254
    v_cmp_eq_u32_e64 vcc, -1, v20
    s_cbranch_vccz cb_127
    s_sub_u32 s47, s47, 1
    s_cbranch_scc0 cs_126
    s_mov_b32 s47, 0
    s_branch cb_127
cs_128:
    s_add_u32 s88, s73, 12288
    buffer_load_dwordx4 v[92:95], v7, s[36:39], s88 offen offset:0 sc1
    buffer_load_dwordx4 v[96:99], v7, s[36:39], s88 offen offset:1024 sc1
    buffer_load_dwordx4 v[108:111], v7, s[36:39], s88 offen offset:2048 sc1
    buffer_load_dwordx4 v[112:115], v7, s[36:39], s88 offen offset:3072 sc1
    s_add_u32 s88, s73, 65536
    buffer_load_dwordx4 v[28:31], v7, s[36:39], s88 offen offset:0 sc1
    buffer_load_dwordx4 v[32:35], v7, s[36:39], s88 offen offset:1024 sc1
    buffer_load_dwordx4 v[36:39], v7, s[36:39], s88 offen offset:2048 sc1
    buffer_load_dwordx4 v[40:43], v7, s[36:39], s88 offen offset:3072 sc1
    s_add_u32 s88, s73, 69632
    buffer_load_dwordx4 v[44:47], v7, s[36:39], s88 offen offset:0 sc1
    buffer_load_dwordx4 v[64:67], v7, s[36:39], s88 offen offset:1024 sc1
    buffer_load_dwordx4 v[68:71], v7, s[36:39], s88 offen offset:2048 sc1
    buffer_load_dwordx4 v[72:75], v7, s[36:39], s88 offen offset:3072 sc1
    s_add_u32 s88, s73, 73728
    buffer_load_dwordx4 v[76:79], v7, s[36:39], s88 offen offset:0 sc1
    buffer_load_dwordx4 v[80:83], v7, s[36:39], s88 offen offset:1024 sc1
    s_waitcnt vmcnt(0) lgkmcnt(0)
    v_bitop3_b32 v20, v92, v96, v108 bitop3:254
    v_bitop3_b32 v20, v20, v112, -2 bitop3:254
    v_cmp_eq_u32 vcc, -1, v20
    s_cbranch_vccz cb_129
    s_sub_u32 s47, s47, 1
    s_cbranch_scc0 cs_128
    s_mov_b32 s47, 0
    s_branch cb_129
cs_178:
L_pad_9832:
    s_cbranch_execz L_ret_4
    s_cmp_eq_u32 s41, 7
    s_cbranch_scc1 cb_179
    s_add_u32 s88, s75, 25165824
    buffer_load_dwordx4 v[28:31], v7, s[36:39], s88 offen offset:0 sc1
    buffer_load_dwordx4 v[32:35], v7, s[36:39], s88 offen offset:1024 sc1
    buffer_load_dwordx4 v[36:39], v7, s[36:39], s88 offen offset:2048 sc1
    buffer_load_dwordx4 v[40:43], v7, s[36:39], s88 offen offset:3072 sc1
    s_add_u32 s88, s75, 25169920
    buffer_load_dwordx4 v[44:47], v7, s[36:39], s88 offen offset:0 sc1
    buffer_load_dwordx4 v[64:67], v7, s[36:39], s88 offen offset:1024 sc1
    buffer_load_dwordx4 v[68:71], v7, s[36:39], s88 offen offset:2048 sc1
    buffer_load_dwordx4 v[72:75], v7, s[36:39], s88 offen offset:3072 sc1
    s_add_u32 s88, s75, 25174016
    buffer_load_dwordx4 v[76:79], v7, s[36:39], s88 offen offset:0 sc1
    buffer_load_dwordx4 v[80:83], v7, s[36:39], s88 offen offset:1024 sc1
    buffer_load_dwordx4 v[84:87], v7, s[36:39], s88 offen offset:2048 sc1
    buffer_load_dwordx4 v[88:91], v7, s[36:39], s88 offen offset:3072 sc1
    s_add_u32 s88, s75, 25178112
    buffer_load_dwordx4 v[92:95], v7, s[36:39], s88 offen offset:0 sc1
    s_waitcnt vmcnt(0) lgkmcnt(0)
    v_bitop3_b32 v20, v28, v32, v36 bitop3:128
    v_bitop3_b32 v20, v20, v40, 1 bitop3:128
    v_cmp_eq_u32_e64 vcc, 0, v20
    s_cbranch_vccz cb_179
    s_sub_u32 s47, s47, 1
    s_cbranch_scc0 cs_178
    s_mov_b32 s47, 0
    s_branch cb_179
cs_180:
    s_cmp_eq_u32 s41, 7
    s_cbranch_scc1 cb_181
    s_add_u32 s88, s75, 25169920
    buffer_load_dwordx4 v[44:47], v7, s[36:39], s88 offen offset:0 sc1
    buffer_load_dwordx4 v[64:67], v7, s[36:39], s88 offen offset:1024 sc1
    buffer_load_dwordx4 v[68:71], v7, s[36:39], s88 offen offset:2048 sc1
    buffer_load_dwordx4 v[72:75], v7, s[36:39], s88 offen offset:3072 sc1
    s_add_u32 s88, s75, 25174016
    buffer_load_dwordx4 v[76:79], v7, s[36:39], s88 offen offset:0 sc1
    buffer_load_dwordx4 v[80:83], v7, s[36:39], s88 offen offset:1024 sc1
    buffer_load_dwordx4 v[84:87], v7, s[36:39], s88 offen offset:2048 sc1
    buffer_load_dwordx4 v[88:91], v7, s[36:39], s88 offen offset:3072 sc1
    s_add_u32 s88, s75, 25178112
    buffer_load_dwordx4 v[92:95], v7, s[36:39], s88 offen offset:0 sc1
    buffer_load_dwordx4 v[96:99], v7, s[36:39], s88 offen offset:1024 sc1
    buffer_load_dwordx4 v[108:111], v7, s[36:39], s88 offen offset:2048 sc1
    buffer_load_dwordx4 v[112:115], v7, s[36:39], s88 offen offset:3072 sc1
    s_add_u32 s88, s75, 25182208
    buffer_load_dwordx4 v[28:31], v7, s[36:39], s88 offen offset:0 sc1
    s_waitcnt vmcnt(0) lgkmcnt(0)
    v_bitop3_b32 v20, v44, v64, v68 bitop3:128
    v_bitop3_b32 v20, v20, v72, 1 bitop3:128
    v_cmp_eq_u32_e64 vcc, 0, v20
    s_cbranch_vccz cb_181
    s_sub_u32 s47, s47, 1
    s_cbranch_scc0 cs_180
    s_mov_b32 s47, 0
    s_branch cb_181
cs_182:
    s_cmp_eq_u32 s41, 7
    s_cbranch_scc1 cb_183
    s_add_u32 s88, s75, 25174016
    buffer_load_dwordx4 v[76:79], v7, s[36:39], s88 offen offset:0 sc1
    buffer_load_dwordx4 v[80:83], v7, s[36:39], s88 offen offset:1024 sc1
    buffer_load_dwordx4 v[84:87], v7, s[36:39], s88 offen offset:2048 sc1
    buffer_load_dwordx4 v[88:91], v7, s[36:39], s88 offen offset:3072 sc1
    s_add_u32 s88, s75, 25178112
    buffer_load_dwordx4 v[92:95], v7, s[36:39], s88 offen offset:0 sc1
    buffer_load_dwordx4 v[96:99], v7, s[36:39], s88 offen offset:1024 sc1
    buffer_load_dwordx4 v[108:111], v7, s[36:39], s88 offen offset:2048 sc1
    buffer_load_dwordx4 v[112:115], v7, s[36:39], s88 offen offset:3072 sc1
    s_add_u32 s88, s75, 25182208
    buffer_load_dwordx4 v[28:31], v7, s[36:39], s88 offen offset:0 sc1
    buffer_load_dwordx4 v[32:35], v7, s[36:39], s88 offen offset:1024 sc1
    buffer_load_dwordx4 v[36:39], v7, s[36:39], s88 offen offset:2048 sc1
    buffer_load_dwordx4 v[40:43], v7, s[36:39], s88 offen offset:3072 sc1
    s_add_u32 s88, s75, 25186304
    buffer_load_dwordx4 v[44:47], v7, s[36:39], s88 offen offset:0 sc1
    s_waitcnt vmcnt(0) lgkmcnt(0)
    v_bitop3_b32 v20, v76, v80, v84 bitop3:128
    v_bitop3_b32 v20, v20, v88, 1 bitop3:128
    v_cmp_eq_u32_e64 vcc, 0, v20
    s_cbranch_vccz cb_183
    s_sub_u32 s47, s47, 1
    s_cbranch_scc0 cs_182
    s_mov_b32 s47, 0
    s_branch cb_183
cs_184:
    s_cmp_eq_u32 s41, 7
    s_cbranch_scc1 cb_185
    s_add_u32 s88, s75, 25178112
    buffer_load_dwordx4 v[92:95], v7, s[36:39], s88 offen offset:0 sc1
    buffer_load_dwordx4 v[96:99], v7, s[36:39], s88 offen offset:1024 sc1
    buffer_load_dwordx4 v[108:111], v7, s[36:39], s88 offen offset:2048 sc1
    buffer_load_dwordx4 v[112:115], v7, s[36:39], s88 offen offset:3072 sc1
    s_add_u32 s88, s75, 25182208
    buffer_load_dwordx4 v[28:31], v7, s[36:39], s88 offen offset:0 sc1
    buffer_load_dwordx4 v[32:35], v7, s[36:39], s88 offen offset:1024 sc1
    buffer_load_dwordx4 v[36:39], v7, s[36:39], s88 offen offset:2048 sc1
    buffer_load_dwordx4 v[40:43], v7, s[36:39], s88 offen offset:3072 sc1
    s_add_u32 s88, s75, 25186304
    buffer_load_dwordx4 v[44:47], v7, s[36:39], s88 offen offset:0 sc1
    buffer_load_dwordx4 v[64:67], v7, s[36:39], s88 offen offset:1024 sc1
    buffer_load_dwordx4 v[68:71], v7, s[36:39], s88 offen offset:2048 sc1
    buffer_load_dwordx4 v[72:75], v7, s[36:39], s88 offen offset:3072 sc1
    s_add_u32 s88, s75, 25190400
    buffer_load_dwordx2 v[76:77], v22, s[36:39], s88 offen offset:0 sc1
    buffer_load_dwordx2 v[78:79], v22, s[36:39], s88 offen offset:512 sc1
    s_waitcnt vmcnt(0) lgkmcnt(0)
    v_bitop3_b32 v20, v92, v96, v108 bitop3:128
    v_bitop3_b32 v20, v20, v112, 1 bitop3:128
    v_cmp_eq_u32_e64 vcc, 0, v20
    s_cbranch_vccz cb_185
    s_sub_u32 s47, s47, 1
    s_cbranch_scc0 cs_184
    s_mov_b32 s47, 0
    s_branch cb_185
cs_186:
    s_cmp_eq_u32 s41, 7
    s_cbranch_scc1 cb_187
    s_add_u32 s88, s75, 25182208
    buffer_load_dwordx4 v[28:31], v7, s[36:39], s88 offen offset:0 sc1
    buffer_load_dwordx4 v[32:35], v7, s[36:39], s88 offen offset:1024 sc1
    buffer_load_dwordx4 v[36:39], v7, s[36:39], s88 offen offset:2048 sc1
    buffer_load_dwordx4 v[40:43], v7, s[36:39], s88 offen offset:3072 sc1
    s_add_u32 s88, s75, 25186304
    buffer_load_dwordx4 v[44:47], v7, s[36:39], s88 offen offset:0 sc1
    buffer_load_dwordx4 v[64:67], v7, s[36:39], s88 offen offset:1024 sc1
    buffer_load_dwordx4 v[68:71], v7, s[36:39], s88 offen offset:2048 sc1
    buffer_load_dwordx4 v[72:75], v7, s[36:39], s88 offen offset:3072 sc1
    s_add_u32 s88, s75, 25190400
    buffer_load_dwordx2 v[76:77], v22, s[36:39], s88 offen offset:0 sc1
    buffer_load_dwordx2 v[78:79], v22, s[36:39], s88 offen offset:512 sc1
    buffer_load_dwordx2 v[80:81], v22, s[36:39], s88 offen offset:1024 sc1
    buffer_load_dwordx2 v[82:83], v22, s[36:39], s88 offen offset:1536 sc1
    buffer_load_dwordx2 v[84:85], v22, s[36:39], s88 offen offset:2048 sc1
    buffer_load_dwordx2 v[86:87], v22, s[36:39], s88 offen offset:2560 sc1
    buffer_load_dwordx2 v[88:89], v22, s[36:39], s88 offen offset:3072 sc1
    buffer_load_dwordx2 v[90:91], v22, s[36:39], s88 offen offset:3584 sc1
    s_waitcnt vmcnt(12) lgkmcnt(0)
    v_bitop3_b32 v20, v28, v32, v36 bitop3:128
    v_bitop3_b32 v20, v20, v40, 1 bitop3:128
    v_cmp_eq_u32_e64 vcc, 0, v20
    s_cbranch_vccz cb_187
    s_sub_u32 s47, s47, 1
    s_cbranch_scc0 cs_186
    s_mov_b32 s47, 0
    s_branch cb_187
cs_188:
    s_cmp_eq_u32 s41, 7
    s_cbranch_scc1 cb_189
    s_add_u32 s88, s75, 25186304
    buffer_load_dwordx4 v[44:47], v7, s[36:39], s88 offen offset:0 sc1
    buffer_load_dwordx4 v[64:67], v7, s[36:39], s88 offen offset:1024 sc1
    buffer_load_dwordx4 v[68:71], v7, s[36:39], s88 offen offset:2048 sc1
    buffer_load_dwordx4 v[72:75], v7, s[36:39], s88 offen offset:3072 sc1
    s_add_u32 s88, s75, 25190400
    buffer_load_dwordx2 v[76:77], v22, s[36:39], s88 offen offset:0 sc1
    buffer_load_dwordx2 v[78:79], v22, s[36:39], s88 offen offset:512 sc1
    buffer_load_dwordx2 v[80:81], v22, s[36:39], s88 offen offset:1024 sc1
    buffer_load_dwordx2 v[82:83], v22, s[36:39], s88 offen offset:1536 sc1
    buffer_load_dwordx2 v[84:85], v22, s[36:39], s88 offen offset:2048 sc1
    buffer_load_dwordx2 v[86:87], v22, s[36:39], s88 offen offset:2560 sc1
    buffer_load_dwordx2 v[88:89], v22, s[36:39], s88 offen offset:3072 sc1
    buffer_load_dwordx2 v[90:91], v22, s[36:39], s88 offen offset:3584 sc1
    s_waitcnt vmcnt(8) lgkmcnt(0)
    v_bitop3_b32 v20, v44, v64, v68 bitop3:128
    v_bitop3_b32 v20, v20, v72, 1 bitop3:128
    v_cmp_eq_u32_e64 vcc, 0, v20
    s_cbranch_vccz cb_189
    s_sub_u32 s47, s47, 1
    s_cbranch_scc0 cs_188
    s_mov_b32 s47, 0
    s_branch cb_189
cs_190:
    s_cmp_eq_u32 s41, 7
    s_cbranch_scc1 cb_191
    s_add_u32 s88, s75, 25190400
    buffer_load_dwordx2 v[76:77], v22, s[36:39], s88 offen offset:0 sc1
    buffer_load_dwordx2 v[78:79], v22, s[36:39], s88 offen offset:512 sc1
    buffer_load_dwordx2 v[80:81], v22, s[36:39], s88 offen offset:1024 sc1
    buffer_load_dwordx2 v[82:83], v22, s[36:39], s88 offen offset:1536 sc1
    buffer_load_dwordx2 v[84:85], v22, s[36:39], s88 offen offset:2048 sc1
    buffer_load_dwordx2 v[86:87], v22, s[36:39], s88 offen offset:2560 sc1
    buffer_load_dwordx2 v[88:89], v22, s[36:39], s88 offen offset:3072 sc1
    buffer_load_dwordx2 v[90:91], v22, s[36:39], s88 offen offset:3584 sc1
    s_waitcnt vmcnt(0) lgkmcnt(0)
    v_bitop3_b32 v20, v76, v80, v84 bitop3:128
    v_bitop3_b32 v20, v20, v88, v78 bitop3:128
    v_bitop3_b32 v20, v20, v82, v86 bitop3:128
    v_bitop3_b32 v20, v20, v90, 1 bitop3:128
    v_cmp_eq_u32 vcc, 0, v20
    s_cbranch_vccz cb_191
    s_sub_u32 s47, s47, 1
    s_cbranch_scc0 cs_190
    s_mov_b32 s47, 0
    s_branch cb_191
cs_32:
    s_nop 0
    s_add_u32 s88, s73, 65536
    buffer_load_dwordx4 v[68:71], v7, s[36:39], s88 offen offset:0 sc1
    buffer_load_dwordx4 v[72:75], v7, s[36:39], s88 offen offset:1024 sc1
    buffer_load_dwordx4 v[76:79], v7, s[36:39], s88 offen offset:2048 sc1
    buffer_load_dwordx4 v[80:83], v7, s[36:39], s88 offen offset:3072 sc1
    s_waitcnt vmcnt(0) lgkmcnt(0)
    v_bitop3_b32 v20, v68, v72, v76 bitop3:254
    v_bitop3_b32 v20, v20, v80, -2 bitop3:254
    v_cmp_eq_u32_e64 vcc, -1, v20
    s_cbranch_vccz cb_33
    s_sub_u32 s47, s47, 1
    s_cbranch_scc0 cs_32
    s_mov_b32 s47, 0
    s_branch cb_33
cs_34:
    s_add_u32 s88, s73, 69632
    buffer_load_dwordx4 v[84:87], v7, s[36:39], s88 offen offset:0 sc1
    buffer_load_dwordx4 v[88:91], v7, s[36:39], s88 offen offset:1024 sc1
    buffer_load_dwordx4 v[92:95], v7, s[36:39], s88 offen offset:2048 sc1
    buffer_load_dwordx4 v[96:99], v7, s[36:39], s88 offen offset:3072 sc1
    s_waitcnt vmcnt(0) lgkmcnt(0)
    v_bitop3_b32 v20, v84, v88, v92 bitop3:254
    v_bitop3_b32 v20, v20, v96, -2 bitop3:254
    v_cmp_eq_u32_e64 vcc, -1, v20
    s_cbranch_vccz cb_35
    s_sub_u32 s47, s47, 1
    s_cbranch_scc0 cs_34
    s_mov_b32 s47, 0
    s_branch cb_35
cs_36:
    s_add_u32 s88, s73, 73728
    buffer_load_dwordx4 v[100:103], v7, s[36:39], s88 offen offset:0 sc1
    buffer_load_dwordx4 v[104:107], v7, s[36:39], s88 offen offset:1024 sc1
    buffer_load_dwordx4 v[108:111], v7, s[36:39], s88 offen offset:2048 sc1
    buffer_load_dwordx4 v[112:115], v7, s[36:39], s88 offen offset:3072 sc1
    s_waitcnt vmcnt(0) lgkmcnt(0)
    v_bitop3_b32 v20, v100, v104, v108 bitop3:254
    v_bitop3_b32 v20, v20, v112, -2 bitop3:254
    v_cmp_eq_u32_e64 vcc, -1, v20
    s_cbranch_vccz cb_37
    s_sub_u32 s47, s47, 1
    s_cbranch_scc0 cs_36
    s_mov_b32 s47, 0
    s_branch cb_37
cs_38:
    s_add_u32 s88, s73, 77824
    buffer_load_dwordx4 v[116:119], v7, s[36:39], s88 offen offset:0 sc1
    buffer_load_dwordx4 v[120:123], v7, s[36:39], s88 offen offset:1024 sc1
    buffer_load_dwordx4 v[124:127], v7, s[36:39], s88 offen offset:2048 sc1
    buffer_load_dwordx4 v[128:131], v7, s[36:39], s88 offen offset:3072 sc1
    s_waitcnt vmcnt(0) lgkmcnt(0)
    v_bitop3_b32 v20, v116, v120, v124 bitop3:254
    v_bitop3_b32 v20, v20, v128, -2 bitop3:254
    v_cmp_eq_u32_e64 vcc, -1, v20
    s_cbranch_vccz cb_39
    s_sub_u32 s47, s47, 1
    s_cbranch_scc0 cs_38
    s_mov_b32 s47, 0
    s_branch cb_39
cs_40:
    s_add_u32 s88, s73, 131072
    buffer_load_dwordx4 v[68:71], v7, s[36:39], s88 offen offset:0 sc1
    buffer_load_dwordx4 v[72:75], v7, s[36:39], s88 offen offset:1024 sc1
    buffer_load_dwordx4 v[76:79], v7, s[36:39], s88 offen offset:2048 sc1
    buffer_load_dwordx4 v[80:83], v7, s[36:39], s88 offen offset:3072 sc1
    s_waitcnt vmcnt(0) lgkmcnt(0)
    v_bitop3_b32 v20, v68, v72, v76 bitop3:254
    v_bitop3_b32 v20, v20, v80, -2 bitop3:254
    v_cmp_eq_u32_e64 vcc, -1, v20
    s_cbranch_vccz cb_41
    s_sub_u32 s47, s47, 1
    s_cbranch_scc0 cs_40
    s_mov_b32 s47, 0
    s_branch cb_41
cs_42:
    s_add_u32 s88, s73, 135168
    buffer_load_dwordx4 v[84:87], v7, s[36:39], s88 offen offset:0 sc1
    buffer_load_dwordx4 v[88:91], v7, s[36:39], s88 offen offset:1024 sc1
    buffer_load_dwordx4 v[92:95], v7, s[36:39], s88 offen offset:2048 sc1
    buffer_load_dwordx4 v[96:99], v7, s[36:39], s88 offen offset:3072 sc1
    s_waitcnt vmcnt(0) lgkmcnt(0)
    v_bitop3_b32 v20, v84, v88, v92 bitop3:254
    v_bitop3_b32 v20, v20, v96, -2 bitop3:254
    v_cmp_eq_u32_e64 vcc, -1, v20
    s_cbranch_vccz cb_43
    s_sub_u32 s47, s47, 1
    s_cbranch_scc0 cs_42
    s_mov_b32 s47, 0
    s_branch cb_43
cs_44:
    s_add_u32 s88, s73, 139264
    buffer_load_dwordx4 v[100:103], v7, s[36:39], s88 offen offset:0 sc1
    buffer_load_dwordx4 v[104:107], v7, s[36:39], s88 offen offset:1024 sc1
    buffer_load_dwordx4 v[108:111], v7, s[36:39], s88 offen offset:2048 sc1
    buffer_load_dwordx4 v[112:115], v7, s[36:39], s88 offen offset:3072 sc1
    s_waitcnt vmcnt(0) lgkmcnt(0)
    v_bitop3_b32 v20, v100, v104, v108 bitop3:254
    v_bitop3_b32 v20, v20, v112, -2 bitop3:254
    v_cmp_eq_u32_e64 vcc, -1, v20
    s_cbranch_vccz cb_45
    s_sub_u32 s47, s47, 1
    s_cbranch_scc0 cs_44
    s_mov_b32 s47, 0
    s_branch cb_45
cs_46:
    s_add_u32 s88, s73, 143360
    s_nop 0
    buffer_load_dwordx4 v[116:119], v7, s[36:39], s88 offen offset:0 sc1
    buffer_load_dwordx4 v[120:123], v7, s[36:39], s88 offen offset:1024 sc1
    buffer_load_dwordx4 v[124:127], v7, s[36:39], s88 offen offset:2048 sc1
    buffer_load_dwordx4 v[128:131], v7, s[36:39], s88 offen offset:3072 sc1
    s_waitcnt vmcnt(0) lgkmcnt(0)
    v_bitop3_b32 v20, v116, v120, v124 bitop3:254
    v_bitop3_b32 v20, v20, v128, -2 bitop3:254
    v_cmp_eq_u32 vcc, -1, v20
    s_cbranch_vccz cb_47
    s_sub_u32 s47, s47, 1
    s_cbranch_scc0 cs_46
    s_mov_b32 s47, 0
    s_branch cb_47
cs_48:
    s_add_u32 s88, s73, 196608
    buffer_load_dwordx4 v[68:71], v7, s[36:39], s88 offen offset:0 sc1
    buffer_load_dwordx4 v[72:75], v7, s[36:39], s88 offen offset:1024 sc1
    buffer_load_dwordx4 v[76:79], v7, s[36:39], s88 offen offset:2048 sc1
    buffer_load_dwordx4 v[80:83], v7, s[36:39], s88 offen offset:3072 sc1
    s_waitcnt vmcnt(0) lgkmcnt(0)
    v_bitop3_b32 v20, v68, v72, v76 bitop3:254
    v_bitop3_b32 v20, v20, v80, -2 bitop3:254
    v_cmp_eq_u32_e64 vcc, -1, v20
    s_cbranch_vccz cb_49
    s_sub_u32 s47, s47, 1
    s_cbranch_scc0 cs_48
    s_mov_b32 s47, 0
    s_branch cb_49
cs_50:
    s_add_u32 s88, s73, 200704
    buffer_load_dwordx4 v[84:87], v7, s[36:39], s88 offen offset:0 sc1
    buffer_load_dwordx4 v[88:91], v7, s[36:39], s88 offen offset:1024 sc1
    buffer_load_dwordx4 v[92:95], v7, s[36:39], s88 offen offset:2048 sc1
    buffer_load_dwordx4 v[96:99], v7, s[36:39], s88 offen offset:3072 sc1
    s_waitcnt vmcnt(0) lgkmcnt(0)
    v_bitop3_b32 v20, v84, v88, v92 bitop3:254
    v_bitop3_b32 v20, v20, v96, -2 bitop3:254
    v_cmp_eq_u32_e64 vcc, -1, v20
    s_cbranch_vccz cb_51
    s_sub_u32 s47, s47, 1
    s_cbranch_scc0 cs_50
    s_mov_b32 s47, 0
    s_branch cb_51
cs_52:
    s_add_u32 s88, s73, 204800
    buffer_load_dwordx4 v[100:103], v7, s[36:39], s88 offen offset:0 sc1
    buffer_load_dwordx4 v[104:107], v7, s[36:39], s88 offen offset:1024 sc1
    buffer_load_dwordx4 v[108:111], v7, s[36:39], s88 offen offset:2048 sc1
    buffer_load_dwordx4 v[112:115], v7, s[36:39], s88 offen offset:3072 sc1
    s_waitcnt vmcnt(0) lgkmcnt(0)
    v_bitop3_b32 v20, v100, v104, v108 bitop3:254
    v_bitop3_b32 v20, v20, v112, -2 bitop3:254
    v_cmp_eq_u32_e64 vcc, -1, v20
    s_cbranch_vccz cb_53
    s_sub_u32 s47, s47, 1
    s_cbranch_scc0 cs_52
    s_mov_b32 s47, 0
    s_branch cb_53
cs_54:
    s_add_u32 s88, s73, 208896
    buffer_load_dwordx4 v[116:119], v7, s[36:39], s88 offen offset:0 sc1
    buffer_load_dwordx4 v[120:123], v7, s[36:39], s88 offen offset:1024 sc1
    buffer_load_dwordx4 v[124:127], v7, s[36:39], s88 offen offset:2048 sc1
    buffer_load_dwordx4 v[128:131], v7, s[36:39], s88 offen offset:3072 sc1
    s_waitcnt vmcnt(0) lgkmcnt(0)
    v_bitop3_b32 v20, v116, v120, v124 bitop3:254
    v_bitop3_b32 v20, v20, v128, -2 bitop3:254
    v_cmp_eq_u32_e64 vcc, -1, v20
    s_cbranch_vccz cb_55
    s_sub_u32 s47, s47, 1
    s_cbranch_scc0 cs_54
    s_mov_b32 s47, 0
    s_branch cb_55
cs_56:
    s_add_u32 s88, s73, 262144
    buffer_load_dwordx4 v[68:71], v7, s[36:39], s88 offen offset:0 sc1
    buffer_load_dwordx4 v[72:75], v7, s[36:39], s88 offen offset:1024 sc1
    buffer_load_dwordx4 v[76:79], v7, s[36:39], s88 offen offset:2048 sc1
    buffer_load_dwordx4 v[80:83], v7, s[36:39], s88 offen offset:3072 sc1
    s_waitcnt vmcnt(0) lgkmcnt(0)
    v_bitop3_b32 v20, v68, v72, v76 bitop3:254
    v_bitop3_b32 v20, v20, v80, -2 bitop3:254
    v_cmp_eq_u32_e64 vcc, -1, v20
    s_cbranch_vccz cb_57
    s_sub_u32 s47, s47, 1
    s_cbranch_scc0 cs_56
    s_mov_b32 s47, 0
    s_branch cb_57
cs_58:
    s_add_u32 s88, s73, 266240
    buffer_load_dwordx4 v[84:87], v7, s[36:39], s88 offen offset:0 sc1
    buffer_load_dwordx4 v[88:91], v7, s[36:39], s88 offen offset:1024 sc1
    buffer_load_dwordx4 v[92:95], v7, s[36:39], s88 offen offset:2048 sc1
    buffer_load_dwordx4 v[96:99], v7, s[36:39], s88 offen offset:3072 sc1
    s_waitcnt vmcnt(0) lgkmcnt(0)
    v_bitop3_b32 v20, v84, v88, v92 bitop3:254
    v_bitop3_b32 v20, v20, v96, -2 bitop3:254
    v_cmp_eq_u32_e64 vcc, -1, v20
    s_cbranch_vccz cb_59
    s_sub_u32 s47, s47, 1
    s_cbranch_scc0 cs_58
    s_mov_b32 s47, 0
    s_branch cb_59
cs_60:
    s_add_u32 s88, s73, 270336
    buffer_load_dwordx4 v[100:103], v7, s[36:39], s88 offen offset:0 sc1
    buffer_load_dwordx4 v[104:107], v7, s[36:39], s88 offen offset:1024 sc1
    buffer_load_dwordx4 v[108:111], v7, s[36:39], s88 offen offset:2048 sc1
    buffer_load_dwordx4 v[112:115], v7, s[36:39], s88 offen offset:3072 sc1
    s_waitcnt vmcnt(0) lgkmcnt(0)
    v_bitop3_b32 v20, v100, v104, v108 bitop3:254
    v_bitop3_b32 v20, v20, v112, -2 bitop3:254
    v_cmp_eq_u32_e64 vcc, -1, v20
    s_cbranch_vccz cb_61
    s_sub_u32 s47, s47, 1
    s_cbranch_scc0 cs_60
    s_mov_b32 s47, 0
    s_branch cb_61
cs_62:
    s_add_u32 s88, s73, 274432
    buffer_load_dwordx4 v[116:119], v7, s[36:39], s88 offen offset:0 sc1
    buffer_load_dwordx4 v[120:123], v7, s[36:39], s88 offen offset:1024 sc1
    buffer_load_dwordx4 v[124:127], v7, s[36:39], s88 offen offset:2048 sc1
    buffer_load_dwordx4 v[128:131], v7, s[36:39], s88 offen offset:3072 sc1
    s_waitcnt vmcnt(0) lgkmcnt(0)
    v_bitop3_b32 v20, v116, v120, v124 bitop3:254
    v_bitop3_b32 v20, v20, v128, -2 bitop3:254
    v_cmp_eq_u32_e64 vcc, -1, v20
    s_cbranch_vccz cb_63
    s_sub_u32 s47, s47, 1
    s_cbranch_scc0 cs_62
    s_mov_b32 s47, 0
    s_branch cb_63
cs_64:
    s_add_u32 s88, s73, 327680
    buffer_load_dwordx4 v[68:71], v7, s[36:39], s88 offen offset:0 sc1
    buffer_load_dwordx4 v[72:75], v7, s[36:39], s88 offen offset:1024 sc1
    buffer_load_dwordx4 v[76:79], v7, s[36:39], s88 offen offset:2048 sc1
    buffer_load_dwordx4 v[80:83], v7, s[36:39], s88 offen offset:3072 sc1
    s_waitcnt vmcnt(0) lgkmcnt(0)
    v_bitop3_b32 v20, v68, v72, v76 bitop3:254
    v_bitop3_b32 v20, v20, v80, -2 bitop3:254
    v_cmp_eq_u32_e64 vcc, -1, v20
    s_cbranch_vccz cb_65
    s_sub_u32 s47, s47, 1
    s_cbranch_scc0 cs_64
    s_mov_b32 s47, 0
    s_branch cb_65
cs_66:
    s_add_u32 s88, s73, 331776
    buffer_load_dwordx4 v[84:87], v7, s[36:39], s88 offen offset:0 sc1
    buffer_load_dwordx4 v[88:91], v7, s[36:39], s88 offen offset:1024 sc1
    buffer_load_dwordx4 v[92:95], v7, s[36:39], s88 offen offset:2048 sc1
    buffer_load_dwordx4 v[96:99], v7, s[36:39], s88 offen offset:3072 sc1
    s_waitcnt vmcnt(0) lgkmcnt(0)
    v_bitop3_b32 v20, v84, v88, v92 bitop3:254
    v_bitop3_b32 v20, v20, v96, -2 bitop3:254
    v_cmp_eq_u32_e64 vcc, -1, v20
    s_cbranch_vccz cb_67
    s_sub_u32 s47, s47, 1
    s_cbranch_scc0 cs_66
    s_mov_b32 s47, 0
    s_branch cb_67
cs_68:
    s_add_u32 s88, s73, 335872
    buffer_load_dwordx4 v[100:103], v7, s[36:39], s88 offen offset:0 sc1
    buffer_load_dwordx4 v[104:107], v7, s[36:39], s88 offen offset:1024 sc1
    buffer_load_dwordx4 v[108:111], v7, s[36:39], s88 offen offset:2048 sc1
    buffer_load_dwordx4 v[112:115], v7, s[36:39], s88 offen offset:3072 sc1
    s_waitcnt vmcnt(0) lgkmcnt(0)
    v_bitop3_b32 v20, v100, v104, v108 bitop3:254
    v_bitop3_b32 v20, v20, v112, -2 bitop3:254
    v_cmp_eq_u32_e64 vcc, -1, v20
    s_cbranch_vccz cb_69
    s_sub_u32 s47, s47, 1
    s_cbranch_scc0 cs_68
    s_mov_b32 s47, 0
    s_branch cb_69
cs_70:
    s_add_u32 s88, s73, 339968
    buffer_load_dwordx4 v[116:119], v7, s[36:39], s88 offen offset:0 sc1
    buffer_load_dwordx4 v[120:123], v7, s[36:39], s88 offen offset:1024 sc1
    buffer_load_dwordx4 v[124:127], v7, s[36:39], s88 offen offset:2048 sc1
    buffer_load_dwordx4 v[128:131], v7, s[36:39], s88 offen offset:3072 sc1
    s_waitcnt vmcnt(0) lgkmcnt(0)
    v_bitop3_b32 v20, v116, v120, v124 bitop3:254
    v_bitop3_b32 v20, v20, v128, -2 bitop3:254
    v_cmp_eq_u32 vcc, -1, v20
    s_cbranch_vccz cb_71
    s_sub_u32 s47, s47, 1
    s_cbranch_scc0 cs_70
    s_mov_b32 s47, 0
    s_branch cb_71
cs_72:
    s_add_u32 s88, s74, 0
    buffer_load_dwordx4 v[68:71], v7, s[36:39], s88 offen offset:0 sc1
    buffer_load_dwordx4 v[72:75], v7, s[36:39], s88 offen offset:1024 sc1
    buffer_load_dwordx4 v[76:79], v7, s[36:39], s88 offen offset:2048 sc1
    buffer_load_dwordx4 v[80:83], v7, s[36:39], s88 offen offset:3072 sc1
    s_waitcnt vmcnt(0) lgkmcnt(0)
    v_bitop3_b32 v20, v68, v72, v76 bitop3:254
    v_bitop3_b32 v20, v20, v80, -2 bitop3:254
    v_cmp_eq_u32_e64 vcc, -1, v20
    s_cbranch_vccz cb_73
    s_sub_u32 s47, s47, 1
    s_cbranch_scc0 cs_72
    s_mov_b32 s47, 0
    s_branch cb_73
cs_74:
    s_add_u32 s88, s74, 4096
    buffer_load_dwordx4 v[84:87], v7, s[36:39], s88 offen offset:0 sc1
    buffer_load_dwordx4 v[88:91], v7, s[36:39], s88 offen offset:1024 sc1
    buffer_load_dwordx4 v[92:95], v7, s[36:39], s88 offen offset:2048 sc1
    buffer_load_dwordx4 v[96:99], v7, s[36:39], s88 offen offset:3072 sc1
    s_waitcnt vmcnt(0) lgkmcnt(0)
    v_bitop3_b32 v20, v84, v88, v92 bitop3:254
    v_bitop3_b32 v20, v20, v96, -2 bitop3:254
    v_cmp_eq_u32_e64 vcc, -1, v20
    s_cbranch_vccz cb_75
    s_sub_u32 s47, s47, 1
    s_cbranch_scc0 cs_74
    s_mov_b32 s47, 0
    s_branch cb_75
cs_76:
    s_add_u32 s88, s74, 8192
    buffer_load_dwordx4 v[100:103], v7, s[36:39], s88 offen offset:0 sc1
    buffer_load_dwordx4 v[104:107], v7, s[36:39], s88 offen offset:1024 sc1
    buffer_load_dwordx4 v[108:111], v7, s[36:39], s88 offen offset:2048 sc1
    buffer_load_dwordx4 v[112:115], v7, s[36:39], s88 offen offset:3072 sc1
    s_waitcnt vmcnt(0) lgkmcnt(0)
    v_bitop3_b32 v20, v100, v104, v108 bitop3:254
    v_bitop3_b32 v20, v20, v112, -2 bitop3:254
    v_cmp_eq_u32_e64 vcc, -1, v20
    s_cbranch_vccz cb_77
    s_sub_u32 s47, s47, 1
    s_cbranch_scc0 cs_76
    s_mov_b32 s47, 0
    s_branch cb_77
cs_78:
    s_add_u32 s88, s74, 12288
    buffer_load_dwordx4 v[116:119], v7, s[36:39], s88 offen offset:0 sc1
    buffer_load_dwordx4 v[120:123], v7, s[36:39], s88 offen offset:1024 sc1
    buffer_load_dwordx4 v[124:127], v7, s[36:39], s88 offen offset:2048 sc1
    buffer_load_dwordx4 v[128:131], v7, s[36:39], s88 offen offset:3072 sc1
    s_waitcnt vmcnt(0) lgkmcnt(0)
    v_bitop3_b32 v20, v116, v120, v124 bitop3:254
    v_bitop3_b32 v20, v20, v128, -2 bitop3:254
    v_cmp_eq_u32_e64 vcc, -1, v20
    s_cbranch_vccz cb_79
    s_sub_u32 s47, s47, 1
    s_cbranch_scc0 cs_78
    s_mov_b32 s47, 0
    s_branch cb_79
cs_130:
    s_add_u32 s88, s73, 65536
    buffer_load_dwordx4 v[28:31], v7, s[36:39], s88 offen offset:0 sc1
    buffer_load_dwordx4 v[32:35], v7, s[36:39], s88 offen offset:1024 sc1
    buffer_load_dwordx4 v[36:39], v7, s[36:39], s88 offen offset:2048 sc1
    buffer_load_dwordx4 v[40:43], v7, s[36:39], s88 offen offset:3072 sc1
    s_waitcnt vmcnt(0) lgkmcnt(0)
    v_bitop3_b32 v20, v28, v32, v36 bitop3:254
    v_bitop3_b32 v20, v20, v40, -2 bitop3:254
    v_cmp_eq_u32_e64 vcc, -1, v20
    s_cbranch_vccz cb_131
    s_sub_u32 s47, s47, 1
    s_cbranch_scc0 cs_130
    s_mov_b32 s47, 0
    s_branch cb_131
cs_132:
    s_add_u32 s88, s73, 69632
    buffer_load_dwordx4 v[44:47], v7, s[36:39], s88 offen offset:0 sc1
    buffer_load_dwordx4 v[64:67], v7, s[36:39], s88 offen offset:1024 sc1
    buffer_load_dwordx4 v[68:71], v7, s[36:39], s88 offen offset:2048 sc1
    buffer_load_dwordx4 v[72:75], v7, s[36:39], s88 offen offset:3072 sc1
    s_waitcnt vmcnt(0) lgkmcnt(0)
    v_bitop3_b32 v20, v44, v64, v68 bitop3:254
    v_bitop3_b32 v20, v20, v72, -2 bitop3:254
    v_cmp_eq_u32_e64 vcc, -1, v20
    s_cbranch_vccz cb_133
    s_sub_u32 s47, s47, 1
    s_cbranch_scc0 cs_132
    s_mov_b32 s47, 0
    s_branch cb_133
cs_134:
    s_add_u32 s88, s73, 73728
    buffer_load_dwordx4 v[76:79], v7, s[36:39], s88 offen offset:0 sc1
    buffer_load_dwordx4 v[80:83], v7, s[36:39], s88 offen offset:1024 sc1
    buffer_load_dwordx4 v[84:87], v7, s[36:39], s88 offen offset:2048 sc1
    buffer_load_dwordx4 v[88:91], v7, s[36:39], s88 offen offset:3072 sc1
    s_waitcnt vmcnt(0) lgkmcnt(0)
    v_bitop3_b32 v20, v76, v80, v84 bitop3:254
    v_bitop3_b32 v20, v20, v88, -2 bitop3:254
    v_cmp_eq_u32_e64 vcc, -1, v20
    s_cbranch_vccz cb_135
    s_sub_u32 s47, s47, 1
    s_cbranch_scc0 cs_134
    s_mov_b32 s47, 0
    s_branch cb_135
cs_136:
    s_add_u32 s88, s73, 77824
    buffer_load_dwordx4 v[92:95], v7, s[36:39], s88 offen offset:0 sc1
    buffer_load_dwordx4 v[96:99], v7, s[36:39], s88 offen offset:1024 sc1
    buffer_load_dwordx4 v[108:111], v7, s[36:39], s88 offen offset:2048 sc1
    buffer_load_dwordx4 v[112:115], v7, s[36:39], s88 offen offset:3072 sc1
    s_waitcnt vmcnt(0) lgkmcnt(0)
    v_bitop3_b32 v20, v92, v96, v108 bitop3:254
    v_bitop3_b32 v20, v20, v112, -2 bitop3:254
    v_cmp_eq_u32_e64 vcc, -1, v20
    s_cbranch_vccz cb_137
    s_sub_u32 s47, s47, 1
    s_cbranch_scc0 cs_136
    s_mov_b32 s47, 0
    s_branch cb_137
cs_138:
    s_add_u32 s88, s73, 131072
    buffer_load_dwordx4 v[28:31], v7, s[36:39], s88 offen offset:0 sc1
    buffer_load_dwordx4 v[32:35], v7, s[36:39], s88 offen offset:1024 sc1
    buffer_load_dwordx4 v[36:39], v7, s[36:39], s88 offen offset:2048 sc1
    buffer_load_dwordx4 v[40:43], v7, s[36:39], s88 offen offset:3072 sc1
    s_waitcnt vmcnt(0) lgkmcnt(0)
    v_bitop3_b32 v20, v28, v32, v36 bitop3:254
    v_bitop3_b32 v20, v20, v40, -2 bitop3:254
    v_cmp_eq_u32_e64 vcc, -1, v20
    s_cbranch_vccz cb_139
    s_sub_u32 s47, s47, 1
    s_cbranch_scc0 cs_138
    s_mov_b32 s47, 0
    s_branch cb_139
cs_140:
    s_add_u32 s88, s73, 135168
    buffer_load_dwordx4 v[44:47], v7, s[36:39], s88 offen offset:0 sc1
    buffer_load_dwordx4 v[64:67], v7, s[36:39], s88 offen offset:1024 sc1
    buffer_load_dwordx4 v[68:71], v7, s[36:39], s88 offen offset:2048 sc1
    buffer_load_dwordx4 v[72:75], v7, s[36:39], s88 offen offset:3072 sc1
    s_waitcnt vmcnt(0) lgkmcnt(0)
    v_bitop3_b32 v20, v44, v64, v68 bitop3:254
    v_bitop3_b32 v20, v20, v72, -2 bitop3:254
    v_cmp_eq_u32_e64 vcc, -1, v20
    s_cbranch_vccz cb_141
    s_sub_u32 s47, s47, 1
    s_cbranch_scc0 cs_140
    s_mov_b32 s47, 0
    s_branch cb_141
cs_142:
    s_add_u32 s88, s73, 139264
    buffer_load_dwordx4 v[76:79], v7, s[36:39], s88 offen offset:0 sc1
    buffer_load_dwordx4 v[80:83], v7, s[36:39], s88 offen offset:1024 sc1
    buffer_load_dwordx4 v[84:87], v7, s[36:39], s88 offen offset:2048 sc1
    buffer_load_dwordx4 v[88:91], v7, s[36:39], s88 offen offset:3072 sc1
    s_waitcnt vmcnt(0) lgkmcnt(0)
    v_bitop3_b32 v20, v76, v80, v84 bitop3:254
    v_bitop3_b32 v20, v20, v88, -2 bitop3:254
    v_cmp_eq_u32_e64 vcc, -1, v20
    s_cbranch_vccz cb_143
    s_sub_u32 s47, s47, 1
    s_cbranch_scc0 cs_142
    s_mov_b32 s47, 0
    s_branch cb_143
cs_144:
    s_add_u32 s88, s73, 143360
    buffer_load_dwordx4 v[92:95], v7, s[36:39], s88 offen offset:0 sc1
    buffer_load_dwordx4 v[96:99], v7, s[36:39], s88 offen offset:1024 sc1
    buffer_load_dwordx4 v[108:111], v7, s[36:39], s88 offen offset:2048 sc1
    buffer_load_dwordx4 v[112:115], v7, s[36:39], s88 offen offset:3072 sc1
    s_waitcnt vmcnt(0) lgkmcnt(0)
    v_bitop3_b32 v20, v92, v96, v108 bitop3:254
    v_bitop3_b32 v20, v20, v112, -2 bitop3:254
    v_cmp_eq_u32_e64 vcc, -1, v20
    s_cbranch_vccz cb_145
    s_sub_u32 s47, s47, 1
    s_cbranch_scc0 cs_144
    s_mov_b32 s47, 0
    s_branch cb_145
cs_146:
    s_add_u32 s88, s73, 196608
    buffer_load_dwordx4 v[28:31], v7, s[36:39], s88 offen offset:0 sc1
    buffer_load_dwordx4 v[32:35], v7, s[36:39], s88 offen offset:1024 sc1
    buffer_load_dwordx4 v[36:39], v7, s[36:39], s88 offen offset:2048 sc1
    buffer_load_dwordx4 v[40:43], v7, s[36:39], s88 offen offset:3072 sc1
    s_waitcnt vmcnt(0) lgkmcnt(0)
    v_bitop3_b32 v20, v28, v32, v36 bitop3:254
    v_bitop3_b32 v20, v20, v40, -2 bitop3:254
    v_cmp_eq_u32_e64 vcc, -1, v20
    s_cbranch_vccz cb_147
    s_sub_u32 s47, s47, 1
    s_cbranch_scc0 cs_146
    s_mov_b32 s47, 0
    s_branch cb_147
cs_148:
    s_add_u32 s88, s73, 200704
    buffer_load_dwordx4 v[44:47], v7, s[36:39], s88 offen offset:0 sc1
    buffer_load_dwordx4 v[64:67], v7, s[36:39], s88 offen offset:1024 sc1
    buffer_load_dwordx4 v[68:71], v7, s[36:39], s88 offen offset:2048 sc1
    buffer_load_dwordx4 v[72:75], v7, s[36:39], s88 offen offset:3072 sc1
    s_waitcnt vmcnt(0) lgkmcnt(0)
    v_bitop3_b32 v20, v44, v64, v68 bitop3:254
    v_bitop3_b32 v20, v20, v72, -2 bitop3:254
    v_cmp_eq_u32_e64 vcc, -1, v20
    s_cbranch_vccz cb_149
    s_sub_u32 s47, s47, 1
    s_cbranch_scc0 cs_148
    s_mov_b32 s47, 0
    s_branch cb_149
cs_150:
    s_add_u32 s88, s73, 204800
    buffer_load_dwordx4 v[76:79], v7, s[36:39], s88 offen offset:0 sc1
    buffer_load_dwordx4 v[80:83], v7, s[36:39], s88 offen offset:1024 sc1
    buffer_load_dwordx4 v[84:87], v7, s[36:39], s88 offen offset:2048 sc1
    buffer_load_dwordx4 v[88:91], v7, s[36:39], s88 offen offset:3072 sc1
    s_waitcnt vmcnt(0) lgkmcnt(0)
    v_bitop3_b32 v20, v76, v80, v84 bitop3:254
    v_bitop3_b32 v20, v20, v88, -2 bitop3:254
    v_cmp_eq_u32_e64 vcc, -1, v20
    s_cbranch_vccz cb_151
    s_sub_u32 s47, s47, 1
    s_cbranch_scc0 cs_150
    s_mov_b32 s47, 0
    s_branch cb_151
cs_152:
    s_add_u32 s88, s73, 208896
    buffer_load_dwordx4 v[92:95], v7, s[36:39], s88 offen offset:0 sc1
    buffer_load_dwordx4 v[96:99], v7, s[36:39], s88 offen offset:1024 sc1
    buffer_load_dwordx4 v[108:111], v7, s[36:39], s88 offen offset:2048 sc1
    buffer_load_dwordx4 v[112:115], v7, s[36:39], s88 offen offset:3072 sc1
    s_waitcnt vmcnt(0) lgkmcnt(0)
    v_bitop3_b32 v20, v92, v96, v108 bitop3:254
    v_bitop3_b32 v20, v20, v112, -2 bitop3:254
    v_cmp_eq_u32_e64 vcc, -1, v20
    s_cbranch_vccz cb_153
    s_sub_u32 s47, s47, 1
    s_cbranch_scc0 cs_152
    s_mov_b32 s47, 0
    s_branch cb_153
cs_154:
    s_add_u32 s88, s73, 262144
    buffer_load_dwordx4 v[28:31], v7, s[36:39], s88 offen offset:0 sc1
    buffer_load_dwordx4 v[32:35], v7, s[36:39], s88 offen offset:1024 sc1
    buffer_load_dwordx4 v[36:39], v7, s[36:39], s88 offen offset:2048 sc1
    buffer_load_dwordx4 v[40:43], v7, s[36:39], s88 offen offset:3072 sc1
    s_waitcnt vmcnt(0) lgkmcnt(0)
    v_bitop3_b32 v20, v28, v32, v36 bitop3:254
    v_bitop3_b32 v20, v20, v40, -2 bitop3:254
    v_cmp_eq_u32_e64 vcc, -1, v20
    s_cbranch_vccz cb_155
    s_sub_u32 s47, s47, 1
    s_cbranch_scc0 cs_154
    s_mov_b32 s47, 0
    s_branch cb_155
cs_156:
    s_add_u32 s88, s73, 266240
    buffer_load_dwordx4 v[44:47], v7, s[36:39], s88 offen offset:0 sc1
    buffer_load_dwordx4 v[64:67], v7, s[36:39], s88 offen offset:1024 sc1
    buffer_load_dwordx4 v[68:71], v7, s[36:39], s88 offen offset:2048 sc1
    buffer_load_dwordx4 v[72:75], v7, s[36:39], s88 offen offset:3072 sc1
    s_waitcnt vmcnt(0) lgkmcnt(0)
    v_bitop3_b32 v20, v44, v64, v68 bitop3:254
    v_bitop3_b32 v20, v20, v72, -2 bitop3:254
    v_cmp_eq_u32_e64 vcc, -1, v20
    s_cbranch_vccz cb_157
    s_sub_u32 s47, s47, 1
    s_cbranch_scc0 cs_156
    s_mov_b32 s47, 0
    s_branch cb_157
cs_158:
    s_add_u32 s88, s73, 270336
    buffer_load_dwordx4 v[76:79], v7, s[36:39], s88 offen offset:0 sc1
    buffer_load_dwordx4 v[80:83], v7, s[36:39], s88 offen offset:1024 sc1
    buffer_load_dwordx4 v[84:87], v7, s[36:39], s88 offen offset:2048 sc1
    buffer_load_dwordx4 v[88:91], v7, s[36:39], s88 offen offset:3072 sc1
    s_waitcnt vmcnt(0) lgkmcnt(0)
    v_bitop3_b32 v20, v76, v80, v84 bitop3:254
    v_bitop3_b32 v20, v20, v88, -2 bitop3:254
    v_cmp_eq_u32_e64 vcc, -1, v20
    s_cbranch_vccz cb_159
    s_sub_u32 s47, s47, 1
    s_cbranch_scc0 cs_158
    s_mov_b32 s47, 0
    s_branch cb_159
cs_160:
    s_add_u32 s88, s73, 274432
    buffer_load_dwordx4 v[92:95], v7, s[36:39], s88 offen offset:0 sc1
    buffer_load_dwordx4 v[96:99], v7, s[36:39], s88 offen offset:1024 sc1
    buffer_load_dwordx4 v[108:111], v7, s[36:39], s88 offen offset:2048 sc1
    buffer_load_dwordx4 v[112:115], v7, s[36:39], s88 offen offset:3072 sc1
    s_waitcnt vmcnt(0) lgkmcnt(0)
    v_bitop3_b32 v20, v92, v96, v108 bitop3:254
    v_bitop3_b32 v20, v20, v112, -2 bitop3:254
    v_cmp_eq_u32_e64 vcc, -1, v20
    s_cbranch_vccz cb_161
    s_sub_u32 s47, s47, 1
    s_cbranch_scc0 cs_160
    s_mov_b32 s47, 0
    s_branch cb_161
cs_162:
    s_add_u32 s88, s73, 327680
    buffer_load_dwordx4 v[28:31], v7, s[36:39], s88 offen offset:0 sc1
    buffer_load_dwordx4 v[32:35], v7, s[36:39], s88 offen offset:1024 sc1
    buffer_load_dwordx4 v[36:39], v7, s[36:39], s88 offen offset:2048 sc1
    buffer_load_dwordx4 v[40:43], v7, s[36:39], s88 offen offset:3072 sc1
    s_waitcnt vmcnt(0) lgkmcnt(0)
    v_bitop3_b32 v20, v28, v32, v36 bitop3:254
    v_bitop3_b32 v20, v20, v40, -2 bitop3:254
    v_cmp_eq_u32_e64 vcc, -1, v20
    s_cbranch_vccz cb_163
    s_sub_u32 s47, s47, 1
    s_cbranch_scc0 cs_162
    s_mov_b32 s47, 0
    s_branch cb_163
cs_164:
    s_add_u32 s88, s73, 331776
    buffer_load_dwordx4 v[44:47], v7, s[36:39], s88 offen offset:0 sc1
    buffer_load_dwordx4 v[64:67], v7, s[36:39], s88 offen offset:1024 sc1
    buffer_load_dwordx4 v[68:71], v7, s[36:39], s88 offen offset:2048 sc1
    buffer_load_dwordx4 v[72:75], v7, s[36:39], s88 offen offset:3072 sc1
    s_waitcnt vmcnt(0) lgkmcnt(0)
    v_bitop3_b32 v20, v44, v64, v68 bitop3:254
    v_bitop3_b32 v20, v20, v72, -2 bitop3:254
    v_cmp_eq_u32_e64 vcc, -1, v20
    s_cbranch_vccz cb_165
    s_sub_u32 s47, s47, 1
    s_cbranch_scc0 cs_164
    s_mov_b32 s47, 0
    s_branch cb_165
cs_166:
    s_add_u32 s88, s73, 335872
    buffer_load_dwordx4 v[76:79], v7, s[36:39], s88 offen offset:0 sc1
    buffer_load_dwordx4 v[80:83], v7, s[36:39], s88 offen offset:1024 sc1
    buffer_load_dwordx4 v[84:87], v7, s[36:39], s88 offen offset:2048 sc1
    buffer_load_dwordx4 v[88:91], v7, s[36:39], s88 offen offset:3072 sc1
    s_waitcnt vmcnt(0) lgkmcnt(0)
    v_bitop3_b32 v20, v76, v80, v84 bitop3:254
    v_bitop3_b32 v20, v20, v88, -2 bitop3:254
    v_cmp_eq_u32_e64 vcc, -1, v20
    s_cbranch_vccz cb_167
    s_sub_u32 s47, s47, 1
    s_cbranch_scc0 cs_166
    s_mov_b32 s47, 0
    s_branch cb_167
cs_168:
    s_add_u32 s88, s73, 339968
    buffer_load_dwordx4 v[92:95], v7, s[36:39], s88 offen offset:0 sc1
    buffer_load_dwordx4 v[96:99], v7, s[36:39], s88 offen offset:1024 sc1
    buffer_load_dwordx4 v[108:111], v7, s[36:39], s88 offen offset:2048 sc1
    buffer_load_dwordx4 v[112:115], v7, s[36:39], s88 offen offset:3072 sc1
    s_waitcnt vmcnt(0) lgkmcnt(0)
    v_bitop3_b32 v20, v92, v96, v108 bitop3:254
    v_bitop3_b32 v20, v20, v112, -2 bitop3:254
    v_cmp_eq_u32 vcc, -1, v20
    s_cbranch_vccz cb_169
    s_sub_u32 s47, s47, 1
    s_cbranch_scc0 cs_168
    s_mov_b32 s47, 0
    s_branch cb_169
cs_170:
    s_add_u32 s88, s74, 0
    buffer_load_dwordx4 v[28:31], v7, s[36:39], s88 offen offset:0 sc1
    buffer_load_dwordx4 v[32:35], v7, s[36:39], s88 offen offset:1024 sc1
    buffer_load_dwordx4 v[36:39], v7, s[36:39], s88 offen offset:2048 sc1
    buffer_load_dwordx4 v[40:43], v7, s[36:39], s88 offen offset:3072 sc1
    s_waitcnt vmcnt(0) lgkmcnt(0)
    v_bitop3_b32 v20, v28, v32, v36 bitop3:254
    v_bitop3_b32 v20, v20, v40, -2 bitop3:254
    v_cmp_eq_u32_e64 vcc, -1, v20
    s_cbranch_vccz cb_171
    s_sub_u32 s47, s47, 1
    s_cbranch_scc0 cs_170
    s_mov_b32 s47, 0
    s_branch cb_171
cs_172:
    s_add_u32 s88, s74, 4096
    buffer_load_dwordx4 v[44:47], v7, s[36:39], s88 offen offset:0 sc1
    buffer_load_dwordx4 v[64:67], v7, s[36:39], s88 offen offset:1024 sc1
    buffer_load_dwordx4 v[68:71], v7, s[36:39], s88 offen offset:2048 sc1
    buffer_load_dwordx4 v[72:75], v7, s[36:39], s88 offen offset:3072 sc1
    s_waitcnt vmcnt(0) lgkmcnt(0)
    v_bitop3_b32 v20, v44, v64, v68 bitop3:254
    v_bitop3_b32 v20, v20, v72, -2 bitop3:254
    v_cmp_eq_u32_e64 vcc, -1, v20
    s_cbranch_vccz cb_173
    s_sub_u32 s47, s47, 1
    s_cbranch_scc0 cs_172
    s_mov_b32 s47, 0
    s_branch cb_173
cs_174:
    s_add_u32 s88, s74, 8192
    buffer_load_dwordx4 v[76:79], v7, s[36:39], s88 offen offset:0 sc1
    buffer_load_dwordx4 v[80:83], v7, s[36:39], s88 offen offset:1024 sc1
    buffer_load_dwordx4 v[84:87], v7, s[36:39], s88 offen offset:2048 sc1
    buffer_load_dwordx4 v[88:91], v7, s[36:39], s88 offen offset:3072 sc1
    s_waitcnt vmcnt(0) lgkmcnt(0)
    v_bitop3_b32 v20, v76, v80, v84 bitop3:254
    v_bitop3_b32 v20, v20, v88, -2 bitop3:254
    v_cmp_eq_u32_e64 vcc, -1, v20
    s_cbranch_vccz cb_175
    s_sub_u32 s47, s47, 1
    s_cbranch_scc0 cs_174
    s_mov_b32 s47, 0
    s_branch cb_175
cs_176:
    s_add_u32 s88, s74, 12288
    buffer_load_dwordx4 v[92:95], v7, s[36:39], s88 offen offset:0 sc1
    buffer_load_dwordx4 v[96:99], v7, s[36:39], s88 offen offset:1024 sc1
    buffer_load_dwordx4 v[108:111], v7, s[36:39], s88 offen offset:2048 sc1
    buffer_load_dwordx4 v[112:115], v7, s[36:39], s88 offen offset:3072 sc1
    s_waitcnt vmcnt(0) lgkmcnt(0)
    v_bitop3_b32 v20, v92, v96, v108 bitop3:254
    v_bitop3_b32 v20, v20, v112, -2 bitop3:254
    v_cmp_eq_u32 vcc, -1, v20
    s_cbranch_vccz cb_177
    s_sub_u32 s47, s47, 1
    s_cbranch_scc0 cs_176
    s_mov_b32 s47, 0
    s_branch cb_177
L_end:
    s_endpgm
.section .rodata,"a"
.p2align 6
.amdhsa_kernel interleave_layers__spectral_fnet__mixer_gmlp__prompt_kernel
  .amdhsa_next_free_vgpr 512
  .amdhsa_next_free_sgpr 102
  .amdhsa_accum_offset 256
  .amdhsa_group_segment_fixed_size 0
  .amdhsa_kernarg_size 104
  .amdhsa_user_sgpr_count 2
  .amdhsa_user_sgpr_kernarg_segment_ptr 1
  .amdhsa_system_sgpr_workgroup_id_x 1
.end_amdhsa_kernel
```
